```python
import torch

def _softmax(x, axis=-1):
    return torch.softmax(x, dim=axis)
def _gelu(x):
    return torch.nn.functional.gelu(x, approximate="tanh")
def _silu(x):
    return torch.nn.functional.silu(x)
def _sigmoid(x):
    return torch.sigmoid(x)
def _layernorm(x, axis=-1, eps=1e-5):
    m = x.mean(dim=axis, keepdim=True)
    v = x.var(dim=axis, keepdim=True, unbiased=False)
    return (x - m) / torch.sqrt(v + eps)
def _scatter_add(tgt, idx, src, axis=0):
    return tgt.clone().index_add_(axis, idx, src)
def _segment_sum(src, seg, n):
    out = torch.zeros((n,) + src.shape[1:], dtype=src.dtype)
    return out.index_add_(0, seg, src)
def _pad(x, pw):
    flat = tuple(v for pair in reversed(pw) for v in pair)
    return torch.nn.functional.pad(x, flat)

kernel_name = 'standalone__mha_softmax__near_ridge'

def setup_inputs():

    _w = (lambda a: (lambda t: t.to(torch.bfloat16) if t.is_floating_point() else t)(torch.as_tensor(a)))
    B, H, Sq, Sk, D = 8, 32, 512, 512, 192
    return {
        "q": _w((lambda *s: torch.randn(*s, dtype=torch.bfloat16) * 0.8)(B, H, Sq, D)),
        "k": _w((lambda *s: torch.randn(*s, dtype=torch.bfloat16) * 0.8)(B, H, Sk, D)),
        "v": _w((lambda *s: torch.randn(*s, dtype=torch.bfloat16) * 0.05)(B, H, Sk, D)),
    }

def reference(q, k, v):
    scale = q.shape[-1] ** -0.5
    scores = torch.einsum("bhqd,bhkd->bhqk", q, k) * scale
    p = _softmax(scores, axis=-1)
    return torch.einsum("bhqk,bhkd->bhqd", p, v)
```

```asm
; @launch grid=(256,1,1) block=(256,1,1) lds=160384
.amdgcn_target "amdgcn-amd-amdhsa--gfx950"
.text
.globl standalone__mha_softmax__near_ridge_kernel
.p2align 8
.type standalone__mha_softmax__near_ridge_kernel,@function
standalone__mha_softmax__near_ridge_kernel:
  s_cmpk_ge_u32 s2, 0x100
  s_cbranch_scc1 L_end
  s_load_dwordx8 s[80:87], s[0:1], 0x0
  s_getpc_b64 s[30:31]
L_pc:
  s_lshr_b32 s3, s2, 4
  v_lshlrev_b32_e32 v204, 4, v0
  v_readfirstlane_b32 s24, v0
  v_lshl_add_u32 v208, s3, 12, v204
  global_load_dword v255, v208, s[30:31] offset:256
  v_and_b32_e32 v205, 64, v0
  v_mov_b32_e32 v206, 48
  s_and_b32 s4, s2, 7
  s_getreg_b32 s99, hwreg(HW_REG_XCC_ID, 0, 4)
  s_lshl3_add_u32 s3, s3, s4
  s_lshl_b32 s5, s24, 5
  v_xad_u32 v7, v204, v205, s5
  v_lshlrev_b32_e32 v207, 1, v206
  v_xor_b32_e32 v8, 48, v7
  v_xor_b32_e32 v9, v207, v7
  s_mul_i32 s71, s3, 7
  s_lshr_b32 s4, s3, 4
  s_add_u32 s71, s71, s4
  v_xor_b32_dpp v7, v206, v7 quad_perm:[0,1,2,3] row_mask:0x8 bank_mask:0xf
  v_xor_b32_dpp v8, v207, v8 quad_perm:[0,1,2,3] row_mask:0xc bank_mask:0xf
  v_xor_b32_dpp v9, v206, v9 quad_perm:[0,1,2,3] row_mask:0x1 bank_mask:0xf
  s_and_b32 s40, s71, 15
  s_mulk_i32 s40, 0x3000
  s_mul_i32 s3, s3, 0x60000
  s_mul_i32 s27, s24, 48
  s_mov_b32 s10, 393216
  s_mov_b32 s11, 0x20000
  s_add_u32 m0, s27, 86528
  s_and_b32 s4, s2, 8
  s_mulk_i32 s4, 0x3000
  s_add_u32 s4, s4, s3
  s_mov_b32 s18, 294912
  s_mov_b32 s19, 0x20000
  s_mul_i32 s33, s27, 7
  s_waitcnt lgkmcnt(0)
  s_add_u32 s8, s82, s3
  s_addc_u32 s9, s83, 0
  buffer_load_dwordx4 v7, s[8:11], s40 offen offset:0 nt lds
  buffer_load_dwordx4 v8, s[8:11], s40 offen offset:1024 nt lds
  buffer_load_dwordx4 v9, s[8:11], s40 offen offset:2048 nt lds
  s_mov_b32 m0, s27
  s_add_u32 s16, s80, s4
  s_addc_u32 s17, s81, 0
  buffer_load_dwordx4 v7, s[16:19], s33 offen offset:0 nt lds
  buffer_load_dwordx4 v8, s[16:19], s33 offen offset:1024 nt lds
  buffer_load_dwordx4 v9, s[16:19], s33 offen offset:2048 nt lds
  s_addk_i32 m0, 0x3000
  s_addk_i32 s33, 0xc00
  buffer_load_dwordx4 v7, s[16:19], s33 offen offset:0 nt lds
  buffer_load_dwordx4 v8, s[16:19], s33 offen offset:1024 nt lds
  buffer_load_dwordx4 v9, s[16:19], s33 offen offset:2048 nt lds
  s_bitcmp1_b32 s99, 0
  s_cbranch_scc1 L_ev2
  s_waitcnt vmcnt(0)
L_ev2:
  s_addk_i32 m0, 0x3100
  s_addk_i32 s33, 0xc00
  buffer_load_dwordx4 v7, s[16:19], s33 offen offset:0 nt lds
  buffer_load_dwordx4 v8, s[16:19], s33 offen offset:1024 nt lds
  buffer_load_dwordx4 v9, s[16:19], s33 offen offset:2048 nt lds
  s_add_u32 s12, s84, s3
  s_addc_u32 s13, s85, 0
  s_add_u32 s20, s86, s4
  s_addc_u32 s21, s87, 0
  s_mov_b32 s14, 393216
  s_mov_b32 s15, 0x20000
  s_mov_b32 s22, 294912
  s_mov_b32 s23, 0x20000
  s_add_u32 s41, s71, 1
  s_and_b32 s41, s41, 15
  s_mulk_i32 s41, 0x3000
  s_mul_i32 s32, s27, 7
  s_lshr_b32 s24, s24, 6
  s_mov_b32 s5, 0x21746530
  v_lshrrev_b32_e32 v202, 6, v0
  v_and_b32_e32 v203, 63, v0
  v_mul_u32_u24_e32 v209, 0xc00, v202
  v_lshlrev_b32_e32 v210, 4, v202
  v_and_b32_e32 v211, 15, v203
  v_lshrrev_b32_e32 v212, 4, v203
  v_lshlrev_b32_e32 v206, 1, v211
  v_and_b32_e32 v206, 28, v206
  v_bfe_u32 v206, s5, v206, 3
  v_lshlrev_b32_e32 v206, 4, v206
  v_lshlrev_b32_e32 v207, 4, v212
  v_mul_u32_u24_e32 v204, 0x180, v211
  v_add_u32_e32 v204, 0xc200, v204
  v_xad_u32 v1, v206, v207, v204
  v_xor_b32_e32 v2, 64, v1
  v_and_b32_e32 v213, 7, v203
  v_bfe_u32 v214, v203, 3, 1
  v_mul_u32_u24_e32 v214, 0x3000, v214
  v_add_u32_e32 v214, v214, v209
  v_lshlrev_b32_e32 v206, 1, v213
  v_and_b32_e32 v206, 12, v206
  v_add_u32_e32 v206, v206, v210
  v_bfe_u32 v206, s5, v206, 3
  v_lshlrev_b32_e32 v206, 4, v206
  v_mul_u32_u24_e32 v204, 0x180, v213
  v_add_u32_e32 v204, v204, v214
  v_xad_u32 v19, v206, v207, v204
  v_xor_b32_e32 v16, 64, v19
  v_lshrrev_b32_e32 v206, 3, v203
  v_lshlrev_b32_e32 v206, 2, v206
  v_bfe_u32 v206, s5, v206, 3
  v_lshlrev_b32_e32 v206, 4, v206
  v_lshrrev_b32_e32 v204, 2, v203
  v_mul_u32_u24_e32 v204, 0x180, v204
  v_add_u32_e32 v204, 0x18200, v204
  v_and_b32_e32 v207, 1, v203
  v_lshl_add_u32 v204, v207, 3, v204
  v_and_b32_e32 v207, 3, v203
  v_lshlrev_b32_e32 v207, 5, v207
  v_xad_u32 v3, v206, v207, v204
  v_xor_b32_e32 v4, 8, v3
  v_xor_b32_e32 v5, 16, v3
  v_xor_b32_e32 v6, 24, v3
  v_bfe_u32 v206, v203, 2, 3
  v_mul_u32_u24_e32 v204, 0x180, v206
  v_lshl_add_u32 v204, v209, 3, v204
  v_lshrrev_b32_e32 v207, 1, v207
  v_add_u32_e32 v204, v204, v207
  v_and_b32_e32 v207, 32, v203
  v_lshl_add_u32 v18, v207, 1, v204
  v_lshl_add_u32 v204, v206, 2, v209
  v_lshl_add_u32 v204, v207, 2, v204
  v_and_b32_e32 v207, 1, v203
  v_mul_u32_u24_e32 v207, 0x3020, v207
  v_add_u32_e32 v204, v204, v207
  v_and_b32_e32 v207, 2, v203
  v_mul_u32_u24_e32 v207, 0x120, v207
  v_add_u32_e32 v11, v204, v207
  v_xor_b32_e32 v13, 0x200, v11
  v_add_u32_e32 v15, 32, v11
  v_add_u32_e32 v17, 32, v13
  v_mov_b32_e32 v204, 0x3f803f80
  v_lshrrev_b32_e32 v206, 4, v203
  v_xor_b32_e32 v206, v206, v203
  v_bfe_i32 v206, v206, 1, 1
  v_bfi_b32 v204, v206, 0, v204
  v_and_b32_e64 v206, 1, v203
  v_mul_u32_u24_e32 v206, 0xaaaa, v206
  v_add_u32_e32 v0, 0x4444, v206
  v_accvgpr_write_b32 a208, 0
  v_accvgpr_write_b32 a209, 0
  v_accvgpr_write_b32 a210, 0
  v_accvgpr_write_b32 a211, 0
  v_accvgpr_write_b32 a212, 0
  v_accvgpr_write_b32 a213, 0
  v_accvgpr_write_b32 a214, 0
  v_accvgpr_write_b32 a215, 0
  v_accvgpr_write_b32 a216, 0
  v_accvgpr_write_b32 a217, 0
  v_accvgpr_write_b32 a218, 0
  v_accvgpr_write_b32 a219, 0
  v_accvgpr_write_b32 a220, 0
  v_accvgpr_write_b32 a221, 0
  v_accvgpr_write_b32 a222, 0
  v_accvgpr_write_b32 a223, 0
  v_accvgpr_write_b32 a224, v204
  v_accvgpr_write_b32 a225, v204
  v_accvgpr_write_b32 a226, v204
  v_accvgpr_write_b32 a227, v204
  s_add_u32 s42, s71, 2
  s_and_b32 s42, s42, 15
  s_mulk_i32 s42, 0x3000
  s_add_u32 s43, s71, 3
  s_and_b32 s43, s43, 15
  s_mulk_i32 s43, 0x3000
  s_add_u32 s44, s71, 4
  s_and_b32 s44, s44, 15
  s_mulk_i32 s44, 0x3000
  s_add_u32 s45, s71, 5
  s_and_b32 s45, s45, 15
  s_mulk_i32 s45, 0x3000
  s_add_u32 s46, s71, 6
  s_and_b32 s46, s46, 15
  s_mulk_i32 s46, 0x3000
  s_add_u32 s47, s71, 7
  s_and_b32 s47, s47, 15
  s_mulk_i32 s47, 0x3000
  s_add_u32 s48, s71, 8
  s_and_b32 s48, s48, 15
  s_mulk_i32 s48, 0x3000
  s_add_u32 s49, s71, 9
  s_and_b32 s49, s49, 15
  s_mulk_i32 s49, 0x3000
  s_add_u32 s50, s71, 10
  s_and_b32 s50, s50, 15
  s_mulk_i32 s50, 0x3000
  s_add_u32 s51, s71, 11
  s_and_b32 s51, s51, 15
  s_mulk_i32 s51, 0x3000
  s_add_u32 s52, s71, 12
  s_and_b32 s52, s52, 15
  s_mulk_i32 s52, 0x3000
  s_add_u32 s53, s71, 13
  s_and_b32 s53, s53, 15
  s_mulk_i32 s53, 0x3000
  s_add_u32 s54, s71, 14
  s_and_b32 s54, s54, 15
  s_mulk_i32 s54, 0x3000
  s_add_u32 s55, s71, 15
  s_and_b32 s55, s55, 15
  s_mulk_i32 s55, 0x3000
  s_add_u32 s56, s40, 196608
  s_add_u32 s57, s41, 196608
  s_add_u32 s58, s42, 196608
  s_add_u32 s59, s43, 196608
  s_add_u32 s60, s44, 196608
  s_add_u32 s61, s45, 196608
  s_add_u32 s62, s46, 196608
  s_add_u32 s63, s47, 196608
  s_add_u32 s64, s48, 196608
  s_add_u32 s65, s49, 196608
  s_add_u32 s66, s50, 196608
  s_add_u32 s67, s51, 196608
  s_add_u32 s68, s52, 196608
  s_add_u32 s69, s53, 196608
  s_add_u32 s70, s54, 196608
  s_add_u32 s71, s55, 196608
  s_mov_b32 s72, 0
  s_mov_b32 s73, 6144
  s_mov_b32 s74, 12288
  s_mov_b32 s75, 18432
  s_mov_b32 s76, 196608
  s_mov_b32 s77, 202752
  s_mov_b32 s78, 208896
  s_mov_b32 s79, 215040
  s_mov_b32 s25, 0x3dd53b95
  s_mov_b64 s[34:35], 0
  s_mov_b64 s[36:37], 0
  s_branch L_main
.p2align 12
L_main:
  s_add_u32 m0, s27, 37120
  s_add_u32 s33, s32, 9216
  buffer_load_dwordx4 v7, s[16:19], s33 offen offset:0 nt lds
  buffer_load_dwordx4 v8, s[16:19], s33 offen offset:1024 nt lds
  buffer_load_dwordx4 v9, s[16:19], s33 offen offset:2048 nt lds
  s_waitcnt vmcnt(12)
  s_barrier
  ds_read_b128 v[76:79], v1 offset:36864
  ds_read_b128 v[92:95], v2 offset:36864
  ds_read_b128 v[108:111], v1 offset:36992
  ds_read_b128 v[124:127], v2 offset:36992
  ds_read_b128 v[140:143], v1 offset:37120
  ds_read_b128 v[156:159], v2 offset:37120
  ds_read_b128 v[172:175], v1 offset:43008
  ds_read_b128 v[188:191], v2 offset:43008
  ds_read_b128 v[204:207], v1 offset:43136
  ds_read_b128 v[220:223], v2 offset:43136
  ds_read_b128 v[236:239], v1 offset:43264
  ds_read_b128 v[252:255], v2 offset:43264
  s_add_u32 m0, s27, 98816
  s_nop 0
  buffer_load_dwordx4 v7, s[8:11], s41 offen offset:0 nt lds
  buffer_load_dwordx4 v8, s[8:11], s41 offen offset:1024 nt lds
  buffer_load_dwordx4 v9, s[8:11], s41 offen offset:2048 nt lds
  s_add_u32 m0, s27, 111104
  s_nop 0
  buffer_load_dwordx4 v7, s[12:15], s40 offen offset:0 nt lds
  buffer_load_dwordx4 v8, s[12:15], s40 offen offset:1024 nt lds
  buffer_load_dwordx4 v9, s[12:15], s40 offen offset:2048 nt lds
  s_waitcnt vmcnt(12)
  ds_read_b128 a[0:3], v19 offset:0
  ds_read_b128 a[4:7], v16 offset:0
  ds_read_b128 a[8:11], v19 offset:128
  ds_read_b128 a[12:15], v16 offset:128
  ds_read_b128 a[16:19], v19 offset:256
  ds_read_b128 a[20:23], v16 offset:256
  s_waitcnt lgkmcnt(5)
  v_mfma_f32_16x16x32_bf16 v[20:23], v[76:79], a[0:3], 0
  s_waitcnt lgkmcnt(4)
  v_mfma_f32_16x16x32_bf16 v[20:23], v[92:95], a[4:7], v[20:23]
  s_waitcnt lgkmcnt(3)
  v_mfma_f32_16x16x32_bf16 v[20:23], v[108:111], a[8:11], v[20:23]
  s_waitcnt lgkmcnt(2)
  v_mfma_f32_16x16x32_bf16 v[20:23], v[124:127], a[12:15], v[20:23]
  s_waitcnt lgkmcnt(1)
  v_mfma_f32_16x16x32_bf16 v[20:23], v[140:143], a[16:19], v[20:23]
  s_waitcnt lgkmcnt(0)
  v_mfma_f32_16x16x32_bf16 v[20:23], v[156:159], a[20:23], v[20:23]
  v_mfma_f32_16x16x32_bf16 v[24:27], v[172:175], a[0:3], 0
  v_mfma_f32_16x16x32_bf16 v[24:27], v[188:191], a[4:7], v[24:27]
  v_mfma_f32_16x16x32_bf16 v[24:27], v[204:207], a[8:11], v[24:27]
  v_mfma_f32_16x16x32_bf16 v[24:27], v[220:223], a[12:15], v[24:27]
  s_nop 3
  v_mul_f32_e32 v20, s25, v20
  v_mul_f32_e32 v21, s25, v21
  v_mul_f32_e32 v22, s25, v22
  v_mul_f32_e32 v23, s25, v23
  v_mfma_f32_16x16x32_bf16 v[24:27], v[236:239], a[16:19], v[24:27]
  v_exp_f32_e32 v20, v20
  v_exp_f32_e32 v21, v21
  v_exp_f32_e32 v22, v22
  v_exp_f32_e32 v23, v23
  v_mfma_f32_16x16x32_bf16 v[24:27], v[252:255], a[20:23], v[24:27]
  v_cvt_pk_bf16_f32 v32, v20, v21
  v_cvt_pk_bf16_f32 v33, v22, v23
  s_nop 5
  v_mul_f32_e32 v24, s25, v24
  v_mul_f32_e32 v25, s25, v25
  v_mul_f32_e32 v26, s25, v26
  v_mul_f32_e32 v27, s25, v27
  v_exp_f32_e32 v24, v24
  v_exp_f32_e32 v25, v25
  v_exp_f32_e32 v26, v26
  v_exp_f32_e32 v27, v27
  v_cvt_pk_bf16_f32 v34, v24, v25
  v_cvt_pk_bf16_f32 v35, v26, v27
  s_mov_b64 exec, 0
  s_cmp_eq_u32 s24, 0
  s_cbranch_scc1 L_tr0
  s_cmp_eq_u32 s24, 1
  s_cbranch_scc1 L_tr1
  s_cmp_eq_u32 s24, 2
  s_cbranch_scc1 L_tr2
  s_branch L_tr3
L_tr14:
L_tr15:
L_tr16:
L_tr17:
L_back:
  s_mov_b64 exec, -1
  s_bitcmp1_b32 s99, 0
  s_cbranch_scc1 L_ev1
  s_waitcnt vmcnt(0)
L_ev1:
  s_add_u32 m0, s27, 123392
  s_nop 0
  buffer_load_dwordx4 v7, s[12:15], s41 offen offset:0 nt lds
  buffer_load_dwordx4 v8, s[12:15], s41 offen offset:1024 nt lds
  buffer_load_dwordx4 v9, s[12:15], s41 offen offset:2048 nt lds
  s_add_u32 m0, s27, 0
  s_add_u32 s33, s32, 12288
  buffer_load_dwordx4 v7, s[16:19], s33 offen offset:0 nt lds
  buffer_load_dwordx4 v8, s[16:19], s33 offen offset:1024 nt lds
  buffer_load_dwordx4 v9, s[16:19], s33 offen offset:2048 nt lds
  s_waitcnt vmcnt(12)
  ds_read_b128 a[24:27], v19 offset:24832
  ds_read_b128 a[28:31], v16 offset:24832
  ds_read_b128 a[32:35], v19 offset:24960
  ds_read_b128 a[36:39], v16 offset:24960
  ds_read_b128 a[40:43], v19 offset:25088
  ds_read_b128 a[44:47], v16 offset:25088
  s_waitcnt lgkmcnt(5)
  v_mfma_f32_16x16x32_bf16 v[28:31], v[76:79], a[24:27], 0
  s_waitcnt lgkmcnt(4)
  v_mfma_f32_16x16x32_bf16 v[28:31], v[92:95], a[28:31], v[28:31]
  s_waitcnt lgkmcnt(3)
  v_mfma_f32_16x16x32_bf16 v[28:31], v[108:111], a[32:35], v[28:31]
  s_waitcnt lgkmcnt(2)
  v_mfma_f32_16x16x32_bf16 v[28:31], v[124:127], a[36:39], v[28:31]
  s_waitcnt lgkmcnt(1)
  v_mfma_f32_16x16x32_bf16 v[28:31], v[140:143], a[40:43], v[28:31]
  s_waitcnt lgkmcnt(0)
  v_mfma_f32_16x16x32_bf16 v[28:31], v[156:159], a[44:47], v[28:31]
  v_mfma_f32_16x16x32_bf16 v[20:23], v[172:175], a[24:27], 0
  v_mfma_f32_16x16x32_bf16 v[20:23], v[188:191], a[28:31], v[20:23]
  v_mfma_f32_16x16x32_bf16 v[20:23], v[204:207], a[32:35], v[20:23]
  v_mfma_f32_16x16x32_bf16 v[20:23], v[220:223], a[36:39], v[20:23]
  s_nop 3
  v_mul_f32_e32 v28, s25, v28
  v_mul_f32_e32 v29, s25, v29
  v_mul_f32_e32 v30, s25, v30
  v_mul_f32_e32 v31, s25, v31
  v_mfma_f32_16x16x32_bf16 v[20:23], v[236:239], a[40:43], v[20:23]
  v_exp_f32_e32 v28, v28
  v_exp_f32_e32 v29, v29
  v_exp_f32_e32 v30, v30
  v_exp_f32_e32 v31, v31
  v_mfma_f32_16x16x32_bf16 v[20:23], v[252:255], a[44:47], v[20:23]
  v_cvt_pk_bf16_f32 v36, v28, v29
  v_cvt_pk_bf16_f32 v37, v30, v31
  s_nop 5
  v_mul_f32_e32 v20, s25, v20
  v_mul_f32_e32 v21, s25, v21
  v_mul_f32_e32 v22, s25, v22
  v_mul_f32_e32 v23, s25, v23
  v_exp_f32_e32 v20, v20
  v_exp_f32_e32 v21, v21
  v_exp_f32_e32 v22, v22
  v_exp_f32_e32 v23, v23
  v_cvt_pk_bf16_f32 v38, v20, v21
  v_cvt_pk_bf16_f32 v39, v22, v23
  s_add_u32 m0, s27, 12288
  s_add_u32 s33, s32, 15360
  buffer_load_dwordx4 v7, s[16:19], s33 offen offset:0 nt lds
  buffer_load_dwordx4 v8, s[16:19], s33 offen offset:1024 nt lds
  buffer_load_dwordx4 v9, s[16:19], s33 offen offset:2048 nt lds
  s_waitcnt vmcnt(12)
  s_barrier
  ds_read_b128 a[96:99], v1 offset:49152
  ds_read_b128 a[100:103], v2 offset:49152
  ds_read_b128 a[104:107], v1 offset:49280
  ds_read_b128 a[108:111], v2 offset:49280
  ds_read_b128 a[112:115], v1 offset:49408
  ds_read_b128 a[116:119], v2 offset:49408
  ds_read_b128 a[120:123], v1 offset:55296
  ds_read_b128 a[124:127], v2 offset:55296
  ds_read_b128 a[128:131], v1 offset:55424
  ds_read_b128 a[132:135], v2 offset:55424
  ds_read_b128 a[136:139], v1 offset:55552
  ds_read_b128 a[140:143], v2 offset:55552
  s_waitcnt lgkmcnt(11)
  v_mfma_f32_16x16x32_bf16 v[24:27], a[96:99], a[0:3], 0
  s_waitcnt lgkmcnt(10)
  v_mfma_f32_16x16x32_bf16 v[24:27], a[100:103], a[4:7], v[24:27]
  s_waitcnt lgkmcnt(9)
  v_mfma_f32_16x16x32_bf16 v[24:27], a[104:107], a[8:11], v[24:27]
  s_waitcnt lgkmcnt(8)
  v_mfma_f32_16x16x32_bf16 v[24:27], a[108:111], a[12:15], v[24:27]
  s_waitcnt lgkmcnt(7)
  v_mfma_f32_16x16x32_bf16 v[24:27], a[112:115], a[16:19], v[24:27]
  s_waitcnt lgkmcnt(6)
  v_mfma_f32_16x16x32_bf16 v[24:27], a[116:119], a[20:23], v[24:27]
  s_waitcnt lgkmcnt(5)
  v_mfma_f32_16x16x32_bf16 v[28:31], a[120:123], a[0:3], 0
  s_waitcnt lgkmcnt(4)
  v_mfma_f32_16x16x32_bf16 v[28:31], a[124:127], a[4:7], v[28:31]
  s_waitcnt lgkmcnt(0)
  v_mfma_f32_16x16x32_bf16 v[28:31], a[128:131], a[8:11], v[28:31]
  v_mfma_f32_16x16x32_bf16 v[28:31], a[132:135], a[12:15], v[28:31]
  s_nop 0
  v_mul_f32_e32 v24, s25, v24
  v_mul_f32_e32 v25, s25, v25
  v_mfma_f32_16x16x32_bf16 v[28:31], a[136:139], a[16:19], v[28:31]
  v_exp_f32_e32 v24, v24
  v_mfma_f32_16x16x32_bf16 v[28:31], a[140:143], a[20:23], v[28:31]
  v_mul_f32_e32 v26, s25, v26
  v_mul_f32_e32 v27, s25, v27
  v_mfma_f32_16x16x32_bf16 v[20:23], a[96:99], a[24:27], 0
  v_exp_f32_e32 v25, v25
  v_mfma_f32_16x16x32_bf16 v[20:23], a[100:103], a[28:31], v[20:23]
  v_exp_f32_e32 v26, v26
  v_mfma_f32_16x16x32_bf16 v[20:23], a[104:107], a[32:35], v[20:23]
  v_exp_f32_e32 v27, v27
  v_mfma_f32_16x16x32_bf16 v[20:23], a[108:111], a[36:39], v[20:23]
  v_cvt_pk_bf16_f32 v40, v24, v25
  v_mul_f32_e32 v28, s25, v28
  v_mfma_f32_16x16x32_bf16 v[20:23], a[112:115], a[40:43], v[20:23]
  v_cvt_pk_bf16_f32 v41, v26, v27
  v_mul_f32_e32 v29, s25, v29
  v_mfma_f32_16x16x32_bf16 v[20:23], a[116:119], a[44:47], v[20:23]
  s_waitcnt vmcnt(9)
  s_barrier
  ds_read_b64_tr_b16 a[192:193], v3 offset:12288
  v_mul_f32_e32 v30, s25, v30
  v_mfma_f32_16x16x32_bf16 v[24:27], a[120:123], a[24:27], 0
  s_add_u32 m0, s27, 24832
  ds_read_b64_tr_b16 a[194:195], v3 offset:18432
  v_mul_f32_e32 v31, s25, v31
  v_mfma_f32_16x16x32_bf16 v[24:27], a[124:127], a[28:31], v[24:27]
  s_add_u32 s33, s32, 18432
  ds_read_b64_tr_b16 a[196:197], v4 offset:12288
  ds_read_b64_tr_b16 a[198:199], v4 offset:18432
  v_mfma_f32_16x16x32_bf16 v[24:27], a[128:131], a[32:35], v[24:27]
  ds_read_b64_tr_b16 a[200:201], v5 offset:12288
  ds_read_b64_tr_b16 a[202:203], v5 offset:18432
  v_mfma_f32_16x16x32_bf16 v[24:27], a[132:135], a[36:39], v[24:27]
  buffer_load_dwordx4 v7, s[16:19], s33 offen offset:0 nt lds
  v_mfma_f32_16x16x32_bf16 v[24:27], a[136:139], a[40:43], v[24:27]
  ds_read_b64_tr_b16 a[204:205], v6 offset:12288
  v_mul_f32_e32 v20, s25, v20
  v_mfma_f32_16x16x32_bf16 v[24:27], a[140:143], a[44:47], v[24:27]
  ds_read_b64_tr_b16 a[206:207], v6 offset:18432
  v_mul_f32_e32 v21, s25, v21
  v_smfmac_f32_16x16x64_bf16 a[208:211], a[224:227], v[32:39], v0
  s_waitcnt lgkmcnt(6)
  buffer_load_dwordx4 v8, s[16:19], s33 offen offset:1024 nt lds
  v_mfma_f32_16x16x32_bf16 v[64:67], a[192:195], v[32:35], 0
  ds_read_b64_tr_b16 a[232:233], v3 offset:12416
  v_mul_f32_e32 v22, s25, v22
  v_mfma_f32_16x16x32_bf16 v[68:71], a[192:195], v[36:39], 0
  s_waitcnt lgkmcnt(5)
  ds_read_b64_tr_b16 a[234:235], v3 offset:18560
  v_mul_f32_e32 v23, s25, v23
  v_mfma_f32_16x16x32_bf16 v[80:83], a[196:199], v[32:35], 0
  buffer_load_dwordx4 v9, s[16:19], s33 offen offset:2048 nt lds
  v_mfma_f32_16x16x32_bf16 v[84:87], a[196:199], v[36:39], 0
  s_waitcnt lgkmcnt(4)
  ds_read_b64_tr_b16 a[236:237], v4 offset:12416
  ds_read_b64_tr_b16 a[238:239], v4 offset:18560
  v_mfma_f32_16x16x32_bf16 v[96:99], a[200:203], v[32:35], 0
  v_exp_f32_e32 v28, v28
  v_mfma_f32_16x16x32_bf16 v[100:103], a[200:203], v[36:39], 0
  s_waitcnt lgkmcnt(4)
  ds_read_b64_tr_b16 a[240:241], v5 offset:12416
  ds_read_b64_tr_b16 a[242:243], v5 offset:18560
  v_mfma_f32_16x16x32_bf16 v[112:115], a[204:207], v[32:35], 0
  v_exp_f32_e32 v29, v29
  v_mfma_f32_16x16x32_bf16 v[116:119], a[204:207], v[36:39], 0
  s_waitcnt lgkmcnt(4)
  ds_read_b64_tr_b16 a[244:245], v6 offset:12416
  ds_read_b64_tr_b16 a[246:247], v6 offset:18560
  v_mfma_f32_16x16x32_bf16 v[128:131], a[232:235], v[32:35], 0
  v_exp_f32_e32 v30, v30
  v_mfma_f32_16x16x32_bf16 v[132:135], a[232:235], v[36:39], 0
  s_waitcnt lgkmcnt(4)
  ds_read_b64_tr_b16 a[248:249], v3 offset:12544
  ds_read_b64_tr_b16 a[250:251], v3 offset:18688
  v_mfma_f32_16x16x32_bf16 v[144:147], a[236:239], v[32:35], 0
  ds_read_b64_tr_b16 a[252:253], v4 offset:12544
  v_cvt_pk_bf16_f32 v42, v28, v29
  v_mfma_f32_16x16x32_bf16 v[148:151], a[236:239], v[36:39], 0
  s_waitcnt lgkmcnt(5)
  ds_read_b64_tr_b16 a[254:255], v4 offset:18688
  v_mul_f32_e32 v24, s25, v24
  v_mfma_f32_16x16x32_bf16 v[160:163], a[240:243], v[32:35], 0
  v_exp_f32_e32 v31, v31
  v_mfma_f32_16x16x32_bf16 v[164:167], a[240:243], v[36:39], 0
  s_waitcnt lgkmcnt(4)
  ds_read_b64_tr_b16 a[192:193], v5 offset:12544
  ds_read_b64_tr_b16 a[194:195], v5 offset:18688
  v_mfma_f32_16x16x32_bf16 v[176:179], a[244:247], v[32:35], 0
  v_exp_f32_e32 v20, v20
  v_mfma_f32_16x16x32_bf16 v[180:183], a[244:247], v[36:39], 0
  s_waitcnt lgkmcnt(4)
  s_waitcnt vmcnt(9)
  s_barrier
  ds_read_b64_tr_b16 a[196:197], v6 offset:12544
  ds_read_b64_tr_b16 a[198:199], v6 offset:18688
  v_mfma_f32_16x16x32_bf16 v[192:195], a[248:251], v[32:35], 0
  s_add_u32 m0, s27, 37120
  ds_read_b64_tr_b16 a[200:201], v3 offset:24576
  v_cvt_pk_bf16_f32 v43, v30, v31
  v_mfma_f32_16x16x32_bf16 v[196:199], a[248:251], v[36:39], 0
  s_waitcnt lgkmcnt(5)
  s_add_u32 s33, s32, 21504
  v_exp_f32_e32 v21, v21
  v_mfma_f32_16x16x32_bf16 v[208:211], a[252:255], v[32:35], 0
  ds_read_b64_tr_b16 a[202:203], v3 offset:30720
  v_cvt_pk_bf16_f32 v44, v20, v21
  v_mfma_f32_16x16x32_bf16 v[212:215], a[252:255], v[36:39], 0
  s_waitcnt lgkmcnt(4)
  buffer_load_dwordx4 v7, s[16:19], s33 offen offset:0 nt lds
  v_mfma_f32_16x16x32_bf16 v[224:227], a[192:195], v[32:35], 0
  ds_read_b64_tr_b16 a[204:205], v4 offset:24576
  ds_read_b64_tr_b16 a[206:207], v4 offset:30720
  v_mul_f32_e32 v25, s25, v25
  v_mul_f32_e32 v26, s25, v26
  v_mul_f32_e32 v27, s25, v27
  v_mfma_f32_16x16x32_bf16 v[228:231], a[192:195], v[36:39], 0
  s_waitcnt lgkmcnt(4)
  v_exp_f32_e32 v22, v22
  v_exp_f32_e32 v23, v23
  v_exp_f32_e32 v24, v24
  v_exp_f32_e32 v25, v25
  v_exp_f32_e32 v26, v26
  v_exp_f32_e32 v27, v27
  v_mfma_f32_16x16x32_bf16 v[240:243], a[196:199], v[32:35], 0
  buffer_load_dwordx4 v8, s[16:19], s33 offen offset:1024 nt lds
  ds_read_b64_tr_b16 a[232:233], v5 offset:24576
  ds_read_b64_tr_b16 a[234:235], v5 offset:30720
  v_cvt_pk_bf16_f32 v45, v22, v23
  v_cvt_pk_bf16_f32 v46, v24, v25
  v_cvt_pk_bf16_f32 v47, v26, v27
  v_mfma_f32_16x16x32_bf16 v[244:247], a[196:199], v[36:39], 0
  ds_read_b64_tr_b16 a[236:237], v6 offset:24576
  ds_read_b64_tr_b16 a[238:239], v6 offset:30720
  v_smfmac_f32_16x16x64_bf16 a[208:211], a[224:227], v[40:47], v0
  s_waitcnt lgkmcnt(6)
  ds_read_b64_tr_b16 a[240:241], v3 offset:24704
  v_mfma_f32_16x16x32_bf16 v[64:67], a[200:203], v[40:43], v[64:67]
  buffer_load_dwordx4 v9, s[16:19], s33 offen offset:2048 nt lds
  v_mfma_f32_16x16x32_bf16 v[68:71], a[200:203], v[44:47], v[68:71]
  s_waitcnt lgkmcnt(5)
  ds_read_b64_tr_b16 a[242:243], v3 offset:30848
  ds_read_b64_tr_b16 a[244:245], v4 offset:24704
  v_mfma_f32_16x16x32_bf16 v[80:83], a[204:207], v[40:43], v[80:83]
  ds_read_b64_tr_b16 a[246:247], v4 offset:30848
  ds_read_b64_tr_b16 a[248:249], v5 offset:24704
  v_mfma_f32_16x16x32_bf16 v[84:87], a[204:207], v[44:47], v[84:87]
  s_waitcnt lgkmcnt(7)
  ds_read_b64_tr_b16 a[250:251], v5 offset:30848
  ds_read_b64_tr_b16 a[252:253], v6 offset:24704
  v_mfma_f32_16x16x32_bf16 v[96:99], a[232:235], v[40:43], v[96:99]
  ds_read_b64_tr_b16 a[254:255], v6 offset:30848
  ds_read_b64_tr_b16 a[192:193], v3 offset:24832
  v_mfma_f32_16x16x32_bf16 v[100:103], a[232:235], v[44:47], v[100:103]
  s_waitcnt lgkmcnt(9)
  ds_read_b64_tr_b16 a[194:195], v3 offset:30976
  ds_read_b64_tr_b16 a[196:197], v4 offset:24832
  v_mfma_f32_16x16x32_bf16 v[112:115], a[236:239], v[40:43], v[112:115]
  ds_read_b64_tr_b16 a[198:199], v4 offset:30976
  ds_read_b64_tr_b16 a[200:201], v5 offset:24832
  v_mfma_f32_16x16x32_bf16 v[116:119], a[236:239], v[44:47], v[116:119]
  s_waitcnt lgkmcnt(11)
  ds_read_b64_tr_b16 a[202:203], v5 offset:30976
  ds_read_b64_tr_b16 a[204:205], v6 offset:24832
  v_mfma_f32_16x16x32_bf16 v[128:131], a[240:243], v[40:43], v[128:131]
  ds_read_b64_tr_b16 a[206:207], v6 offset:30976
  ds_read_b64_tr_b16 a[232:233], v3 offset:12288
  v_mfma_f32_16x16x32_bf16 v[132:135], a[240:243], v[44:47], v[132:135]
  s_waitcnt lgkmcnt(13)
  ds_read_b64_tr_b16 a[234:235], v3 offset:18432
  ds_read_b64_tr_b16 a[236:237], v4 offset:12288
  v_mfma_f32_16x16x32_bf16 v[144:147], a[244:247], v[40:43], v[144:147]
  ds_read_b64_tr_b16 a[238:239], v4 offset:18432
  ds_read_b64_tr_b16 a[240:241], v5 offset:12288
  v_mfma_f32_16x16x32_bf16 v[148:151], a[244:247], v[44:47], v[148:151]
  s_waitcnt lgkmcnt(14)
  ds_read_b64_tr_b16 a[242:243], v5 offset:18432
  ds_read_b64_tr_b16 a[244:245], v6 offset:12288
  v_mfma_f32_16x16x32_bf16 v[160:163], a[248:251], v[40:43], v[160:163]
  ds_read_b64_tr_b16 a[246:247], v6 offset:18432
  v_mfma_f32_16x16x32_bf16 v[164:167], a[248:251], v[44:47], v[164:167]
  s_waitcnt lgkmcnt(13)
  ds_read_b64_tr_b16 a[248:249], v3 offset:12416
  ds_read_b64_tr_b16 a[250:251], v3 offset:18560
  v_mfma_f32_16x16x32_bf16 v[176:179], a[252:255], v[40:43], v[176:179]
  v_mfma_f32_16x16x32_bf16 v[180:183], a[252:255], v[44:47], v[180:183]
  ds_read_b64_tr_b16 a[252:253], v4 offset:12416
  ds_read_b64_tr_b16 a[254:255], v4 offset:18560
  v_mfma_f32_16x16x32_bf16 v[192:195], a[192:195], v[40:43], v[192:195]
  v_mfma_f32_16x16x32_bf16 v[196:199], a[192:195], v[44:47], v[196:199]
  s_waitcnt lgkmcnt(9)
  ds_read_b64_tr_b16 a[192:193], v5 offset:12416
  ds_read_b64_tr_b16 a[194:195], v5 offset:18560
  v_mfma_f32_16x16x32_bf16 v[208:211], a[196:199], v[40:43], v[208:211]
  v_mfma_f32_16x16x32_bf16 v[212:215], a[196:199], v[44:47], v[212:215]
  ds_read_b64_tr_b16 a[196:197], v6 offset:12416
  ds_read_b64_tr_b16 a[198:199], v6 offset:18560
  v_mfma_f32_16x16x32_bf16 v[224:227], a[200:203], v[40:43], v[224:227]
  v_mfma_f32_16x16x32_bf16 v[228:231], a[200:203], v[44:47], v[228:231]
  ds_read_b64_tr_b16 a[200:201], v3 offset:12544
  ds_read_b64_tr_b16 a[202:203], v3 offset:18688
  v_mfma_f32_16x16x32_bf16 v[240:243], a[204:207], v[40:43], v[240:243]
  v_mfma_f32_16x16x32_bf16 v[244:247], a[204:207], v[44:47], v[244:247]
  ds_read_b64_tr_b16 a[204:205], v4 offset:12544
  ds_read_b64_tr_b16 a[206:207], v4 offset:18688
  s_add_u32 m0, s27, 49664
  s_nop 0
  buffer_load_dwordx4 v7, s[8:11], s42 offen offset:0 nt lds
  buffer_load_dwordx4 v8, s[8:11], s42 offen offset:1024 nt lds
  buffer_load_dwordx4 v9, s[8:11], s42 offen offset:2048 nt lds
  s_add_u32 m0, s27, 61952
  s_nop 0
  buffer_load_dwordx4 v7, s[8:11], s43 offen offset:0 nt lds
  buffer_load_dwordx4 v8, s[8:11], s43 offen offset:1024 nt lds
  buffer_load_dwordx4 v9, s[8:11], s43 offen offset:2048 nt lds
  s_waitcnt vmcnt(12)
  ds_read_b128 a[48:51], v19 offset:0
  ds_read_b128 a[52:55], v16 offset:0
  ds_read_b128 a[56:59], v19 offset:128
  ds_read_b128 a[60:63], v16 offset:128
  ds_read_b128 a[64:67], v19 offset:256
  ds_read_b128 a[68:71], v16 offset:256
  s_waitcnt lgkmcnt(5)
  v_mfma_f32_16x16x32_bf16 v[28:31], v[76:79], a[48:51], 0
  s_waitcnt lgkmcnt(4)
  v_mfma_f32_16x16x32_bf16 v[28:31], v[92:95], a[52:55], v[28:31]
  s_waitcnt lgkmcnt(3)
  v_mfma_f32_16x16x32_bf16 v[28:31], v[108:111], a[56:59], v[28:31]
  s_waitcnt lgkmcnt(2)
  v_mfma_f32_16x16x32_bf16 v[28:31], v[124:127], a[60:63], v[28:31]
  s_waitcnt lgkmcnt(1)
  v_mfma_f32_16x16x32_bf16 v[28:31], v[140:143], a[64:67], v[28:31]
  s_waitcnt lgkmcnt(0)
  v_mfma_f32_16x16x32_bf16 v[28:31], v[156:159], a[68:71], v[28:31]
  v_mfma_f32_16x16x32_bf16 v[20:23], v[172:175], a[48:51], 0
  v_mfma_f32_16x16x32_bf16 v[20:23], v[188:191], a[52:55], v[20:23]
  v_mfma_f32_16x16x32_bf16 v[20:23], v[204:207], a[56:59], v[20:23]
  v_mfma_f32_16x16x32_bf16 v[20:23], v[220:223], a[60:63], v[20:23]
  s_nop 3
  v_mul_f32_e32 v28, s25, v28
  v_mul_f32_e32 v29, s25, v29
  v_mfma_f32_16x16x32_bf16 v[20:23], v[236:239], a[64:67], v[20:23]
  v_exp_f32_e32 v28, v28
  v_mfma_f32_16x16x32_bf16 v[20:23], v[252:255], a[68:71], v[20:23]
  v_mul_f32_e32 v30, s25, v30
  v_mul_f32_e32 v31, s25, v31
  v_mfma_f32_16x16x32_bf16 v[24:27], a[96:99], a[48:51], 0
  v_exp_f32_e32 v29, v29
  v_mfma_f32_16x16x32_bf16 v[24:27], a[100:103], a[52:55], v[24:27]
  v_exp_f32_e32 v30, v30
  v_mfma_f32_16x16x32_bf16 v[24:27], a[104:107], a[56:59], v[24:27]
  v_exp_f32_e32 v31, v31
  v_mfma_f32_16x16x32_bf16 v[24:27], a[108:111], a[60:63], v[24:27]
  v_cvt_pk_bf16_f32 v48, v28, v29
  v_mul_f32_e32 v20, s25, v20
  v_mfma_f32_16x16x32_bf16 v[24:27], a[112:115], a[64:67], v[24:27]
  v_cvt_pk_bf16_f32 v49, v30, v31
  v_mul_f32_e32 v21, s25, v21
  v_mfma_f32_16x16x32_bf16 v[24:27], a[116:119], a[68:71], v[24:27]
  v_exp_f32_e32 v20, v20
  v_mfma_f32_16x16x32_bf16 v[28:31], a[120:123], a[48:51], 0
  v_mul_f32_e32 v22, s25, v22
  v_mul_f32_e32 v23, s25, v23
  v_mfma_f32_16x16x32_bf16 v[28:31], a[124:127], a[52:55], v[28:31]
  v_exp_f32_e32 v21, v21
  v_mfma_f32_16x16x32_bf16 v[28:31], a[128:131], a[56:59], v[28:31]
  v_exp_f32_e32 v22, v22
  v_mfma_f32_16x16x32_bf16 v[28:31], a[132:135], a[60:63], v[28:31]
  v_mul_f32_e32 v24, s25, v24
  v_mul_f32_e32 v25, s25, v25
  v_mul_f32_e32 v26, s25, v26
  v_mul_f32_e32 v27, s25, v27
  v_mfma_f32_16x16x32_bf16 v[28:31], a[136:139], a[64:67], v[28:31]
  v_exp_f32_e32 v23, v23
  v_exp_f32_e32 v24, v24
  v_exp_f32_e32 v25, v25
  v_exp_f32_e32 v26, v26
  v_exp_f32_e32 v27, v27
  v_mfma_f32_16x16x32_bf16 v[28:31], a[140:143], a[68:71], v[28:31]
  v_cvt_pk_bf16_f32 v50, v20, v21
  v_cvt_pk_bf16_f32 v51, v22, v23
  v_cvt_pk_bf16_f32 v56, v24, v25
  v_cvt_pk_bf16_f32 v57, v26, v27
  s_nop 3
  v_mul_f32_e32 v28, s25, v28
  v_mul_f32_e32 v29, s25, v29
  v_mul_f32_e32 v30, s25, v30
  v_mul_f32_e32 v31, s25, v31
  v_exp_f32_e32 v28, v28
  v_exp_f32_e32 v29, v29
  v_exp_f32_e32 v30, v30
  v_exp_f32_e64 v31, v31
  v_cvt_pk_bf16_f32 v58, v28, v29
  v_cvt_pk_bf16_f32 v59, v30, v31
  s_add_u32 m0, s27, 135680
  s_nop 0
  buffer_load_dwordx4 v7, s[12:15], s42 offen offset:0 nt lds
  buffer_load_dwordx4 v8, s[12:15], s42 offen offset:1024 nt lds
  buffer_load_dwordx4 v9, s[12:15], s42 offen offset:2048 nt lds
  s_add_u32 m0, s27, 74240
  s_nop 0
  buffer_load_dwordx4 v7, s[8:11], s44 offen offset:0 nt lds
  buffer_load_dwordx4 v8, s[8:11], s44 offen offset:1024 nt lds
  buffer_load_dwordx4 v9, s[8:11], s44 offen offset:2048 nt lds
  s_waitcnt vmcnt(12)
  ds_read_b128 a[72:75], v19 offset:24832
  ds_read_b128 a[76:79], v16 offset:24832
  ds_read_b128 a[80:83], v19 offset:24960
  ds_read_b128 a[84:87], v16 offset:24960
  ds_read_b128 a[88:91], v19 offset:25088
  ds_read_b128 a[92:95], v16 offset:25088
  s_waitcnt lgkmcnt(5)
  v_mfma_f32_16x16x32_bf16 v[20:23], v[76:79], a[72:75], 0
  s_waitcnt lgkmcnt(4)
  v_mfma_f32_16x16x32_bf16 v[20:23], v[92:95], a[76:79], v[20:23]
  s_waitcnt lgkmcnt(3)
  v_mfma_f32_16x16x32_bf16 v[20:23], v[108:111], a[80:83], v[20:23]
  s_waitcnt lgkmcnt(2)
  v_mfma_f32_16x16x32_bf16 v[20:23], v[124:127], a[84:87], v[20:23]
  s_waitcnt lgkmcnt(1)
  v_mfma_f32_16x16x32_bf16 v[20:23], v[140:143], a[88:91], v[20:23]
  s_waitcnt lgkmcnt(0)
  v_mfma_f32_16x16x32_bf16 v[20:23], v[156:159], a[92:95], v[20:23]
  v_mfma_f32_16x16x32_bf16 v[24:27], v[172:175], a[72:75], 0
  v_mfma_f32_16x16x32_bf16 v[24:27], v[188:191], a[76:79], v[24:27]
  v_mfma_f32_16x16x32_bf16 v[24:27], v[204:207], a[80:83], v[24:27]
  v_mfma_f32_16x16x32_bf16 v[24:27], v[220:223], a[84:87], v[24:27]
  s_nop 3
  v_mul_f32_e32 v20, s25, v20
  v_mul_f32_e32 v21, s25, v21
  v_mfma_f32_16x16x32_bf16 v[24:27], v[236:239], a[88:91], v[24:27]
  v_exp_f32_e32 v20, v20
  v_mfma_f32_16x16x32_bf16 v[24:27], v[252:255], a[92:95], v[24:27]
  s_waitcnt vmcnt(9)
  s_barrier
  ds_read_b128 a[144:147], v1 offset:0
  v_mul_f32_e32 v22, s25, v22
  v_mfma_f32_16x16x32_bf16 v[28:31], a[96:99], a[72:75], 0
  ds_read_b128 a[148:151], v2 offset:0
  v_mul_f32_e32 v23, s25, v23
  v_mfma_f32_16x16x32_bf16 v[28:31], a[100:103], a[76:79], v[28:31]
  ds_read_b128 a[152:155], v1 offset:128
  ds_read_b128 a[156:159], v2 offset:128
  v_mfma_f32_16x16x32_bf16 v[28:31], a[104:107], a[80:83], v[28:31]
  v_exp_f32_e32 v21, v21
  v_mfma_f32_16x16x32_bf16 v[28:31], a[108:111], a[84:87], v[28:31]
  ds_read_b128 a[160:163], v1 offset:256
  v_mul_f32_e32 v24, s25, v24
  v_mfma_f32_16x16x32_bf16 v[28:31], a[112:115], a[88:91], v[28:31]
  v_exp_f32_e32 v22, v22
  v_exp_f32_e32 v23, v23
  v_mfma_f32_16x16x32_bf16 v[28:31], a[116:119], a[92:95], v[28:31]
  v_cvt_pk_bf16_f32 v52, v20, v21
  v_cvt_pk_bf16_f32 v53, v22, v23
  v_mfma_f32_16x16x32_bf16 v[20:23], a[120:123], a[72:75], 0
  ds_read_b128 a[168:171], v1 offset:6144
  v_mul_f32_e32 v25, s25, v25
  v_mfma_f32_16x16x32_bf16 v[20:23], a[124:127], a[76:79], v[20:23]
  ds_read_b128 a[164:167], v2 offset:256
  v_mul_f32_e32 v26, s25, v26
  v_mfma_f32_16x16x32_bf16 v[20:23], a[128:131], a[80:83], v[20:23]
  v_exp_f32_e32 v24, v24
  v_mfma_f32_16x16x32_bf16 v[20:23], a[132:135], a[84:87], v[20:23]
  ds_read_b128 a[172:175], v2 offset:6144
  v_mul_f32_e32 v27, s25, v27
  v_mfma_f32_16x16x32_bf16 v[20:23], a[136:139], a[88:91], v[20:23]
  v_exp_f32_e32 v25, v25
  v_exp_f32_e32 v26, v26
  v_exp_f32_e32 v27, v27
  v_mfma_f32_16x16x32_bf16 v[20:23], a[140:143], a[92:95], v[20:23]
  s_waitcnt lgkmcnt(3)
  v_cvt_pk_bf16_f32 v54, v24, v25
  v_cvt_pk_bf16_f32 v55, v26, v27
  v_mfma_f32_16x16x32_bf16 v[24:27], a[144:147], a[0:3], 0
  v_mul_f32_e32 v28, s25, v28
  v_mul_f32_e32 v29, s25, v29
  v_mfma_f32_16x16x32_bf16 v[24:27], a[148:151], a[4:7], v[24:27]
  v_exp_f32_e32 v28, v28
  v_mfma_f32_16x16x32_bf16 v[24:27], a[152:155], a[8:11], v[24:27]
  v_mul_f32_e32 v30, s25, v30
  v_mul_f32_e32 v31, s25, v31
  v_mfma_f32_16x16x32_bf16 v[24:27], a[156:159], a[12:15], v[24:27]
  v_exp_f32_e32 v29, v29
  v_mfma_f32_16x16x32_bf16 v[24:27], a[160:163], a[16:19], v[24:27]
  s_waitcnt lgkmcnt(1)
  v_exp_f32_e32 v30, v30
  v_mfma_f32_16x16x32_bf16 v[24:27], a[164:167], a[20:23], v[24:27]
  ds_read_b128 a[176:179], v1 offset:6272
  v_mul_f32_e32 v20, s25, v20
  v_smfmac_f32_16x16x64_bf16 a[212:215], a[224:227], v[48:55], v0
  v_exp_f32_e32 v31, v31
  v_mfma_f32_16x16x32_bf16 v[72:75], a[232:235], v[48:51], 0
  v_cvt_pk_bf16_f32 v60, v28, v29
  v_cvt_pk_bf16_f32 v61, v30, v31
  v_mfma_f32_16x16x32_bf16 v[28:31], a[144:147], a[24:27], 0
  v_mul_f32_e32 v21, s25, v21
  v_mul_f32_e32 v22, s25, v22
  v_mfma_f32_16x16x32_bf16 v[28:31], a[148:151], a[28:31], v[28:31]
  v_exp_f32_e32 v20, v20
  v_mfma_f32_16x16x32_bf16 v[28:31], a[152:155], a[32:35], v[28:31]
  v_exp_f32_e32 v21, v21
  v_mfma_f32_16x16x32_bf16 v[28:31], a[156:159], a[36:39], v[28:31]
  v_mul_f32_e32 v23, s25, v23
  v_mul_f32_e32 v24, s25, v24
  v_mfma_f32_16x16x32_bf16 v[28:31], a[160:163], a[40:43], v[28:31]
  v_exp_f32_e32 v22, v22
  v_mfma_f32_16x16x32_bf16 v[28:31], a[164:167], a[44:47], v[28:31]
  ds_read_b128 a[180:183], v2 offset:6272
  v_cvt_pk_bf16_f32 v62, v20, v21
  v_mfma_f32_16x16x32_bf16 v[76:79], a[232:235], v[52:55], 0
  v_mul_f32_e32 v25, s25, v25
  v_mul_f32_e32 v26, s25, v26
  v_mfma_f32_16x16x32_bf16 v[88:91], a[236:239], v[48:51], 0
  v_exp_f32_e32 v23, v23
  v_mfma_f32_16x16x32_bf16 v[92:95], a[236:239], v[52:55], 0
  v_exp_f32_e32 v24, v24
  v_mfma_f32_16x16x32_bf16 v[104:107], a[240:243], v[48:51], 0
  v_cvt_pk_bf16_f32 v63, v22, v23
  v_mul_f32_e32 v27, s25, v27
  v_mfma_f32_16x16x32_bf16 v[108:111], a[240:243], v[52:55], 0
  v_exp_f32_e32 v25, v25
  v_mfma_f32_16x16x32_bf16 v[120:123], a[244:247], v[48:51], 0
  v_exp_f32_e32 v26, v26
  v_mfma_f32_16x16x32_bf16 v[124:127], a[244:247], v[52:55], 0
  v_cvt_pk_bf16_f32 v32, v24, v25
  v_mul_f32_e32 v28, s25, v28
  v_mfma_f32_16x16x32_bf16 v[20:23], a[144:147], a[48:51], 0
  v_exp_f32_e32 v27, v27
  v_mfma_f32_16x16x32_bf16 v[20:23], a[148:151], a[52:55], v[20:23]
  ds_read_b128 a[184:187], v1 offset:6400
  v_mul_f32_e32 v29, s25, v29
  v_mfma_f32_16x16x32_bf16 v[20:23], a[152:155], a[56:59], v[20:23]
  v_cvt_pk_bf16_f32 v33, v26, v27
  v_mul_f32_e32 v30, s25, v30
  v_mfma_f32_16x16x32_bf16 v[20:23], a[156:159], a[60:63], v[20:23]
  v_exp_f32_e32 v28, v28
  v_mfma_f32_16x16x32_bf16 v[20:23], a[160:163], a[64:67], v[20:23]
  v_exp_f32_e32 v29, v29
  v_mfma_f32_16x16x32_bf16 v[20:23], a[164:167], a[68:71], v[20:23]
  v_mul_f32_e32 v31, s25, v31
  v_cvt_pk_bf16_f32 v36, v28, v29
  v_mfma_f32_16x16x32_bf16 v[136:139], a[248:251], v[48:51], 0
  v_exp_f32_e32 v30, v30
  v_mfma_f32_16x16x32_bf16 v[140:143], a[248:251], v[52:55], 0
  v_exp_f32_e32 v31, v31
  v_mfma_f32_16x16x32_bf16 v[152:155], a[252:255], v[48:51], 0
  v_cvt_pk_bf16_f32 v37, v30, v31
  v_mfma_f32_16x16x32_bf16 v[156:159], a[252:255], v[52:55], 0
L_tr0:
  s_cbranch_execz L_tr4
  s_waitcnt vmcnt(6)
  s_barrier
  ds_read_b128 a[188:191], v2 offset:6400
  v_mul_f32_e32 v20, s25, v20
  v_mfma_f32_16x16x32_bf16 v[168:171], a[192:195], v[48:51], 0
  v_mul_f32_e32 v21, s25, v21
  v_mul_f32_e32 v22, s25, v22
  v_mfma_f32_16x16x32_bf16 v[172:175], a[192:195], v[52:55], 0
  v_exp_f32_e32 v20, v20
  v_mfma_f32_16x16x32_bf16 v[24:27], a[144:147], a[72:75], 0
  v_exp_f32_e32 v21, v21
  v_mfma_f32_16x16x32_bf16 v[24:27], a[148:151], a[76:79], v[24:27]
  ds_read_b64_tr_b16 a[232:233], v5 offset:12544
  v_mul_f32_e32 v23, s25, v23
  v_mfma_f32_16x16x32_bf16 v[24:27], a[152:155], a[80:83], v[24:27]
  s_add_u32 m0, s27, 147968
  v_exp_f32_e32 v22, v22
  v_mfma_f32_16x16x32_bf16 v[24:27], a[156:159], a[84:87], v[24:27]
  buffer_load_dwordx4 v7, s[12:15], s43 offen offset:0 nt lds
  v_mfma_f32_16x16x32_bf16 v[24:27], a[160:163], a[88:91], v[24:27]
  ds_read_b64_tr_b16 a[234:235], v5 offset:18688
  v_cvt_pk_bf16_f32 v40, v20, v21
  v_mfma_f32_16x16x32_bf16 v[24:27], a[164:167], a[92:95], v[24:27]
  ds_read_b64_tr_b16 a[236:237], v6 offset:12544
  ds_read_b64_tr_b16 a[238:239], v6 offset:18688
  v_mfma_f32_16x16x32_bf16 v[184:187], a[196:199], v[48:51], 0
  v_exp_f32_e32 v23, v23
  v_mfma_f32_16x16x32_bf16 v[188:191], a[196:199], v[52:55], 0
  ds_read_b64_tr_b16 a[240:241], v3 offset:24576
  v_cvt_pk_bf16_f32 v41, v22, v23
  v_mfma_f32_16x16x32_bf16 v[200:203], a[200:203], v[48:51], 0
  ds_read_b128 a[144:147], v1 offset:12288
  ds_read_b64_tr_b16 a[242:243], v3 offset:30720
  v_mfma_f32_16x16x32_bf16 v[204:207], a[200:203], v[52:55], 0
  v_mul_f32_e32 v24, s25, v24
  v_mul_f32_e32 v25, s25, v25
  v_mfma_f32_16x16x32_bf16 v[216:219], a[204:207], v[48:51], 0
  v_exp_f32_e32 v24, v24
  v_mfma_f32_16x16x32_bf16 v[220:223], a[204:207], v[52:55], 0
  buffer_load_dwordx4 v8, s[12:15], s43 offen offset:1024 nt lds
  v_mfma_f32_16x16x32_bf16 v[28:31], a[168:171], a[0:3], 0
  s_waitcnt lgkmcnt(5)
  ds_read_b64_tr_b16 a[244:245], v4 offset:24576
  v_mul_f32_e32 v26, s25, v26
  v_mfma_f32_16x16x32_bf16 v[28:31], a[172:175], a[4:7], v[28:31]
  v_exp_f32_e32 v25, v25
  v_mfma_f32_16x16x32_bf16 v[28:31], a[176:179], a[8:11], v[28:31]
  ds_read_b128 a[148:151], v2 offset:12288
  v_mul_f32_e32 v27, s25, v27
  v_mfma_f32_16x16x32_bf16 v[28:31], a[180:183], a[12:15], v[28:31]
  v_exp_f32_e32 v26, v26
  v_mfma_f32_16x16x32_bf16 v[28:31], a[184:187], a[16:19], v[28:31]
  ds_read_b64_tr_b16 a[246:247], v4 offset:30720
  v_cvt_pk_bf16_f32 v44, v24, v25
  v_mfma_f32_16x16x32_bf16 v[28:31], a[188:191], a[20:23], v[28:31]
  ds_read_b64_tr_b16 a[248:249], v5 offset:24576
  ds_read_b64_tr_b16 a[250:251], v5 offset:30720
  v_mfma_f32_16x16x32_bf16 v[232:235], a[232:235], v[48:51], 0
  v_exp_f32_e32 v27, v27
  v_mfma_f32_16x16x32_bf16 v[236:239], a[232:235], v[52:55], 0
  s_waitcnt lgkmcnt(5)
  buffer_load_dwordx4 v9, s[12:15], s43 offen offset:2048 nt lds
  v_mfma_f32_16x16x32_bf16 v[248:251], a[236:239], v[48:51], 0
  ds_read_b64_tr_b16 a[252:253], v6 offset:24576
  v_cvt_pk_bf16_f32 v45, v26, v27
  v_mfma_f32_16x16x32_bf16 v[252:255], a[236:239], v[52:55], 0
  ds_read_b64_tr_b16 a[254:255], v6 offset:30720
  v_mul_f32_e32 v28, s25, v28
  v_smfmac_f32_16x16x64_bf16 a[212:215], a[224:227], v[56:63], v0
  ds_read_b128 a[152:155], v1 offset:12416
  v_mfma_f32_16x16x32_bf16 v[72:75], a[240:243], v[56:59], v[72:75]
  v_mul_f32_e32 v29, s25, v29
  v_mul_f32_e32 v30, s25, v30
  v_mfma_f32_16x16x32_bf16 v[20:23], a[168:171], a[24:27], 0
  v_exp_f32_e32 v28, v28
  v_mfma_f32_16x16x32_bf16 v[20:23], a[172:175], a[28:31], v[20:23]
  v_exp_f32_e32 v29, v29
  v_mfma_f32_16x16x32_bf16 v[20:23], a[176:179], a[32:35], v[20:23]
  s_add_u32 m0, s27, 86528
  ds_read_b64_tr_b16 a[192:193], v3 offset:24704
  v_mul_f32_e32 v31, s25, v31
  v_mfma_f32_16x16x32_bf16 v[20:23], a[180:183], a[36:39], v[20:23]
  buffer_load_dwordx4 v7, s[8:11], s45 offen offset:0 nt lds
  v_mfma_f32_16x16x32_bf16 v[20:23], a[184:187], a[40:43], v[20:23]
  v_exp_f32_e32 v30, v30
  v_mfma_f32_16x16x32_bf16 v[20:23], a[188:191], a[44:47], v[20:23]
  ds_read_b64_tr_b16 a[194:195], v3 offset:30848
  v_cvt_pk_bf16_f32 v34, v28, v29
  v_mfma_f32_16x16x32_bf16 v[76:79], a[240:243], v[60:63], v[76:79]
  s_waitcnt lgkmcnt(2)
  ds_read_b64_tr_b16 a[196:197], v4 offset:24704
  ds_read_b64_tr_b16 a[198:199], v4 offset:30848
  v_mfma_f32_16x16x32_bf16 v[88:91], a[244:247], v[56:59], v[88:91]
  v_exp_f32_e32 v31, v31
  v_mfma_f32_16x16x32_bf16 v[92:95], a[244:247], v[60:63], v[92:95]
  ds_read_b64_tr_b16 a[200:201], v5 offset:24704
  v_cvt_pk_bf16_f32 v35, v30, v31
  v_mfma_f32_16x16x32_bf16 v[104:107], a[248:251], v[56:59], v[104:107]
  ds_read_b128 a[156:159], v2 offset:12416
  v_mul_f32_e32 v20, s25, v20
  v_mfma_f32_16x16x32_bf16 v[108:111], a[248:251], v[60:63], v[108:111]
  ds_read_b64_tr_b16 a[202:203], v5 offset:30848
  v_mul_f32_e32 v21, s25, v21
  v_mfma_f32_16x16x32_bf16 v[120:123], a[252:255], v[56:59], v[120:123]
  buffer_load_dwordx4 v8, s[8:11], s45 offen offset:1024 nt lds
  v_mfma_f32_16x16x32_bf16 v[124:127], a[252:255], v[60:63], v[124:127]
  v_exp_f32_e32 v20, v20
  v_mfma_f32_16x16x32_bf16 v[24:27], a[168:171], a[48:51], 0
  ds_read_b64_tr_b16 a[204:205], v6 offset:24704
  v_mul_f32_e32 v22, s25, v22
  v_mfma_f32_16x16x32_bf16 v[24:27], a[172:175], a[52:55], v[24:27]
  v_exp_f32_e32 v21, v21
  v_mfma_f32_16x16x32_bf16 v[24:27], a[176:179], a[56:59], v[24:27]
  ds_read_b128 a[160:163], v1 offset:12544
  v_mul_f32_e32 v23, s25, v23
  v_mfma_f32_16x16x32_bf16 v[24:27], a[180:183], a[60:63], v[24:27]
  v_exp_f32_e32 v22, v22
  v_mfma_f32_16x16x32_bf16 v[24:27], a[184:187], a[64:67], v[24:27]
  ds_read_b64_tr_b16 a[206:207], v6 offset:30848
  v_cvt_pk_bf16_f32 v38, v20, v21
  v_mfma_f32_16x16x32_bf16 v[24:27], a[188:191], a[68:71], v[24:27]
  s_waitcnt lgkmcnt(3)
  ds_read_b64_tr_b16 a[232:233], v3 offset:24832
  ds_read_b64_tr_b16 a[234:235], v3 offset:30976
  v_mfma_f32_16x16x32_bf16 v[136:139], a[192:195], v[56:59], v[136:139]
  v_exp_f32_e32 v23, v23
  v_mfma_f32_16x16x32_bf16 v[140:143], a[192:195], v[60:63], v[140:143]
  buffer_load_dwordx4 v9, s[8:11], s45 offen offset:2048 nt lds
  v_mfma_f32_16x16x32_bf16 v[152:155], a[196:199], v[56:59], v[152:155]
  ds_read_b64_tr_b16 a[236:237], v4 offset:24832
  v_cvt_pk_bf16_f32 v39, v22, v23
  v_mfma_f32_16x16x32_bf16 v[156:159], a[196:199], v[60:63], v[156:159]
  ds_read_b64_tr_b16 a[238:239], v4 offset:30976
  v_mul_f32_e32 v24, s25, v24
  v_mfma_f32_16x16x32_bf16 v[168:171], a[200:203], v[56:59], v[168:171]
  ds_read_b128 a[164:167], v2 offset:12544
  v_mul_f32_e32 v25, s25, v25
  v_mfma_f32_16x16x32_bf16 v[172:175], a[200:203], v[60:63], v[172:175]
  v_exp_f32_e32 v24, v24
  v_mfma_f32_16x16x32_bf16 v[28:31], a[168:171], a[72:75], 0
  ds_read_b64_tr_b16 a[240:241], v5 offset:24832
  v_mul_f32_e32 v26, s25, v26
  v_mfma_f32_16x16x32_bf16 v[28:31], a[172:175], a[76:79], v[28:31]
  v_exp_f32_e32 v25, v25
  v_mfma_f32_16x16x32_bf16 v[28:31], a[176:179], a[80:83], v[28:31]
  ds_read_b64_tr_b16 a[242:243], v5 offset:30976
  v_mul_f32_e32 v27, s25, v27
  v_mfma_f32_16x16x32_bf16 v[28:31], a[180:183], a[84:87], v[28:31]
  v_exp_f32_e32 v26, v26
  v_mfma_f32_16x16x32_bf16 v[28:31], a[184:187], a[88:91], v[28:31]
  ds_read_b64_tr_b16 a[244:245], v6 offset:24832
  v_cvt_pk_bf16_f32 v42, v24, v25
  v_mfma_f32_16x16x32_bf16 v[28:31], a[188:191], a[92:95], v[28:31]
  s_waitcnt lgkmcnt(4)
  v_exp_f32_e32 v27, v27
  v_mfma_f32_16x16x32_bf16 v[184:187], a[204:207], v[56:59], v[184:187]
  ds_read_b64_tr_b16 a[246:247], v6 offset:30976
  v_cvt_pk_bf16_f32 v43, v26, v27
  v_mfma_f32_16x16x32_bf16 v[188:191], a[204:207], v[60:63], v[188:191]
  ds_read_b128 a[168:171], v1 offset:18432
  v_mfma_f32_16x16x32_bf16 v[200:203], a[232:235], v[56:59], v[200:203]
  s_waitcnt vmcnt(6)
  s_barrier
  v_mfma_f32_16x16x32_bf16 v[204:207], a[232:235], v[60:63], v[204:207]
  v_mul_f32_e32 v28, s25, v28
  v_mul_f32_e32 v29, s25, v29
  v_mfma_f32_16x16x32_bf16 v[216:219], a[236:239], v[56:59], v[216:219]
  v_exp_f32_e32 v28, v28
  v_mfma_f32_16x16x32_bf16 v[220:223], a[236:239], v[60:63], v[220:223]
  ds_read_b64_tr_b16 a[248:249], v3 offset:36864
  v_mul_f32_e32 v30, s25, v30
  v_mfma_f32_16x16x32_bf16 v[20:23], a[144:147], a[0:3], 0
  v_exp_f32_e32 v29, v29
  v_mfma_f32_16x16x32_bf16 v[20:23], a[148:151], a[4:7], v[20:23]
  s_add_u32 m0, s27, 111104
  v_mul_f32_e32 v31, s25, v31
  v_cvt_pk_bf16_f32 v46, v28, v29
  v_mfma_f32_16x16x32_bf16 v[20:23], a[152:155], a[8:11], v[20:23]
  buffer_load_dwordx4 v7, s[12:15], s44 offen offset:0 nt lds
  v_mfma_f32_16x16x32_bf16 v[20:23], a[156:159], a[12:15], v[20:23]
  v_exp_f32_e32 v30, v30
  v_mfma_f32_16x16x32_bf16 v[20:23], a[160:163], a[16:19], v[20:23]
  s_waitcnt lgkmcnt(1)
  ds_read_b128 a[172:175], v2 offset:18432
  ds_read_b64_tr_b16 a[250:251], v3 offset:43008
  v_mfma_f32_16x16x32_bf16 v[20:23], a[164:167], a[20:23], v[20:23]
  v_exp_f32_e32 v31, v31
  v_mfma_f32_16x16x32_bf16 v[232:235], a[240:243], v[56:59], v[232:235]
  ds_read_b64_tr_b16 a[252:253], v4 offset:36864
  v_cvt_pk_bf16_f32 v47, v30, v31
  v_mfma_f32_16x16x32_bf16 v[236:239], a[240:243], v[60:63], v[236:239]
  ds_read_b64_tr_b16 a[254:255], v4 offset:43008
  v_mfma_f32_16x16x32_bf16 v[248:251], a[244:247], v[56:59], v[248:251]
  v_mfma_f32_16x16x32_bf16 v[252:255], a[244:247], v[60:63], v[252:255]
  v_mul_f32_e32 v20, s25, v20
  v_mul_f32_e32 v21, s25, v21
  v_smfmac_f32_16x16x64_bf16 a[208:211], a[224:227], v[32:39], v0
  ds_read_b128 a[176:179], v1 offset:18560
  v_smfmac_f32_16x16x64_bf16 a[212:215], a[224:227], v[40:47], v0
  v_mul_f32_e32 v22, s25, v22
  v_mfma_f32_16x16x32_bf16 v[24:27], a[144:147], a[24:27], 0
  buffer_load_dwordx4 v8, s[12:15], s44 offen offset:1024 nt lds
  v_mfma_f32_16x16x32_bf16 v[24:27], a[148:151], a[28:31], v[24:27]
  v_exp_f32_e32 v20, v20
  v_mfma_f32_16x16x32_bf16 v[24:27], a[152:155], a[32:35], v[24:27]
  v_exp_f32_e32 v21, v21
  v_mfma_f32_16x16x32_bf16 v[24:27], a[156:159], a[36:39], v[24:27]
  ds_read_b64_tr_b16 a[192:193], v5 offset:36864
  v_mul_f32_e32 v23, s25, v23
  v_mfma_f32_16x16x32_bf16 v[24:27], a[160:163], a[40:43], v[24:27]
  v_exp_f32_e32 v22, v22
  v_mfma_f32_16x16x32_bf16 v[24:27], a[164:167], a[44:47], v[24:27]
  s_waitcnt lgkmcnt(2)
  ds_read_b64_tr_b16 a[194:195], v5 offset:43008
  v_cvt_pk_bf16_f32 v48, v20, v21
  v_mfma_f32_16x16x32_bf16 v[64:67], a[248:251], v[32:35], v[64:67]
  v_exp_f32_e32 v23, v23
  v_mfma_f32_16x16x32_bf16 v[68:71], a[248:251], v[36:39], v[68:71]
  buffer_load_dwordx4 v9, s[12:15], s44 offen offset:2048 nt lds
  v_mfma_f32_16x16x32_bf16 v[72:75], a[248:251], v[40:43], v[72:75]
  ds_read_b64_tr_b16 a[196:197], v6 offset:36864
  v_cvt_pk_bf16_f32 v49, v22, v23
  v_mfma_f32_16x16x32_bf16 v[76:79], a[248:251], v[44:47], v[76:79]
  ds_read_b128 a[180:183], v2 offset:18560
  v_mul_f32_e32 v24, s25, v24
  v_mfma_f32_16x16x32_bf16 v[80:83], a[252:255], v[32:35], v[80:83]
  ds_read_b64_tr_b16 a[198:199], v6 offset:43008
  v_mul_f32_e32 v25, s25, v25
  v_mfma_f32_16x16x32_bf16 v[84:87], a[252:255], v[36:39], v[84:87]
  v_exp_f32_e32 v24, v24
  v_mfma_f32_16x16x32_bf16 v[88:91], a[252:255], v[40:43], v[88:91]
  v_mul_f32_e32 v26, s25, v26
  v_mul_f32_e32 v27, s25, v27
  v_mfma_f32_16x16x32_bf16 v[28:31], a[144:147], a[48:51], 0
  s_add_u32 m0, s27, 98816
  v_exp_f32_e32 v25, v25
  v_mfma_f32_16x16x32_bf16 v[28:31], a[148:151], a[52:55], v[28:31]
  buffer_load_dwordx4 v7, s[8:11], s46 offen offset:0 nt lds
  v_mfma_f32_16x16x32_bf16 v[28:31], a[152:155], a[56:59], v[28:31]
  v_exp_f32_e32 v26, v26
  v_mfma_f32_16x16x32_bf16 v[28:31], a[156:159], a[60:63], v[28:31]
  ds_read_b128 a[184:187], v1 offset:18688
  v_cvt_pk_bf16_f32 v52, v24, v25
  v_mfma_f32_16x16x32_bf16 v[28:31], a[160:163], a[64:67], v[28:31]
  v_exp_f32_e32 v27, v27
  v_mfma_f32_16x16x32_bf16 v[28:31], a[164:167], a[68:71], v[28:31]
  ds_read_b64_tr_b16 a[200:201], v3 offset:36992
  v_cvt_pk_bf16_f32 v53, v26, v27
  v_mfma_f32_16x16x32_bf16 v[92:95], a[252:255], v[44:47], v[92:95]
  s_waitcnt lgkmcnt(2)
  ds_read_b64_tr_b16 a[202:203], v3 offset:43136
  v_mfma_f32_16x16x32_bf16 v[96:99], a[192:195], v[32:35], v[96:99]
  v_mfma_f32_16x16x32_bf16 v[100:103], a[192:195], v[36:39], v[100:103]
  v_mfma_f32_16x16x32_bf16 v[104:107], a[192:195], v[40:43], v[104:107]
  buffer_load_dwordx4 v8, s[8:11], s46 offen offset:1024 nt lds
  v_mfma_f32_16x16x32_bf16 v[108:111], a[192:195], v[44:47], v[108:111]
  ds_read_b128 a[188:191], v2 offset:18688
  v_mul_f32_e32 v28, s25, v28
  v_mfma_f32_16x16x32_bf16 v[112:115], a[196:199], v[32:35], v[112:115]
  v_mul_f32_e32 v29, s25, v29
  v_mul_f32_e32 v30, s25, v30
  v_mfma_f32_16x16x32_bf16 v[20:23], a[144:147], a[72:75], 0
  v_exp_f32_e32 v28, v28
  v_mfma_f32_16x16x32_bf16 v[20:23], a[148:151], a[76:79], v[20:23]
  v_exp_f32_e32 v29, v29
  v_mfma_f32_16x16x32_bf16 v[20:23], a[152:155], a[80:83], v[20:23]
  ds_read_b64_tr_b16 a[204:205], v4 offset:36992
  v_mul_f32_e32 v31, s25, v31
  v_mfma_f32_16x16x32_bf16 v[20:23], a[156:159], a[84:87], v[20:23]
  v_exp_f32_e32 v30, v30
  v_mfma_f32_16x16x32_bf16 v[20:23], a[160:163], a[88:91], v[20:23]
  ds_read_b64_tr_b16 a[206:207], v4 offset:43136
  v_cvt_pk_bf16_f32 v56, v28, v29
  v_mfma_f32_16x16x32_bf16 v[20:23], a[164:167], a[92:95], v[20:23]
  buffer_load_dwordx4 v9, s[8:11], s46 offen offset:2048 nt lds
  v_mfma_f32_16x16x32_bf16 v[116:119], a[196:199], v[36:39], v[116:119]
  v_exp_f32_e32 v31, v31
  v_mfma_f32_16x16x32_bf16 v[120:123], a[196:199], v[40:43], v[120:123]
  ds_read_b64_tr_b16 a[232:233], v5 offset:36992
  v_cvt_pk_bf16_f32 v57, v30, v31
  v_mfma_f32_16x16x32_bf16 v[124:127], a[196:199], v[44:47], v[124:127]
  s_waitcnt lgkmcnt(3)
  ds_read_b128 a[144:147], v1 offset:24576
  ds_read_b64_tr_b16 a[234:235], v5 offset:43136
  v_mfma_f32_16x16x32_bf16 v[128:131], a[200:203], v[32:35], v[128:131]
  v_mul_f32_e32 v20, s25, v20
  v_mul_f32_e32 v21, s25, v21
  v_mfma_f32_16x16x32_bf16 v[132:135], a[200:203], v[36:39], v[132:135]
  v_exp_f32_e32 v20, v20
  v_mfma_f32_16x16x32_bf16 v[136:139], a[200:203], v[40:43], v[136:139]
  v_mul_f32_e32 v22, s25, v22
  v_mul_f32_e32 v23, s25, v23
  v_mfma_f32_16x16x32_bf16 v[24:27], a[168:171], a[0:3], 0
  v_exp_f32_e32 v21, v21
  v_mfma_f32_16x16x32_bf16 v[24:27], a[172:175], a[4:7], v[24:27]
  v_exp_f32_e32 v22, v22
  v_mfma_f32_16x16x32_bf16 v[24:27], a[176:179], a[8:11], v[24:27]
  ds_read_b128 a[148:151], v2 offset:24576
  v_cvt_pk_bf16_f32 v60, v20, v21
  v_mfma_f32_16x16x32_bf16 v[24:27], a[180:183], a[12:15], v[24:27]
  v_exp_f32_e32 v23, v23
  v_mfma_f32_16x16x32_bf16 v[24:27], a[184:187], a[16:19], v[24:27]
  ds_read_b64_tr_b16 a[236:237], v6 offset:36992
  v_cvt_pk_bf16_f32 v61, v22, v23
  v_mfma_f32_16x16x32_bf16 v[24:27], a[188:191], a[20:23], v[24:27]
  v_mfma_f32_16x16x32_bf16 v[140:143], a[200:203], v[44:47], v[140:143]
  s_waitcnt lgkmcnt(2)
  ds_read_b64_tr_b16 a[238:239], v6 offset:43136
  v_mfma_f32_16x16x32_bf16 v[144:147], a[204:207], v[32:35], v[144:147]
  v_mfma_f32_16x16x32_bf16 v[148:151], a[204:207], v[36:39], v[148:151]
  v_mfma_f32_16x16x32_bf16 v[152:155], a[204:207], v[40:43], v[152:155]
  s_nop 1
  v_mul_f32_e32 v24, s25, v24
  v_mul_f32_e32 v25, s25, v25
  v_mfma_f32_16x16x32_bf16 v[156:159], a[204:207], v[44:47], v[156:159]
  v_exp_f32_e32 v24, v24
  v_mfma_f32_16x16x32_bf16 v[160:163], a[232:235], v[32:35], v[160:163]
  ds_read_b128 a[152:155], v1 offset:24704
  v_mul_f32_e32 v26, s25, v26
  v_mfma_f32_16x16x32_bf16 v[28:31], a[168:171], a[24:27], 0
  v_exp_f32_e32 v25, v25
  v_mfma_f32_16x16x32_bf16 v[28:31], a[172:175], a[28:31], v[28:31]
  ds_read_b64_tr_b16 a[240:241], v3 offset:37120
  v_mul_f32_e32 v27, s25, v27
  v_mfma_f32_16x16x32_bf16 v[28:31], a[176:179], a[32:35], v[28:31]
  v_exp_f32_e32 v26, v26
  v_mfma_f32_16x16x32_bf16 v[28:31], a[180:183], a[36:39], v[28:31]
  v_exp_f32_e32 v27, v27
  v_mfma_f32_16x16x32_bf16 v[28:31], a[184:187], a[40:43], v[28:31]
  ds_read_b64_tr_b16 a[242:243], v3 offset:43264
  v_cvt_pk_bf16_f32 v50, v24, v25
  v_mfma_f32_16x16x32_bf16 v[28:31], a[188:191], a[44:47], v[28:31]
  ds_read_b64_tr_b16 a[244:245], v4 offset:37120
  v_cvt_pk_bf16_f32 v51, v26, v27
  v_mfma_f32_16x16x32_bf16 v[164:167], a[232:235], v[36:39], v[164:167]
  ds_read_b128 a[156:159], v2 offset:24704
  v_mfma_f32_16x16x32_bf16 v[168:171], a[232:235], v[40:43], v[168:171]
  v_mfma_f32_16x16x32_bf16 v[172:175], a[232:235], v[44:47], v[172:175]
  s_waitcnt lgkmcnt(4)
  ds_read_b64_tr_b16 a[246:247], v4 offset:43264
  v_mfma_f32_16x16x32_bf16 v[176:179], a[236:239], v[32:35], v[176:179]
  v_mul_f32_e32 v28, s25, v28
  v_mul_f32_e32 v29, s25, v29
  v_mfma_f32_16x16x32_bf16 v[180:183], a[236:239], v[36:39], v[180:183]
  v_exp_f32_e32 v28, v28
  v_mfma_f32_16x16x32_bf16 v[184:187], a[236:239], v[40:43], v[184:187]
  v_mul_f32_e32 v30, s25, v30
  v_mul_f32_e32 v31, s25, v31
  v_mfma_f32_16x16x32_bf16 v[188:191], a[236:239], v[44:47], v[188:191]
  v_exp_f32_e32 v29, v29
  v_mfma_f32_16x16x32_bf16 v[20:23], a[168:171], a[48:51], 0
  v_exp_f32_e32 v30, v30
  v_mfma_f32_16x16x32_bf16 v[20:23], a[172:175], a[52:55], v[20:23]
  ds_read_b128 a[160:163], v1 offset:24832
  v_cvt_pk_bf16_f32 v54, v28, v29
  v_mfma_f32_16x16x32_bf16 v[20:23], a[176:179], a[56:59], v[20:23]
  v_exp_f32_e32 v31, v31
  v_mfma_f32_16x16x32_bf16 v[20:23], a[180:183], a[60:63], v[20:23]
  ds_read_b64_tr_b16 a[248:249], v5 offset:37120
  v_cvt_pk_bf16_f32 v55, v30, v31
  v_mfma_f32_16x16x32_bf16 v[20:23], a[184:187], a[64:67], v[20:23]
  v_mfma_f32_16x16x32_bf16 v[20:23], a[188:191], a[68:71], v[20:23]
  s_waitcnt lgkmcnt(2)
  ds_read_b64_tr_b16 a[250:251], v5 offset:43264
  v_mfma_f32_16x16x32_bf16 v[192:195], a[240:243], v[32:35], v[192:195]
  v_mfma_f32_16x16x32_bf16 v[196:199], a[240:243], v[36:39], v[196:199]
  v_mfma_f32_16x16x32_bf16 v[200:203], a[240:243], v[40:43], v[200:203]
  v_mfma_f32_16x16x32_bf16 v[204:207], a[240:243], v[44:47], v[204:207]
  ds_read_b128 a[164:167], v2 offset:24832
  s_nop 0
  v_mul_f32_e32 v20, s25, v20
  v_mfma_f32_16x16x32_bf16 v[208:211], a[244:247], v[32:35], v[208:211]
  v_mul_f32_e32 v21, s25, v21
  v_mul_f32_e32 v22, s25, v22
  v_mfma_f32_16x16x32_bf16 v[212:215], a[244:247], v[36:39], v[212:215]
  v_exp_f32_e32 v20, v20
  v_mfma_f32_16x16x32_bf16 v[24:27], a[168:171], a[72:75], 0
  v_exp_f32_e32 v21, v21
  v_mfma_f32_16x16x32_bf16 v[24:27], a[172:175], a[76:79], v[24:27]
  ds_read_b64_tr_b16 a[252:253], v6 offset:37120
  v_mul_f32_e32 v23, s25, v23
  v_mfma_f32_16x16x32_bf16 v[24:27], a[176:179], a[80:83], v[24:27]
  v_exp_f32_e32 v22, v22
  v_mfma_f32_16x16x32_bf16 v[24:27], a[180:183], a[84:87], v[24:27]
  ds_read_b64_tr_b16 a[254:255], v6 offset:43264
  v_cvt_pk_bf16_f32 v58, v20, v21
  v_mfma_f32_16x16x32_bf16 v[24:27], a[184:187], a[88:91], v[24:27]
  v_exp_f32_e32 v23, v23
  v_mfma_f32_16x16x32_bf16 v[24:27], a[188:191], a[92:95], v[24:27]
  v_cvt_pk_bf16_f32 v59, v22, v23
  v_mfma_f32_16x16x32_bf16 v[216:219], a[244:247], v[40:43], v[216:219]
  ds_read_b128 a[168:171], v1 offset:30720
  v_mfma_f32_16x16x32_bf16 v[220:223], a[244:247], v[44:47], v[220:223]
  s_waitcnt lgkmcnt(3)
  v_mfma_f32_16x16x32_bf16 v[224:227], a[248:251], v[32:35], v[224:227]
  s_waitcnt vmcnt(6)
  s_barrier
  v_mfma_f32_16x16x32_bf16 v[228:231], a[248:251], v[36:39], v[228:231]
  v_mul_f32_e32 v24, s25, v24
  v_mul_f32_e32 v25, s25, v25
  v_mfma_f32_16x16x32_bf16 v[232:235], a[248:251], v[40:43], v[232:235]
  v_exp_f32_e32 v24, v24
  v_mfma_f32_16x16x32_bf16 v[236:239], a[248:251], v[44:47], v[236:239]
  ds_read_b64_tr_b16 a[192:193], v3 offset:49152
  v_mul_f32_e32 v26, s25, v26
  v_mfma_f32_16x16x32_bf16 v[28:31], a[144:147], a[0:3], 0
  v_exp_f32_e32 v25, v25
  v_mfma_f32_16x16x32_bf16 v[28:31], a[148:151], a[4:7], v[28:31]
  s_add_u32 m0, s27, 123392
  v_mul_f32_e32 v27, s25, v27
  v_cvt_pk_bf16_f32 v62, v24, v25
  v_mfma_f32_16x16x32_bf16 v[28:31], a[152:155], a[8:11], v[28:31]
  buffer_load_dwordx4 v7, s[12:15], s45 offen offset:0 nt lds
  v_mfma_f32_16x16x32_bf16 v[28:31], a[156:159], a[12:15], v[28:31]
  v_exp_f32_e32 v26, v26
  v_mfma_f32_16x16x32_bf16 v[28:31], a[160:163], a[16:19], v[28:31]
  ds_read_b128 a[172:175], v2 offset:30720
  ds_read_b64_tr_b16 a[194:195], v3 offset:55296
  v_mfma_f32_16x16x32_bf16 v[28:31], a[164:167], a[20:23], v[28:31]
  s_waitcnt lgkmcnt(3)
  v_exp_f32_e32 v27, v27
  v_mfma_f32_16x16x32_bf16 v[240:243], a[252:255], v[32:35], v[240:243]
  ds_read_b64_tr_b16 a[196:197], v4 offset:49152
  v_cvt_pk_bf16_f32 v63, v26, v27
  v_mfma_f32_16x16x32_bf16 v[244:247], a[252:255], v[36:39], v[244:247]
  ds_read_b64_tr_b16 a[198:199], v4 offset:55296
  v_mfma_f32_16x16x32_bf16 v[248:251], a[252:255], v[40:43], v[248:251]
  v_mfma_f32_16x16x32_bf16 v[252:255], a[252:255], v[44:47], v[252:255]
  v_mul_f32_e32 v28, s25, v28
  v_mul_f32_e32 v29, s25, v29
  v_smfmac_f32_16x16x64_bf16 a[208:211], a[224:227], v[48:55], v0
  ds_read_b128 a[176:179], v1 offset:30848
  v_smfmac_f32_16x16x64_bf16 a[212:215], a[224:227], v[56:63], v0
  v_mul_f32_e32 v30, s25, v30
  v_mfma_f32_16x16x32_bf16 v[20:23], a[144:147], a[24:27], 0
  buffer_load_dwordx4 v8, s[12:15], s45 offen offset:1024 nt lds
  v_mfma_f32_16x16x32_bf16 v[20:23], a[148:151], a[28:31], v[20:23]
  v_exp_f32_e32 v28, v28
  v_mfma_f32_16x16x32_bf16 v[20:23], a[152:155], a[32:35], v[20:23]
  v_exp_f32_e32 v29, v29
  v_mfma_f32_16x16x32_bf16 v[20:23], a[156:159], a[36:39], v[20:23]
  ds_read_b64_tr_b16 a[200:201], v5 offset:49152
  v_mul_f32_e32 v31, s25, v31
  v_mfma_f32_16x16x32_bf16 v[20:23], a[160:163], a[40:43], v[20:23]
  v_exp_f32_e32 v30, v30
  v_mfma_f32_16x16x32_bf16 v[20:23], a[164:167], a[44:47], v[20:23]
  s_waitcnt lgkmcnt(2)
  ds_read_b64_tr_b16 a[202:203], v5 offset:55296
  v_cvt_pk_bf16_f32 v32, v28, v29
  v_mfma_f32_16x16x32_bf16 v[64:67], a[192:195], v[48:51], v[64:67]
  v_exp_f32_e32 v31, v31
  v_mfma_f32_16x16x32_bf16 v[68:71], a[192:195], v[52:55], v[68:71]
  buffer_load_dwordx4 v9, s[12:15], s45 offen offset:2048 nt lds
  v_mfma_f32_16x16x32_bf16 v[72:75], a[192:195], v[56:59], v[72:75]
  ds_read_b64_tr_b16 a[204:205], v6 offset:49152
  v_cvt_pk_bf16_f32 v33, v30, v31
  v_mfma_f32_16x16x32_bf16 v[76:79], a[192:195], v[60:63], v[76:79]
  ds_read_b128 a[180:183], v2 offset:30848
  v_mul_f32_e32 v20, s25, v20
  v_mfma_f32_16x16x32_bf16 v[80:83], a[196:199], v[48:51], v[80:83]
  ds_read_b64_tr_b16 a[206:207], v6 offset:55296
  v_mul_f32_e32 v21, s25, v21
  v_mfma_f32_16x16x32_bf16 v[84:87], a[196:199], v[52:55], v[84:87]
  v_exp_f32_e32 v20, v20
  v_mfma_f32_16x16x32_bf16 v[88:91], a[196:199], v[56:59], v[88:91]
  v_mul_f32_e32 v22, s25, v22
  v_mul_f32_e32 v23, s25, v23
  v_mfma_f32_16x16x32_bf16 v[24:27], a[144:147], a[48:51], 0
  s_add_u32 m0, s27, 49664
  v_exp_f32_e32 v21, v21
  v_mfma_f32_16x16x32_bf16 v[24:27], a[148:151], a[52:55], v[24:27]
  buffer_load_dwordx4 v7, s[8:11], s47 offen offset:0 nt lds
  v_mfma_f32_16x16x32_bf16 v[24:27], a[152:155], a[56:59], v[24:27]
  v_exp_f32_e32 v22, v22
  v_mfma_f32_16x16x32_bf16 v[24:27], a[156:159], a[60:63], v[24:27]
  ds_read_b128 a[184:187], v1 offset:30976
  v_cvt_pk_bf16_f32 v36, v20, v21
  v_mfma_f32_16x16x32_bf16 v[24:27], a[160:163], a[64:67], v[24:27]
  v_exp_f32_e32 v23, v23
  v_mfma_f32_16x16x32_bf16 v[24:27], a[164:167], a[68:71], v[24:27]
  ds_read_b64_tr_b16 a[232:233], v3 offset:49280
  v_cvt_pk_bf16_f32 v37, v22, v23
  v_mfma_f32_16x16x32_bf16 v[92:95], a[196:199], v[60:63], v[92:95]
  s_waitcnt lgkmcnt(2)
  ds_read_b64_tr_b16 a[234:235], v3 offset:55424
  v_mfma_f32_16x16x32_bf16 v[96:99], a[200:203], v[48:51], v[96:99]
  v_mfma_f32_16x16x32_bf16 v[100:103], a[200:203], v[52:55], v[100:103]
  v_mfma_f32_16x16x32_bf16 v[104:107], a[200:203], v[56:59], v[104:107]
  buffer_load_dwordx4 v8, s[8:11], s47 offen offset:1024 nt lds
  v_mfma_f32_16x16x32_bf16 v[108:111], a[200:203], v[60:63], v[108:111]
  ds_read_b128 a[188:191], v2 offset:30976
  v_mul_f32_e32 v24, s25, v24
  v_mfma_f32_16x16x32_bf16 v[112:115], a[204:207], v[48:51], v[112:115]
  v_mul_f32_e32 v25, s25, v25
  v_mul_f32_e32 v26, s25, v26
  v_mfma_f32_16x16x32_bf16 v[28:31], a[144:147], a[72:75], 0
  v_exp_f32_e32 v24, v24
  v_mfma_f32_16x16x32_bf16 v[28:31], a[148:151], a[76:79], v[28:31]
  v_exp_f32_e32 v25, v25
  v_mfma_f32_16x16x32_bf16 v[28:31], a[152:155], a[80:83], v[28:31]
  ds_read_b64_tr_b16 a[236:237], v4 offset:49280
  v_mul_f32_e32 v27, s25, v27
  v_mfma_f32_16x16x32_bf16 v[28:31], a[156:159], a[84:87], v[28:31]
  v_exp_f32_e32 v26, v26
  v_mfma_f32_16x16x32_bf16 v[28:31], a[160:163], a[88:91], v[28:31]
  ds_read_b64_tr_b16 a[238:239], v4 offset:55424
  v_cvt_pk_bf16_f32 v40, v24, v25
  v_mfma_f32_16x16x32_bf16 v[28:31], a[164:167], a[92:95], v[28:31]
  buffer_load_dwordx4 v9, s[8:11], s47 offen offset:2048 nt lds
  v_mfma_f32_16x16x32_bf16 v[116:119], a[204:207], v[52:55], v[116:119]
  v_exp_f32_e32 v27, v27
  v_mfma_f32_16x16x32_bf16 v[120:123], a[204:207], v[56:59], v[120:123]
  ds_read_b64_tr_b16 a[240:241], v5 offset:49280
  v_cvt_pk_bf16_f32 v41, v26, v27
  v_mfma_f32_16x16x32_bf16 v[124:127], a[204:207], v[60:63], v[124:127]
  s_waitcnt lgkmcnt(3)
  ds_read_b128 a[144:147], v1 offset:36864
  ds_read_b64_tr_b16 a[242:243], v5 offset:55424
  v_mfma_f32_16x16x32_bf16 v[128:131], a[232:235], v[48:51], v[128:131]
  v_mul_f32_e32 v28, s25, v28
  v_mul_f32_e32 v29, s25, v29
  v_mfma_f32_16x16x32_bf16 v[132:135], a[232:235], v[52:55], v[132:135]
  v_exp_f32_e32 v28, v28
  v_mfma_f32_16x16x32_bf16 v[136:139], a[232:235], v[56:59], v[136:139]
  s_add_u32 m0, s27, 0
  v_mul_f32_e32 v30, s25, v30
  v_mul_f32_e32 v31, s25, v31
  v_mfma_f32_16x16x32_bf16 v[20:23], a[168:171], a[0:3], 0
  s_add_u32 s33, s32, 196608
  v_exp_f32_e32 v29, v29
  v_mfma_f32_16x16x32_bf16 v[20:23], a[172:175], a[4:7], v[20:23]
  buffer_load_dwordx4 v7, s[16:19], s33 offen offset:0 nt lds
  v_mfma_f32_16x16x32_bf16 v[20:23], a[176:179], a[8:11], v[20:23]
  v_exp_f32_e32 v30, v30
  v_mfma_f32_16x16x32_bf16 v[20:23], a[180:183], a[12:15], v[20:23]
  ds_read_b128 a[148:151], v2 offset:36864
  v_cvt_pk_bf16_f32 v44, v28, v29
  v_mfma_f32_16x16x32_bf16 v[20:23], a[184:187], a[16:19], v[20:23]
  v_exp_f32_e32 v31, v31
  v_mfma_f32_16x16x32_bf16 v[20:23], a[188:191], a[20:23], v[20:23]
  ds_read_b64_tr_b16 a[244:245], v6 offset:49280
  v_cvt_pk_bf16_f32 v45, v30, v31
  v_mfma_f32_16x16x32_bf16 v[140:143], a[232:235], v[60:63], v[140:143]
  s_waitcnt lgkmcnt(2)
  ds_read_b64_tr_b16 a[246:247], v6 offset:55424
  v_mfma_f32_16x16x32_bf16 v[144:147], a[236:239], v[48:51], v[144:147]
  v_mfma_f32_16x16x32_bf16 v[148:151], a[236:239], v[52:55], v[148:151]
  v_mfma_f32_16x16x32_bf16 v[152:155], a[236:239], v[56:59], v[152:155]
  v_mul_f32_e32 v20, s25, v20
  v_mul_f32_e32 v21, s25, v21
  v_mfma_f32_16x16x32_bf16 v[156:159], a[236:239], v[60:63], v[156:159]
  v_exp_f32_e32 v20, v20
  v_mfma_f32_16x16x32_bf16 v[160:163], a[240:243], v[48:51], v[160:163]
  ds_read_b128 a[152:155], v1 offset:36992
  v_mul_f32_e32 v22, s25, v22
  v_mfma_f32_16x16x32_bf16 v[24:27], a[168:171], a[24:27], 0
  v_exp_f32_e32 v21, v21
  v_mfma_f32_16x16x32_bf16 v[24:27], a[172:175], a[28:31], v[24:27]
  ds_read_b64_tr_b16 a[248:249], v3 offset:49408
  v_mul_f32_e32 v23, s25, v23
  v_mfma_f32_16x16x32_bf16 v[24:27], a[176:179], a[32:35], v[24:27]
  v_exp_f32_e32 v22, v22
  v_mfma_f32_16x16x32_bf16 v[24:27], a[180:183], a[36:39], v[24:27]
  v_exp_f32_e32 v23, v23
  v_mfma_f32_16x16x32_bf16 v[24:27], a[184:187], a[40:43], v[24:27]
  ds_read_b64_tr_b16 a[250:251], v3 offset:55552
  v_cvt_pk_bf16_f32 v34, v20, v21
  v_mfma_f32_16x16x32_bf16 v[24:27], a[188:191], a[44:47], v[24:27]
  ds_read_b64_tr_b16 a[252:253], v4 offset:49408
  v_cvt_pk_bf16_f32 v35, v22, v23
  v_mfma_f32_16x16x32_bf16 v[164:167], a[240:243], v[52:55], v[164:167]
  ds_read_b128 a[156:159], v2 offset:36992
  v_mfma_f32_16x16x32_bf16 v[168:171], a[240:243], v[56:59], v[168:171]
  v_mfma_f32_16x16x32_bf16 v[172:175], a[240:243], v[60:63], v[172:175]
  s_waitcnt lgkmcnt(4)
  ds_read_b64_tr_b16 a[254:255], v4 offset:55552
  v_mfma_f32_16x16x32_bf16 v[176:179], a[244:247], v[48:51], v[176:179]
  v_mul_f32_e32 v24, s25, v24
  v_mul_f32_e32 v25, s25, v25
  v_mfma_f32_16x16x32_bf16 v[180:183], a[244:247], v[52:55], v[180:183]
  v_exp_f32_e32 v24, v24
  v_mfma_f32_16x16x32_bf16 v[184:187], a[244:247], v[56:59], v[184:187]
  v_mul_f32_e32 v26, s25, v26
  v_mul_f32_e32 v27, s25, v27
  v_mfma_f32_16x16x32_bf16 v[188:191], a[244:247], v[60:63], v[188:191]
  v_exp_f32_e32 v25, v25
  v_mfma_f32_16x16x32_bf16 v[28:31], a[168:171], a[48:51], 0
  v_exp_f32_e32 v26, v26
  v_mfma_f32_16x16x32_bf16 v[28:31], a[172:175], a[52:55], v[28:31]
  ds_read_b128 a[160:163], v1 offset:37120
  v_cvt_pk_bf16_f32 v38, v24, v25
  v_mfma_f32_16x16x32_bf16 v[28:31], a[176:179], a[56:59], v[28:31]
  v_exp_f32_e32 v27, v27
  v_mfma_f32_16x16x32_bf16 v[28:31], a[180:183], a[60:63], v[28:31]
  ds_read_b64_tr_b16 a[192:193], v5 offset:49408
  v_cvt_pk_bf16_f32 v39, v26, v27
  v_mfma_f32_16x16x32_bf16 v[28:31], a[184:187], a[64:67], v[28:31]
  v_mfma_f32_16x16x32_bf16 v[28:31], a[188:191], a[68:71], v[28:31]
  s_waitcnt lgkmcnt(2)
  ds_read_b64_tr_b16 a[194:195], v5 offset:55552
  v_mfma_f32_16x16x32_bf16 v[192:195], a[248:251], v[48:51], v[192:195]
  v_mfma_f32_16x16x32_bf16 v[196:199], a[248:251], v[52:55], v[196:199]
  v_mfma_f32_16x16x32_bf16 v[200:203], a[248:251], v[56:59], v[200:203]
  v_mfma_f32_16x16x32_bf16 v[204:207], a[248:251], v[60:63], v[204:207]
  ds_read_b128 a[164:167], v2 offset:37120
  s_nop 0
  v_mul_f32_e32 v28, s25, v28
  v_mfma_f32_16x16x32_bf16 v[208:211], a[252:255], v[48:51], v[208:211]
L_tr1:
  s_cbranch_execz L_tr5
  v_mul_f32_e32 v29, s25, v29
  v_mul_f32_e32 v30, s25, v30
  v_mfma_f32_16x16x32_bf16 v[212:215], a[252:255], v[52:55], v[212:215]
  v_exp_f32_e32 v28, v28
  v_mfma_f32_16x16x32_bf16 v[20:23], a[168:171], a[72:75], 0
  v_exp_f32_e32 v29, v29
  v_mfma_f32_16x16x32_bf16 v[20:23], a[172:175], a[76:79], v[20:23]
  ds_read_b64_tr_b16 a[196:197], v6 offset:49408
  v_mul_f32_e32 v31, s25, v31
  v_mfma_f32_16x16x32_bf16 v[20:23], a[176:179], a[80:83], v[20:23]
  v_exp_f32_e32 v30, v30
  v_mfma_f32_16x16x32_bf16 v[20:23], a[180:183], a[84:87], v[20:23]
  ds_read_b64_tr_b16 a[198:199], v6 offset:55552
  v_cvt_pk_bf16_f32 v42, v28, v29
  v_mfma_f32_16x16x32_bf16 v[20:23], a[184:187], a[88:91], v[20:23]
  v_exp_f32_e32 v31, v31
  v_mfma_f32_16x16x32_bf16 v[20:23], a[188:191], a[92:95], v[20:23]
  v_cvt_pk_bf16_f32 v43, v30, v31
  v_mfma_f32_16x16x32_bf16 v[216:219], a[252:255], v[56:59], v[216:219]
  ds_read_b128 a[168:171], v1 offset:43008
  v_mfma_f32_16x16x32_bf16 v[220:223], a[252:255], v[60:63], v[220:223]
  s_waitcnt lgkmcnt(3)
  v_mfma_f32_16x16x32_bf16 v[224:227], a[192:195], v[48:51], v[224:227]
  s_waitcnt vmcnt(7)
  s_barrier
  v_mfma_f32_16x16x32_bf16 v[228:231], a[192:195], v[52:55], v[228:231]
  v_mul_f32_e32 v20, s25, v20
  v_mul_f32_e32 v21, s25, v21
  v_mfma_f32_16x16x32_bf16 v[232:235], a[192:195], v[56:59], v[232:235]
  v_exp_f32_e32 v20, v20
  v_mfma_f32_16x16x32_bf16 v[236:239], a[192:195], v[60:63], v[236:239]
  ds_read_b64_tr_b16 a[200:201], v3 offset:12288
  v_mul_f32_e32 v22, s25, v22
  v_mfma_f32_16x16x32_bf16 v[24:27], a[144:147], a[0:3], 0
  v_exp_f32_e32 v21, v21
  v_mfma_f32_16x16x32_bf16 v[24:27], a[148:151], a[4:7], v[24:27]
  s_add_u32 m0, s27, 135680
  v_mul_f32_e32 v23, s25, v23
  v_cvt_pk_bf16_f32 v46, v20, v21
  v_mfma_f32_16x16x32_bf16 v[24:27], a[152:155], a[8:11], v[24:27]
  buffer_load_dwordx4 v7, s[12:15], s46 offen offset:0 nt lds
  v_mfma_f32_16x16x32_bf16 v[24:27], a[156:159], a[12:15], v[24:27]
  v_exp_f32_e32 v22, v22
  v_mfma_f32_16x16x32_bf16 v[24:27], a[160:163], a[16:19], v[24:27]
  ds_read_b128 a[172:175], v2 offset:43008
  ds_read_b64_tr_b16 a[202:203], v3 offset:18432
  v_mfma_f32_16x16x32_bf16 v[24:27], a[164:167], a[20:23], v[24:27]
  s_waitcnt lgkmcnt(3)
  v_exp_f32_e32 v23, v23
  v_mfma_f32_16x16x32_bf16 v[240:243], a[196:199], v[48:51], v[240:243]
  ds_read_b64_tr_b16 a[204:205], v4 offset:12288
  v_cvt_pk_bf16_f32 v47, v22, v23
  v_mfma_f32_16x16x32_bf16 v[244:247], a[196:199], v[52:55], v[244:247]
  ds_read_b64_tr_b16 a[206:207], v4 offset:18432
  v_mfma_f32_16x16x32_bf16 v[248:251], a[196:199], v[56:59], v[248:251]
  v_mfma_f32_16x16x32_bf16 v[252:255], a[196:199], v[60:63], v[252:255]
  v_mul_f32_e32 v24, s25, v24
  v_mul_f32_e32 v25, s25, v25
  v_smfmac_f32_16x16x64_bf16 a[208:211], a[224:227], v[32:39], v0
  ds_read_b128 a[176:179], v1 offset:43136
  v_smfmac_f32_16x16x64_bf16 a[212:215], a[224:227], v[40:47], v0
  v_mul_f32_e32 v26, s25, v26
  v_mfma_f32_16x16x32_bf16 v[28:31], a[144:147], a[24:27], 0
  buffer_load_dwordx4 v8, s[12:15], s46 offen offset:1024 nt lds
  v_mfma_f32_16x16x32_bf16 v[28:31], a[148:151], a[28:31], v[28:31]
  v_exp_f32_e32 v24, v24
  v_mfma_f32_16x16x32_bf16 v[28:31], a[152:155], a[32:35], v[28:31]
  v_exp_f32_e32 v25, v25
  v_mfma_f32_16x16x32_bf16 v[28:31], a[156:159], a[36:39], v[28:31]
  ds_read_b64_tr_b16 a[232:233], v5 offset:12288
  v_mul_f32_e32 v27, s25, v27
  v_mfma_f32_16x16x32_bf16 v[28:31], a[160:163], a[40:43], v[28:31]
  v_exp_f32_e32 v26, v26
  v_mfma_f32_16x16x32_bf16 v[28:31], a[164:167], a[44:47], v[28:31]
  s_waitcnt lgkmcnt(2)
  ds_read_b64_tr_b16 a[234:235], v5 offset:18432
  v_cvt_pk_bf16_f32 v48, v24, v25
  v_mfma_f32_16x16x32_bf16 v[64:67], a[200:203], v[32:35], v[64:67]
  v_exp_f32_e32 v27, v27
  v_mfma_f32_16x16x32_bf16 v[68:71], a[200:203], v[36:39], v[68:71]
  buffer_load_dwordx4 v9, s[12:15], s46 offen offset:2048 nt lds
  v_mfma_f32_16x16x32_bf16 v[72:75], a[200:203], v[40:43], v[72:75]
  ds_read_b64_tr_b16 a[236:237], v6 offset:12288
  v_cvt_pk_bf16_f32 v49, v26, v27
  v_mfma_f32_16x16x32_bf16 v[76:79], a[200:203], v[44:47], v[76:79]
  ds_read_b128 a[180:183], v2 offset:43136
  v_mul_f32_e32 v28, s25, v28
  v_mfma_f32_16x16x32_bf16 v[80:83], a[204:207], v[32:35], v[80:83]
  ds_read_b64_tr_b16 a[238:239], v6 offset:18432
  v_mul_f32_e32 v29, s25, v29
  v_mfma_f32_16x16x32_bf16 v[84:87], a[204:207], v[36:39], v[84:87]
  v_exp_f32_e32 v28, v28
  v_mfma_f32_16x16x32_bf16 v[88:91], a[204:207], v[40:43], v[88:91]
  v_mul_f32_e32 v30, s25, v30
  v_mul_f32_e32 v31, s25, v31
  v_mfma_f32_16x16x32_bf16 v[20:23], a[144:147], a[48:51], 0
  s_add_u32 m0, s27, 61952
  v_exp_f32_e32 v29, v29
  v_mfma_f32_16x16x32_bf16 v[20:23], a[148:151], a[52:55], v[20:23]
  buffer_load_dwordx4 v7, s[8:11], s48 offen offset:0 nt lds
  v_mfma_f32_16x16x32_bf16 v[20:23], a[152:155], a[56:59], v[20:23]
  v_exp_f32_e32 v30, v30
  v_mfma_f32_16x16x32_bf16 v[20:23], a[156:159], a[60:63], v[20:23]
  ds_read_b128 a[184:187], v1 offset:43264
  v_cvt_pk_bf16_f32 v52, v28, v29
  v_mfma_f32_16x16x32_bf16 v[20:23], a[160:163], a[64:67], v[20:23]
  v_exp_f32_e32 v31, v31
  v_mfma_f32_16x16x32_bf16 v[20:23], a[164:167], a[68:71], v[20:23]
  ds_read_b64_tr_b16 a[240:241], v3 offset:12416
  v_cvt_pk_bf16_f32 v53, v30, v31
  v_mfma_f32_16x16x32_bf16 v[92:95], a[204:207], v[44:47], v[92:95]
  s_waitcnt lgkmcnt(2)
  ds_read_b64_tr_b16 a[242:243], v3 offset:18560
  v_mfma_f32_16x16x32_bf16 v[96:99], a[232:235], v[32:35], v[96:99]
  v_mfma_f32_16x16x32_bf16 v[100:103], a[232:235], v[36:39], v[100:103]
  v_mfma_f32_16x16x32_bf16 v[104:107], a[232:235], v[40:43], v[104:107]
  buffer_load_dwordx4 v8, s[8:11], s48 offen offset:1024 nt lds
  v_mfma_f32_16x16x32_bf16 v[108:111], a[232:235], v[44:47], v[108:111]
  ds_read_b128 a[188:191], v2 offset:43264
  v_mul_f32_e32 v20, s25, v20
  v_mfma_f32_16x16x32_bf16 v[112:115], a[236:239], v[32:35], v[112:115]
  v_mul_f32_e32 v21, s25, v21
  v_mul_f32_e32 v22, s25, v22
  v_mfma_f32_16x16x32_bf16 v[24:27], a[144:147], a[72:75], 0
  v_exp_f32_e32 v20, v20
  v_mfma_f32_16x16x32_bf16 v[24:27], a[148:151], a[76:79], v[24:27]
  v_exp_f32_e32 v21, v21
  v_mfma_f32_16x16x32_bf16 v[24:27], a[152:155], a[80:83], v[24:27]
  ds_read_b64_tr_b16 a[244:245], v4 offset:12416
  v_mul_f32_e32 v23, s25, v23
  v_mfma_f32_16x16x32_bf16 v[24:27], a[156:159], a[84:87], v[24:27]
  v_exp_f32_e32 v22, v22
  v_mfma_f32_16x16x32_bf16 v[24:27], a[160:163], a[88:91], v[24:27]
  ds_read_b64_tr_b16 a[246:247], v4 offset:18560
  v_cvt_pk_bf16_f32 v56, v20, v21
  v_mfma_f32_16x16x32_bf16 v[24:27], a[164:167], a[92:95], v[24:27]
  buffer_load_dwordx4 v9, s[8:11], s48 offen offset:2048 nt lds
  v_mfma_f32_16x16x32_bf16 v[116:119], a[236:239], v[36:39], v[116:119]
  v_exp_f32_e32 v23, v23
  v_mfma_f32_16x16x32_bf16 v[120:123], a[236:239], v[40:43], v[120:123]
  ds_read_b64_tr_b16 a[248:249], v5 offset:12416
  v_cvt_pk_bf16_f32 v57, v22, v23
  v_mfma_f32_16x16x32_bf16 v[124:127], a[236:239], v[44:47], v[124:127]
  s_waitcnt lgkmcnt(3)
  ds_read_b128 a[144:147], v1 offset:49152
  ds_read_b64_tr_b16 a[250:251], v5 offset:18560
  v_mfma_f32_16x16x32_bf16 v[128:131], a[240:243], v[32:35], v[128:131]
  v_mul_f32_e32 v24, s25, v24
  v_mul_f32_e32 v25, s25, v25
  v_mfma_f32_16x16x32_bf16 v[132:135], a[240:243], v[36:39], v[132:135]
  v_exp_f32_e32 v24, v24
  v_mfma_f32_16x16x32_bf16 v[136:139], a[240:243], v[40:43], v[136:139]
  s_add_u32 m0, s27, 0
  v_mul_f32_e32 v26, s25, v26
  v_mul_f32_e32 v27, s25, v27
  v_mfma_f32_16x16x32_bf16 v[28:31], a[168:171], a[0:3], 0
  s_add_u32 s33, s32, 196608
  v_exp_f32_e32 v25, v25
  v_mfma_f32_16x16x32_bf16 v[28:31], a[172:175], a[4:7], v[28:31]
  buffer_load_dwordx4 v8, s[16:19], s33 offen offset:1024 nt lds
  v_mfma_f32_16x16x32_bf16 v[28:31], a[176:179], a[8:11], v[28:31]
  v_exp_f32_e32 v26, v26
  v_mfma_f32_16x16x32_bf16 v[28:31], a[180:183], a[12:15], v[28:31]
  ds_read_b128 a[148:151], v2 offset:49152
  v_cvt_pk_bf16_f32 v60, v24, v25
  v_mfma_f32_16x16x32_bf16 v[28:31], a[184:187], a[16:19], v[28:31]
  v_exp_f32_e32 v27, v27
  v_mfma_f32_16x16x32_bf16 v[28:31], a[188:191], a[20:23], v[28:31]
  ds_read_b64_tr_b16 a[252:253], v6 offset:12416
  v_cvt_pk_bf16_f32 v61, v26, v27
  v_mfma_f32_16x16x32_bf16 v[140:143], a[240:243], v[44:47], v[140:143]
  s_waitcnt lgkmcnt(2)
  ds_read_b64_tr_b16 a[254:255], v6 offset:18560
  v_mfma_f32_16x16x32_bf16 v[144:147], a[244:247], v[32:35], v[144:147]
  v_mfma_f32_16x16x32_bf16 v[148:151], a[244:247], v[36:39], v[148:151]
  v_mfma_f32_16x16x32_bf16 v[152:155], a[244:247], v[40:43], v[152:155]
  buffer_load_dwordx4 v9, s[16:19], s33 offen offset:2048 nt lds
  v_mfma_f32_16x16x32_bf16 v[156:159], a[244:247], v[44:47], v[156:159]
  ds_read_b128 a[152:155], v1 offset:49280
  v_mul_f32_e32 v28, s25, v28
  v_mfma_f32_16x16x32_bf16 v[160:163], a[248:251], v[32:35], v[160:163]
  v_mul_f32_e32 v29, s25, v29
  v_mul_f32_e32 v30, s25, v30
  v_mfma_f32_16x16x32_bf16 v[20:23], a[168:171], a[24:27], 0
  v_exp_f32_e32 v28, v28
  v_mfma_f32_16x16x32_bf16 v[20:23], a[172:175], a[28:31], v[20:23]
  v_exp_f32_e32 v29, v29
  v_mfma_f32_16x16x32_bf16 v[20:23], a[176:179], a[32:35], v[20:23]
  ds_read_b64_tr_b16 a[192:193], v3 offset:12544
  v_mul_f32_e32 v31, s25, v31
  v_mfma_f32_16x16x32_bf16 v[20:23], a[180:183], a[36:39], v[20:23]
  v_exp_f32_e32 v30, v30
  v_mfma_f32_16x16x32_bf16 v[20:23], a[184:187], a[40:43], v[20:23]
  ds_read_b64_tr_b16 a[194:195], v3 offset:18688
  v_cvt_pk_bf16_f32 v50, v28, v29
  v_mfma_f32_16x16x32_bf16 v[20:23], a[188:191], a[44:47], v[20:23]
  v_exp_f32_e32 v31, v31
  v_mfma_f32_16x16x32_bf16 v[164:167], a[248:251], v[36:39], v[164:167]
  ds_read_b64_tr_b16 a[196:197], v4 offset:12544
  v_cvt_pk_bf16_f32 v51, v30, v31
  v_mfma_f32_16x16x32_bf16 v[168:171], a[248:251], v[40:43], v[168:171]
  ds_read_b128 a[156:159], v2 offset:49280
  v_mfma_f32_16x16x32_bf16 v[172:175], a[248:251], v[44:47], v[172:175]
  s_waitcnt lgkmcnt(4)
  ds_read_b64_tr_b16 a[198:199], v4 offset:18688
  v_mfma_f32_16x16x32_bf16 v[176:179], a[252:255], v[32:35], v[176:179]
  v_mul_f32_e32 v20, s25, v20
  v_mul_f32_e32 v21, s25, v21
  v_mfma_f32_16x16x32_bf16 v[180:183], a[252:255], v[36:39], v[180:183]
  v_exp_f32_e32 v20, v20
  v_mfma_f32_16x16x32_bf16 v[184:187], a[252:255], v[40:43], v[184:187]
  v_mul_f32_e32 v22, s25, v22
  v_mul_f32_e32 v23, s25, v23
  v_mfma_f32_16x16x32_bf16 v[188:191], a[252:255], v[44:47], v[188:191]
  v_exp_f32_e32 v21, v21
  v_mfma_f32_16x16x32_bf16 v[24:27], a[168:171], a[48:51], 0
  v_exp_f32_e32 v22, v22
  v_mfma_f32_16x16x32_bf16 v[24:27], a[172:175], a[52:55], v[24:27]
  ds_read_b128 a[160:163], v1 offset:49408
  v_cvt_pk_bf16_f32 v54, v20, v21
  v_mfma_f32_16x16x32_bf16 v[24:27], a[176:179], a[56:59], v[24:27]
  v_exp_f32_e32 v23, v23
  v_mfma_f32_16x16x32_bf16 v[24:27], a[180:183], a[60:63], v[24:27]
  ds_read_b64_tr_b16 a[200:201], v5 offset:12544
  v_cvt_pk_bf16_f32 v55, v22, v23
  v_mfma_f32_16x16x32_bf16 v[24:27], a[184:187], a[64:67], v[24:27]
  v_mfma_f32_16x16x32_bf16 v[24:27], a[188:191], a[68:71], v[24:27]
  s_waitcnt lgkmcnt(2)
  ds_read_b64_tr_b16 a[202:203], v5 offset:18688
  v_mfma_f32_16x16x32_bf16 v[192:195], a[192:195], v[32:35], v[192:195]
  v_mfma_f32_16x16x32_bf16 v[196:199], a[192:195], v[36:39], v[196:199]
  v_mfma_f32_16x16x32_bf16 v[200:203], a[192:195], v[40:43], v[200:203]
  v_mfma_f32_16x16x32_bf16 v[204:207], a[192:195], v[44:47], v[204:207]
  ds_read_b128 a[164:167], v2 offset:49408
  s_nop 0
  v_mul_f32_e32 v24, s25, v24
  v_mfma_f32_16x16x32_bf16 v[208:211], a[196:199], v[32:35], v[208:211]
  v_mul_f32_e32 v25, s25, v25
  v_mul_f32_e32 v26, s25, v26
  v_mfma_f32_16x16x32_bf16 v[212:215], a[196:199], v[36:39], v[212:215]
  v_exp_f32_e32 v24, v24
  v_mfma_f32_16x16x32_bf16 v[28:31], a[168:171], a[72:75], 0
  v_exp_f32_e32 v25, v25
  v_mfma_f32_16x16x32_bf16 v[28:31], a[172:175], a[76:79], v[28:31]
  ds_read_b64_tr_b16 a[204:205], v6 offset:12544
  v_mul_f32_e32 v27, s25, v27
  v_mfma_f32_16x16x32_bf16 v[28:31], a[176:179], a[80:83], v[28:31]
  v_exp_f32_e32 v26, v26
  v_mfma_f32_16x16x32_bf16 v[28:31], a[180:183], a[84:87], v[28:31]
  ds_read_b64_tr_b16 a[206:207], v6 offset:18688
  v_cvt_pk_bf16_f32 v58, v24, v25
  v_mfma_f32_16x16x32_bf16 v[28:31], a[184:187], a[88:91], v[28:31]
  v_exp_f32_e32 v27, v27
  v_mfma_f32_16x16x32_bf16 v[28:31], a[188:191], a[92:95], v[28:31]
  v_cvt_pk_bf16_f32 v59, v26, v27
  v_mfma_f32_16x16x32_bf16 v[216:219], a[196:199], v[40:43], v[216:219]
  ds_read_b128 a[168:171], v1 offset:55296
  v_mfma_f32_16x16x32_bf16 v[220:223], a[196:199], v[44:47], v[220:223]
  s_waitcnt lgkmcnt(3)
  v_mfma_f32_16x16x32_bf16 v[224:227], a[200:203], v[32:35], v[224:227]
  s_waitcnt vmcnt(9)
  s_barrier
  v_mfma_f32_16x16x32_bf16 v[228:231], a[200:203], v[36:39], v[228:231]
  v_mul_f32_e32 v28, s25, v28
  v_mul_f32_e32 v29, s25, v29
  v_mfma_f32_16x16x32_bf16 v[232:235], a[200:203], v[40:43], v[232:235]
  v_exp_f32_e32 v28, v28
  v_mfma_f32_16x16x32_bf16 v[236:239], a[200:203], v[44:47], v[236:239]
  ds_read_b64_tr_b16 a[232:233], v3 offset:24576
  v_mul_f32_e32 v30, s25, v30
  v_mfma_f32_16x16x32_bf16 v[20:23], a[144:147], a[0:3], 0
  v_exp_f32_e32 v29, v29
  v_mfma_f32_16x16x32_bf16 v[20:23], a[148:151], a[4:7], v[20:23]
  s_add_u32 m0, s27, 147968
  v_mul_f32_e32 v31, s25, v31
  v_cvt_pk_bf16_f32 v62, v28, v29
  v_mfma_f32_16x16x32_bf16 v[20:23], a[152:155], a[8:11], v[20:23]
  buffer_load_dwordx4 v7, s[12:15], s47 offen offset:0 nt lds
  v_mfma_f32_16x16x32_bf16 v[20:23], a[156:159], a[12:15], v[20:23]
  v_exp_f32_e32 v30, v30
  v_mfma_f32_16x16x32_bf16 v[20:23], a[160:163], a[16:19], v[20:23]
  ds_read_b128 a[172:175], v2 offset:55296
  ds_read_b64_tr_b16 a[234:235], v3 offset:30720
  v_mfma_f32_16x16x32_bf16 v[20:23], a[164:167], a[20:23], v[20:23]
  s_waitcnt lgkmcnt(3)
  v_exp_f32_e32 v31, v31
  v_mfma_f32_16x16x32_bf16 v[240:243], a[204:207], v[32:35], v[240:243]
  ds_read_b64_tr_b16 a[236:237], v4 offset:24576
  v_cvt_pk_bf16_f32 v63, v30, v31
  v_mfma_f32_16x16x32_bf16 v[244:247], a[204:207], v[36:39], v[244:247]
  ds_read_b64_tr_b16 a[238:239], v4 offset:30720
  v_mfma_f32_16x16x32_bf16 v[248:251], a[204:207], v[40:43], v[248:251]
  v_mfma_f32_16x16x32_bf16 v[252:255], a[204:207], v[44:47], v[252:255]
  v_mul_f32_e32 v20, s25, v20
  v_mul_f32_e32 v21, s25, v21
  v_smfmac_f32_16x16x64_bf16 a[208:211], a[224:227], v[48:55], v0
  ds_read_b128 a[176:179], v1 offset:55424
  v_smfmac_f32_16x16x64_bf16 a[212:215], a[224:227], v[56:63], v0
  v_mul_f32_e32 v22, s25, v22
  v_mfma_f32_16x16x32_bf16 v[24:27], a[144:147], a[24:27], 0
  buffer_load_dwordx4 v8, s[12:15], s47 offen offset:1024 nt lds
  v_mfma_f32_16x16x32_bf16 v[24:27], a[148:151], a[28:31], v[24:27]
  v_exp_f32_e32 v20, v20
  v_mfma_f32_16x16x32_bf16 v[24:27], a[152:155], a[32:35], v[24:27]
  v_exp_f32_e32 v21, v21
  v_mfma_f32_16x16x32_bf16 v[24:27], a[156:159], a[36:39], v[24:27]
  ds_read_b64_tr_b16 a[240:241], v5 offset:24576
  v_mul_f32_e32 v23, s25, v23
  v_mfma_f32_16x16x32_bf16 v[24:27], a[160:163], a[40:43], v[24:27]
  v_exp_f32_e32 v22, v22
  v_mfma_f32_16x16x32_bf16 v[24:27], a[164:167], a[44:47], v[24:27]
  s_waitcnt lgkmcnt(2)
  ds_read_b64_tr_b16 a[242:243], v5 offset:30720
  v_cvt_pk_bf16_f32 v32, v20, v21
  v_mfma_f32_16x16x32_bf16 v[64:67], a[232:235], v[48:51], v[64:67]
  v_exp_f32_e32 v23, v23
  v_mfma_f32_16x16x32_bf16 v[68:71], a[232:235], v[52:55], v[68:71]
  buffer_load_dwordx4 v9, s[12:15], s47 offen offset:2048 nt lds
  v_mfma_f32_16x16x32_bf16 v[72:75], a[232:235], v[56:59], v[72:75]
  ds_read_b64_tr_b16 a[244:245], v6 offset:24576
  v_cvt_pk_bf16_f32 v33, v22, v23
  v_mfma_f32_16x16x32_bf16 v[76:79], a[232:235], v[60:63], v[76:79]
  ds_read_b128 a[180:183], v2 offset:55424
  v_mul_f32_e32 v24, s25, v24
  v_mfma_f32_16x16x32_bf16 v[80:83], a[236:239], v[48:51], v[80:83]
  ds_read_b64_tr_b16 a[246:247], v6 offset:30720
  v_mul_f32_e32 v25, s25, v25
  v_mfma_f32_16x16x32_bf16 v[84:87], a[236:239], v[52:55], v[84:87]
  v_exp_f32_e32 v24, v24
  v_mfma_f32_16x16x32_bf16 v[88:91], a[236:239], v[56:59], v[88:91]
  v_mul_f32_e32 v26, s25, v26
  v_mul_f32_e32 v27, s25, v27
  v_mfma_f32_16x16x32_bf16 v[28:31], a[144:147], a[48:51], 0
  s_add_u32 m0, s27, 74240
  v_exp_f32_e32 v25, v25
  v_mfma_f32_16x16x32_bf16 v[28:31], a[148:151], a[52:55], v[28:31]
  buffer_load_dwordx4 v7, s[8:11], s49 offen offset:0 nt lds
  v_mfma_f32_16x16x32_bf16 v[28:31], a[152:155], a[56:59], v[28:31]
  v_exp_f32_e32 v26, v26
  v_mfma_f32_16x16x32_bf16 v[28:31], a[156:159], a[60:63], v[28:31]
  ds_read_b128 a[184:187], v1 offset:55552
  v_cvt_pk_bf16_f32 v36, v24, v25
  v_mfma_f32_16x16x32_bf16 v[28:31], a[160:163], a[64:67], v[28:31]
  v_exp_f32_e32 v27, v27
  v_mfma_f32_16x16x32_bf16 v[28:31], a[164:167], a[68:71], v[28:31]
  ds_read_b64_tr_b16 a[248:249], v3 offset:24704
  v_cvt_pk_bf16_f32 v37, v26, v27
  v_mfma_f32_16x16x32_bf16 v[92:95], a[236:239], v[60:63], v[92:95]
  s_waitcnt lgkmcnt(2)
  ds_read_b64_tr_b16 a[250:251], v3 offset:30848
  v_mfma_f32_16x16x32_bf16 v[96:99], a[240:243], v[48:51], v[96:99]
  v_mfma_f32_16x16x32_bf16 v[100:103], a[240:243], v[52:55], v[100:103]
  v_mfma_f32_16x16x32_bf16 v[104:107], a[240:243], v[56:59], v[104:107]
  buffer_load_dwordx4 v8, s[8:11], s49 offen offset:1024 nt lds
  v_mfma_f32_16x16x32_bf16 v[108:111], a[240:243], v[60:63], v[108:111]
  ds_read_b128 a[188:191], v2 offset:55552
  v_mul_f32_e32 v28, s25, v28
  v_mfma_f32_16x16x32_bf16 v[112:115], a[244:247], v[48:51], v[112:115]
  v_mul_f32_e32 v29, s25, v29
  v_mul_f32_e32 v30, s25, v30
  v_mfma_f32_16x16x32_bf16 v[20:23], a[144:147], a[72:75], 0
  v_exp_f32_e32 v28, v28
  v_mfma_f32_16x16x32_bf16 v[20:23], a[148:151], a[76:79], v[20:23]
  v_exp_f32_e32 v29, v29
  v_mfma_f32_16x16x32_bf16 v[20:23], a[152:155], a[80:83], v[20:23]
  ds_read_b64_tr_b16 a[252:253], v4 offset:24704
  v_mul_f32_e32 v31, s25, v31
  v_mfma_f32_16x16x32_bf16 v[20:23], a[156:159], a[84:87], v[20:23]
  v_exp_f32_e32 v30, v30
  v_mfma_f32_16x16x32_bf16 v[20:23], a[160:163], a[88:91], v[20:23]
  ds_read_b64_tr_b16 a[254:255], v4 offset:30848
  v_cvt_pk_bf16_f32 v40, v28, v29
  v_mfma_f32_16x16x32_bf16 v[20:23], a[164:167], a[92:95], v[20:23]
  buffer_load_dwordx4 v9, s[8:11], s49 offen offset:2048 nt lds
  v_mfma_f32_16x16x32_bf16 v[116:119], a[244:247], v[52:55], v[116:119]
  v_exp_f32_e32 v31, v31
  v_mfma_f32_16x16x32_bf16 v[120:123], a[244:247], v[56:59], v[120:123]
  ds_read_b64_tr_b16 a[192:193], v5 offset:24704
  v_cvt_pk_bf16_f32 v41, v30, v31
  v_mfma_f32_16x16x32_bf16 v[124:127], a[244:247], v[60:63], v[124:127]
  s_waitcnt lgkmcnt(3)
  ds_read_b128 a[144:147], v1 offset:0
  ds_read_b64_tr_b16 a[194:195], v5 offset:30848
  v_mfma_f32_16x16x32_bf16 v[128:131], a[248:251], v[48:51], v[128:131]
  v_mul_f32_e32 v20, s25, v20
  v_mul_f32_e32 v21, s25, v21
  v_mfma_f32_16x16x32_bf16 v[132:135], a[248:251], v[52:55], v[132:135]
  v_exp_f32_e32 v20, v20
  v_mfma_f32_16x16x32_bf16 v[136:139], a[248:251], v[56:59], v[136:139]
  s_add_u32 m0, s27, 12288
  v_mul_f32_e32 v22, s25, v22
  v_mul_f32_e32 v23, s25, v23
  v_mfma_f32_16x16x32_bf16 v[24:27], a[168:171], a[0:3], 0
  s_add_u32 s33, s32, 199680
  v_exp_f32_e32 v21, v21
  v_mfma_f32_16x16x32_bf16 v[24:27], a[172:175], a[4:7], v[24:27]
  buffer_load_dwordx4 v7, s[16:19], s33 offen offset:0 nt lds
  v_mfma_f32_16x16x32_bf16 v[24:27], a[176:179], a[8:11], v[24:27]
  v_exp_f32_e32 v22, v22
  v_mfma_f32_16x16x32_bf16 v[24:27], a[180:183], a[12:15], v[24:27]
  ds_read_b128 a[148:151], v2 offset:0
  v_cvt_pk_bf16_f32 v44, v20, v21
  v_mfma_f32_16x16x32_bf16 v[24:27], a[184:187], a[16:19], v[24:27]
  v_exp_f32_e32 v23, v23
  v_mfma_f32_16x16x32_bf16 v[24:27], a[188:191], a[20:23], v[24:27]
  ds_read_b64_tr_b16 a[196:197], v6 offset:24704
  v_cvt_pk_bf16_f32 v45, v22, v23
  v_mfma_f32_16x16x32_bf16 v[140:143], a[248:251], v[60:63], v[140:143]
  s_waitcnt lgkmcnt(2)
  ds_read_b64_tr_b16 a[198:199], v6 offset:30848
  v_mfma_f32_16x16x32_bf16 v[144:147], a[252:255], v[48:51], v[144:147]
  v_mfma_f32_16x16x32_bf16 v[148:151], a[252:255], v[52:55], v[148:151]
  v_mfma_f32_16x16x32_bf16 v[152:155], a[252:255], v[56:59], v[152:155]
  buffer_load_dwordx4 v8, s[16:19], s33 offen offset:1024 nt lds
  v_mfma_f32_16x16x32_bf16 v[156:159], a[252:255], v[60:63], v[156:159]
  ds_read_b128 a[152:155], v1 offset:128
  v_mul_f32_e32 v24, s25, v24
  v_mfma_f32_16x16x32_bf16 v[160:163], a[192:195], v[48:51], v[160:163]
  v_mul_f32_e32 v25, s25, v25
  v_mul_f32_e32 v26, s25, v26
  v_mfma_f32_16x16x32_bf16 v[28:31], a[168:171], a[24:27], 0
  v_exp_f32_e32 v24, v24
  v_mfma_f32_16x16x32_bf16 v[28:31], a[172:175], a[28:31], v[28:31]
  v_exp_f32_e32 v25, v25
  v_mfma_f32_16x16x32_bf16 v[28:31], a[176:179], a[32:35], v[28:31]
  ds_read_b64_tr_b16 a[200:201], v3 offset:24832
  v_mul_f32_e32 v27, s25, v27
  v_mfma_f32_16x16x32_bf16 v[28:31], a[180:183], a[36:39], v[28:31]
  v_exp_f32_e32 v26, v26
  v_mfma_f32_16x16x32_bf16 v[28:31], a[184:187], a[40:43], v[28:31]
  ds_read_b64_tr_b16 a[202:203], v3 offset:30976
  v_cvt_pk_bf16_f32 v34, v24, v25
  v_mfma_f32_16x16x32_bf16 v[28:31], a[188:191], a[44:47], v[28:31]
  v_exp_f32_e32 v27, v27
  v_mfma_f32_16x16x32_bf16 v[164:167], a[192:195], v[52:55], v[164:167]
  ds_read_b64_tr_b16 a[204:205], v4 offset:24832
  v_cvt_pk_bf16_f32 v35, v26, v27
  v_mfma_f32_16x16x32_bf16 v[168:171], a[192:195], v[56:59], v[168:171]
  ds_read_b128 a[156:159], v2 offset:128
  v_mfma_f32_16x16x32_bf16 v[172:175], a[192:195], v[60:63], v[172:175]
  s_waitcnt lgkmcnt(4)
  ds_read_b64_tr_b16 a[206:207], v4 offset:30976
  v_mfma_f32_16x16x32_bf16 v[176:179], a[196:199], v[48:51], v[176:179]
  v_mul_f32_e32 v28, s25, v28
  v_mul_f32_e32 v29, s25, v29
  v_mfma_f32_16x16x32_bf16 v[180:183], a[196:199], v[52:55], v[180:183]
  v_exp_f32_e32 v28, v28
  v_mfma_f32_16x16x32_bf16 v[184:187], a[196:199], v[56:59], v[184:187]
  v_mul_f32_e32 v30, s25, v30
  v_mul_f32_e32 v31, s25, v31
  v_mfma_f32_16x16x32_bf16 v[188:191], a[196:199], v[60:63], v[188:191]
  v_exp_f32_e32 v29, v29
  v_mfma_f32_16x16x32_bf16 v[20:23], a[168:171], a[48:51], 0
  v_exp_f32_e32 v30, v30
  v_mfma_f32_16x16x32_bf16 v[20:23], a[172:175], a[52:55], v[20:23]
  ds_read_b128 a[160:163], v1 offset:256
  v_cvt_pk_bf16_f32 v38, v28, v29
  v_mfma_f32_16x16x32_bf16 v[20:23], a[176:179], a[56:59], v[20:23]
  v_exp_f32_e32 v31, v31
  v_mfma_f32_16x16x32_bf16 v[20:23], a[180:183], a[60:63], v[20:23]
  ds_read_b64_tr_b16 a[232:233], v5 offset:24832
  v_cvt_pk_bf16_f32 v39, v30, v31
  v_mfma_f32_16x16x32_bf16 v[20:23], a[184:187], a[64:67], v[20:23]
  v_mfma_f32_16x16x32_bf16 v[20:23], a[188:191], a[68:71], v[20:23]
  s_waitcnt lgkmcnt(2)
  ds_read_b64_tr_b16 a[234:235], v5 offset:30976
  v_mfma_f32_16x16x32_bf16 v[192:195], a[200:203], v[48:51], v[192:195]
  v_mfma_f32_16x16x32_bf16 v[196:199], a[200:203], v[52:55], v[196:199]
  v_mfma_f32_16x16x32_bf16 v[200:203], a[200:203], v[56:59], v[200:203]
  v_mfma_f32_16x16x32_bf16 v[204:207], a[200:203], v[60:63], v[204:207]
  ds_read_b128 a[164:167], v2 offset:256
  s_nop 0
  v_mul_f32_e32 v20, s25, v20
  v_mfma_f32_16x16x32_bf16 v[208:211], a[204:207], v[48:51], v[208:211]
  v_mul_f32_e32 v21, s25, v21
  v_mul_f32_e32 v22, s25, v22
  v_mfma_f32_16x16x32_bf16 v[212:215], a[204:207], v[52:55], v[212:215]
  v_exp_f32_e32 v20, v20
  v_mfma_f32_16x16x32_bf16 v[24:27], a[168:171], a[72:75], 0
  v_exp_f32_e32 v21, v21
  v_mfma_f32_16x16x32_bf16 v[24:27], a[172:175], a[76:79], v[24:27]
  ds_read_b64_tr_b16 a[236:237], v6 offset:24832
  v_mul_f32_e32 v23, s25, v23
  v_mfma_f32_16x16x32_bf16 v[24:27], a[176:179], a[80:83], v[24:27]
  v_exp_f32_e32 v22, v22
  v_mfma_f32_16x16x32_bf16 v[24:27], a[180:183], a[84:87], v[24:27]
  ds_read_b64_tr_b16 a[238:239], v6 offset:30976
  v_cvt_pk_bf16_f32 v42, v20, v21
  v_mfma_f32_16x16x32_bf16 v[24:27], a[184:187], a[88:91], v[24:27]
  v_exp_f32_e32 v23, v23
  v_mfma_f32_16x16x32_bf16 v[24:27], a[188:191], a[92:95], v[24:27]
  v_cvt_pk_bf16_f32 v43, v22, v23
  v_mfma_f32_16x16x32_bf16 v[216:219], a[204:207], v[56:59], v[216:219]
  ds_read_b128 a[168:171], v1 offset:6144
  v_mfma_f32_16x16x32_bf16 v[220:223], a[204:207], v[60:63], v[220:223]
  s_waitcnt lgkmcnt(3)
  v_mfma_f32_16x16x32_bf16 v[224:227], a[232:235], v[48:51], v[224:227]
  s_waitcnt vmcnt(10)
  s_barrier
  v_mfma_f32_16x16x32_bf16 v[228:231], a[232:235], v[52:55], v[228:231]
  v_mul_f32_e32 v24, s25, v24
  v_mul_f32_e32 v25, s25, v25
  v_mfma_f32_16x16x32_bf16 v[232:235], a[232:235], v[56:59], v[232:235]
  v_exp_f32_e32 v24, v24
  v_mfma_f32_16x16x32_bf16 v[236:239], a[232:235], v[60:63], v[236:239]
  ds_read_b64_tr_b16 a[240:241], v3 offset:36864
  v_mul_f32_e32 v26, s25, v26
  v_mfma_f32_16x16x32_bf16 v[28:31], a[144:147], a[0:3], 0
  v_exp_f32_e32 v25, v25
  v_mfma_f32_16x16x32_bf16 v[28:31], a[148:151], a[4:7], v[28:31]
  s_add_u32 m0, s27, 111104
  v_mul_f32_e32 v27, s25, v27
  v_cvt_pk_bf16_f32 v46, v24, v25
  v_mfma_f32_16x16x32_bf16 v[28:31], a[152:155], a[8:11], v[28:31]
  buffer_load_dwordx4 v7, s[12:15], s48 offen offset:0 nt lds
  v_mfma_f32_16x16x32_bf16 v[28:31], a[156:159], a[12:15], v[28:31]
  v_exp_f32_e32 v26, v26
  v_mfma_f32_16x16x32_bf16 v[28:31], a[160:163], a[16:19], v[28:31]
  ds_read_b128 a[172:175], v2 offset:6144
  ds_read_b64_tr_b16 a[242:243], v3 offset:43008
  v_mfma_f32_16x16x32_bf16 v[28:31], a[164:167], a[20:23], v[28:31]
  s_waitcnt lgkmcnt(3)
  v_exp_f32_e32 v27, v27
  v_mfma_f32_16x16x32_bf16 v[240:243], a[236:239], v[48:51], v[240:243]
  ds_read_b64_tr_b16 a[244:245], v4 offset:36864
  v_cvt_pk_bf16_f32 v47, v26, v27
  v_mfma_f32_16x16x32_bf16 v[244:247], a[236:239], v[52:55], v[244:247]
  ds_read_b64_tr_b16 a[246:247], v4 offset:43008
  v_mfma_f32_16x16x32_bf16 v[248:251], a[236:239], v[56:59], v[248:251]
  v_mfma_f32_16x16x32_bf16 v[252:255], a[236:239], v[60:63], v[252:255]
  v_mul_f32_e32 v28, s25, v28
  v_mul_f32_e32 v29, s25, v29
  v_smfmac_f32_16x16x64_bf16 a[208:211], a[224:227], v[32:39], v0
  ds_read_b128 a[176:179], v1 offset:6272
  v_smfmac_f32_16x16x64_bf16 a[212:215], a[224:227], v[40:47], v0
  v_mul_f32_e32 v30, s25, v30
  v_mfma_f32_16x16x32_bf16 v[20:23], a[144:147], a[24:27], 0
  buffer_load_dwordx4 v8, s[12:15], s48 offen offset:1024 nt lds
  v_mfma_f32_16x16x32_bf16 v[20:23], a[148:151], a[28:31], v[20:23]
  v_exp_f32_e32 v28, v28
  v_mfma_f32_16x16x32_bf16 v[20:23], a[152:155], a[32:35], v[20:23]
  v_exp_f32_e32 v29, v29
  v_mfma_f32_16x16x32_bf16 v[20:23], a[156:159], a[36:39], v[20:23]
  ds_read_b64_tr_b16 a[248:249], v5 offset:36864
  v_mul_f32_e32 v31, s25, v31
  v_mfma_f32_16x16x32_bf16 v[20:23], a[160:163], a[40:43], v[20:23]
  v_exp_f32_e32 v30, v30
  v_mfma_f32_16x16x32_bf16 v[20:23], a[164:167], a[44:47], v[20:23]
  s_waitcnt lgkmcnt(2)
  ds_read_b64_tr_b16 a[250:251], v5 offset:43008
  v_cvt_pk_bf16_f32 v48, v28, v29
  v_mfma_f32_16x16x32_bf16 v[64:67], a[240:243], v[32:35], v[64:67]
  v_exp_f32_e32 v31, v31
  v_mfma_f32_16x16x32_bf16 v[68:71], a[240:243], v[36:39], v[68:71]
  buffer_load_dwordx4 v9, s[12:15], s48 offen offset:2048 nt lds
  v_mfma_f32_16x16x32_bf16 v[72:75], a[240:243], v[40:43], v[72:75]
  ds_read_b64_tr_b16 a[252:253], v6 offset:36864
  v_cvt_pk_bf16_f32 v49, v30, v31
  v_mfma_f32_16x16x32_bf16 v[76:79], a[240:243], v[44:47], v[76:79]
  ds_read_b128 a[180:183], v2 offset:6272
  v_mul_f32_e32 v20, s25, v20
  v_mfma_f32_16x16x32_bf16 v[80:83], a[244:247], v[32:35], v[80:83]
  ds_read_b64_tr_b16 a[254:255], v6 offset:43008
  v_mul_f32_e32 v21, s25, v21
  v_mfma_f32_16x16x32_bf16 v[84:87], a[244:247], v[36:39], v[84:87]
  v_exp_f32_e32 v20, v20
  v_mfma_f32_16x16x32_bf16 v[88:91], a[244:247], v[40:43], v[88:91]
  v_mul_f32_e32 v22, s25, v22
  v_mul_f32_e32 v23, s25, v23
  v_mfma_f32_16x16x32_bf16 v[24:27], a[144:147], a[48:51], 0
  s_add_u32 m0, s27, 86528
  v_exp_f32_e32 v21, v21
  v_mfma_f32_16x16x32_bf16 v[24:27], a[148:151], a[52:55], v[24:27]
  buffer_load_dwordx4 v7, s[8:11], s50 offen offset:0 nt lds
  v_mfma_f32_16x16x32_bf16 v[24:27], a[152:155], a[56:59], v[24:27]
  v_exp_f32_e32 v22, v22
  v_mfma_f32_16x16x32_bf16 v[24:27], a[156:159], a[60:63], v[24:27]
  ds_read_b128 a[184:187], v1 offset:6400
  v_cvt_pk_bf16_f32 v52, v20, v21
  v_mfma_f32_16x16x32_bf16 v[24:27], a[160:163], a[64:67], v[24:27]
  v_exp_f32_e32 v23, v23
  v_mfma_f32_16x16x32_bf16 v[24:27], a[164:167], a[68:71], v[24:27]
  ds_read_b64_tr_b16 a[192:193], v3 offset:36992
  v_cvt_pk_bf16_f32 v53, v22, v23
  v_mfma_f32_16x16x32_bf16 v[92:95], a[244:247], v[44:47], v[92:95]
  s_waitcnt lgkmcnt(2)
  ds_read_b64_tr_b16 a[194:195], v3 offset:43136
  v_mfma_f32_16x16x32_bf16 v[96:99], a[248:251], v[32:35], v[96:99]
  v_mfma_f32_16x16x32_bf16 v[100:103], a[248:251], v[36:39], v[100:103]
  v_mfma_f32_16x16x32_bf16 v[104:107], a[248:251], v[40:43], v[104:107]
  buffer_load_dwordx4 v8, s[8:11], s50 offen offset:1024 nt lds
  v_mfma_f32_16x16x32_bf16 v[108:111], a[248:251], v[44:47], v[108:111]
  ds_read_b128 a[188:191], v2 offset:6400
  v_mul_f32_e32 v24, s25, v24
  v_mfma_f32_16x16x32_bf16 v[112:115], a[252:255], v[32:35], v[112:115]
  v_mul_f32_e32 v25, s25, v25
  v_mul_f32_e32 v26, s25, v26
  v_mfma_f32_16x16x32_bf16 v[28:31], a[144:147], a[72:75], 0
  v_exp_f32_e32 v24, v24
  v_mfma_f32_16x16x32_bf16 v[28:31], a[148:151], a[76:79], v[28:31]
  v_exp_f32_e32 v25, v25
  v_mfma_f32_16x16x32_bf16 v[28:31], a[152:155], a[80:83], v[28:31]
  ds_read_b64_tr_b16 a[196:197], v4 offset:36992
  v_mul_f32_e32 v27, s25, v27
  v_mfma_f32_16x16x32_bf16 v[28:31], a[156:159], a[84:87], v[28:31]
  v_exp_f32_e32 v26, v26
  v_mfma_f32_16x16x32_bf16 v[28:31], a[160:163], a[88:91], v[28:31]
L_tr2:
  s_cbranch_execz L_tr6
  ds_read_b64_tr_b16 a[198:199], v4 offset:43136
  v_cvt_pk_bf16_f32 v56, v24, v25
  v_mfma_f32_16x16x32_bf16 v[28:31], a[164:167], a[92:95], v[28:31]
  buffer_load_dwordx4 v9, s[8:11], s50 offen offset:2048 nt lds
  v_mfma_f32_16x16x32_bf16 v[116:119], a[252:255], v[36:39], v[116:119]
  v_exp_f32_e32 v27, v27
  v_mfma_f32_16x16x32_bf16 v[120:123], a[252:255], v[40:43], v[120:123]
  ds_read_b64_tr_b16 a[200:201], v5 offset:36992
  v_cvt_pk_bf16_f32 v57, v26, v27
  v_mfma_f32_16x16x32_bf16 v[124:127], a[252:255], v[44:47], v[124:127]
  s_waitcnt lgkmcnt(3)
  ds_read_b128 a[144:147], v1 offset:12288
  ds_read_b64_tr_b16 a[202:203], v5 offset:43136
  v_mfma_f32_16x16x32_bf16 v[128:131], a[192:195], v[32:35], v[128:131]
  v_mul_f32_e32 v28, s25, v28
  v_mul_f32_e32 v29, s25, v29
  v_mfma_f32_16x16x32_bf16 v[132:135], a[192:195], v[36:39], v[132:135]
  v_exp_f32_e32 v28, v28
  v_mfma_f32_16x16x32_bf16 v[136:139], a[192:195], v[40:43], v[136:139]
  s_add_u32 m0, s27, 12288
  v_mul_f32_e32 v30, s25, v30
  v_mul_f32_e32 v31, s25, v31
  v_mfma_f32_16x16x32_bf16 v[20:23], a[168:171], a[0:3], 0
  s_add_u32 s33, s32, 199680
  v_exp_f32_e32 v29, v29
  v_mfma_f32_16x16x32_bf16 v[20:23], a[172:175], a[4:7], v[20:23]
  buffer_load_dwordx4 v9, s[16:19], s33 offen offset:2048 nt lds
  v_mfma_f32_16x16x32_bf16 v[20:23], a[176:179], a[8:11], v[20:23]
  v_exp_f32_e32 v30, v30
  v_mfma_f32_16x16x32_bf16 v[20:23], a[180:183], a[12:15], v[20:23]
  ds_read_b128 a[148:151], v2 offset:12288
  v_cvt_pk_bf16_f32 v60, v28, v29
  v_mfma_f32_16x16x32_bf16 v[20:23], a[184:187], a[16:19], v[20:23]
  v_exp_f32_e32 v31, v31
  v_mfma_f32_16x16x32_bf16 v[20:23], a[188:191], a[20:23], v[20:23]
  ds_read_b64_tr_b16 a[204:205], v6 offset:36992
  v_cvt_pk_bf16_f32 v61, v30, v31
  v_mfma_f32_16x16x32_bf16 v[140:143], a[192:195], v[44:47], v[140:143]
  s_waitcnt lgkmcnt(2)
  ds_read_b64_tr_b16 a[206:207], v6 offset:43136
  v_mfma_f32_16x16x32_bf16 v[144:147], a[196:199], v[32:35], v[144:147]
  s_add_u32 m0, s27, 24832
  v_mfma_f32_16x16x32_bf16 v[148:151], a[196:199], v[36:39], v[148:151]
  s_add_u32 s33, s32, 202752
  v_mfma_f32_16x16x32_bf16 v[152:155], a[196:199], v[40:43], v[152:155]
  buffer_load_dwordx4 v7, s[16:19], s33 offen offset:0 nt lds
  v_mfma_f32_16x16x32_bf16 v[156:159], a[196:199], v[44:47], v[156:159]
  ds_read_b128 a[152:155], v1 offset:12416
  v_mul_f32_e32 v20, s25, v20
  v_mfma_f32_16x16x32_bf16 v[160:163], a[200:203], v[32:35], v[160:163]
  v_mul_f32_e32 v21, s25, v21
  v_mul_f32_e32 v22, s25, v22
  v_mfma_f32_16x16x32_bf16 v[24:27], a[168:171], a[24:27], 0
  v_exp_f32_e32 v20, v20
  v_mfma_f32_16x16x32_bf16 v[24:27], a[172:175], a[28:31], v[24:27]
  v_exp_f32_e32 v21, v21
  v_mfma_f32_16x16x32_bf16 v[24:27], a[176:179], a[32:35], v[24:27]
  ds_read_b64_tr_b16 a[232:233], v3 offset:37120
  v_mul_f32_e32 v23, s25, v23
  v_mfma_f32_16x16x32_bf16 v[24:27], a[180:183], a[36:39], v[24:27]
  v_exp_f32_e32 v22, v22
  v_mfma_f32_16x16x32_bf16 v[24:27], a[184:187], a[40:43], v[24:27]
  ds_read_b64_tr_b16 a[234:235], v3 offset:43264
  v_cvt_pk_bf16_f32 v50, v20, v21
  v_mfma_f32_16x16x32_bf16 v[24:27], a[188:191], a[44:47], v[24:27]
  v_exp_f32_e32 v23, v23
  v_mfma_f32_16x16x32_bf16 v[164:167], a[200:203], v[36:39], v[164:167]
  ds_read_b64_tr_b16 a[236:237], v4 offset:37120
  v_cvt_pk_bf16_f32 v51, v22, v23
  v_mfma_f32_16x16x32_bf16 v[168:171], a[200:203], v[40:43], v[168:171]
  ds_read_b128 a[156:159], v2 offset:12416
  v_mfma_f32_16x16x32_bf16 v[172:175], a[200:203], v[44:47], v[172:175]
  s_waitcnt lgkmcnt(4)
  ds_read_b64_tr_b16 a[238:239], v4 offset:43264
  v_mfma_f32_16x16x32_bf16 v[176:179], a[204:207], v[32:35], v[176:179]
  v_mul_f32_e32 v24, s25, v24
  v_mul_f32_e32 v25, s25, v25
  v_mfma_f32_16x16x32_bf16 v[180:183], a[204:207], v[36:39], v[180:183]
  v_exp_f32_e32 v24, v24
  v_mfma_f32_16x16x32_bf16 v[184:187], a[204:207], v[40:43], v[184:187]
  v_mul_f32_e32 v26, s25, v26
  v_mul_f32_e32 v27, s25, v27
  v_mfma_f32_16x16x32_bf16 v[188:191], a[204:207], v[44:47], v[188:191]
  v_exp_f32_e32 v25, v25
  v_mfma_f32_16x16x32_bf16 v[28:31], a[168:171], a[48:51], 0
  v_exp_f32_e32 v26, v26
  v_mfma_f32_16x16x32_bf16 v[28:31], a[172:175], a[52:55], v[28:31]
  ds_read_b128 a[160:163], v1 offset:12544
  v_cvt_pk_bf16_f32 v54, v24, v25
  v_mfma_f32_16x16x32_bf16 v[28:31], a[176:179], a[56:59], v[28:31]
  v_exp_f32_e32 v27, v27
  v_mfma_f32_16x16x32_bf16 v[28:31], a[180:183], a[60:63], v[28:31]
  ds_read_b64_tr_b16 a[240:241], v5 offset:37120
  v_cvt_pk_bf16_f32 v55, v26, v27
  v_mfma_f32_16x16x32_bf16 v[28:31], a[184:187], a[64:67], v[28:31]
  v_mfma_f32_16x16x32_bf16 v[28:31], a[188:191], a[68:71], v[28:31]
  s_waitcnt lgkmcnt(2)
  ds_read_b64_tr_b16 a[242:243], v5 offset:43264
  v_mfma_f32_16x16x32_bf16 v[192:195], a[232:235], v[32:35], v[192:195]
  v_mfma_f32_16x16x32_bf16 v[196:199], a[232:235], v[36:39], v[196:199]
  v_mfma_f32_16x16x32_bf16 v[200:203], a[232:235], v[40:43], v[200:203]
  v_mfma_f32_16x16x32_bf16 v[204:207], a[232:235], v[44:47], v[204:207]
  ds_read_b128 a[164:167], v2 offset:12544
  s_nop 0
  v_mul_f32_e32 v28, s25, v28
  v_mfma_f32_16x16x32_bf16 v[208:211], a[236:239], v[32:35], v[208:211]
  v_mul_f32_e32 v29, s25, v29
  v_mul_f32_e32 v30, s25, v30
  v_mfma_f32_16x16x32_bf16 v[212:215], a[236:239], v[36:39], v[212:215]
  v_exp_f32_e32 v28, v28
  v_mfma_f32_16x16x32_bf16 v[20:23], a[168:171], a[72:75], 0
  v_exp_f32_e32 v29, v29
  v_mfma_f32_16x16x32_bf16 v[20:23], a[172:175], a[76:79], v[20:23]
  ds_read_b64_tr_b16 a[244:245], v6 offset:37120
  v_mul_f32_e32 v31, s25, v31
  v_mfma_f32_16x16x32_bf16 v[20:23], a[176:179], a[80:83], v[20:23]
  v_exp_f32_e32 v30, v30
  v_mfma_f32_16x16x32_bf16 v[20:23], a[180:183], a[84:87], v[20:23]
  ds_read_b64_tr_b16 a[246:247], v6 offset:43264
  v_cvt_pk_bf16_f32 v58, v28, v29
  v_mfma_f32_16x16x32_bf16 v[20:23], a[184:187], a[88:91], v[20:23]
  v_exp_f32_e32 v31, v31
  v_mfma_f32_16x16x32_bf16 v[20:23], a[188:191], a[92:95], v[20:23]
  v_cvt_pk_bf16_f32 v59, v30, v31
  v_mfma_f32_16x16x32_bf16 v[216:219], a[236:239], v[40:43], v[216:219]
  ds_read_b128 a[168:171], v1 offset:18432
  v_mfma_f32_16x16x32_bf16 v[220:223], a[236:239], v[44:47], v[220:223]
  s_waitcnt lgkmcnt(3)
  v_mfma_f32_16x16x32_bf16 v[224:227], a[240:243], v[32:35], v[224:227]
  s_waitcnt vmcnt(10)
  s_barrier
  v_mfma_f32_16x16x32_bf16 v[228:231], a[240:243], v[36:39], v[228:231]
  v_mul_f32_e32 v20, s25, v20
  v_mul_f32_e32 v21, s25, v21
  v_mfma_f32_16x16x32_bf16 v[232:235], a[240:243], v[40:43], v[232:235]
  v_exp_f32_e32 v20, v20
  v_mfma_f32_16x16x32_bf16 v[236:239], a[240:243], v[44:47], v[236:239]
  ds_read_b64_tr_b16 a[248:249], v3 offset:49152
  v_mul_f32_e32 v22, s25, v22
  v_mfma_f32_16x16x32_bf16 v[24:27], a[144:147], a[0:3], 0
  v_exp_f32_e32 v21, v21
  v_mfma_f32_16x16x32_bf16 v[24:27], a[148:151], a[4:7], v[24:27]
  s_add_u32 m0, s27, 123392
  v_mul_f32_e32 v23, s25, v23
  v_cvt_pk_bf16_f32 v62, v20, v21
  v_mfma_f32_16x16x32_bf16 v[24:27], a[152:155], a[8:11], v[24:27]
  buffer_load_dwordx4 v7, s[12:15], s49 offen offset:0 nt lds
  v_mfma_f32_16x16x32_bf16 v[24:27], a[156:159], a[12:15], v[24:27]
  v_exp_f32_e32 v22, v22
  v_mfma_f32_16x16x32_bf16 v[24:27], a[160:163], a[16:19], v[24:27]
  ds_read_b128 a[172:175], v2 offset:18432
  ds_read_b64_tr_b16 a[250:251], v3 offset:55296
  v_mfma_f32_16x16x32_bf16 v[24:27], a[164:167], a[20:23], v[24:27]
  s_waitcnt lgkmcnt(3)
  v_exp_f32_e32 v23, v23
  v_mfma_f32_16x16x32_bf16 v[240:243], a[244:247], v[32:35], v[240:243]
  ds_read_b64_tr_b16 a[252:253], v4 offset:49152
  v_cvt_pk_bf16_f32 v63, v22, v23
  v_mfma_f32_16x16x32_bf16 v[244:247], a[244:247], v[36:39], v[244:247]
  ds_read_b64_tr_b16 a[254:255], v4 offset:55296
  v_mfma_f32_16x16x32_bf16 v[248:251], a[244:247], v[40:43], v[248:251]
  v_mfma_f32_16x16x32_bf16 v[252:255], a[244:247], v[44:47], v[252:255]
  v_mul_f32_e32 v24, s25, v24
  v_mul_f32_e32 v25, s25, v25
  v_smfmac_f32_16x16x64_bf16 a[208:211], a[224:227], v[48:55], v0
  ds_read_b128 a[176:179], v1 offset:18560
  v_smfmac_f32_16x16x64_bf16 a[212:215], a[224:227], v[56:63], v0
  v_mul_f32_e32 v26, s25, v26
  v_mfma_f32_16x16x32_bf16 v[28:31], a[144:147], a[24:27], 0
  buffer_load_dwordx4 v8, s[12:15], s49 offen offset:1024 nt lds
  v_mfma_f32_16x16x32_bf16 v[28:31], a[148:151], a[28:31], v[28:31]
  v_exp_f32_e32 v24, v24
  v_mfma_f32_16x16x32_bf16 v[28:31], a[152:155], a[32:35], v[28:31]
  v_exp_f32_e32 v25, v25
  v_mfma_f32_16x16x32_bf16 v[28:31], a[156:159], a[36:39], v[28:31]
  ds_read_b64_tr_b16 a[192:193], v5 offset:49152
  v_mul_f32_e32 v27, s25, v27
  v_mfma_f32_16x16x32_bf16 v[28:31], a[160:163], a[40:43], v[28:31]
  v_exp_f32_e32 v26, v26
  v_mfma_f32_16x16x32_bf16 v[28:31], a[164:167], a[44:47], v[28:31]
  s_waitcnt lgkmcnt(2)
  ds_read_b64_tr_b16 a[194:195], v5 offset:55296
  v_cvt_pk_bf16_f32 v32, v24, v25
  v_mfma_f32_16x16x32_bf16 v[64:67], a[248:251], v[48:51], v[64:67]
  v_exp_f32_e32 v27, v27
  v_mfma_f32_16x16x32_bf16 v[68:71], a[248:251], v[52:55], v[68:71]
  buffer_load_dwordx4 v9, s[12:15], s49 offen offset:2048 nt lds
  v_mfma_f32_16x16x32_bf16 v[72:75], a[248:251], v[56:59], v[72:75]
  ds_read_b64_tr_b16 a[196:197], v6 offset:49152
  v_cvt_pk_bf16_f32 v33, v26, v27
  v_mfma_f32_16x16x32_bf16 v[76:79], a[248:251], v[60:63], v[76:79]
  ds_read_b128 a[180:183], v2 offset:18560
  v_mul_f32_e32 v28, s25, v28
  v_mfma_f32_16x16x32_bf16 v[80:83], a[252:255], v[48:51], v[80:83]
  ds_read_b64_tr_b16 a[198:199], v6 offset:55296
  v_mul_f32_e32 v29, s25, v29
  v_mfma_f32_16x16x32_bf16 v[84:87], a[252:255], v[52:55], v[84:87]
  v_exp_f32_e32 v28, v28
  v_mfma_f32_16x16x32_bf16 v[88:91], a[252:255], v[56:59], v[88:91]
  v_mul_f32_e32 v30, s25, v30
  v_mul_f32_e32 v31, s25, v31
  v_mfma_f32_16x16x32_bf16 v[20:23], a[144:147], a[48:51], 0
  s_add_u32 m0, s27, 98816
  v_exp_f32_e32 v29, v29
  v_mfma_f32_16x16x32_bf16 v[20:23], a[148:151], a[52:55], v[20:23]
  buffer_load_dwordx4 v7, s[8:11], s51 offen offset:0 nt lds
  v_mfma_f32_16x16x32_bf16 v[20:23], a[152:155], a[56:59], v[20:23]
  v_exp_f32_e32 v30, v30
  v_mfma_f32_16x16x32_bf16 v[20:23], a[156:159], a[60:63], v[20:23]
  ds_read_b128 a[184:187], v1 offset:18688
  v_cvt_pk_bf16_f32 v36, v28, v29
  v_mfma_f32_16x16x32_bf16 v[20:23], a[160:163], a[64:67], v[20:23]
  v_exp_f32_e32 v31, v31
  v_mfma_f32_16x16x32_bf16 v[20:23], a[164:167], a[68:71], v[20:23]
  ds_read_b64_tr_b16 a[200:201], v3 offset:49280
  v_cvt_pk_bf16_f32 v37, v30, v31
  v_mfma_f32_16x16x32_bf16 v[92:95], a[252:255], v[60:63], v[92:95]
  s_waitcnt lgkmcnt(2)
  ds_read_b64_tr_b16 a[202:203], v3 offset:55424
  v_mfma_f32_16x16x32_bf16 v[96:99], a[192:195], v[48:51], v[96:99]
  v_mfma_f32_16x16x32_bf16 v[100:103], a[192:195], v[52:55], v[100:103]
  v_mfma_f32_16x16x32_bf16 v[104:107], a[192:195], v[56:59], v[104:107]
  buffer_load_dwordx4 v8, s[8:11], s51 offen offset:1024 nt lds
  v_mfma_f32_16x16x32_bf16 v[108:111], a[192:195], v[60:63], v[108:111]
  ds_read_b128 a[188:191], v2 offset:18688
  v_mul_f32_e32 v20, s25, v20
  v_mfma_f32_16x16x32_bf16 v[112:115], a[196:199], v[48:51], v[112:115]
  v_mul_f32_e32 v21, s25, v21
  v_mul_f32_e32 v22, s25, v22
  v_mfma_f32_16x16x32_bf16 v[24:27], a[144:147], a[72:75], 0
  v_exp_f32_e32 v20, v20
  v_mfma_f32_16x16x32_bf16 v[24:27], a[148:151], a[76:79], v[24:27]
  v_exp_f32_e32 v21, v21
  v_mfma_f32_16x16x32_bf16 v[24:27], a[152:155], a[80:83], v[24:27]
  ds_read_b64_tr_b16 a[204:205], v4 offset:49280
  v_mul_f32_e32 v23, s25, v23
  v_mfma_f32_16x16x32_bf16 v[24:27], a[156:159], a[84:87], v[24:27]
  v_exp_f32_e32 v22, v22
  v_mfma_f32_16x16x32_bf16 v[24:27], a[160:163], a[88:91], v[24:27]
  ds_read_b64_tr_b16 a[206:207], v4 offset:55424
  v_cvt_pk_bf16_f32 v40, v20, v21
  v_mfma_f32_16x16x32_bf16 v[24:27], a[164:167], a[92:95], v[24:27]
  buffer_load_dwordx4 v9, s[8:11], s51 offen offset:2048 nt lds
  v_mfma_f32_16x16x32_bf16 v[116:119], a[196:199], v[52:55], v[116:119]
  v_exp_f32_e32 v23, v23
  v_mfma_f32_16x16x32_bf16 v[120:123], a[196:199], v[56:59], v[120:123]
  ds_read_b64_tr_b16 a[232:233], v5 offset:49280
  v_cvt_pk_bf16_f32 v41, v22, v23
  v_mfma_f32_16x16x32_bf16 v[124:127], a[196:199], v[60:63], v[124:127]
  s_waitcnt lgkmcnt(3)
  ds_read_b128 a[144:147], v1 offset:24576
  ds_read_b64_tr_b16 a[234:235], v5 offset:55424
  v_mfma_f32_16x16x32_bf16 v[128:131], a[200:203], v[48:51], v[128:131]
  v_mul_f32_e32 v24, s25, v24
  v_mul_f32_e32 v25, s25, v25
  v_mfma_f32_16x16x32_bf16 v[132:135], a[200:203], v[52:55], v[132:135]
  v_exp_f32_e32 v24, v24
  v_mfma_f32_16x16x32_bf16 v[136:139], a[200:203], v[56:59], v[136:139]
  s_add_u32 m0, s27, 24832
  v_mul_f32_e32 v26, s25, v26
  v_mul_f32_e32 v27, s25, v27
  v_mfma_f32_16x16x32_bf16 v[28:31], a[168:171], a[0:3], 0
  s_add_u32 s33, s32, 202752
  v_exp_f32_e32 v25, v25
  v_mfma_f32_16x16x32_bf16 v[28:31], a[172:175], a[4:7], v[28:31]
  buffer_load_dwordx4 v8, s[16:19], s33 offen offset:1024 nt lds
  v_mfma_f32_16x16x32_bf16 v[28:31], a[176:179], a[8:11], v[28:31]
  v_exp_f32_e32 v26, v26
  v_mfma_f32_16x16x32_bf16 v[28:31], a[180:183], a[12:15], v[28:31]
  ds_read_b128 a[148:151], v2 offset:24576
  v_cvt_pk_bf16_f32 v44, v24, v25
  v_mfma_f32_16x16x32_bf16 v[28:31], a[184:187], a[16:19], v[28:31]
  v_exp_f32_e32 v27, v27
  v_mfma_f32_16x16x32_bf16 v[28:31], a[188:191], a[20:23], v[28:31]
  ds_read_b64_tr_b16 a[236:237], v6 offset:49280
  v_cvt_pk_bf16_f32 v45, v26, v27
  v_mfma_f32_16x16x32_bf16 v[140:143], a[200:203], v[60:63], v[140:143]
  s_waitcnt lgkmcnt(2)
  ds_read_b64_tr_b16 a[238:239], v6 offset:55424
  v_mfma_f32_16x16x32_bf16 v[144:147], a[204:207], v[48:51], v[144:147]
  v_mfma_f32_16x16x32_bf16 v[148:151], a[204:207], v[52:55], v[148:151]
  v_mfma_f32_16x16x32_bf16 v[152:155], a[204:207], v[56:59], v[152:155]
  buffer_load_dwordx4 v9, s[16:19], s33 offen offset:2048 nt lds
  v_mfma_f32_16x16x32_bf16 v[156:159], a[204:207], v[60:63], v[156:159]
  ds_read_b128 a[152:155], v1 offset:24704
  v_mul_f32_e32 v28, s25, v28
  v_mfma_f32_16x16x32_bf16 v[160:163], a[232:235], v[48:51], v[160:163]
  v_mul_f32_e32 v29, s25, v29
  v_mul_f32_e32 v30, s25, v30
  v_mfma_f32_16x16x32_bf16 v[20:23], a[168:171], a[24:27], 0
  v_exp_f32_e32 v28, v28
  v_mfma_f32_16x16x32_bf16 v[20:23], a[172:175], a[28:31], v[20:23]
  v_exp_f32_e32 v29, v29
  v_mfma_f32_16x16x32_bf16 v[20:23], a[176:179], a[32:35], v[20:23]
  ds_read_b64_tr_b16 a[240:241], v3 offset:49408
  v_mul_f32_e32 v31, s25, v31
  v_mfma_f32_16x16x32_bf16 v[20:23], a[180:183], a[36:39], v[20:23]
  v_exp_f32_e32 v30, v30
  v_mfma_f32_16x16x32_bf16 v[20:23], a[184:187], a[40:43], v[20:23]
  ds_read_b64_tr_b16 a[242:243], v3 offset:55552
  v_cvt_pk_bf16_f32 v34, v28, v29
  v_mfma_f32_16x16x32_bf16 v[20:23], a[188:191], a[44:47], v[20:23]
  v_exp_f32_e32 v31, v31
  v_mfma_f32_16x16x32_bf16 v[164:167], a[232:235], v[52:55], v[164:167]
  ds_read_b64_tr_b16 a[244:245], v4 offset:49408
  v_cvt_pk_bf16_f32 v35, v30, v31
  v_mfma_f32_16x16x32_bf16 v[168:171], a[232:235], v[56:59], v[168:171]
  ds_read_b128 a[156:159], v2 offset:24704
  v_mfma_f32_16x16x32_bf16 v[172:175], a[232:235], v[60:63], v[172:175]
  s_waitcnt lgkmcnt(4)
  ds_read_b64_tr_b16 a[246:247], v4 offset:55552
  v_mfma_f32_16x16x32_bf16 v[176:179], a[236:239], v[48:51], v[176:179]
  v_mul_f32_e32 v20, s25, v20
  v_mul_f32_e32 v21, s25, v21
  v_mfma_f32_16x16x32_bf16 v[180:183], a[236:239], v[52:55], v[180:183]
  v_exp_f32_e32 v20, v20
  v_mfma_f32_16x16x32_bf16 v[184:187], a[236:239], v[56:59], v[184:187]
  v_mul_f32_e32 v22, s25, v22
  v_mul_f32_e32 v23, s25, v23
  v_mfma_f32_16x16x32_bf16 v[188:191], a[236:239], v[60:63], v[188:191]
  v_exp_f32_e32 v21, v21
  v_mfma_f32_16x16x32_bf16 v[24:27], a[168:171], a[48:51], 0
  v_exp_f32_e32 v22, v22
  v_mfma_f32_16x16x32_bf16 v[24:27], a[172:175], a[52:55], v[24:27]
  ds_read_b128 a[160:163], v1 offset:24832
  v_cvt_pk_bf16_f32 v38, v20, v21
  v_mfma_f32_16x16x32_bf16 v[24:27], a[176:179], a[56:59], v[24:27]
  v_exp_f32_e32 v23, v23
  v_mfma_f32_16x16x32_bf16 v[24:27], a[180:183], a[60:63], v[24:27]
  ds_read_b64_tr_b16 a[248:249], v5 offset:49408
  v_cvt_pk_bf16_f32 v39, v22, v23
  v_mfma_f32_16x16x32_bf16 v[24:27], a[184:187], a[64:67], v[24:27]
  v_mfma_f32_16x16x32_bf16 v[24:27], a[188:191], a[68:71], v[24:27]
  s_waitcnt lgkmcnt(2)
  ds_read_b64_tr_b16 a[250:251], v5 offset:55552
  v_mfma_f32_16x16x32_bf16 v[192:195], a[240:243], v[48:51], v[192:195]
  v_mfma_f32_16x16x32_bf16 v[196:199], a[240:243], v[52:55], v[196:199]
  v_mfma_f32_16x16x32_bf16 v[200:203], a[240:243], v[56:59], v[200:203]
  v_mfma_f32_16x16x32_bf16 v[204:207], a[240:243], v[60:63], v[204:207]
  ds_read_b128 a[164:167], v2 offset:24832
  s_nop 0
  v_mul_f32_e32 v24, s25, v24
  v_mfma_f32_16x16x32_bf16 v[208:211], a[244:247], v[48:51], v[208:211]
  v_mul_f32_e32 v25, s25, v25
  v_mul_f32_e32 v26, s25, v26
  v_mfma_f32_16x16x32_bf16 v[212:215], a[244:247], v[52:55], v[212:215]
  v_exp_f32_e32 v24, v24
  v_mfma_f32_16x16x32_bf16 v[28:31], a[168:171], a[72:75], 0
  v_exp_f32_e32 v25, v25
  v_mfma_f32_16x16x32_bf16 v[28:31], a[172:175], a[76:79], v[28:31]
  ds_read_b64_tr_b16 a[252:253], v6 offset:49408
  v_mul_f32_e32 v27, s25, v27
  v_mfma_f32_16x16x32_bf16 v[28:31], a[176:179], a[80:83], v[28:31]
  v_exp_f32_e32 v26, v26
  v_mfma_f32_16x16x32_bf16 v[28:31], a[180:183], a[84:87], v[28:31]
  ds_read_b64_tr_b16 a[254:255], v6 offset:55552
  v_cvt_pk_bf16_f32 v42, v24, v25
  v_mfma_f32_16x16x32_bf16 v[28:31], a[184:187], a[88:91], v[28:31]
  v_exp_f32_e32 v27, v27
  v_mfma_f32_16x16x32_bf16 v[28:31], a[188:191], a[92:95], v[28:31]
  v_cvt_pk_bf16_f32 v43, v26, v27
  v_mfma_f32_16x16x32_bf16 v[216:219], a[244:247], v[56:59], v[216:219]
  ds_read_b128 a[168:171], v1 offset:30720
  v_mfma_f32_16x16x32_bf16 v[220:223], a[244:247], v[60:63], v[220:223]
  s_waitcnt lgkmcnt(3)
  v_mfma_f32_16x16x32_bf16 v[224:227], a[248:251], v[48:51], v[224:227]
  s_waitcnt vmcnt(10)
  s_barrier
  v_mfma_f32_16x16x32_bf16 v[228:231], a[248:251], v[52:55], v[228:231]
  v_mul_f32_e32 v28, s25, v28
  v_mul_f32_e32 v29, s25, v29
  v_mfma_f32_16x16x32_bf16 v[232:235], a[248:251], v[56:59], v[232:235]
  v_exp_f32_e32 v28, v28
  v_mfma_f32_16x16x32_bf16 v[236:239], a[248:251], v[60:63], v[236:239]
  ds_read_b64_tr_b16 a[192:193], v3 offset:12288
  v_mul_f32_e32 v30, s25, v30
  v_mfma_f32_16x16x32_bf16 v[20:23], a[144:147], a[0:3], 0
  v_exp_f32_e32 v29, v29
  v_mfma_f32_16x16x32_bf16 v[20:23], a[148:151], a[4:7], v[20:23]
  s_add_u32 m0, s27, 135680
  v_mul_f32_e32 v31, s25, v31
  v_cvt_pk_bf16_f32 v46, v28, v29
  v_mfma_f32_16x16x32_bf16 v[20:23], a[152:155], a[8:11], v[20:23]
  buffer_load_dwordx4 v7, s[12:15], s50 offen offset:0 nt lds
  v_mfma_f32_16x16x32_bf16 v[20:23], a[156:159], a[12:15], v[20:23]
  v_exp_f32_e32 v30, v30
  v_mfma_f32_16x16x32_bf16 v[20:23], a[160:163], a[16:19], v[20:23]
  ds_read_b128 a[172:175], v2 offset:30720
  ds_read_b64_tr_b16 a[194:195], v3 offset:18432
  v_mfma_f32_16x16x32_bf16 v[20:23], a[164:167], a[20:23], v[20:23]
  s_waitcnt lgkmcnt(3)
  v_exp_f32_e32 v31, v31
  v_mfma_f32_16x16x32_bf16 v[240:243], a[252:255], v[48:51], v[240:243]
  ds_read_b64_tr_b16 a[196:197], v4 offset:12288
  v_cvt_pk_bf16_f32 v47, v30, v31
  v_mfma_f32_16x16x32_bf16 v[244:247], a[252:255], v[52:55], v[244:247]
  ds_read_b64_tr_b16 a[198:199], v4 offset:18432
  v_mfma_f32_16x16x32_bf16 v[248:251], a[252:255], v[56:59], v[248:251]
  v_mfma_f32_16x16x32_bf16 v[252:255], a[252:255], v[60:63], v[252:255]
  v_mul_f32_e32 v20, s25, v20
  v_mul_f32_e32 v21, s25, v21
  v_smfmac_f32_16x16x64_bf16 a[208:211], a[224:227], v[32:39], v0
  ds_read_b128 a[176:179], v1 offset:30848
  v_smfmac_f32_16x16x64_bf16 a[212:215], a[224:227], v[40:47], v0
  v_mul_f32_e32 v22, s25, v22
  v_mfma_f32_16x16x32_bf16 v[24:27], a[144:147], a[24:27], 0
  buffer_load_dwordx4 v8, s[12:15], s50 offen offset:1024 nt lds
  v_mfma_f32_16x16x32_bf16 v[24:27], a[148:151], a[28:31], v[24:27]
  v_exp_f32_e32 v20, v20
  v_mfma_f32_16x16x32_bf16 v[24:27], a[152:155], a[32:35], v[24:27]
  v_exp_f32_e32 v21, v21
  v_mfma_f32_16x16x32_bf16 v[24:27], a[156:159], a[36:39], v[24:27]
  ds_read_b64_tr_b16 a[200:201], v5 offset:12288
  v_mul_f32_e32 v23, s25, v23
  v_mfma_f32_16x16x32_bf16 v[24:27], a[160:163], a[40:43], v[24:27]
  v_exp_f32_e32 v22, v22
  v_mfma_f32_16x16x32_bf16 v[24:27], a[164:167], a[44:47], v[24:27]
  s_waitcnt lgkmcnt(2)
  ds_read_b64_tr_b16 a[202:203], v5 offset:18432
  v_cvt_pk_bf16_f32 v48, v20, v21
  v_mfma_f32_16x16x32_bf16 v[64:67], a[192:195], v[32:35], v[64:67]
  v_exp_f32_e32 v23, v23
  v_mfma_f32_16x16x32_bf16 v[68:71], a[192:195], v[36:39], v[68:71]
  buffer_load_dwordx4 v9, s[12:15], s50 offen offset:2048 nt lds
  v_mfma_f32_16x16x32_bf16 v[72:75], a[192:195], v[40:43], v[72:75]
  ds_read_b64_tr_b16 a[204:205], v6 offset:12288
  v_cvt_pk_bf16_f32 v49, v22, v23
  v_mfma_f32_16x16x32_bf16 v[76:79], a[192:195], v[44:47], v[76:79]
  ds_read_b128 a[180:183], v2 offset:30848
  v_mul_f32_e32 v24, s25, v24
  v_mfma_f32_16x16x32_bf16 v[80:83], a[196:199], v[32:35], v[80:83]
  ds_read_b64_tr_b16 a[206:207], v6 offset:18432
  v_mul_f32_e32 v25, s25, v25
  v_mfma_f32_16x16x32_bf16 v[84:87], a[196:199], v[36:39], v[84:87]
  v_exp_f32_e32 v24, v24
  v_mfma_f32_16x16x32_bf16 v[88:91], a[196:199], v[40:43], v[88:91]
  v_mul_f32_e32 v26, s25, v26
  v_mul_f32_e32 v27, s25, v27
  v_mfma_f32_16x16x32_bf16 v[28:31], a[144:147], a[48:51], 0
  s_add_u32 m0, s27, 49664
  v_exp_f32_e32 v25, v25
  v_mfma_f32_16x16x32_bf16 v[28:31], a[148:151], a[52:55], v[28:31]
  buffer_load_dwordx4 v7, s[8:11], s52 offen offset:0 nt lds
  v_mfma_f32_16x16x32_bf16 v[28:31], a[152:155], a[56:59], v[28:31]
  v_exp_f32_e32 v26, v26
  v_mfma_f32_16x16x32_bf16 v[28:31], a[156:159], a[60:63], v[28:31]
  ds_read_b128 a[184:187], v1 offset:30976
  v_cvt_pk_bf16_f32 v52, v24, v25
  v_mfma_f32_16x16x32_bf16 v[28:31], a[160:163], a[64:67], v[28:31]
  v_exp_f32_e32 v27, v27
  v_mfma_f32_16x16x32_bf16 v[28:31], a[164:167], a[68:71], v[28:31]
  ds_read_b64_tr_b16 a[232:233], v3 offset:12416
  v_cvt_pk_bf16_f32 v53, v26, v27
  v_mfma_f32_16x16x32_bf16 v[92:95], a[196:199], v[44:47], v[92:95]
  s_waitcnt lgkmcnt(2)
  ds_read_b64_tr_b16 a[234:235], v3 offset:18560
  v_mfma_f32_16x16x32_bf16 v[96:99], a[200:203], v[32:35], v[96:99]
  v_mfma_f32_16x16x32_bf16 v[100:103], a[200:203], v[36:39], v[100:103]
  v_mfma_f32_16x16x32_bf16 v[104:107], a[200:203], v[40:43], v[104:107]
  buffer_load_dwordx4 v8, s[8:11], s52 offen offset:1024 nt lds
  v_mfma_f32_16x16x32_bf16 v[108:111], a[200:203], v[44:47], v[108:111]
  ds_read_b128 a[188:191], v2 offset:30976
  v_mul_f32_e32 v28, s25, v28
  v_mfma_f32_16x16x32_bf16 v[112:115], a[204:207], v[32:35], v[112:115]
  v_mul_f32_e32 v29, s25, v29
  v_mul_f32_e32 v30, s25, v30
  v_mfma_f32_16x16x32_bf16 v[20:23], a[144:147], a[72:75], 0
  v_exp_f32_e32 v28, v28
  v_mfma_f32_16x16x32_bf16 v[20:23], a[148:151], a[76:79], v[20:23]
  v_exp_f32_e32 v29, v29
  v_mfma_f32_16x16x32_bf16 v[20:23], a[152:155], a[80:83], v[20:23]
  ds_read_b64_tr_b16 a[236:237], v4 offset:12416
  v_mul_f32_e32 v31, s25, v31
  v_mfma_f32_16x16x32_bf16 v[20:23], a[156:159], a[84:87], v[20:23]
  v_exp_f32_e32 v30, v30
  v_mfma_f32_16x16x32_bf16 v[20:23], a[160:163], a[88:91], v[20:23]
  ds_read_b64_tr_b16 a[238:239], v4 offset:18560
  v_cvt_pk_bf16_f32 v56, v28, v29
  v_mfma_f32_16x16x32_bf16 v[20:23], a[164:167], a[92:95], v[20:23]
  buffer_load_dwordx4 v9, s[8:11], s52 offen offset:2048 nt lds
  v_mfma_f32_16x16x32_bf16 v[116:119], a[204:207], v[36:39], v[116:119]
  v_exp_f32_e32 v31, v31
  v_mfma_f32_16x16x32_bf16 v[120:123], a[204:207], v[40:43], v[120:123]
  ds_read_b64_tr_b16 a[240:241], v5 offset:12416
  v_cvt_pk_bf16_f32 v57, v30, v31
  v_mfma_f32_16x16x32_bf16 v[124:127], a[204:207], v[44:47], v[124:127]
  s_waitcnt lgkmcnt(3)
  ds_read_b128 a[144:147], v1 offset:36864
  ds_read_b64_tr_b16 a[242:243], v5 offset:18560
  v_mfma_f32_16x16x32_bf16 v[128:131], a[232:235], v[32:35], v[128:131]
  v_mul_f32_e32 v20, s25, v20
  v_mul_f32_e32 v21, s25, v21
  v_mfma_f32_16x16x32_bf16 v[132:135], a[232:235], v[36:39], v[132:135]
  v_exp_f32_e32 v20, v20
  v_mfma_f32_16x16x32_bf16 v[136:139], a[232:235], v[40:43], v[136:139]
  s_add_u32 m0, s27, 37120
  v_mul_f32_e32 v22, s25, v22
  v_mul_f32_e32 v23, s25, v23
  v_mfma_f32_16x16x32_bf16 v[24:27], a[168:171], a[0:3], 0
  s_add_u32 s33, s32, 205824
  v_exp_f32_e32 v21, v21
  v_mfma_f32_16x16x32_bf16 v[24:27], a[172:175], a[4:7], v[24:27]
  buffer_load_dwordx4 v7, s[16:19], s33 offen offset:0 nt lds
  v_mfma_f32_16x16x32_bf16 v[24:27], a[176:179], a[8:11], v[24:27]
  v_exp_f32_e32 v22, v22
  v_mfma_f32_16x16x32_bf16 v[24:27], a[180:183], a[12:15], v[24:27]
  ds_read_b128 a[148:151], v2 offset:36864
  v_cvt_pk_bf16_f32 v60, v20, v21
  v_mfma_f32_16x16x32_bf16 v[24:27], a[184:187], a[16:19], v[24:27]
  v_exp_f32_e32 v23, v23
  v_mfma_f32_16x16x32_bf16 v[24:27], a[188:191], a[20:23], v[24:27]
  ds_read_b64_tr_b16 a[244:245], v6 offset:12416
  v_cvt_pk_bf16_f32 v61, v22, v23
  v_mfma_f32_16x16x32_bf16 v[140:143], a[232:235], v[44:47], v[140:143]
  s_waitcnt lgkmcnt(2)
  ds_read_b64_tr_b16 a[246:247], v6 offset:18560
  v_mfma_f32_16x16x32_bf16 v[144:147], a[236:239], v[32:35], v[144:147]
  v_mfma_f32_16x16x32_bf16 v[148:151], a[236:239], v[36:39], v[148:151]
  v_mfma_f32_16x16x32_bf16 v[152:155], a[236:239], v[40:43], v[152:155]
  buffer_load_dwordx4 v8, s[16:19], s33 offen offset:1024 nt lds
  v_mfma_f32_16x16x32_bf16 v[156:159], a[236:239], v[44:47], v[156:159]
  ds_read_b128 a[152:155], v1 offset:36992
  v_mul_f32_e32 v24, s25, v24
  v_mfma_f32_16x16x32_bf16 v[160:163], a[240:243], v[32:35], v[160:163]
  v_mul_f32_e32 v25, s25, v25
  v_mul_f32_e32 v26, s25, v26
  v_mfma_f32_16x16x32_bf16 v[28:31], a[168:171], a[24:27], 0
  v_exp_f32_e32 v24, v24
  v_mfma_f32_16x16x32_bf16 v[28:31], a[172:175], a[28:31], v[28:31]
  v_exp_f32_e32 v25, v25
  v_mfma_f32_16x16x32_bf16 v[28:31], a[176:179], a[32:35], v[28:31]
  ds_read_b64_tr_b16 a[248:249], v3 offset:12544
  v_mul_f32_e32 v27, s25, v27
  v_mfma_f32_16x16x32_bf16 v[28:31], a[180:183], a[36:39], v[28:31]
  v_exp_f32_e32 v26, v26
  v_mfma_f32_16x16x32_bf16 v[28:31], a[184:187], a[40:43], v[28:31]
  ds_read_b64_tr_b16 a[250:251], v3 offset:18688
  v_cvt_pk_bf16_f32 v50, v24, v25
  v_mfma_f32_16x16x32_bf16 v[28:31], a[188:191], a[44:47], v[28:31]
  buffer_load_dwordx4 v9, s[16:19], s33 offen offset:2048 nt lds
  v_mfma_f32_16x16x32_bf16 v[164:167], a[240:243], v[36:39], v[164:167]
  v_exp_f32_e32 v27, v27
  v_mfma_f32_16x16x32_bf16 v[168:171], a[240:243], v[40:43], v[168:171]
  ds_read_b64_tr_b16 a[252:253], v4 offset:12544
  v_cvt_pk_bf16_f32 v51, v26, v27
  v_mfma_f32_16x16x32_bf16 v[172:175], a[240:243], v[44:47], v[172:175]
  s_waitcnt lgkmcnt(3)
  ds_read_b128 a[156:159], v2 offset:36992
  ds_read_b64_tr_b16 a[254:255], v4 offset:18688
  v_mfma_f32_16x16x32_bf16 v[176:179], a[244:247], v[32:35], v[176:179]
  v_mul_f32_e32 v28, s25, v28
  v_mul_f32_e32 v29, s25, v29
  v_mfma_f32_16x16x32_bf16 v[180:183], a[244:247], v[36:39], v[180:183]
  v_exp_f32_e32 v28, v28
  v_mfma_f32_16x16x32_bf16 v[184:187], a[244:247], v[40:43], v[184:187]
  v_mul_f32_e32 v30, s25, v30
  v_mul_f32_e32 v31, s25, v31
  v_mfma_f32_16x16x32_bf16 v[188:191], a[244:247], v[44:47], v[188:191]
  v_exp_f32_e32 v29, v29
  v_mfma_f32_16x16x32_bf16 v[20:23], a[168:171], a[48:51], 0
  v_exp_f32_e32 v30, v30
  v_mfma_f32_16x16x32_bf16 v[20:23], a[172:175], a[52:55], v[20:23]
  ds_read_b128 a[160:163], v1 offset:37120
  v_cvt_pk_bf16_f32 v54, v28, v29
  v_mfma_f32_16x16x32_bf16 v[20:23], a[176:179], a[56:59], v[20:23]
  v_exp_f32_e32 v31, v31
  v_mfma_f32_16x16x32_bf16 v[20:23], a[180:183], a[60:63], v[20:23]
  ds_read_b64_tr_b16 a[192:193], v5 offset:12544
  v_cvt_pk_bf16_f32 v55, v30, v31
  v_mfma_f32_16x16x32_bf16 v[20:23], a[184:187], a[64:67], v[20:23]
  v_mfma_f32_16x16x32_bf16 v[20:23], a[188:191], a[68:71], v[20:23]
  s_waitcnt lgkmcnt(2)
  ds_read_b64_tr_b16 a[194:195], v5 offset:18688
  v_mfma_f32_16x16x32_bf16 v[192:195], a[248:251], v[32:35], v[192:195]
  v_mfma_f32_16x16x32_bf16 v[196:199], a[248:251], v[36:39], v[196:199]
  v_mfma_f32_16x16x32_bf16 v[200:203], a[248:251], v[40:43], v[200:203]
  v_mfma_f32_16x16x32_bf16 v[204:207], a[248:251], v[44:47], v[204:207]
  ds_read_b128 a[164:167], v2 offset:37120
  s_nop 0
  v_mul_f32_e32 v20, s25, v20
  v_mfma_f32_16x16x32_bf16 v[208:211], a[252:255], v[32:35], v[208:211]
  v_mul_f32_e32 v21, s25, v21
  v_mul_f32_e32 v22, s25, v22
  v_mfma_f32_16x16x32_bf16 v[212:215], a[252:255], v[36:39], v[212:215]
  v_exp_f32_e32 v20, v20
  v_mfma_f32_16x16x32_bf16 v[24:27], a[168:171], a[72:75], 0
  v_exp_f32_e32 v21, v21
  v_mfma_f32_16x16x32_bf16 v[24:27], a[172:175], a[76:79], v[24:27]
  ds_read_b64_tr_b16 a[196:197], v6 offset:12544
  v_mul_f32_e32 v23, s25, v23
  v_mfma_f32_16x16x32_bf16 v[24:27], a[176:179], a[80:83], v[24:27]
  v_exp_f32_e32 v22, v22
  v_mfma_f32_16x16x32_bf16 v[24:27], a[180:183], a[84:87], v[24:27]
  ds_read_b64_tr_b16 a[198:199], v6 offset:18688
  v_cvt_pk_bf16_f32 v58, v20, v21
  v_mfma_f32_16x16x32_bf16 v[24:27], a[184:187], a[88:91], v[24:27]
  v_exp_f32_e32 v23, v23
  v_mfma_f32_16x16x32_bf16 v[24:27], a[188:191], a[92:95], v[24:27]
  v_cvt_pk_bf16_f32 v59, v22, v23
  v_mfma_f32_16x16x32_bf16 v[216:219], a[252:255], v[40:43], v[216:219]
  ds_read_b128 a[168:171], v1 offset:43008
  v_mfma_f32_16x16x32_bf16 v[220:223], a[252:255], v[44:47], v[220:223]
  s_waitcnt lgkmcnt(3)
  v_mfma_f32_16x16x32_bf16 v[224:227], a[192:195], v[32:35], v[224:227]
  s_waitcnt vmcnt(11)
  s_barrier
  v_mfma_f32_16x16x32_bf16 v[228:231], a[192:195], v[36:39], v[228:231]
L_tr3:
  s_cbranch_execz L_tr7
  v_mul_f32_e32 v24, s25, v24
  v_mul_f32_e32 v25, s25, v25
  v_mfma_f32_16x16x32_bf16 v[232:235], a[192:195], v[40:43], v[232:235]
  v_exp_f32_e32 v24, v24
  v_mfma_f32_16x16x32_bf16 v[236:239], a[192:195], v[44:47], v[236:239]
  ds_read_b64_tr_b16 a[200:201], v3 offset:24576
  v_mul_f32_e32 v26, s25, v26
  v_mfma_f32_16x16x32_bf16 v[28:31], a[144:147], a[0:3], 0
  v_exp_f32_e32 v25, v25
  v_mfma_f32_16x16x32_bf16 v[28:31], a[148:151], a[4:7], v[28:31]
  s_add_u32 m0, s27, 147968
  v_mul_f32_e32 v27, s25, v27
  v_cvt_pk_bf16_f32 v62, v24, v25
  v_mfma_f32_16x16x32_bf16 v[28:31], a[152:155], a[8:11], v[28:31]
  buffer_load_dwordx4 v7, s[12:15], s51 offen offset:0 nt lds
  v_mfma_f32_16x16x32_bf16 v[28:31], a[156:159], a[12:15], v[28:31]
  v_exp_f32_e32 v26, v26
  v_mfma_f32_16x16x32_bf16 v[28:31], a[160:163], a[16:19], v[28:31]
  ds_read_b128 a[172:175], v2 offset:43008
  ds_read_b64_tr_b16 a[202:203], v3 offset:30720
  v_mfma_f32_16x16x32_bf16 v[28:31], a[164:167], a[20:23], v[28:31]
  s_waitcnt lgkmcnt(3)
  v_exp_f32_e32 v27, v27
  v_mfma_f32_16x16x32_bf16 v[240:243], a[196:199], v[32:35], v[240:243]
  ds_read_b64_tr_b16 a[204:205], v4 offset:24576
  v_cvt_pk_bf16_f32 v63, v26, v27
  v_mfma_f32_16x16x32_bf16 v[244:247], a[196:199], v[36:39], v[244:247]
  ds_read_b64_tr_b16 a[206:207], v4 offset:30720
  ds_read_b128 a[96:99], v19 offset:0
  v_mfma_f32_16x16x32_bf16 v[248:251], a[196:199], v[40:43], v[248:251]
  v_mfma_f32_16x16x32_bf16 v[252:255], a[196:199], v[44:47], v[252:255]
  v_mul_f32_e32 v28, s25, v28
  v_mul_f32_e32 v29, s25, v29
  v_smfmac_f32_16x16x64_bf16 a[208:211], a[224:227], v[48:55], v0
  ds_read_b128 a[100:103], v16 offset:0
  v_smfmac_f32_16x16x64_bf16 a[212:215], a[224:227], v[56:63], v0
  ds_read_b128 a[176:179], v1 offset:43136
  v_mfma_f32_16x16x32_bf16 v[20:23], a[144:147], a[24:27], 0
  buffer_load_dwordx4 v8, s[12:15], s51 offen offset:1024 nt lds
  v_mfma_f32_16x16x32_bf16 v[20:23], a[148:151], a[28:31], v[20:23]
  v_exp_f32_e32 v28, v28
  v_mfma_f32_16x16x32_bf16 v[20:23], a[152:155], a[32:35], v[20:23]
  ds_read_b128 a[104:107], v19 offset:128
  v_mul_f32_e32 v30, s25, v30
  v_mfma_f32_16x16x32_bf16 v[20:23], a[156:159], a[36:39], v[20:23]
  v_exp_f32_e32 v29, v29
  v_mfma_f32_16x16x32_bf16 v[20:23], a[160:163], a[40:43], v[20:23]
  ds_read_b64_tr_b16 a[232:233], v5 offset:24576
  v_mul_f32_e32 v31, s25, v31
  v_mfma_f32_16x16x32_bf16 v[20:23], a[164:167], a[44:47], v[20:23]
  s_waitcnt lgkmcnt(4)
  v_exp_f32_e32 v30, v30
  v_mfma_f32_16x16x32_bf16 v[64:67], a[200:203], v[48:51], v[64:67]
  ds_read_b128 a[108:111], v16 offset:128
  v_cvt_pk_bf16_f32 v32, v28, v29
  v_mfma_f32_16x16x32_bf16 v[68:71], a[200:203], v[52:55], v[68:71]
  v_exp_f32_e32 v31, v31
  v_mfma_f32_16x16x32_bf16 v[72:75], a[200:203], v[56:59], v[72:75]
  buffer_load_dwordx4 v9, s[12:15], s51 offen offset:2048 nt lds
  v_mfma_f32_16x16x32_bf16 v[76:79], a[200:203], v[60:63], v[76:79]
  ds_read_b64_tr_b16 a[234:235], v5 offset:30720
  v_cvt_pk_bf16_f32 v33, v30, v31
  v_mfma_f32_16x16x32_bf16 v[80:83], a[204:207], v[48:51], v[80:83]
  ds_read_b64_tr_b16 a[236:237], v6 offset:24576
  v_mul_f32_e32 v20, s25, v20
  v_mfma_f32_16x16x32_bf16 v[84:87], a[204:207], v[52:55], v[84:87]
  ds_read_b128 a[180:183], v2 offset:43136
  v_mul_f32_e32 v21, s25, v21
  v_mfma_f32_16x16x32_bf16 v[88:91], a[204:207], v[56:59], v[88:91]
  ds_read_b128 a[112:115], v19 offset:256
  v_mul_f32_e32 v22, s25, v22
  v_mfma_f32_16x16x32_bf16 v[24:27], a[144:147], a[48:51], 0
  s_add_u32 m0, s27, 61952
  v_exp_f32_e32 v20, v20
  v_mfma_f32_16x16x32_bf16 v[24:27], a[148:151], a[52:55], v[24:27]
  ds_read_b64_tr_b16 a[238:239], v6 offset:30720
  v_mul_f32_e32 v23, s25, v23
  v_mfma_f32_16x16x32_bf16 v[24:27], a[152:155], a[56:59], v[24:27]
  v_exp_f32_e32 v21, v21
  v_mfma_f32_16x16x32_bf16 v[24:27], a[156:159], a[60:63], v[24:27]
  buffer_load_dwordx4 v7, s[8:11], s53 offen offset:0 nt lds
  v_mfma_f32_16x16x32_bf16 v[24:27], a[160:163], a[64:67], v[24:27]
  ds_read_b128 a[116:119], v16 offset:256
  v_cvt_pk_bf16_f32 v36, v20, v21
  v_mfma_f32_16x16x32_bf16 v[24:27], a[164:167], a[68:71], v[24:27]
  v_exp_f32_e32 v22, v22
  v_mfma_f32_16x16x32_bf16 v[92:95], a[204:207], v[60:63], v[92:95]
  s_waitcnt lgkmcnt(3)
  ds_read_b128 a[184:187], v1 offset:43264
  ds_read_b64_tr_b16 a[240:241], v3 offset:24704
  v_mfma_f32_16x16x32_bf16 v[96:99], a[232:235], v[48:51], v[96:99]
  v_exp_f32_e32 v23, v23
  v_mfma_f32_16x16x32_bf16 v[100:103], a[232:235], v[52:55], v[100:103]
  ds_read_b64_tr_b16 a[242:243], v3 offset:30848
  v_cvt_pk_bf16_f32 v37, v22, v23
  v_mfma_f32_16x16x32_bf16 v[104:107], a[232:235], v[56:59], v[104:107]
  buffer_load_dwordx4 v8, s[8:11], s53 offen offset:1024 nt lds
  v_mfma_f32_16x16x32_bf16 v[108:111], a[232:235], v[60:63], v[108:111]
  s_waitcnt lgkmcnt(4)
  ds_read_b128 a[188:191], v2 offset:43264
  v_mul_f32_e32 v24, s25, v24
  v_mfma_f32_16x16x32_bf16 v[112:115], a[236:239], v[48:51], v[112:115]
  v_mul_f32_e32 v25, s25, v25
  v_mul_f32_e32 v26, s25, v26
  v_mfma_f32_16x16x32_bf16 v[28:31], a[144:147], a[72:75], 0
  v_exp_f32_e32 v24, v24
  v_mfma_f32_16x16x32_bf16 v[28:31], a[148:151], a[76:79], v[28:31]
  s_waitcnt lgkmcnt(4)
  v_exp_f32_e32 v25, v25
  v_mfma_f32_16x16x32_bf16 v[28:31], a[152:155], a[80:83], v[28:31]
  ds_read_b64_tr_b16 a[244:245], v4 offset:24704
  v_mul_f32_e32 v27, s25, v27
  v_mfma_f32_16x16x32_bf16 v[28:31], a[156:159], a[84:87], v[28:31]
  v_exp_f32_e32 v26, v26
  v_mfma_f32_16x16x32_bf16 v[28:31], a[160:163], a[88:91], v[28:31]
  ds_read_b64_tr_b16 a[246:247], v4 offset:30848
  v_cvt_pk_bf16_f32 v40, v24, v25
  v_mfma_f32_16x16x32_bf16 v[28:31], a[164:167], a[92:95], v[28:31]
  buffer_load_dwordx4 v9, s[8:11], s53 offen offset:2048 nt lds
  v_mfma_f32_16x16x32_bf16 v[116:119], a[236:239], v[52:55], v[116:119]
  v_exp_f32_e32 v27, v27
  v_mfma_f32_16x16x32_bf16 v[120:123], a[236:239], v[56:59], v[120:123]
  ds_read_b64_tr_b16 a[248:249], v5 offset:24704
  v_cvt_pk_bf16_f32 v41, v26, v27
  v_mfma_f32_16x16x32_bf16 v[124:127], a[236:239], v[60:63], v[124:127]
  s_waitcnt lgkmcnt(3)
  ds_read_b128 a[144:147], v1 offset:49152
  ds_read_b64_tr_b16 a[250:251], v5 offset:30848
  v_mfma_f32_16x16x32_bf16 v[128:131], a[240:243], v[48:51], v[128:131]
  v_mul_f32_e32 v28, s25, v28
  v_mul_f32_e32 v29, s25, v29
  v_mfma_f32_16x16x32_bf16 v[132:135], a[240:243], v[52:55], v[132:135]
  v_exp_f32_e32 v28, v28
  v_mfma_f32_16x16x32_bf16 v[136:139], a[240:243], v[56:59], v[136:139]
  s_add_u32 m0, s27, 0
  v_mul_f32_e32 v30, s25, v30
  v_mul_f32_e32 v31, s25, v31
  v_mfma_f32_16x16x32_bf16 v[20:23], a[168:171], a[0:3], 0
  s_add_u32 s33, s32, 208896
  v_exp_f32_e32 v29, v29
  v_mfma_f32_16x16x32_bf16 v[20:23], a[172:175], a[4:7], v[20:23]
  buffer_load_dwordx4 v7, s[16:19], s33 offen offset:0 nt lds
  v_mfma_f32_16x16x32_bf16 v[20:23], a[176:179], a[8:11], v[20:23]
  v_exp_f32_e32 v30, v30
  v_mfma_f32_16x16x32_bf16 v[20:23], a[180:183], a[12:15], v[20:23]
  ds_read_b128 a[148:151], v2 offset:49152
  v_cvt_pk_bf16_f32 v44, v28, v29
  v_mfma_f32_16x16x32_bf16 v[20:23], a[184:187], a[16:19], v[20:23]
  v_exp_f32_e32 v31, v31
  v_mfma_f32_16x16x32_bf16 v[20:23], a[188:191], a[20:23], v[20:23]
  ds_read_b64_tr_b16 a[252:253], v6 offset:24704
  v_cvt_pk_bf16_f32 v45, v30, v31
  v_mfma_f32_16x16x32_bf16 v[140:143], a[240:243], v[60:63], v[140:143]
  s_waitcnt lgkmcnt(2)
  ds_read_b64_tr_b16 a[254:255], v6 offset:30848
  v_mfma_f32_16x16x32_bf16 v[144:147], a[244:247], v[48:51], v[144:147]
  v_mfma_f32_16x16x32_bf16 v[148:151], a[244:247], v[52:55], v[148:151]
  v_mfma_f32_16x16x32_bf16 v[152:155], a[244:247], v[56:59], v[152:155]
  buffer_load_dwordx4 v8, s[16:19], s33 offen offset:1024 nt lds
  v_mfma_f32_16x16x32_bf16 v[156:159], a[244:247], v[60:63], v[156:159]
  ds_read_b128 a[152:155], v1 offset:49280
  v_mul_f32_e32 v20, s25, v20
  v_mfma_f32_16x16x32_bf16 v[160:163], a[248:251], v[48:51], v[160:163]
  v_mul_f32_e32 v21, s25, v21
  v_mul_f32_e32 v22, s25, v22
  v_mfma_f32_16x16x32_bf16 v[24:27], a[168:171], a[24:27], 0
  v_exp_f32_e32 v20, v20
  v_mfma_f32_16x16x32_bf16 v[24:27], a[172:175], a[28:31], v[24:27]
  v_exp_f32_e32 v21, v21
  v_mfma_f32_16x16x32_bf16 v[24:27], a[176:179], a[32:35], v[24:27]
  ds_read_b64_tr_b16 a[192:193], v3 offset:24832
  v_mul_f32_e32 v23, s25, v23
  v_mfma_f32_16x16x32_bf16 v[24:27], a[180:183], a[36:39], v[24:27]
  v_exp_f32_e32 v22, v22
  v_mfma_f32_16x16x32_bf16 v[24:27], a[184:187], a[40:43], v[24:27]
  ds_read_b64_tr_b16 a[194:195], v3 offset:30976
  v_cvt_pk_bf16_f32 v34, v20, v21
  v_mfma_f32_16x16x32_bf16 v[24:27], a[188:191], a[44:47], v[24:27]
  buffer_load_dwordx4 v9, s[16:19], s33 offen offset:2048 nt lds
  v_mfma_f32_16x16x32_bf16 v[164:167], a[248:251], v[52:55], v[164:167]
  v_exp_f32_e32 v23, v23
  v_mfma_f32_16x16x32_bf16 v[168:171], a[248:251], v[56:59], v[168:171]
  ds_read_b64_tr_b16 a[196:197], v4 offset:24832
  v_cvt_pk_bf16_f32 v35, v22, v23
  v_mfma_f32_16x16x32_bf16 v[172:175], a[248:251], v[60:63], v[172:175]
  s_waitcnt lgkmcnt(3)
  ds_read_b128 a[156:159], v2 offset:49280
  ds_read_b64_tr_b16 a[198:199], v4 offset:30976
  v_mfma_f32_16x16x32_bf16 v[176:179], a[252:255], v[48:51], v[176:179]
  v_mul_f32_e32 v24, s25, v24
  v_mul_f32_e32 v25, s25, v25
  v_mfma_f32_16x16x32_bf16 v[180:183], a[252:255], v[52:55], v[180:183]
  v_exp_f32_e32 v24, v24
  v_mfma_f32_16x16x32_bf16 v[184:187], a[252:255], v[56:59], v[184:187]
  v_mul_f32_e32 v26, s25, v26
  v_mul_f32_e32 v27, s25, v27
  v_mfma_f32_16x16x32_bf16 v[188:191], a[252:255], v[60:63], v[188:191]
  v_exp_f32_e32 v25, v25
  v_mfma_f32_16x16x32_bf16 v[28:31], a[168:171], a[48:51], 0
  v_exp_f32_e32 v26, v26
  v_mfma_f32_16x16x32_bf16 v[28:31], a[172:175], a[52:55], v[28:31]
  ds_read_b128 a[160:163], v1 offset:49408
  v_cvt_pk_bf16_f32 v38, v24, v25
  v_mfma_f32_16x16x32_bf16 v[28:31], a[176:179], a[56:59], v[28:31]
  v_exp_f32_e32 v27, v27
  v_mfma_f32_16x16x32_bf16 v[28:31], a[180:183], a[60:63], v[28:31]
  ds_read_b64_tr_b16 a[200:201], v5 offset:24832
  v_cvt_pk_bf16_f32 v39, v26, v27
  v_mfma_f32_16x16x32_bf16 v[28:31], a[184:187], a[64:67], v[28:31]
  v_mfma_f32_16x16x32_bf16 v[28:31], a[188:191], a[68:71], v[28:31]
  s_waitcnt lgkmcnt(2)
  ds_read_b64_tr_b16 a[202:203], v5 offset:30976
  v_mfma_f32_16x16x32_bf16 v[192:195], a[192:195], v[48:51], v[192:195]
  v_mfma_f32_16x16x32_bf16 v[196:199], a[192:195], v[52:55], v[196:199]
  v_mfma_f32_16x16x32_bf16 v[200:203], a[192:195], v[56:59], v[200:203]
  v_mfma_f32_16x16x32_bf16 v[204:207], a[192:195], v[60:63], v[204:207]
  ds_read_b128 a[164:167], v2 offset:49408
  s_nop 0
  v_mul_f32_e32 v28, s25, v28
  v_mfma_f32_16x16x32_bf16 v[208:211], a[196:199], v[48:51], v[208:211]
  v_mul_f32_e32 v29, s25, v29
  v_mul_f32_e32 v30, s25, v30
  v_mfma_f32_16x16x32_bf16 v[212:215], a[196:199], v[52:55], v[212:215]
  v_exp_f32_e32 v28, v28
  v_mfma_f32_16x16x32_bf16 v[20:23], a[168:171], a[72:75], 0
  v_exp_f32_e32 v29, v29
  v_mfma_f32_16x16x32_bf16 v[20:23], a[172:175], a[76:79], v[20:23]
  ds_read_b64_tr_b16 a[204:205], v6 offset:24832
  v_mul_f32_e32 v31, s25, v31
  v_mfma_f32_16x16x32_bf16 v[20:23], a[176:179], a[80:83], v[20:23]
  v_exp_f32_e32 v30, v30
  v_mfma_f32_16x16x32_bf16 v[20:23], a[180:183], a[84:87], v[20:23]
  ds_read_b64_tr_b16 a[206:207], v6 offset:30976
  v_cvt_pk_bf16_f32 v42, v28, v29
  v_mfma_f32_16x16x32_bf16 v[20:23], a[184:187], a[88:91], v[20:23]
  v_exp_f32_e32 v31, v31
  v_mfma_f32_16x16x32_bf16 v[20:23], a[188:191], a[92:95], v[20:23]
  v_cvt_pk_bf16_f32 v43, v30, v31
  v_mfma_f32_16x16x32_bf16 v[216:219], a[196:199], v[56:59], v[216:219]
  ds_read_b128 a[168:171], v1 offset:55296
  v_mfma_f32_16x16x32_bf16 v[220:223], a[196:199], v[60:63], v[220:223]
  s_waitcnt lgkmcnt(3)
  v_mfma_f32_16x16x32_bf16 v[224:227], a[200:203], v[48:51], v[224:227]
  s_waitcnt vmcnt(12)
  s_barrier
  v_mfma_f32_16x16x32_bf16 v[228:231], a[200:203], v[52:55], v[228:231]
  v_mul_f32_e32 v20, s25, v20
  v_mul_f32_e32 v21, s25, v21
  v_mfma_f32_16x16x32_bf16 v[232:235], a[200:203], v[56:59], v[232:235]
  v_exp_f32_e32 v20, v20
  v_mfma_f32_16x16x32_bf16 v[236:239], a[200:203], v[60:63], v[236:239]
  ds_read_b64_tr_b16 a[232:233], v3 offset:36864
  v_mul_f32_e32 v22, s25, v22
  v_mfma_f32_16x16x32_bf16 v[24:27], a[144:147], a[0:3], 0
  v_exp_f32_e32 v21, v21
  v_mfma_f32_16x16x32_bf16 v[24:27], a[148:151], a[4:7], v[24:27]
  s_add_u32 m0, s27, 111104
  v_mul_f32_e32 v23, s25, v23
  v_cvt_pk_bf16_f32 v46, v20, v21
  v_mfma_f32_16x16x32_bf16 v[24:27], a[152:155], a[8:11], v[24:27]
  buffer_load_dwordx4 v7, s[12:15], s52 offen offset:0 nt lds
  v_mfma_f32_16x16x32_bf16 v[24:27], a[156:159], a[12:15], v[24:27]
  v_exp_f32_e32 v22, v22
  v_mfma_f32_16x16x32_bf16 v[24:27], a[160:163], a[16:19], v[24:27]
  ds_read_b128 a[172:175], v2 offset:55296
  ds_read_b64_tr_b16 a[234:235], v3 offset:43008
  v_mfma_f32_16x16x32_bf16 v[24:27], a[164:167], a[20:23], v[24:27]
  s_waitcnt lgkmcnt(3)
  v_exp_f32_e32 v23, v23
  v_mfma_f32_16x16x32_bf16 v[240:243], a[204:207], v[48:51], v[240:243]
  ds_read_b64_tr_b16 a[236:237], v4 offset:36864
  v_cvt_pk_bf16_f32 v47, v22, v23
  v_mfma_f32_16x16x32_bf16 v[244:247], a[204:207], v[52:55], v[244:247]
  ds_read_b64_tr_b16 a[238:239], v4 offset:43008
  v_mfma_f32_16x16x32_bf16 v[248:251], a[204:207], v[56:59], v[248:251]
  v_mfma_f32_16x16x32_bf16 v[252:255], a[204:207], v[60:63], v[252:255]
  v_mul_f32_e32 v24, s25, v24
  v_mul_f32_e32 v25, s25, v25
  v_smfmac_f32_16x16x64_bf16 a[208:211], a[224:227], v[32:39], v0
  ds_read_b128 a[176:179], v1 offset:55424
  v_smfmac_f32_16x16x64_bf16 a[212:215], a[224:227], v[40:47], v0
  v_mul_f32_e32 v26, s25, v26
  v_mfma_f32_16x16x32_bf16 v[28:31], a[144:147], a[24:27], 0
  buffer_load_dwordx4 v8, s[12:15], s52 offen offset:1024 nt lds
  v_mfma_f32_16x16x32_bf16 v[28:31], a[148:151], a[28:31], v[28:31]
  v_exp_f32_e32 v24, v24
  v_mfma_f32_16x16x32_bf16 v[28:31], a[152:155], a[32:35], v[28:31]
  v_exp_f32_e32 v25, v25
  v_mfma_f32_16x16x32_bf16 v[28:31], a[156:159], a[36:39], v[28:31]
  ds_read_b64_tr_b16 a[240:241], v5 offset:36864
  v_mul_f32_e32 v27, s25, v27
  v_mfma_f32_16x16x32_bf16 v[28:31], a[160:163], a[40:43], v[28:31]
  v_exp_f32_e32 v26, v26
  v_mfma_f32_16x16x32_bf16 v[28:31], a[164:167], a[44:47], v[28:31]
  s_waitcnt lgkmcnt(2)
  ds_read_b64_tr_b16 a[242:243], v5 offset:43008
  v_cvt_pk_bf16_f32 v48, v24, v25
  v_mfma_f32_16x16x32_bf16 v[64:67], a[232:235], v[32:35], v[64:67]
  v_exp_f32_e32 v27, v27
  v_mfma_f32_16x16x32_bf16 v[68:71], a[232:235], v[36:39], v[68:71]
  buffer_load_dwordx4 v9, s[12:15], s52 offen offset:2048 nt lds
  v_mfma_f32_16x16x32_bf16 v[72:75], a[232:235], v[40:43], v[72:75]
  ds_read_b64_tr_b16 a[244:245], v6 offset:36864
  v_cvt_pk_bf16_f32 v49, v26, v27
  v_mfma_f32_16x16x32_bf16 v[76:79], a[232:235], v[44:47], v[76:79]
  ds_read_b128 a[180:183], v2 offset:55424
  v_mul_f32_e32 v28, s25, v28
  v_mfma_f32_16x16x32_bf16 v[80:83], a[236:239], v[32:35], v[80:83]
  ds_read_b64_tr_b16 a[246:247], v6 offset:43008
  v_mul_f32_e32 v29, s25, v29
  v_mfma_f32_16x16x32_bf16 v[84:87], a[236:239], v[36:39], v[84:87]
  v_exp_f32_e32 v28, v28
  v_mfma_f32_16x16x32_bf16 v[88:91], a[236:239], v[40:43], v[88:91]
  v_mul_f32_e32 v30, s25, v30
  v_mul_f32_e32 v31, s25, v31
  v_mfma_f32_16x16x32_bf16 v[20:23], a[144:147], a[48:51], 0
  s_add_u32 m0, s27, 74240
  v_exp_f32_e32 v29, v29
  v_mfma_f32_16x16x32_bf16 v[20:23], a[148:151], a[52:55], v[20:23]
  buffer_load_dwordx4 v7, s[8:11], s54 offen offset:0 nt lds
  v_mfma_f32_16x16x32_bf16 v[20:23], a[152:155], a[56:59], v[20:23]
  v_exp_f32_e32 v30, v30
  v_mfma_f32_16x16x32_bf16 v[20:23], a[156:159], a[60:63], v[20:23]
  ds_read_b128 a[184:187], v1 offset:55552
  v_cvt_pk_bf16_f32 v52, v28, v29
  v_mfma_f32_16x16x32_bf16 v[20:23], a[160:163], a[64:67], v[20:23]
  v_exp_f32_e32 v31, v31
  v_mfma_f32_16x16x32_bf16 v[20:23], a[164:167], a[68:71], v[20:23]
  ds_read_b64_tr_b16 a[248:249], v3 offset:36992
  v_cvt_pk_bf16_f32 v53, v30, v31
  v_mfma_f32_16x16x32_bf16 v[92:95], a[236:239], v[44:47], v[92:95]
  s_waitcnt lgkmcnt(2)
  ds_read_b64_tr_b16 a[250:251], v3 offset:43136
  v_mfma_f32_16x16x32_bf16 v[96:99], a[240:243], v[32:35], v[96:99]
  v_mfma_f32_16x16x32_bf16 v[100:103], a[240:243], v[36:39], v[100:103]
  v_mfma_f32_16x16x32_bf16 v[104:107], a[240:243], v[40:43], v[104:107]
  buffer_load_dwordx4 v8, s[8:11], s54 offen offset:1024 nt lds
  v_mfma_f32_16x16x32_bf16 v[108:111], a[240:243], v[44:47], v[108:111]
  ds_read_b128 a[188:191], v2 offset:55552
  v_mul_f32_e32 v20, s25, v20
  v_mfma_f32_16x16x32_bf16 v[112:115], a[244:247], v[32:35], v[112:115]
  v_mul_f32_e32 v21, s25, v21
  v_mul_f32_e32 v22, s25, v22
  v_mfma_f32_16x16x32_bf16 v[24:27], a[144:147], a[72:75], 0
  v_exp_f32_e32 v20, v20
  v_mfma_f32_16x16x32_bf16 v[24:27], a[148:151], a[76:79], v[24:27]
  v_exp_f32_e32 v21, v21
  v_mfma_f32_16x16x32_bf16 v[24:27], a[152:155], a[80:83], v[24:27]
  ds_read_b64_tr_b16 a[252:253], v4 offset:36992
  v_mul_f32_e32 v23, s25, v23
  v_mfma_f32_16x16x32_bf16 v[24:27], a[156:159], a[84:87], v[24:27]
  v_exp_f32_e32 v22, v22
  v_mfma_f32_16x16x32_bf16 v[24:27], a[160:163], a[88:91], v[24:27]
  ds_read_b64_tr_b16 a[254:255], v4 offset:43136
  v_cvt_pk_bf16_f32 v56, v20, v21
  v_mfma_f32_16x16x32_bf16 v[24:27], a[164:167], a[92:95], v[24:27]
  buffer_load_dwordx4 v9, s[8:11], s54 offen offset:2048 nt lds
  v_mfma_f32_16x16x32_bf16 v[116:119], a[244:247], v[36:39], v[116:119]
  v_exp_f32_e32 v23, v23
  v_mfma_f32_16x16x32_bf16 v[120:123], a[244:247], v[40:43], v[120:123]
  ds_read_b64_tr_b16 a[192:193], v5 offset:36992
  v_cvt_pk_bf16_f32 v57, v22, v23
  v_mfma_f32_16x16x32_bf16 v[124:127], a[244:247], v[44:47], v[124:127]
  s_waitcnt lgkmcnt(3)
  ds_read_b128 a[144:147], v1 offset:0
  ds_read_b64_tr_b16 a[194:195], v5 offset:43136
  v_mfma_f32_16x16x32_bf16 v[128:131], a[248:251], v[32:35], v[128:131]
  v_mul_f32_e32 v24, s25, v24
  v_mul_f32_e32 v25, s25, v25
  v_mfma_f32_16x16x32_bf16 v[132:135], a[248:251], v[36:39], v[132:135]
  v_exp_f32_e32 v24, v24
  v_mfma_f32_16x16x32_bf16 v[136:139], a[248:251], v[40:43], v[136:139]
  s_add_u32 m0, s27, 12288
  v_mul_f32_e32 v26, s25, v26
  v_mul_f32_e32 v27, s25, v27
  v_mfma_f32_16x16x32_bf16 v[28:31], a[168:171], a[0:3], 0
  s_add_u32 s33, s32, 211968
  v_exp_f32_e32 v25, v25
  v_mfma_f32_16x16x32_bf16 v[28:31], a[172:175], a[4:7], v[28:31]
  buffer_load_dwordx4 v7, s[16:19], s33 offen offset:0 nt lds
  v_mfma_f32_16x16x32_bf16 v[28:31], a[176:179], a[8:11], v[28:31]
  v_exp_f32_e32 v26, v26
  v_mfma_f32_16x16x32_bf16 v[28:31], a[180:183], a[12:15], v[28:31]
  ds_read_b128 a[148:151], v2 offset:0
  v_cvt_pk_bf16_f32 v60, v24, v25
  v_mfma_f32_16x16x32_bf16 v[28:31], a[184:187], a[16:19], v[28:31]
  v_exp_f32_e32 v27, v27
  v_mfma_f32_16x16x32_bf16 v[28:31], a[188:191], a[20:23], v[28:31]
  ds_read_b64_tr_b16 a[196:197], v6 offset:36992
  v_cvt_pk_bf16_f32 v61, v26, v27
  v_mfma_f32_16x16x32_bf16 v[140:143], a[248:251], v[44:47], v[140:143]
  s_waitcnt lgkmcnt(2)
  ds_read_b64_tr_b16 a[198:199], v6 offset:43136
  v_mfma_f32_16x16x32_bf16 v[144:147], a[252:255], v[32:35], v[144:147]
  v_mfma_f32_16x16x32_bf16 v[148:151], a[252:255], v[36:39], v[148:151]
  v_mfma_f32_16x16x32_bf16 v[152:155], a[252:255], v[40:43], v[152:155]
  buffer_load_dwordx4 v8, s[16:19], s33 offen offset:1024 nt lds
  v_mfma_f32_16x16x32_bf16 v[156:159], a[252:255], v[44:47], v[156:159]
  ds_read_b128 a[152:155], v1 offset:128
  v_mul_f32_e32 v28, s25, v28
  v_mfma_f32_16x16x32_bf16 v[160:163], a[192:195], v[32:35], v[160:163]
  v_mul_f32_e32 v29, s25, v29
  v_mul_f32_e32 v30, s25, v30
  v_mfma_f32_16x16x32_bf16 v[20:23], a[168:171], a[24:27], 0
  v_exp_f32_e32 v28, v28
  v_mfma_f32_16x16x32_bf16 v[20:23], a[172:175], a[28:31], v[20:23]
  v_exp_f32_e32 v29, v29
  v_mfma_f32_16x16x32_bf16 v[20:23], a[176:179], a[32:35], v[20:23]
  ds_read_b64_tr_b16 a[200:201], v3 offset:37120
  v_mul_f32_e32 v31, s25, v31
  v_mfma_f32_16x16x32_bf16 v[20:23], a[180:183], a[36:39], v[20:23]
  v_exp_f32_e32 v30, v30
  v_mfma_f32_16x16x32_bf16 v[20:23], a[184:187], a[40:43], v[20:23]
  ds_read_b64_tr_b16 a[202:203], v3 offset:43264
  v_cvt_pk_bf16_f32 v50, v28, v29
  v_mfma_f32_16x16x32_bf16 v[20:23], a[188:191], a[44:47], v[20:23]
  buffer_load_dwordx4 v9, s[16:19], s33 offen offset:2048 nt lds
  v_mfma_f32_16x16x32_bf16 v[164:167], a[192:195], v[36:39], v[164:167]
  v_exp_f32_e32 v31, v31
  v_mfma_f32_16x16x32_bf16 v[168:171], a[192:195], v[40:43], v[168:171]
  ds_read_b64_tr_b16 a[204:205], v4 offset:37120
  v_cvt_pk_bf16_f32 v51, v30, v31
  v_mfma_f32_16x16x32_bf16 v[172:175], a[192:195], v[44:47], v[172:175]
  s_waitcnt lgkmcnt(3)
  ds_read_b128 a[156:159], v2 offset:128
  ds_read_b64_tr_b16 a[206:207], v4 offset:43264
  v_mfma_f32_16x16x32_bf16 v[176:179], a[196:199], v[32:35], v[176:179]
  v_mul_f32_e32 v20, s25, v20
  v_mul_f32_e32 v21, s25, v21
  v_mfma_f32_16x16x32_bf16 v[180:183], a[196:199], v[36:39], v[180:183]
  v_exp_f32_e32 v20, v20
  v_mfma_f32_16x16x32_bf16 v[184:187], a[196:199], v[40:43], v[184:187]
  v_mul_f32_e32 v22, s25, v22
  v_mul_f32_e32 v23, s25, v23
  v_mfma_f32_16x16x32_bf16 v[188:191], a[196:199], v[44:47], v[188:191]
  v_exp_f32_e32 v21, v21
  v_mfma_f32_16x16x32_bf16 v[24:27], a[168:171], a[48:51], 0
  v_exp_f32_e32 v22, v22
  v_mfma_f32_16x16x32_bf16 v[24:27], a[172:175], a[52:55], v[24:27]
  ds_read_b128 a[160:163], v1 offset:256
  v_cvt_pk_bf16_f32 v54, v20, v21
  v_mfma_f32_16x16x32_bf16 v[24:27], a[176:179], a[56:59], v[24:27]
  v_exp_f32_e32 v23, v23
  v_mfma_f32_16x16x32_bf16 v[24:27], a[180:183], a[60:63], v[24:27]
  ds_read_b64_tr_b16 a[232:233], v5 offset:37120
  v_cvt_pk_bf16_f32 v55, v22, v23
  v_mfma_f32_16x16x32_bf16 v[24:27], a[184:187], a[64:67], v[24:27]
  v_mfma_f32_16x16x32_bf16 v[24:27], a[188:191], a[68:71], v[24:27]
  s_waitcnt lgkmcnt(2)
  ds_read_b64_tr_b16 a[234:235], v5 offset:43264
  v_mfma_f32_16x16x32_bf16 v[192:195], a[200:203], v[32:35], v[192:195]
  v_mfma_f32_16x16x32_bf16 v[196:199], a[200:203], v[36:39], v[196:199]
  v_mfma_f32_16x16x32_bf16 v[200:203], a[200:203], v[40:43], v[200:203]
  v_mfma_f32_16x16x32_bf16 v[204:207], a[200:203], v[44:47], v[204:207]
  ds_read_b128 a[164:167], v2 offset:256
  s_nop 0
  v_mul_f32_e32 v24, s25, v24
  v_mfma_f32_16x16x32_bf16 v[208:211], a[204:207], v[32:35], v[208:211]
  v_mul_f32_e32 v25, s25, v25
  v_mul_f32_e32 v26, s25, v26
  v_mfma_f32_16x16x32_bf16 v[212:215], a[204:207], v[36:39], v[212:215]
  v_exp_f32_e32 v24, v24
  v_mfma_f32_16x16x32_bf16 v[28:31], a[168:171], a[72:75], 0
  v_exp_f32_e32 v25, v25
  v_mfma_f32_16x16x32_bf16 v[28:31], a[172:175], a[76:79], v[28:31]
  ds_read_b64_tr_b16 a[236:237], v6 offset:37120
  v_mul_f32_e32 v27, s25, v27
  v_mfma_f32_16x16x32_bf16 v[28:31], a[176:179], a[80:83], v[28:31]
  v_exp_f32_e32 v26, v26
  v_mfma_f32_16x16x32_bf16 v[28:31], a[180:183], a[84:87], v[28:31]
  ds_read_b64_tr_b16 a[238:239], v6 offset:43264
  v_cvt_pk_bf16_f32 v58, v24, v25
  v_mfma_f32_16x16x32_bf16 v[28:31], a[184:187], a[88:91], v[28:31]
  v_exp_f32_e32 v27, v27
  v_mfma_f32_16x16x32_bf16 v[28:31], a[188:191], a[92:95], v[28:31]
  v_cvt_pk_bf16_f32 v59, v26, v27
  v_mfma_f32_16x16x32_bf16 v[216:219], a[204:207], v[40:43], v[216:219]
  ds_read_b128 a[168:171], v1 offset:6144
  v_mfma_f32_16x16x32_bf16 v[220:223], a[204:207], v[44:47], v[220:223]
  s_waitcnt lgkmcnt(3)
  v_mfma_f32_16x16x32_bf16 v[224:227], a[232:235], v[32:35], v[224:227]
  s_waitcnt vmcnt(12)
  s_barrier
  v_mfma_f32_16x16x32_bf16 v[228:231], a[232:235], v[36:39], v[228:231]
  v_mul_f32_e32 v28, s25, v28
  v_mul_f32_e32 v29, s25, v29
  v_mfma_f32_16x16x32_bf16 v[232:235], a[232:235], v[40:43], v[232:235]
  v_exp_f32_e32 v28, v28
  v_mfma_f32_16x16x32_bf16 v[236:239], a[232:235], v[44:47], v[236:239]
  ds_read_b64_tr_b16 a[240:241], v3 offset:49152
  v_mul_f32_e32 v30, s25, v30
  v_mfma_f32_16x16x32_bf16 v[20:23], a[144:147], a[0:3], 0
  v_exp_f32_e32 v29, v29
  v_mfma_f32_16x16x32_bf16 v[20:23], a[148:151], a[4:7], v[20:23]
  s_add_u32 m0, s27, 123392
  v_mul_f32_e32 v31, s25, v31
  v_cvt_pk_bf16_f32 v62, v28, v29
  v_mfma_f32_16x16x32_bf16 v[20:23], a[152:155], a[8:11], v[20:23]
  buffer_load_dwordx4 v7, s[12:15], s53 offen offset:0 nt lds
  v_mfma_f32_16x16x32_bf16 v[20:23], a[156:159], a[12:15], v[20:23]
  v_exp_f32_e32 v30, v30
  v_mfma_f32_16x16x32_bf16 v[20:23], a[160:163], a[16:19], v[20:23]
  ds_read_b128 a[172:175], v2 offset:6144
  ds_read_b64_tr_b16 a[242:243], v3 offset:55296
  v_mfma_f32_16x16x32_bf16 v[20:23], a[164:167], a[20:23], v[20:23]
  s_waitcnt lgkmcnt(3)
  v_exp_f32_e32 v31, v31
  v_mfma_f32_16x16x32_bf16 v[240:243], a[236:239], v[32:35], v[240:243]
  ds_read_b64_tr_b16 a[244:245], v4 offset:49152
  v_cvt_pk_bf16_f32 v63, v30, v31
  v_mfma_f32_16x16x32_bf16 v[244:247], a[236:239], v[36:39], v[244:247]
  ds_read_b64_tr_b16 a[246:247], v4 offset:55296
  ds_read_b128 a[120:123], v19 offset:24832
  v_mfma_f32_16x16x32_bf16 v[248:251], a[236:239], v[40:43], v[248:251]
  v_mfma_f32_16x16x32_bf16 v[252:255], a[236:239], v[44:47], v[252:255]
  v_mul_f32_e32 v20, s25, v20
  v_mul_f32_e32 v21, s25, v21
  v_smfmac_f32_16x16x64_bf16 a[208:211], a[224:227], v[48:55], v0
  ds_read_b128 a[124:127], v16 offset:24832
  v_smfmac_f32_16x16x64_bf16 a[212:215], a[224:227], v[56:63], v0
  ds_read_b128 a[176:179], v1 offset:6272
  v_mfma_f32_16x16x32_bf16 v[24:27], a[144:147], a[24:27], 0
  buffer_load_dwordx4 v8, s[12:15], s53 offen offset:1024 nt lds
  v_mfma_f32_16x16x32_bf16 v[24:27], a[148:151], a[28:31], v[24:27]
  v_exp_f32_e32 v20, v20
  v_mfma_f32_16x16x32_bf16 v[24:27], a[152:155], a[32:35], v[24:27]
  ds_read_b128 a[128:131], v19 offset:24960
  v_mul_f32_e32 v22, s25, v22
  v_mfma_f32_16x16x32_bf16 v[24:27], a[156:159], a[36:39], v[24:27]
  v_exp_f32_e32 v21, v21
  v_mfma_f32_16x16x32_bf16 v[24:27], a[160:163], a[40:43], v[24:27]
  ds_read_b64_tr_b16 a[248:249], v5 offset:49152
  v_mul_f32_e32 v23, s25, v23
  v_mfma_f32_16x16x32_bf16 v[24:27], a[164:167], a[44:47], v[24:27]
  s_waitcnt lgkmcnt(4)
  v_exp_f32_e32 v22, v22
  v_mfma_f32_16x16x32_bf16 v[64:67], a[240:243], v[48:51], v[64:67]
  ds_read_b128 a[132:135], v16 offset:24960
  v_cvt_pk_bf16_f32 v32, v20, v21
  v_mfma_f32_16x16x32_bf16 v[68:71], a[240:243], v[52:55], v[68:71]
  v_exp_f32_e32 v23, v23
  v_mfma_f32_16x16x32_bf16 v[72:75], a[240:243], v[56:59], v[72:75]
  buffer_load_dwordx4 v9, s[12:15], s53 offen offset:2048 nt lds
  v_mfma_f32_16x16x32_bf16 v[76:79], a[240:243], v[60:63], v[76:79]
  ds_read_b64_tr_b16 a[250:251], v5 offset:55296
  v_cvt_pk_bf16_f32 v33, v22, v23
  v_mfma_f32_16x16x32_bf16 v[80:83], a[244:247], v[48:51], v[80:83]
  ds_read_b64_tr_b16 a[252:253], v6 offset:49152
  v_mul_f32_e32 v24, s25, v24
  v_mfma_f32_16x16x32_bf16 v[84:87], a[244:247], v[52:55], v[84:87]
  ds_read_b128 a[180:183], v2 offset:6272
  v_mul_f32_e32 v25, s25, v25
  v_mfma_f32_16x16x32_bf16 v[88:91], a[244:247], v[56:59], v[88:91]
  ds_read_b128 a[136:139], v19 offset:25088
  v_mul_f32_e32 v26, s25, v26
  v_mfma_f32_16x16x32_bf16 v[28:31], a[144:147], a[48:51], 0
  s_add_u32 m0, s27, 86528
  v_exp_f32_e32 v24, v24
  v_mfma_f32_16x16x32_bf16 v[28:31], a[148:151], a[52:55], v[28:31]
  ds_read_b64_tr_b16 a[254:255], v6 offset:55296
  v_mul_f32_e32 v27, s25, v27
  v_mfma_f32_16x16x32_bf16 v[28:31], a[152:155], a[56:59], v[28:31]
  v_exp_f32_e32 v25, v25
  v_mfma_f32_16x16x32_bf16 v[28:31], a[156:159], a[60:63], v[28:31]
  buffer_load_dwordx4 v7, s[8:11], s55 offen offset:0 nt lds
  v_mfma_f32_16x16x32_bf16 v[28:31], a[160:163], a[64:67], v[28:31]
  ds_read_b128 a[140:143], v16 offset:25088
  v_cvt_pk_bf16_f32 v36, v24, v25
  v_mfma_f32_16x16x32_bf16 v[28:31], a[164:167], a[68:71], v[28:31]
  v_exp_f32_e32 v26, v26
  v_mfma_f32_16x16x32_bf16 v[92:95], a[244:247], v[60:63], v[92:95]
  s_waitcnt lgkmcnt(3)
  ds_read_b128 a[184:187], v1 offset:6400
  ds_read_b64_tr_b16 a[192:193], v3 offset:49280
  v_mfma_f32_16x16x32_bf16 v[96:99], a[248:251], v[48:51], v[96:99]
  v_exp_f32_e32 v27, v27
  v_mfma_f32_16x16x32_bf16 v[100:103], a[248:251], v[52:55], v[100:103]
  ds_read_b64_tr_b16 a[194:195], v3 offset:55424
  v_cvt_pk_bf16_f32 v37, v26, v27
  v_mfma_f32_16x16x32_bf16 v[104:107], a[248:251], v[56:59], v[104:107]
  buffer_load_dwordx4 v8, s[8:11], s55 offen offset:1024 nt lds
  v_mfma_f32_16x16x32_bf16 v[108:111], a[248:251], v[60:63], v[108:111]
  s_waitcnt lgkmcnt(4)
  ds_read_b128 a[188:191], v2 offset:6400
  v_mul_f32_e32 v28, s25, v28
  v_mfma_f32_16x16x32_bf16 v[112:115], a[252:255], v[48:51], v[112:115]
  v_mul_f32_e32 v29, s25, v29
  v_mul_f32_e32 v30, s25, v30
  v_mfma_f32_16x16x32_bf16 v[20:23], a[144:147], a[72:75], 0
  v_exp_f32_e32 v28, v28
  v_mfma_f32_16x16x32_bf16 v[20:23], a[148:151], a[76:79], v[20:23]
  s_waitcnt lgkmcnt(4)
  v_exp_f32_e32 v29, v29
  v_mfma_f32_16x16x32_bf16 v[20:23], a[152:155], a[80:83], v[20:23]
  ds_read_b64_tr_b16 a[196:197], v4 offset:49280
  v_mul_f32_e32 v31, s25, v31
  v_mfma_f32_16x16x32_bf16 v[20:23], a[156:159], a[84:87], v[20:23]
  v_exp_f32_e32 v30, v30
  v_mfma_f32_16x16x32_bf16 v[20:23], a[160:163], a[88:91], v[20:23]
  ds_read_b64_tr_b16 a[198:199], v4 offset:55424
  v_cvt_pk_bf16_f32 v40, v28, v29
  v_mfma_f32_16x16x32_bf16 v[20:23], a[164:167], a[92:95], v[20:23]
  buffer_load_dwordx4 v9, s[8:11], s55 offen offset:2048 nt lds
  v_mfma_f32_16x16x32_bf16 v[116:119], a[252:255], v[52:55], v[116:119]
  v_exp_f32_e32 v31, v31
  v_mfma_f32_16x16x32_bf16 v[120:123], a[252:255], v[56:59], v[120:123]
L_tr4:
  s_cbranch_execz L_tr8
  ds_read_b64_tr_b16 a[200:201], v5 offset:49280
  v_cvt_pk_bf16_f32 v41, v30, v31
  v_mfma_f32_16x16x32_bf16 v[124:127], a[252:255], v[60:63], v[124:127]
  s_waitcnt lgkmcnt(3)
  ds_read_b128 a[144:147], v1 offset:12288
  ds_read_b64_tr_b16 a[202:203], v5 offset:55424
  v_mfma_f32_16x16x32_bf16 v[128:131], a[192:195], v[48:51], v[128:131]
  v_mul_f32_e32 v20, s25, v20
  v_mul_f32_e32 v21, s25, v21
  v_mfma_f32_16x16x32_bf16 v[132:135], a[192:195], v[52:55], v[132:135]
  v_exp_f32_e32 v20, v20
  v_mfma_f32_16x16x32_bf16 v[136:139], a[192:195], v[56:59], v[136:139]
  s_add_u32 m0, s27, 24832
  v_mul_f32_e32 v22, s25, v22
  v_mul_f32_e32 v23, s25, v23
  v_mfma_f32_16x16x32_bf16 v[24:27], a[168:171], a[0:3], 0
  s_add_u32 s33, s32, 215040
  v_exp_f32_e32 v21, v21
  v_mfma_f32_16x16x32_bf16 v[24:27], a[172:175], a[4:7], v[24:27]
  buffer_load_dwordx4 v7, s[16:19], s33 offen offset:0 nt lds
  v_mfma_f32_16x16x32_bf16 v[24:27], a[176:179], a[8:11], v[24:27]
  v_exp_f32_e32 v22, v22
  v_mfma_f32_16x16x32_bf16 v[24:27], a[180:183], a[12:15], v[24:27]
  ds_read_b128 a[148:151], v2 offset:12288
  v_cvt_pk_bf16_f32 v44, v20, v21
  v_mfma_f32_16x16x32_bf16 v[24:27], a[184:187], a[16:19], v[24:27]
  v_exp_f32_e32 v23, v23
  v_mfma_f32_16x16x32_bf16 v[24:27], a[188:191], a[20:23], v[24:27]
  ds_read_b64_tr_b16 a[204:205], v6 offset:49280
  v_cvt_pk_bf16_f32 v45, v22, v23
  v_mfma_f32_16x16x32_bf16 v[140:143], a[192:195], v[60:63], v[140:143]
  s_waitcnt lgkmcnt(2)
  ds_read_b64_tr_b16 a[206:207], v6 offset:55424
  v_mfma_f32_16x16x32_bf16 v[144:147], a[196:199], v[48:51], v[144:147]
  v_mfma_f32_16x16x32_bf16 v[148:151], a[196:199], v[52:55], v[148:151]
  v_mfma_f32_16x16x32_bf16 v[152:155], a[196:199], v[56:59], v[152:155]
  buffer_load_dwordx4 v8, s[16:19], s33 offen offset:1024 nt lds
  v_mfma_f32_16x16x32_bf16 v[156:159], a[196:199], v[60:63], v[156:159]
  ds_read_b128 a[152:155], v1 offset:12416
  v_mul_f32_e32 v24, s25, v24
  v_mfma_f32_16x16x32_bf16 v[160:163], a[200:203], v[48:51], v[160:163]
  v_mul_f32_e32 v25, s25, v25
  v_mul_f32_e32 v26, s25, v26
  v_mfma_f32_16x16x32_bf16 v[28:31], a[168:171], a[24:27], 0
  v_exp_f32_e32 v24, v24
  v_mfma_f32_16x16x32_bf16 v[28:31], a[172:175], a[28:31], v[28:31]
  v_exp_f32_e32 v25, v25
  v_mfma_f32_16x16x32_bf16 v[28:31], a[176:179], a[32:35], v[28:31]
  ds_read_b64_tr_b16 a[232:233], v3 offset:49408
  v_mul_f32_e32 v27, s25, v27
  v_mfma_f32_16x16x32_bf16 v[28:31], a[180:183], a[36:39], v[28:31]
  v_exp_f32_e32 v26, v26
  v_mfma_f32_16x16x32_bf16 v[28:31], a[184:187], a[40:43], v[28:31]
  ds_read_b64_tr_b16 a[234:235], v3 offset:55552
  v_cvt_pk_bf16_f32 v34, v24, v25
  v_mfma_f32_16x16x32_bf16 v[28:31], a[188:191], a[44:47], v[28:31]
  v_exp_f32_e32 v27, v27
  v_mfma_f32_16x16x32_bf16 v[164:167], a[200:203], v[52:55], v[164:167]
  ds_read_b64_tr_b16 a[236:237], v4 offset:49408
  v_cvt_pk_bf16_f32 v35, v26, v27
  v_mfma_f32_16x16x32_bf16 v[168:171], a[200:203], v[56:59], v[168:171]
  ds_read_b128 a[156:159], v2 offset:12416
  v_mfma_f32_16x16x32_bf16 v[172:175], a[200:203], v[60:63], v[172:175]
  s_waitcnt lgkmcnt(4)
  ds_read_b64_tr_b16 a[238:239], v4 offset:55552
  v_mfma_f32_16x16x32_bf16 v[176:179], a[204:207], v[48:51], v[176:179]
  v_mul_f32_e32 v28, s25, v28
  v_mul_f32_e32 v29, s25, v29
  v_mfma_f32_16x16x32_bf16 v[180:183], a[204:207], v[52:55], v[180:183]
  v_exp_f32_e32 v28, v28
  v_mfma_f32_16x16x32_bf16 v[184:187], a[204:207], v[56:59], v[184:187]
  v_mul_f32_e32 v30, s25, v30
  v_mul_f32_e32 v31, s25, v31
  v_mfma_f32_16x16x32_bf16 v[188:191], a[204:207], v[60:63], v[188:191]
  v_exp_f32_e32 v29, v29
  v_mfma_f32_16x16x32_bf16 v[20:23], a[168:171], a[48:51], 0
  v_exp_f32_e32 v30, v30
  v_mfma_f32_16x16x32_bf16 v[20:23], a[172:175], a[52:55], v[20:23]
  ds_read_b128 a[160:163], v1 offset:12544
  v_cvt_pk_bf16_f32 v38, v28, v29
  v_mfma_f32_16x16x32_bf16 v[20:23], a[176:179], a[56:59], v[20:23]
  v_exp_f32_e32 v31, v31
  v_mfma_f32_16x16x32_bf16 v[20:23], a[180:183], a[60:63], v[20:23]
  ds_read_b64_tr_b16 a[240:241], v5 offset:49408
  v_cvt_pk_bf16_f32 v39, v30, v31
  v_mfma_f32_16x16x32_bf16 v[20:23], a[184:187], a[64:67], v[20:23]
  v_mfma_f32_16x16x32_bf16 v[20:23], a[188:191], a[68:71], v[20:23]
  s_waitcnt lgkmcnt(2)
  ds_read_b64_tr_b16 a[242:243], v5 offset:55552
  v_mfma_f32_16x16x32_bf16 v[192:195], a[232:235], v[48:51], v[192:195]
  v_mfma_f32_16x16x32_bf16 v[196:199], a[232:235], v[52:55], v[196:199]
  v_mfma_f32_16x16x32_bf16 v[200:203], a[232:235], v[56:59], v[200:203]
  v_mfma_f32_16x16x32_bf16 v[204:207], a[232:235], v[60:63], v[204:207]
  ds_read_b128 a[164:167], v2 offset:12544
  s_nop 0
  v_mul_f32_e32 v20, s25, v20
  v_mfma_f32_16x16x32_bf16 v[208:211], a[236:239], v[48:51], v[208:211]
  v_mul_f32_e32 v21, s25, v21
  v_mul_f32_e32 v22, s25, v22
  v_mfma_f32_16x16x32_bf16 v[212:215], a[236:239], v[52:55], v[212:215]
  v_exp_f32_e32 v20, v20
  v_mfma_f32_16x16x32_bf16 v[24:27], a[168:171], a[72:75], 0
  v_exp_f32_e32 v21, v21
  v_mfma_f32_16x16x32_bf16 v[24:27], a[172:175], a[76:79], v[24:27]
  ds_read_b64_tr_b16 a[244:245], v6 offset:49408
  v_mul_f32_e32 v23, s25, v23
  v_mfma_f32_16x16x32_bf16 v[24:27], a[176:179], a[80:83], v[24:27]
  v_exp_f32_e32 v22, v22
  v_mfma_f32_16x16x32_bf16 v[24:27], a[180:183], a[84:87], v[24:27]
  ds_read_b64_tr_b16 a[246:247], v6 offset:55552
  v_cvt_pk_bf16_f32 v42, v20, v21
  v_mfma_f32_16x16x32_bf16 v[24:27], a[184:187], a[88:91], v[24:27]
  v_exp_f32_e32 v23, v23
  v_mfma_f32_16x16x32_bf16 v[24:27], a[188:191], a[92:95], v[24:27]
  v_cvt_pk_bf16_f32 v43, v22, v23
  v_mfma_f32_16x16x32_bf16 v[216:219], a[236:239], v[56:59], v[216:219]
  ds_read_b128 a[168:171], v1 offset:18432
  v_mfma_f32_16x16x32_bf16 v[220:223], a[236:239], v[60:63], v[220:223]
  s_waitcnt lgkmcnt(3)
  v_mfma_f32_16x16x32_bf16 v[224:227], a[240:243], v[48:51], v[224:227]
  s_waitcnt vmcnt(11)
  s_barrier
  v_mfma_f32_16x16x32_bf16 v[228:231], a[240:243], v[52:55], v[228:231]
  v_mul_f32_e32 v24, s25, v24
  v_mul_f32_e32 v25, s25, v25
  v_mfma_f32_16x16x32_bf16 v[232:235], a[240:243], v[56:59], v[232:235]
  v_exp_f32_e32 v24, v24
  v_mfma_f32_16x16x32_bf16 v[236:239], a[240:243], v[60:63], v[236:239]
  ds_read_b64_tr_b16 a[248:249], v3 offset:12288
  v_mul_f32_e32 v26, s25, v26
  v_mfma_f32_16x16x32_bf16 v[28:31], a[144:147], a[0:3], 0
  v_exp_f32_e32 v25, v25
  v_mfma_f32_16x16x32_bf16 v[28:31], a[148:151], a[4:7], v[28:31]
  s_add_u32 m0, s27, 135680
  v_mul_f32_e32 v27, s25, v27
  v_cvt_pk_bf16_f32 v46, v24, v25
  v_mfma_f32_16x16x32_bf16 v[28:31], a[152:155], a[8:11], v[28:31]
  buffer_load_dwordx4 v7, s[12:15], s54 offen offset:0 nt lds
  v_mfma_f32_16x16x32_bf16 v[28:31], a[156:159], a[12:15], v[28:31]
  v_exp_f32_e32 v26, v26
  v_mfma_f32_16x16x32_bf16 v[28:31], a[160:163], a[16:19], v[28:31]
  ds_read_b128 a[172:175], v2 offset:18432
  ds_read_b64_tr_b16 a[250:251], v3 offset:18432
  v_mfma_f32_16x16x32_bf16 v[28:31], a[164:167], a[20:23], v[28:31]
  s_waitcnt lgkmcnt(3)
  v_exp_f32_e32 v27, v27
  v_mfma_f32_16x16x32_bf16 v[240:243], a[244:247], v[48:51], v[240:243]
  ds_read_b64_tr_b16 a[252:253], v4 offset:12288
  v_cvt_pk_bf16_f32 v47, v26, v27
  v_mfma_f32_16x16x32_bf16 v[244:247], a[244:247], v[52:55], v[244:247]
  ds_read_b64_tr_b16 a[254:255], v4 offset:18432
  v_mfma_f32_16x16x32_bf16 v[248:251], a[244:247], v[56:59], v[248:251]
  v_mfma_f32_16x16x32_bf16 v[252:255], a[244:247], v[60:63], v[252:255]
  v_mul_f32_e32 v28, s25, v28
  v_mul_f32_e32 v29, s25, v29
  v_smfmac_f32_16x16x64_bf16 a[208:211], a[224:227], v[32:39], v0
  ds_read_b128 a[176:179], v1 offset:18560
  v_smfmac_f32_16x16x64_bf16 a[212:215], a[224:227], v[40:47], v0
  v_mul_f32_e32 v30, s25, v30
  v_mfma_f32_16x16x32_bf16 v[20:23], a[144:147], a[24:27], 0
  buffer_load_dwordx4 v8, s[12:15], s54 offen offset:1024 nt lds
  v_mfma_f32_16x16x32_bf16 v[20:23], a[148:151], a[28:31], v[20:23]
  v_exp_f32_e32 v28, v28
  v_mfma_f32_16x16x32_bf16 v[20:23], a[152:155], a[32:35], v[20:23]
  v_exp_f32_e32 v29, v29
  v_mfma_f32_16x16x32_bf16 v[20:23], a[156:159], a[36:39], v[20:23]
  ds_read_b64_tr_b16 a[192:193], v5 offset:12288
  v_mul_f32_e32 v31, s25, v31
  v_mfma_f32_16x16x32_bf16 v[20:23], a[160:163], a[40:43], v[20:23]
  v_exp_f32_e32 v30, v30
  v_mfma_f32_16x16x32_bf16 v[20:23], a[164:167], a[44:47], v[20:23]
  s_waitcnt lgkmcnt(2)
  ds_read_b64_tr_b16 a[194:195], v5 offset:18432
  v_cvt_pk_bf16_f32 v48, v28, v29
  v_mfma_f32_16x16x32_bf16 v[64:67], a[248:251], v[32:35], v[64:67]
  v_exp_f32_e32 v31, v31
  v_mfma_f32_16x16x32_bf16 v[68:71], a[248:251], v[36:39], v[68:71]
  buffer_load_dwordx4 v9, s[12:15], s54 offen offset:2048 nt lds
  v_mfma_f32_16x16x32_bf16 v[72:75], a[248:251], v[40:43], v[72:75]
  ds_read_b64_tr_b16 a[196:197], v6 offset:12288
  v_cvt_pk_bf16_f32 v49, v30, v31
  v_mfma_f32_16x16x32_bf16 v[76:79], a[248:251], v[44:47], v[76:79]
  ds_read_b128 a[180:183], v2 offset:18560
  v_mul_f32_e32 v20, s25, v20
  v_mfma_f32_16x16x32_bf16 v[80:83], a[252:255], v[32:35], v[80:83]
  ds_read_b64_tr_b16 a[198:199], v6 offset:18432
  v_mul_f32_e32 v21, s25, v21
  v_mfma_f32_16x16x32_bf16 v[84:87], a[252:255], v[36:39], v[84:87]
  v_exp_f32_e32 v20, v20
  v_mfma_f32_16x16x32_bf16 v[88:91], a[252:255], v[40:43], v[88:91]
  v_mul_f32_e32 v22, s25, v22
  v_mul_f32_e32 v23, s25, v23
  v_mfma_f32_16x16x32_bf16 v[24:27], a[144:147], a[48:51], 0
  s_add_u32 m0, s27, 98816
  v_exp_f32_e32 v21, v21
  v_mfma_f32_16x16x32_bf16 v[24:27], a[148:151], a[52:55], v[24:27]
  buffer_load_dwordx4 v7, s[8:11], s56 offen offset:0 nt lds
  v_mfma_f32_16x16x32_bf16 v[24:27], a[152:155], a[56:59], v[24:27]
  v_exp_f32_e32 v22, v22
  v_mfma_f32_16x16x32_bf16 v[24:27], a[156:159], a[60:63], v[24:27]
  ds_read_b128 a[184:187], v1 offset:18688
  v_cvt_pk_bf16_f32 v52, v20, v21
  v_mfma_f32_16x16x32_bf16 v[24:27], a[160:163], a[64:67], v[24:27]
  v_exp_f32_e32 v23, v23
  v_mfma_f32_16x16x32_bf16 v[24:27], a[164:167], a[68:71], v[24:27]
  ds_read_b64_tr_b16 a[200:201], v3 offset:12416
  v_cvt_pk_bf16_f32 v53, v22, v23
  v_mfma_f32_16x16x32_bf16 v[92:95], a[252:255], v[44:47], v[92:95]
  s_waitcnt lgkmcnt(2)
  ds_read_b64_tr_b16 a[202:203], v3 offset:18560
  v_mfma_f32_16x16x32_bf16 v[96:99], a[192:195], v[32:35], v[96:99]
  v_mfma_f32_16x16x32_bf16 v[100:103], a[192:195], v[36:39], v[100:103]
  v_mfma_f32_16x16x32_bf16 v[104:107], a[192:195], v[40:43], v[104:107]
  buffer_load_dwordx4 v8, s[8:11], s56 offen offset:1024 nt lds
  v_mfma_f32_16x16x32_bf16 v[108:111], a[192:195], v[44:47], v[108:111]
  ds_read_b128 a[188:191], v2 offset:18688
  v_mul_f32_e32 v24, s25, v24
  v_mfma_f32_16x16x32_bf16 v[112:115], a[196:199], v[32:35], v[112:115]
  v_mul_f32_e32 v25, s25, v25
  v_mul_f32_e32 v26, s25, v26
  v_mfma_f32_16x16x32_bf16 v[28:31], a[144:147], a[72:75], 0
  v_exp_f32_e32 v24, v24
  v_mfma_f32_16x16x32_bf16 v[28:31], a[148:151], a[76:79], v[28:31]
  v_exp_f32_e32 v25, v25
  v_mfma_f32_16x16x32_bf16 v[28:31], a[152:155], a[80:83], v[28:31]
  ds_read_b64_tr_b16 a[204:205], v4 offset:12416
  v_mul_f32_e32 v27, s25, v27
  v_mfma_f32_16x16x32_bf16 v[28:31], a[156:159], a[84:87], v[28:31]
  v_exp_f32_e32 v26, v26
  v_mfma_f32_16x16x32_bf16 v[28:31], a[160:163], a[88:91], v[28:31]
  ds_read_b64_tr_b16 a[206:207], v4 offset:18560
  v_cvt_pk_bf16_f32 v56, v24, v25
  v_mfma_f32_16x16x32_bf16 v[28:31], a[164:167], a[92:95], v[28:31]
  buffer_load_dwordx4 v9, s[8:11], s56 offen offset:2048 nt lds
  v_mfma_f32_16x16x32_bf16 v[116:119], a[196:199], v[36:39], v[116:119]
  v_exp_f32_e32 v27, v27
  v_mfma_f32_16x16x32_bf16 v[120:123], a[196:199], v[40:43], v[120:123]
  ds_read_b64_tr_b16 a[232:233], v5 offset:12416
  v_cvt_pk_bf16_f32 v57, v26, v27
  v_mfma_f32_16x16x32_bf16 v[124:127], a[196:199], v[44:47], v[124:127]
  s_waitcnt lgkmcnt(3)
  ds_read_b128 a[144:147], v1 offset:24576
  ds_read_b64_tr_b16 a[234:235], v5 offset:18560
  v_mfma_f32_16x16x32_bf16 v[128:131], a[200:203], v[32:35], v[128:131]
  v_mul_f32_e32 v28, s25, v28
  v_mul_f32_e32 v29, s25, v29
  v_mfma_f32_16x16x32_bf16 v[132:135], a[200:203], v[36:39], v[132:135]
  v_exp_f32_e32 v28, v28
  v_mfma_f32_16x16x32_bf16 v[136:139], a[200:203], v[40:43], v[136:139]
  s_add_u32 m0, s27, 24832
  v_mul_f32_e32 v30, s25, v30
  v_mul_f32_e32 v31, s25, v31
  v_mfma_f32_16x16x32_bf16 v[20:23], a[168:171], a[0:3], 0
  s_add_u32 s33, s32, 215040
  v_exp_f32_e32 v29, v29
  v_mfma_f32_16x16x32_bf16 v[20:23], a[172:175], a[4:7], v[20:23]
  buffer_load_dwordx4 v9, s[16:19], s33 offen offset:2048 nt lds
  v_mfma_f32_16x16x32_bf16 v[20:23], a[176:179], a[8:11], v[20:23]
  v_exp_f32_e32 v30, v30
  v_mfma_f32_16x16x32_bf16 v[20:23], a[180:183], a[12:15], v[20:23]
  ds_read_b128 a[148:151], v2 offset:24576
  v_cvt_pk_bf16_f32 v60, v28, v29
  v_mfma_f32_16x16x32_bf16 v[20:23], a[184:187], a[16:19], v[20:23]
  v_exp_f32_e32 v31, v31
  v_mfma_f32_16x16x32_bf16 v[20:23], a[188:191], a[20:23], v[20:23]
  ds_read_b64_tr_b16 a[236:237], v6 offset:12416
  v_cvt_pk_bf16_f32 v61, v30, v31
  v_mfma_f32_16x16x32_bf16 v[140:143], a[200:203], v[44:47], v[140:143]
  s_waitcnt lgkmcnt(2)
  ds_read_b64_tr_b16 a[238:239], v6 offset:18560
  v_mfma_f32_16x16x32_bf16 v[144:147], a[204:207], v[32:35], v[144:147]
  s_add_u32 m0, s27, 37120
  v_mfma_f32_16x16x32_bf16 v[148:151], a[204:207], v[36:39], v[148:151]
  s_add_u32 s33, s32, 218112
  v_mfma_f32_16x16x32_bf16 v[152:155], a[204:207], v[40:43], v[152:155]
  buffer_load_dwordx4 v7, s[16:19], s33 offen offset:0 nt lds
  v_mfma_f32_16x16x32_bf16 v[156:159], a[204:207], v[44:47], v[156:159]
  ds_read_b128 a[152:155], v1 offset:24704
  v_mul_f32_e32 v20, s25, v20
  v_mfma_f32_16x16x32_bf16 v[160:163], a[232:235], v[32:35], v[160:163]
  v_mul_f32_e32 v21, s25, v21
  v_mul_f32_e32 v22, s25, v22
  v_mfma_f32_16x16x32_bf16 v[24:27], a[168:171], a[24:27], 0
  v_exp_f32_e32 v20, v20
  v_mfma_f32_16x16x32_bf16 v[24:27], a[172:175], a[28:31], v[24:27]
  v_exp_f32_e32 v21, v21
  v_mfma_f32_16x16x32_bf16 v[24:27], a[176:179], a[32:35], v[24:27]
  ds_read_b64_tr_b16 a[240:241], v3 offset:12544
  v_mul_f32_e32 v23, s25, v23
  v_mfma_f32_16x16x32_bf16 v[24:27], a[180:183], a[36:39], v[24:27]
  v_exp_f32_e32 v22, v22
  v_mfma_f32_16x16x32_bf16 v[24:27], a[184:187], a[40:43], v[24:27]
  ds_read_b64_tr_b16 a[242:243], v3 offset:18688
  v_cvt_pk_bf16_f32 v50, v20, v21
  v_mfma_f32_16x16x32_bf16 v[24:27], a[188:191], a[44:47], v[24:27]
  v_exp_f32_e32 v23, v23
  v_mfma_f32_16x16x32_bf16 v[164:167], a[232:235], v[36:39], v[164:167]
  ds_read_b64_tr_b16 a[244:245], v4 offset:12544
  v_cvt_pk_bf16_f32 v51, v22, v23
  v_mfma_f32_16x16x32_bf16 v[168:171], a[232:235], v[40:43], v[168:171]
  ds_read_b128 a[156:159], v2 offset:24704
  v_mfma_f32_16x16x32_bf16 v[172:175], a[232:235], v[44:47], v[172:175]
  s_waitcnt lgkmcnt(4)
  ds_read_b64_tr_b16 a[246:247], v4 offset:18688
  v_mfma_f32_16x16x32_bf16 v[176:179], a[236:239], v[32:35], v[176:179]
  v_mul_f32_e32 v24, s25, v24
  v_mul_f32_e32 v25, s25, v25
  v_mfma_f32_16x16x32_bf16 v[180:183], a[236:239], v[36:39], v[180:183]
  v_exp_f32_e32 v24, v24
  v_mfma_f32_16x16x32_bf16 v[184:187], a[236:239], v[40:43], v[184:187]
  v_mul_f32_e32 v26, s25, v26
  v_mul_f32_e32 v27, s25, v27
  v_mfma_f32_16x16x32_bf16 v[188:191], a[236:239], v[44:47], v[188:191]
  v_exp_f32_e32 v25, v25
  v_mfma_f32_16x16x32_bf16 v[28:31], a[168:171], a[48:51], 0
  v_exp_f32_e32 v26, v26
  v_mfma_f32_16x16x32_bf16 v[28:31], a[172:175], a[52:55], v[28:31]
  ds_read_b128 a[160:163], v1 offset:24832
  v_cvt_pk_bf16_f32 v54, v24, v25
  v_mfma_f32_16x16x32_bf16 v[28:31], a[176:179], a[56:59], v[28:31]
  v_exp_f32_e32 v27, v27
  v_mfma_f32_16x16x32_bf16 v[28:31], a[180:183], a[60:63], v[28:31]
  ds_read_b64_tr_b16 a[248:249], v5 offset:12544
  v_cvt_pk_bf16_f32 v55, v26, v27
  v_mfma_f32_16x16x32_bf16 v[28:31], a[184:187], a[64:67], v[28:31]
  v_mfma_f32_16x16x32_bf16 v[28:31], a[188:191], a[68:71], v[28:31]
  s_waitcnt lgkmcnt(2)
  ds_read_b64_tr_b16 a[250:251], v5 offset:18688
  v_mfma_f32_16x16x32_bf16 v[192:195], a[240:243], v[32:35], v[192:195]
  v_mfma_f32_16x16x32_bf16 v[196:199], a[240:243], v[36:39], v[196:199]
  v_mfma_f32_16x16x32_bf16 v[200:203], a[240:243], v[40:43], v[200:203]
  v_mfma_f32_16x16x32_bf16 v[204:207], a[240:243], v[44:47], v[204:207]
  ds_read_b128 a[164:167], v2 offset:24832
  s_nop 0
  v_mul_f32_e32 v28, s25, v28
  v_mfma_f32_16x16x32_bf16 v[208:211], a[244:247], v[32:35], v[208:211]
  v_mul_f32_e32 v29, s25, v29
  v_mul_f32_e32 v30, s25, v30
  v_mfma_f32_16x16x32_bf16 v[212:215], a[244:247], v[36:39], v[212:215]
  v_exp_f32_e32 v28, v28
  v_mfma_f32_16x16x32_bf16 v[20:23], a[168:171], a[72:75], 0
  v_exp_f32_e32 v29, v29
  v_mfma_f32_16x16x32_bf16 v[20:23], a[172:175], a[76:79], v[20:23]
  ds_read_b64_tr_b16 a[252:253], v6 offset:12544
  v_mul_f32_e32 v31, s25, v31
  v_mfma_f32_16x16x32_bf16 v[20:23], a[176:179], a[80:83], v[20:23]
  v_exp_f32_e32 v30, v30
  v_mfma_f32_16x16x32_bf16 v[20:23], a[180:183], a[84:87], v[20:23]
  ds_read_b64_tr_b16 a[254:255], v6 offset:18688
  v_cvt_pk_bf16_f32 v58, v28, v29
  v_mfma_f32_16x16x32_bf16 v[20:23], a[184:187], a[88:91], v[20:23]
  v_exp_f32_e32 v31, v31
  v_mfma_f32_16x16x32_bf16 v[20:23], a[188:191], a[92:95], v[20:23]
  v_cvt_pk_bf16_f32 v59, v30, v31
  v_mfma_f32_16x16x32_bf16 v[216:219], a[244:247], v[40:43], v[216:219]
  ds_read_b128 a[168:171], v1 offset:30720
  v_mfma_f32_16x16x32_bf16 v[220:223], a[244:247], v[44:47], v[220:223]
  s_waitcnt lgkmcnt(3)
  v_mfma_f32_16x16x32_bf16 v[224:227], a[248:251], v[32:35], v[224:227]
  s_waitcnt vmcnt(10)
  s_barrier
  v_mfma_f32_16x16x32_bf16 v[228:231], a[248:251], v[36:39], v[228:231]
  v_mul_f32_e32 v20, s25, v20
  v_mul_f32_e32 v21, s25, v21
  v_mfma_f32_16x16x32_bf16 v[232:235], a[248:251], v[40:43], v[232:235]
  v_exp_f32_e32 v20, v20
  v_mfma_f32_16x16x32_bf16 v[236:239], a[248:251], v[44:47], v[236:239]
  ds_read_b64_tr_b16 a[192:193], v3 offset:24576
  v_mul_f32_e32 v22, s25, v22
  v_mfma_f32_16x16x32_bf16 v[24:27], a[144:147], a[0:3], 0
  v_exp_f32_e32 v21, v21
  v_mfma_f32_16x16x32_bf16 v[24:27], a[148:151], a[4:7], v[24:27]
  s_add_u32 m0, s27, 147968
  v_mul_f32_e32 v23, s25, v23
  v_cvt_pk_bf16_f32 v62, v20, v21
  v_mfma_f32_16x16x32_bf16 v[24:27], a[152:155], a[8:11], v[24:27]
  buffer_load_dwordx4 v7, s[12:15], s55 offen offset:0 nt lds
  v_mfma_f32_16x16x32_bf16 v[24:27], a[156:159], a[12:15], v[24:27]
  v_exp_f32_e32 v22, v22
  v_mfma_f32_16x16x32_bf16 v[24:27], a[160:163], a[16:19], v[24:27]
  ds_read_b128 a[172:175], v2 offset:30720
  ds_read_b64_tr_b16 a[194:195], v3 offset:30720
  v_mfma_f32_16x16x32_bf16 v[24:27], a[164:167], a[20:23], v[24:27]
  s_waitcnt lgkmcnt(3)
  v_exp_f32_e32 v23, v23
  v_mfma_f32_16x16x32_bf16 v[240:243], a[252:255], v[32:35], v[240:243]
  ds_read_b64_tr_b16 a[196:197], v4 offset:24576
  v_cvt_pk_bf16_f32 v63, v22, v23
  v_mfma_f32_16x16x32_bf16 v[244:247], a[252:255], v[36:39], v[244:247]
  ds_read_b64_tr_b16 a[198:199], v4 offset:30720
  v_mfma_f32_16x16x32_bf16 v[248:251], a[252:255], v[40:43], v[248:251]
  v_mfma_f32_16x16x32_bf16 v[252:255], a[252:255], v[44:47], v[252:255]
  v_mul_f32_e32 v24, s25, v24
  v_mul_f32_e32 v25, s25, v25
  v_smfmac_f32_16x16x64_bf16 a[208:211], a[224:227], v[48:55], v0
  ds_read_b128 a[176:179], v1 offset:30848
  v_smfmac_f32_16x16x64_bf16 a[212:215], a[224:227], v[56:63], v0
  v_mul_f32_e32 v26, s25, v26
  v_mfma_f32_16x16x32_bf16 v[28:31], a[144:147], a[24:27], 0
  buffer_load_dwordx4 v8, s[12:15], s55 offen offset:1024 nt lds
  v_mfma_f32_16x16x32_bf16 v[28:31], a[148:151], a[28:31], v[28:31]
  v_exp_f32_e32 v24, v24
  v_mfma_f32_16x16x32_bf16 v[28:31], a[152:155], a[32:35], v[28:31]
  v_exp_f32_e32 v25, v25
  v_mfma_f32_16x16x32_bf16 v[28:31], a[156:159], a[36:39], v[28:31]
  ds_read_b64_tr_b16 a[200:201], v5 offset:24576
  v_mul_f32_e32 v27, s25, v27
  v_mfma_f32_16x16x32_bf16 v[28:31], a[160:163], a[40:43], v[28:31]
  v_exp_f32_e32 v26, v26
  v_mfma_f32_16x16x32_bf16 v[28:31], a[164:167], a[44:47], v[28:31]
  s_waitcnt lgkmcnt(2)
  ds_read_b64_tr_b16 a[202:203], v5 offset:30720
  v_cvt_pk_bf16_f32 v32, v24, v25
  v_mfma_f32_16x16x32_bf16 v[64:67], a[192:195], v[48:51], v[64:67]
  v_exp_f32_e32 v27, v27
  v_mfma_f32_16x16x32_bf16 v[68:71], a[192:195], v[52:55], v[68:71]
  buffer_load_dwordx4 v9, s[12:15], s55 offen offset:2048 nt lds
  v_mfma_f32_16x16x32_bf16 v[72:75], a[192:195], v[56:59], v[72:75]
  ds_read_b64_tr_b16 a[204:205], v6 offset:24576
  v_cvt_pk_bf16_f32 v33, v26, v27
  v_mfma_f32_16x16x32_bf16 v[76:79], a[192:195], v[60:63], v[76:79]
  ds_read_b128 a[180:183], v2 offset:30848
  v_mul_f32_e32 v28, s25, v28
  v_mfma_f32_16x16x32_bf16 v[80:83], a[196:199], v[48:51], v[80:83]
  ds_read_b64_tr_b16 a[206:207], v6 offset:30720
  v_mul_f32_e32 v29, s25, v29
  v_mfma_f32_16x16x32_bf16 v[84:87], a[196:199], v[52:55], v[84:87]
  v_exp_f32_e32 v28, v28
  v_mfma_f32_16x16x32_bf16 v[88:91], a[196:199], v[56:59], v[88:91]
  v_mul_f32_e32 v30, s25, v30
  v_mul_f32_e32 v31, s25, v31
  v_mfma_f32_16x16x32_bf16 v[20:23], a[144:147], a[48:51], 0
  s_add_u32 m0, s27, 49664
  v_exp_f32_e32 v29, v29
  v_mfma_f32_16x16x32_bf16 v[20:23], a[148:151], a[52:55], v[20:23]
  buffer_load_dwordx4 v7, s[8:11], s57 offen offset:0 nt lds
  v_mfma_f32_16x16x32_bf16 v[20:23], a[152:155], a[56:59], v[20:23]
  v_exp_f32_e32 v30, v30
  v_mfma_f32_16x16x32_bf16 v[20:23], a[156:159], a[60:63], v[20:23]
  ds_read_b128 a[184:187], v1 offset:30976
  v_cvt_pk_bf16_f32 v36, v28, v29
  v_mfma_f32_16x16x32_bf16 v[20:23], a[160:163], a[64:67], v[20:23]
  v_exp_f32_e32 v31, v31
  v_mfma_f32_16x16x32_bf16 v[20:23], a[164:167], a[68:71], v[20:23]
  ds_read_b64_tr_b16 a[232:233], v3 offset:24704
  v_cvt_pk_bf16_f32 v37, v30, v31
  v_mfma_f32_16x16x32_bf16 v[92:95], a[196:199], v[60:63], v[92:95]
  s_waitcnt lgkmcnt(2)
  ds_read_b64_tr_b16 a[234:235], v3 offset:30848
  v_mfma_f32_16x16x32_bf16 v[96:99], a[200:203], v[48:51], v[96:99]
  v_mfma_f32_16x16x32_bf16 v[100:103], a[200:203], v[52:55], v[100:103]
  v_mfma_f32_16x16x32_bf16 v[104:107], a[200:203], v[56:59], v[104:107]
  buffer_load_dwordx4 v8, s[8:11], s57 offen offset:1024 nt lds
  v_mfma_f32_16x16x32_bf16 v[108:111], a[200:203], v[60:63], v[108:111]
  ds_read_b128 a[188:191], v2 offset:30976
  v_mul_f32_e32 v20, s25, v20
  v_mfma_f32_16x16x32_bf16 v[112:115], a[204:207], v[48:51], v[112:115]
  v_mul_f32_e32 v21, s25, v21
  v_mul_f32_e32 v22, s25, v22
  v_mfma_f32_16x16x32_bf16 v[24:27], a[144:147], a[72:75], 0
  v_exp_f32_e32 v20, v20
  v_mfma_f32_16x16x32_bf16 v[24:27], a[148:151], a[76:79], v[24:27]
  v_exp_f32_e32 v21, v21
  v_mfma_f32_16x16x32_bf16 v[24:27], a[152:155], a[80:83], v[24:27]
  ds_read_b64_tr_b16 a[236:237], v4 offset:24704
  v_mul_f32_e32 v23, s25, v23
  v_mfma_f32_16x16x32_bf16 v[24:27], a[156:159], a[84:87], v[24:27]
  v_exp_f32_e32 v22, v22
  v_mfma_f32_16x16x32_bf16 v[24:27], a[160:163], a[88:91], v[24:27]
  ds_read_b64_tr_b16 a[238:239], v4 offset:30848
  v_cvt_pk_bf16_f32 v40, v20, v21
  v_mfma_f32_16x16x32_bf16 v[24:27], a[164:167], a[92:95], v[24:27]
  buffer_load_dwordx4 v9, s[8:11], s57 offen offset:2048 nt lds
  v_mfma_f32_16x16x32_bf16 v[116:119], a[204:207], v[52:55], v[116:119]
  v_exp_f32_e32 v23, v23
  v_mfma_f32_16x16x32_bf16 v[120:123], a[204:207], v[56:59], v[120:123]
  ds_read_b64_tr_b16 a[240:241], v5 offset:24704
  v_cvt_pk_bf16_f32 v41, v22, v23
  v_mfma_f32_16x16x32_bf16 v[124:127], a[204:207], v[60:63], v[124:127]
  s_waitcnt lgkmcnt(3)
  ds_read_b128 a[144:147], v1 offset:36864
  ds_read_b64_tr_b16 a[242:243], v5 offset:30848
  v_mfma_f32_16x16x32_bf16 v[128:131], a[232:235], v[48:51], v[128:131]
  v_mul_f32_e32 v24, s25, v24
  v_mul_f32_e32 v25, s25, v25
  v_mfma_f32_16x16x32_bf16 v[132:135], a[232:235], v[52:55], v[132:135]
  v_exp_f32_e32 v24, v24
  v_mfma_f32_16x16x32_bf16 v[136:139], a[232:235], v[56:59], v[136:139]
  s_add_u32 m0, s27, 37120
  v_mul_f32_e32 v26, s25, v26
  v_mul_f32_e32 v27, s25, v27
  v_mfma_f32_16x16x32_bf16 v[28:31], a[168:171], a[0:3], 0
  s_add_u32 s33, s32, 218112
  v_exp_f32_e32 v25, v25
  v_mfma_f32_16x16x32_bf16 v[28:31], a[172:175], a[4:7], v[28:31]
  buffer_load_dwordx4 v8, s[16:19], s33 offen offset:1024 nt lds
  v_mfma_f32_16x16x32_bf16 v[28:31], a[176:179], a[8:11], v[28:31]
  v_exp_f32_e32 v26, v26
  v_mfma_f32_16x16x32_bf16 v[28:31], a[180:183], a[12:15], v[28:31]
  ds_read_b128 a[148:151], v2 offset:36864
  v_cvt_pk_bf16_f32 v44, v24, v25
  v_mfma_f32_16x16x32_bf16 v[28:31], a[184:187], a[16:19], v[28:31]
  v_exp_f32_e32 v27, v27
  v_mfma_f32_16x16x32_bf16 v[28:31], a[188:191], a[20:23], v[28:31]
  ds_read_b64_tr_b16 a[244:245], v6 offset:24704
  v_cvt_pk_bf16_f32 v45, v26, v27
  v_mfma_f32_16x16x32_bf16 v[140:143], a[232:235], v[60:63], v[140:143]
  s_waitcnt lgkmcnt(2)
  ds_read_b64_tr_b16 a[246:247], v6 offset:30848
  v_mfma_f32_16x16x32_bf16 v[144:147], a[236:239], v[48:51], v[144:147]
  v_mfma_f32_16x16x32_bf16 v[148:151], a[236:239], v[52:55], v[148:151]
  v_mfma_f32_16x16x32_bf16 v[152:155], a[236:239], v[56:59], v[152:155]
  buffer_load_dwordx4 v9, s[16:19], s33 offen offset:2048 nt lds
  v_mfma_f32_16x16x32_bf16 v[156:159], a[236:239], v[60:63], v[156:159]
  ds_read_b128 a[152:155], v1 offset:36992
  v_mul_f32_e32 v28, s25, v28
  v_mfma_f32_16x16x32_bf16 v[160:163], a[240:243], v[48:51], v[160:163]
  v_mul_f32_e32 v29, s25, v29
  v_mul_f32_e32 v30, s25, v30
  v_mfma_f32_16x16x32_bf16 v[20:23], a[168:171], a[24:27], 0
  v_exp_f32_e32 v28, v28
  v_mfma_f32_16x16x32_bf16 v[20:23], a[172:175], a[28:31], v[20:23]
  v_exp_f32_e32 v29, v29
  v_mfma_f32_16x16x32_bf16 v[20:23], a[176:179], a[32:35], v[20:23]
  ds_read_b64_tr_b16 a[248:249], v3 offset:24832
  v_mul_f32_e32 v31, s25, v31
  v_mfma_f32_16x16x32_bf16 v[20:23], a[180:183], a[36:39], v[20:23]
  v_exp_f32_e32 v30, v30
  v_mfma_f32_16x16x32_bf16 v[20:23], a[184:187], a[40:43], v[20:23]
  ds_read_b64_tr_b16 a[250:251], v3 offset:30976
  v_cvt_pk_bf16_f32 v34, v28, v29
  v_mfma_f32_16x16x32_bf16 v[20:23], a[188:191], a[44:47], v[20:23]
  v_exp_f32_e32 v31, v31
  v_mfma_f32_16x16x32_bf16 v[164:167], a[240:243], v[52:55], v[164:167]
  ds_read_b64_tr_b16 a[252:253], v4 offset:24832
  v_cvt_pk_bf16_f32 v35, v30, v31
  v_mfma_f32_16x16x32_bf16 v[168:171], a[240:243], v[56:59], v[168:171]
  ds_read_b128 a[156:159], v2 offset:36992
  v_mfma_f32_16x16x32_bf16 v[172:175], a[240:243], v[60:63], v[172:175]
  s_waitcnt lgkmcnt(4)
  ds_read_b64_tr_b16 a[254:255], v4 offset:30976
  v_mfma_f32_16x16x32_bf16 v[176:179], a[244:247], v[48:51], v[176:179]
  v_mul_f32_e32 v20, s25, v20
  v_mul_f32_e32 v21, s25, v21
  v_mfma_f32_16x16x32_bf16 v[180:183], a[244:247], v[52:55], v[180:183]
  v_exp_f32_e32 v20, v20
  v_mfma_f32_16x16x32_bf16 v[184:187], a[244:247], v[56:59], v[184:187]
  v_mul_f32_e32 v22, s25, v22
  v_mul_f32_e32 v23, s25, v23
  v_mfma_f32_16x16x32_bf16 v[188:191], a[244:247], v[60:63], v[188:191]
  v_exp_f32_e32 v21, v21
  v_mfma_f32_16x16x32_bf16 v[24:27], a[168:171], a[48:51], 0
  v_exp_f32_e32 v22, v22
  v_mfma_f32_16x16x32_bf16 v[24:27], a[172:175], a[52:55], v[24:27]
  ds_read_b128 a[160:163], v1 offset:37120
  v_cvt_pk_bf16_f32 v38, v20, v21
  v_mfma_f32_16x16x32_bf16 v[24:27], a[176:179], a[56:59], v[24:27]
  v_exp_f32_e32 v23, v23
  v_mfma_f32_16x16x32_bf16 v[24:27], a[180:183], a[60:63], v[24:27]
  ds_read_b64_tr_b16 a[192:193], v5 offset:24832
  v_cvt_pk_bf16_f32 v39, v22, v23
  v_mfma_f32_16x16x32_bf16 v[24:27], a[184:187], a[64:67], v[24:27]
  v_mfma_f32_16x16x32_bf16 v[24:27], a[188:191], a[68:71], v[24:27]
  s_waitcnt lgkmcnt(2)
  ds_read_b64_tr_b16 a[194:195], v5 offset:30976
  v_mfma_f32_16x16x32_bf16 v[192:195], a[248:251], v[48:51], v[192:195]
  v_mfma_f32_16x16x32_bf16 v[196:199], a[248:251], v[52:55], v[196:199]
  v_mfma_f32_16x16x32_bf16 v[200:203], a[248:251], v[56:59], v[200:203]
  v_mfma_f32_16x16x32_bf16 v[204:207], a[248:251], v[60:63], v[204:207]
  ds_read_b128 a[164:167], v2 offset:37120
  s_nop 0
  v_mul_f32_e32 v24, s25, v24
  v_mfma_f32_16x16x32_bf16 v[208:211], a[252:255], v[48:51], v[208:211]
  v_mul_f32_e32 v25, s25, v25
  v_mul_f32_e32 v26, s25, v26
  v_mfma_f32_16x16x32_bf16 v[212:215], a[252:255], v[52:55], v[212:215]
  v_exp_f32_e32 v24, v24
  v_mfma_f32_16x16x32_bf16 v[28:31], a[168:171], a[72:75], 0
  v_exp_f32_e32 v25, v25
  v_mfma_f32_16x16x32_bf16 v[28:31], a[172:175], a[76:79], v[28:31]
  ds_read_b64_tr_b16 a[196:197], v6 offset:24832
  v_mul_f32_e32 v27, s25, v27
  v_mfma_f32_16x16x32_bf16 v[28:31], a[176:179], a[80:83], v[28:31]
  v_exp_f32_e32 v26, v26
  v_mfma_f32_16x16x32_bf16 v[28:31], a[180:183], a[84:87], v[28:31]
  ds_read_b64_tr_b16 a[198:199], v6 offset:30976
  v_cvt_pk_bf16_f32 v42, v24, v25
  v_mfma_f32_16x16x32_bf16 v[28:31], a[184:187], a[88:91], v[28:31]
  v_exp_f32_e32 v27, v27
  v_mfma_f32_16x16x32_bf16 v[28:31], a[188:191], a[92:95], v[28:31]
  v_cvt_pk_bf16_f32 v43, v26, v27
  v_mfma_f32_16x16x32_bf16 v[216:219], a[252:255], v[56:59], v[216:219]
  ds_read_b128 a[168:171], v1 offset:43008
  v_mfma_f32_16x16x32_bf16 v[220:223], a[252:255], v[60:63], v[220:223]
  s_waitcnt lgkmcnt(3)
  v_mfma_f32_16x16x32_bf16 v[224:227], a[192:195], v[48:51], v[224:227]
  s_waitcnt vmcnt(10)
  s_barrier
  v_mfma_f32_16x16x32_bf16 v[228:231], a[192:195], v[52:55], v[228:231]
  v_mul_f32_e32 v28, s25, v28
  v_mul_f32_e32 v29, s25, v29
  v_mfma_f32_16x16x32_bf16 v[232:235], a[192:195], v[56:59], v[232:235]
  v_exp_f32_e32 v28, v28
  v_mfma_f32_16x16x32_bf16 v[236:239], a[192:195], v[60:63], v[236:239]
  ds_read_b64_tr_b16 a[200:201], v3 offset:36864
  v_mul_f32_e32 v30, s25, v30
  v_mfma_f32_16x16x32_bf16 v[20:23], a[144:147], a[0:3], 0
  v_exp_f32_e32 v29, v29
  v_mfma_f32_16x16x32_bf16 v[20:23], a[148:151], a[4:7], v[20:23]
L_tr5:
  s_cbranch_execz L_tr9
  s_add_u32 m0, s27, 111104
  v_mul_f32_e32 v31, s25, v31
  v_cvt_pk_bf16_f32 v46, v28, v29
  v_mfma_f32_16x16x32_bf16 v[20:23], a[152:155], a[8:11], v[20:23]
  buffer_load_dwordx4 v7, s[12:15], s56 offen offset:0 nt lds
  v_mfma_f32_16x16x32_bf16 v[20:23], a[156:159], a[12:15], v[20:23]
  v_exp_f32_e32 v30, v30
  v_mfma_f32_16x16x32_bf16 v[20:23], a[160:163], a[16:19], v[20:23]
  ds_read_b128 a[172:175], v2 offset:43008
  ds_read_b64_tr_b16 a[202:203], v3 offset:43008
  v_mfma_f32_16x16x32_bf16 v[20:23], a[164:167], a[20:23], v[20:23]
  s_waitcnt lgkmcnt(3)
  v_exp_f32_e32 v31, v31
  v_mfma_f32_16x16x32_bf16 v[240:243], a[196:199], v[48:51], v[240:243]
  ds_read_b64_tr_b16 a[204:205], v4 offset:36864
  v_cvt_pk_bf16_f32 v47, v30, v31
  v_mfma_f32_16x16x32_bf16 v[244:247], a[196:199], v[52:55], v[244:247]
  ds_read_b64_tr_b16 a[206:207], v4 offset:43008
  v_mfma_f32_16x16x32_bf16 v[248:251], a[196:199], v[56:59], v[248:251]
  v_mfma_f32_16x16x32_bf16 v[252:255], a[196:199], v[60:63], v[252:255]
  v_mul_f32_e32 v20, s25, v20
  v_mul_f32_e32 v21, s25, v21
  v_smfmac_f32_16x16x64_bf16 a[208:211], a[224:227], v[32:39], v0
  ds_read_b128 a[176:179], v1 offset:43136
  v_smfmac_f32_16x16x64_bf16 a[212:215], a[224:227], v[40:47], v0
  v_mul_f32_e32 v22, s25, v22
  v_mfma_f32_16x16x32_bf16 v[24:27], a[144:147], a[24:27], 0
  buffer_load_dwordx4 v8, s[12:15], s56 offen offset:1024 nt lds
  v_mfma_f32_16x16x32_bf16 v[24:27], a[148:151], a[28:31], v[24:27]
  v_exp_f32_e32 v20, v20
  v_mfma_f32_16x16x32_bf16 v[24:27], a[152:155], a[32:35], v[24:27]
  v_exp_f32_e32 v21, v21
  v_mfma_f32_16x16x32_bf16 v[24:27], a[156:159], a[36:39], v[24:27]
  ds_read_b64_tr_b16 a[232:233], v5 offset:36864
  v_mul_f32_e32 v23, s25, v23
  v_mfma_f32_16x16x32_bf16 v[24:27], a[160:163], a[40:43], v[24:27]
  v_exp_f32_e32 v22, v22
  v_mfma_f32_16x16x32_bf16 v[24:27], a[164:167], a[44:47], v[24:27]
  s_waitcnt lgkmcnt(2)
  ds_read_b64_tr_b16 a[234:235], v5 offset:43008
  v_cvt_pk_bf16_f32 v48, v20, v21
  v_mfma_f32_16x16x32_bf16 v[64:67], a[200:203], v[32:35], v[64:67]
  v_exp_f32_e32 v23, v23
  v_mfma_f32_16x16x32_bf16 v[68:71], a[200:203], v[36:39], v[68:71]
  buffer_load_dwordx4 v9, s[12:15], s56 offen offset:2048 nt lds
  v_mfma_f32_16x16x32_bf16 v[72:75], a[200:203], v[40:43], v[72:75]
  ds_read_b64_tr_b16 a[236:237], v6 offset:36864
  v_cvt_pk_bf16_f32 v49, v22, v23
  v_mfma_f32_16x16x32_bf16 v[76:79], a[200:203], v[44:47], v[76:79]
  ds_read_b128 a[180:183], v2 offset:43136
  v_mul_f32_e32 v24, s25, v24
  v_mfma_f32_16x16x32_bf16 v[80:83], a[204:207], v[32:35], v[80:83]
  ds_read_b64_tr_b16 a[238:239], v6 offset:43008
  v_mul_f32_e32 v25, s25, v25
  v_mfma_f32_16x16x32_bf16 v[84:87], a[204:207], v[36:39], v[84:87]
  v_exp_f32_e32 v24, v24
  v_mfma_f32_16x16x32_bf16 v[88:91], a[204:207], v[40:43], v[88:91]
  v_mul_f32_e32 v26, s25, v26
  v_mul_f32_e32 v27, s25, v27
  v_mfma_f32_16x16x32_bf16 v[28:31], a[144:147], a[48:51], 0
  s_add_u32 m0, s27, 61952
  v_exp_f32_e32 v25, v25
  v_mfma_f32_16x16x32_bf16 v[28:31], a[148:151], a[52:55], v[28:31]
  buffer_load_dwordx4 v7, s[8:11], s58 offen offset:0 nt lds
  v_mfma_f32_16x16x32_bf16 v[28:31], a[152:155], a[56:59], v[28:31]
  v_exp_f32_e32 v26, v26
  v_mfma_f32_16x16x32_bf16 v[28:31], a[156:159], a[60:63], v[28:31]
  ds_read_b128 a[184:187], v1 offset:43264
  v_cvt_pk_bf16_f32 v52, v24, v25
  v_mfma_f32_16x16x32_bf16 v[28:31], a[160:163], a[64:67], v[28:31]
  v_exp_f32_e32 v27, v27
  v_mfma_f32_16x16x32_bf16 v[28:31], a[164:167], a[68:71], v[28:31]
  ds_read_b64_tr_b16 a[240:241], v3 offset:36992
  v_cvt_pk_bf16_f32 v53, v26, v27
  v_mfma_f32_16x16x32_bf16 v[92:95], a[204:207], v[44:47], v[92:95]
  s_waitcnt lgkmcnt(2)
  ds_read_b64_tr_b16 a[242:243], v3 offset:43136
  v_mfma_f32_16x16x32_bf16 v[96:99], a[232:235], v[32:35], v[96:99]
  v_mfma_f32_16x16x32_bf16 v[100:103], a[232:235], v[36:39], v[100:103]
  v_mfma_f32_16x16x32_bf16 v[104:107], a[232:235], v[40:43], v[104:107]
  buffer_load_dwordx4 v8, s[8:11], s58 offen offset:1024 nt lds
  v_mfma_f32_16x16x32_bf16 v[108:111], a[232:235], v[44:47], v[108:111]
  ds_read_b128 a[188:191], v2 offset:43264
  v_mul_f32_e32 v28, s25, v28
  v_mfma_f32_16x16x32_bf16 v[112:115], a[236:239], v[32:35], v[112:115]
  v_mul_f32_e32 v29, s25, v29
  v_mul_f32_e32 v30, s25, v30
  v_mfma_f32_16x16x32_bf16 v[20:23], a[144:147], a[72:75], 0
  v_exp_f32_e32 v28, v28
  v_mfma_f32_16x16x32_bf16 v[20:23], a[148:151], a[76:79], v[20:23]
  v_exp_f32_e32 v29, v29
  v_mfma_f32_16x16x32_bf16 v[20:23], a[152:155], a[80:83], v[20:23]
  ds_read_b64_tr_b16 a[244:245], v4 offset:36992
  v_mul_f32_e32 v31, s25, v31
  v_mfma_f32_16x16x32_bf16 v[20:23], a[156:159], a[84:87], v[20:23]
  v_exp_f32_e32 v30, v30
  v_mfma_f32_16x16x32_bf16 v[20:23], a[160:163], a[88:91], v[20:23]
  ds_read_b64_tr_b16 a[246:247], v4 offset:43136
  v_cvt_pk_bf16_f32 v56, v28, v29
  v_mfma_f32_16x16x32_bf16 v[20:23], a[164:167], a[92:95], v[20:23]
  buffer_load_dwordx4 v9, s[8:11], s58 offen offset:2048 nt lds
  v_mfma_f32_16x16x32_bf16 v[116:119], a[236:239], v[36:39], v[116:119]
  v_exp_f32_e32 v31, v31
  v_mfma_f32_16x16x32_bf16 v[120:123], a[236:239], v[40:43], v[120:123]
  ds_read_b64_tr_b16 a[248:249], v5 offset:36992
  v_cvt_pk_bf16_f32 v57, v30, v31
  v_mfma_f32_16x16x32_bf16 v[124:127], a[236:239], v[44:47], v[124:127]
  s_waitcnt lgkmcnt(3)
  ds_read_b128 a[144:147], v1 offset:49152
  ds_read_b64_tr_b16 a[250:251], v5 offset:43136
  v_mfma_f32_16x16x32_bf16 v[128:131], a[240:243], v[32:35], v[128:131]
  v_mul_f32_e32 v20, s25, v20
  v_mul_f32_e32 v21, s25, v21
  v_mfma_f32_16x16x32_bf16 v[132:135], a[240:243], v[36:39], v[132:135]
  v_exp_f32_e32 v20, v20
  v_mfma_f32_16x16x32_bf16 v[136:139], a[240:243], v[40:43], v[136:139]
  v_mul_f32_e32 v22, s25, v22
  v_mul_f32_e32 v23, s25, v23
  v_mfma_f32_16x16x32_bf16 v[24:27], a[168:171], a[0:3], 0
  v_exp_f32_e32 v21, v21
  v_mfma_f32_16x16x32_bf16 v[24:27], a[172:175], a[4:7], v[24:27]
  v_exp_f32_e32 v22, v22
  v_mfma_f32_16x16x32_bf16 v[24:27], a[176:179], a[8:11], v[24:27]
  ds_read_b128 a[148:151], v2 offset:49152
  v_cvt_pk_bf16_f32 v60, v20, v21
  v_mfma_f32_16x16x32_bf16 v[24:27], a[180:183], a[12:15], v[24:27]
  v_exp_f32_e32 v23, v23
  v_mfma_f32_16x16x32_bf16 v[24:27], a[184:187], a[16:19], v[24:27]
  ds_read_b64_tr_b16 a[252:253], v6 offset:36992
  v_cvt_pk_bf16_f32 v61, v22, v23
  v_mfma_f32_16x16x32_bf16 v[24:27], a[188:191], a[20:23], v[24:27]
  v_mfma_f32_16x16x32_bf16 v[140:143], a[240:243], v[44:47], v[140:143]
  s_waitcnt lgkmcnt(2)
  ds_read_b64_tr_b16 a[254:255], v6 offset:43136
  v_mfma_f32_16x16x32_bf16 v[144:147], a[244:247], v[32:35], v[144:147]
  v_mfma_f32_16x16x32_bf16 v[148:151], a[244:247], v[36:39], v[148:151]
  v_mfma_f32_16x16x32_bf16 v[152:155], a[244:247], v[40:43], v[152:155]
  s_nop 1
  v_mul_f32_e32 v24, s25, v24
  v_mul_f32_e32 v25, s25, v25
  v_mfma_f32_16x16x32_bf16 v[156:159], a[244:247], v[44:47], v[156:159]
  v_exp_f32_e32 v24, v24
  v_mfma_f32_16x16x32_bf16 v[160:163], a[248:251], v[32:35], v[160:163]
  ds_read_b128 a[152:155], v1 offset:49280
  v_mul_f32_e32 v26, s25, v26
  v_mfma_f32_16x16x32_bf16 v[28:31], a[168:171], a[24:27], 0
  v_exp_f32_e32 v25, v25
  v_mfma_f32_16x16x32_bf16 v[28:31], a[172:175], a[28:31], v[28:31]
  ds_read_b64_tr_b16 a[192:193], v3 offset:37120
  v_mul_f32_e32 v27, s25, v27
  v_mfma_f32_16x16x32_bf16 v[28:31], a[176:179], a[32:35], v[28:31]
  v_exp_f32_e32 v26, v26
  v_mfma_f32_16x16x32_bf16 v[28:31], a[180:183], a[36:39], v[28:31]
  v_exp_f32_e32 v27, v27
  v_mfma_f32_16x16x32_bf16 v[28:31], a[184:187], a[40:43], v[28:31]
  ds_read_b64_tr_b16 a[194:195], v3 offset:43264
  v_cvt_pk_bf16_f32 v50, v24, v25
  v_mfma_f32_16x16x32_bf16 v[28:31], a[188:191], a[44:47], v[28:31]
  ds_read_b64_tr_b16 a[196:197], v4 offset:37120
  v_cvt_pk_bf16_f32 v51, v26, v27
  v_mfma_f32_16x16x32_bf16 v[164:167], a[248:251], v[36:39], v[164:167]
  ds_read_b128 a[156:159], v2 offset:49280
  v_mfma_f32_16x16x32_bf16 v[168:171], a[248:251], v[40:43], v[168:171]
  ds_read_b128 a[0:3], v19 offset:0
  ds_read_b128 a[4:7], v16 offset:0
  v_mfma_f32_16x16x32_bf16 v[172:175], a[248:251], v[44:47], v[172:175]
  s_waitcnt lgkmcnt(6)
  ds_read_b64_tr_b16 a[198:199], v4 offset:43264
  ds_read_b128 a[8:11], v19 offset:128
  v_mfma_f32_16x16x32_bf16 v[176:179], a[252:255], v[32:35], v[176:179]
  ds_read_b128 a[12:15], v16 offset:128
  v_mul_f32_e32 v28, s25, v28
  v_mfma_f32_16x16x32_bf16 v[180:183], a[252:255], v[36:39], v[180:183]
  v_mul_f32_e32 v29, s25, v29
  v_mul_f32_e32 v30, s25, v30
  v_mfma_f32_16x16x32_bf16 v[184:187], a[252:255], v[40:43], v[184:187]
  v_exp_f32_e32 v28, v28
  v_mfma_f32_16x16x32_bf16 v[188:191], a[252:255], v[44:47], v[188:191]
  v_exp_f32_e32 v29, v29
  v_mfma_f32_16x16x32_bf16 v[20:23], a[168:171], a[48:51], 0
  ds_read_b128 a[16:19], v19 offset:256
  v_mul_f32_e32 v31, s25, v31
  v_mfma_f32_16x16x32_bf16 v[20:23], a[172:175], a[52:55], v[20:23]
  v_exp_f32_e32 v30, v30
  v_mfma_f32_16x16x32_bf16 v[20:23], a[176:179], a[56:59], v[20:23]
  ds_read_b128 a[160:163], v1 offset:49408
  v_cvt_pk_bf16_f32 v54, v28, v29
  v_mfma_f32_16x16x32_bf16 v[20:23], a[180:183], a[60:63], v[20:23]
  ds_read_b64_tr_b16 a[200:201], v5 offset:37120
  ds_read_b128 a[20:23], v16 offset:256
  v_mfma_f32_16x16x32_bf16 v[20:23], a[184:187], a[64:67], v[20:23]
  v_exp_f32_e32 v31, v31
  v_mfma_f32_16x16x32_bf16 v[20:23], a[188:191], a[68:71], v[20:23]
  s_waitcnt lgkmcnt(4)
  ds_read_b64_tr_b16 a[202:203], v5 offset:43264
  v_cvt_pk_bf16_f32 v55, v30, v31
  v_mfma_f32_16x16x32_bf16 v[192:195], a[192:195], v[32:35], v[192:195]
  v_mfma_f32_16x16x32_bf16 v[196:199], a[192:195], v[36:39], v[196:199]
  v_mfma_f32_16x16x32_bf16 v[200:203], a[192:195], v[40:43], v[200:203]
  v_mfma_f32_16x16x32_bf16 v[204:207], a[192:195], v[44:47], v[204:207]
  ds_read_b128 a[164:167], v2 offset:49408
  v_mul_f32_e32 v20, s25, v20
  v_mfma_f32_16x16x32_bf16 v[208:211], a[196:199], v[32:35], v[208:211]
  v_mul_f32_e32 v21, s25, v21
  v_mul_f32_e32 v22, s25, v22
  v_mfma_f32_16x16x32_bf16 v[212:215], a[196:199], v[36:39], v[212:215]
  v_exp_f32_e32 v20, v20
  v_mfma_f32_16x16x32_bf16 v[24:27], a[168:171], a[72:75], 0
  v_exp_f32_e32 v21, v21
  v_mfma_f32_16x16x32_bf16 v[24:27], a[172:175], a[76:79], v[24:27]
  ds_read_b64_tr_b16 a[204:205], v6 offset:37120
  v_mul_f32_e32 v23, s25, v23
  v_mfma_f32_16x16x32_bf16 v[24:27], a[176:179], a[80:83], v[24:27]
  v_exp_f32_e32 v22, v22
  v_mfma_f32_16x16x32_bf16 v[24:27], a[180:183], a[84:87], v[24:27]
  ds_read_b64_tr_b16 a[206:207], v6 offset:43264
  v_cvt_pk_bf16_f32 v58, v20, v21
  v_mfma_f32_16x16x32_bf16 v[24:27], a[184:187], a[88:91], v[24:27]
  v_exp_f32_e32 v23, v23
  v_mfma_f32_16x16x32_bf16 v[24:27], a[188:191], a[92:95], v[24:27]
  v_cvt_pk_bf16_f32 v59, v22, v23
  v_mfma_f32_16x16x32_bf16 v[216:219], a[196:199], v[40:43], v[216:219]
  ds_read_b128 a[168:171], v1 offset:55296
  v_mfma_f32_16x16x32_bf16 v[220:223], a[196:199], v[44:47], v[220:223]
  s_waitcnt lgkmcnt(3)
  v_mfma_f32_16x16x32_bf16 v[224:227], a[200:203], v[32:35], v[224:227]
  s_waitcnt vmcnt(8)
  s_barrier
  v_mfma_f32_16x16x32_bf16 v[228:231], a[200:203], v[36:39], v[228:231]
  v_mul_f32_e32 v24, s25, v24
  v_mul_f32_e32 v25, s25, v25
  v_mfma_f32_16x16x32_bf16 v[232:235], a[200:203], v[40:43], v[232:235]
  v_exp_f32_e32 v24, v24
  v_mfma_f32_16x16x32_bf16 v[236:239], a[200:203], v[44:47], v[236:239]
  ds_read_b64_tr_b16 a[232:233], v3 offset:49152
  v_mul_f32_e32 v26, s25, v26
  v_mfma_f32_16x16x32_bf16 v[28:31], a[144:147], a[96:99], 0
  s_waitcnt vmcnt(6)
  ds_read_b128 a[24:27], v19 offset:24832
  v_mul_f32_e32 v27, s25, v27
  v_mfma_f32_16x16x32_bf16 v[28:31], a[148:151], a[100:103], v[28:31]
  s_add_u32 m0, s27, 123392
  v_exp_f32_e32 v25, v25
  v_mfma_f32_16x16x32_bf16 v[28:31], a[152:155], a[104:107], v[28:31]
  buffer_load_dwordx4 v7, s[12:15], s57 offen offset:0 nt lds
  v_mfma_f32_16x16x32_bf16 v[28:31], a[156:159], a[108:111], v[28:31]
  v_exp_f32_e32 v26, v26
  v_mfma_f32_16x16x32_bf16 v[28:31], a[160:163], a[112:115], v[28:31]
  ds_read_b128 a[172:175], v2 offset:55296
  v_cvt_pk_bf16_f32 v62, v24, v25
  v_mfma_f32_16x16x32_bf16 v[28:31], a[164:167], a[116:119], v[28:31]
  s_waitcnt lgkmcnt(3)
  v_exp_f32_e32 v27, v27
  v_mfma_f32_16x16x32_bf16 v[240:243], a[204:207], v[32:35], v[240:243]
  ds_read_b128 a[28:31], v16 offset:24832
  v_cvt_pk_bf16_f32 v63, v26, v27
  v_mfma_f32_16x16x32_bf16 v[244:247], a[204:207], v[36:39], v[244:247]
  ds_read_b64_tr_b16 a[234:235], v3 offset:55296
  ds_read_b64_tr_b16 a[236:237], v4 offset:49152
  v_mfma_f32_16x16x32_bf16 v[248:251], a[204:207], v[40:43], v[248:251]
  ds_read_b64_tr_b16 a[238:239], v4 offset:55296
  ds_read_b128 a[32:35], v19 offset:24960
  v_mfma_f32_16x16x32_bf16 v[252:255], a[204:207], v[44:47], v[252:255]
  ds_read_b128 a[36:39], v16 offset:24960
  v_mul_f32_e32 v28, s25, v28
  v_smfmac_f32_16x16x64_bf16 a[208:211], a[224:227], v[48:55], v0
  ds_read_b128 a[176:179], v1 offset:55424
  v_smfmac_f32_16x16x64_bf16 a[212:215], a[224:227], v[56:63], v0
  ds_read_b128 a[40:43], v19 offset:25088
  v_mfma_f32_16x16x32_bf16 v[20:23], a[144:147], a[120:123], 0
  buffer_load_dwordx4 v8, s[12:15], s57 offen offset:1024 nt lds
  v_mfma_f32_16x16x32_bf16 v[20:23], a[148:151], a[124:127], v[20:23]
  ds_read_b64_tr_b16 a[240:241], v5 offset:49152
  v_mul_f32_e32 v29, s25, v29
  v_mfma_f32_16x16x32_bf16 v[20:23], a[152:155], a[128:131], v[20:23]
  v_exp_f32_e32 v28, v28
  v_mfma_f32_16x16x32_bf16 v[20:23], a[156:159], a[132:135], v[20:23]
  ds_read_b128 a[44:47], v16 offset:25088
  v_mul_f32_e32 v30, s25, v30
  v_mfma_f32_16x16x32_bf16 v[20:23], a[160:163], a[136:139], v[20:23]
  v_exp_f32_e32 v29, v29
  v_mfma_f32_16x16x32_bf16 v[20:23], a[164:167], a[140:143], v[20:23]
  s_waitcnt lgkmcnt(4)
  ds_read_b64_tr_b16 a[242:243], v5 offset:55296
  v_mul_f32_e32 v31, s25, v31
  v_mfma_f32_16x16x32_bf16 v[64:67], a[232:235], v[48:51], v[64:67]
  v_exp_f32_e32 v30, v30
  v_mfma_f32_16x16x32_bf16 v[68:71], a[232:235], v[52:55], v[68:71]
  ds_read_b64_tr_b16 a[244:245], v6 offset:49152
  v_cvt_pk_bf16_f32 v32, v28, v29
  v_mfma_f32_16x16x32_bf16 v[72:75], a[232:235], v[56:59], v[72:75]
  v_exp_f32_e32 v31, v31
  v_mfma_f32_16x16x32_bf16 v[76:79], a[232:235], v[60:63], v[76:79]
  buffer_load_dwordx4 v9, s[12:15], s57 offen offset:2048 nt lds
  v_mfma_f32_16x16x32_bf16 v[80:83], a[236:239], v[48:51], v[80:83]
  ds_read_b128 a[180:183], v2 offset:55424
  v_cvt_pk_bf16_f32 v33, v30, v31
  v_mfma_f32_16x16x32_bf16 v[84:87], a[236:239], v[52:55], v[84:87]
  ds_read_b64_tr_b16 a[246:247], v6 offset:55296
  v_mul_f32_e32 v20, s25, v20
  v_mfma_f32_16x16x32_bf16 v[88:91], a[236:239], v[56:59], v[88:91]
  v_mul_f32_e32 v21, s25, v21
  v_mul_f32_e32 v22, s25, v22
  v_mfma_f32_16x16x32_bf16 v[24:27], a[144:147], a[0:3], 0
  s_add_u32 m0, s27, 74240
  v_exp_f32_e32 v20, v20
  v_mfma_f32_16x16x32_bf16 v[24:27], a[148:151], a[4:7], v[24:27]
  v_exp_f32_e32 v21, v21
  v_mfma_f32_16x16x32_bf16 v[24:27], a[152:155], a[8:11], v[24:27]
  buffer_load_dwordx4 v7, s[8:11], s59 offen offset:0 nt lds
  v_mfma_f32_16x16x32_bf16 v[24:27], a[156:159], a[12:15], v[24:27]
  ds_read_b128 a[184:187], v1 offset:55552
  v_mul_f32_e32 v23, s25, v23
  v_mfma_f32_16x16x32_bf16 v[24:27], a[160:163], a[16:19], v[24:27]
  v_exp_f32_e32 v22, v22
  v_mfma_f32_16x16x32_bf16 v[24:27], a[164:167], a[20:23], v[24:27]
  ds_read_b64_tr_b16 a[248:249], v3 offset:49280
  v_cvt_pk_bf16_f32 v36, v20, v21
  v_mfma_f32_16x16x32_bf16 v[92:95], a[236:239], v[60:63], v[92:95]
  s_waitcnt lgkmcnt(2)
  v_exp_f32_e32 v23, v23
  v_mfma_f32_16x16x32_bf16 v[96:99], a[240:243], v[48:51], v[96:99]
  ds_read_b64_tr_b16 a[250:251], v3 offset:55424
  v_cvt_pk_bf16_f32 v37, v22, v23
  v_mfma_f32_16x16x32_bf16 v[100:103], a[240:243], v[52:55], v[100:103]
  v_accvgpr_read_b32 v10, a208
  v_accvgpr_read_b32 v12, a209
  v_mfma_f32_16x16x32_bf16 v[104:107], a[240:243], v[56:59], v[104:107]
  buffer_load_dwordx4 v8, s[8:11], s59 offen offset:1024 nt lds
  v_mfma_f32_16x16x32_bf16 v[108:111], a[240:243], v[60:63], v[108:111]
  ds_read_b128 a[188:191], v2 offset:55552
  v_mul_f32_e32 v24, s25, v24
  v_mfma_f32_16x16x32_bf16 v[112:115], a[244:247], v[48:51], v[112:115]
  v_mul_f32_e32 v25, s25, v25
  v_mul_f32_e32 v26, s25, v26
  v_mfma_f32_16x16x32_bf16 v[28:31], a[144:147], a[24:27], 0
  v_exp_f32_e32 v24, v24
  v_mfma_f32_16x16x32_bf16 v[28:31], a[148:151], a[28:31], v[28:31]
  v_exp_f32_e32 v25, v25
  v_mfma_f32_16x16x32_bf16 v[28:31], a[152:155], a[32:35], v[28:31]
  ds_read_b64_tr_b16 a[252:253], v4 offset:49280
  v_mul_f32_e32 v27, s25, v27
  v_mfma_f32_16x16x32_bf16 v[28:31], a[156:159], a[36:39], v[28:31]
  v_exp_f32_e32 v26, v26
  v_mfma_f32_16x16x32_bf16 v[28:31], a[160:163], a[40:43], v[28:31]
  ds_read_b64_tr_b16 a[254:255], v4 offset:55424
  v_cvt_pk_bf16_f32 v40, v24, v25
  v_mfma_f32_16x16x32_bf16 v[28:31], a[164:167], a[44:47], v[28:31]
  buffer_load_dwordx4 v9, s[8:11], s59 offen offset:2048 nt lds
  v_mfma_f32_16x16x32_bf16 v[116:119], a[244:247], v[52:55], v[116:119]
  v_exp_f32_e32 v27, v27
  v_mfma_f32_16x16x32_bf16 v[120:123], a[244:247], v[56:59], v[120:123]
  ds_read_b64_tr_b16 a[192:193], v5 offset:49280
  v_cvt_pk_bf16_f32 v41, v26, v27
  v_mfma_f32_16x16x32_bf16 v[124:127], a[244:247], v[60:63], v[124:127]
  s_waitcnt lgkmcnt(3)
  ds_read_b128 a[144:147], v1 offset:0
  ds_read_b64_tr_b16 a[194:195], v5 offset:55424
  v_mfma_f32_16x16x32_bf16 v[128:131], a[248:251], v[48:51], v[128:131]
  v_mul_f32_e32 v28, s25, v28
  v_mul_f32_e32 v29, s25, v29
  v_mfma_f32_16x16x32_bf16 v[132:135], a[248:251], v[52:55], v[132:135]
  v_exp_f32_e32 v28, v28
  v_mfma_f32_16x16x32_bf16 v[136:139], a[248:251], v[56:59], v[136:139]
  v_mul_f32_e32 v30, s25, v30
  v_mul_f32_e32 v31, s25, v31
  v_mfma_f32_16x16x32_bf16 v[20:23], a[168:171], a[96:99], 0
  s_add_u32 m0, s27, 86528
  v_exp_f32_e32 v29, v29
  v_mfma_f32_16x16x32_bf16 v[20:23], a[172:175], a[100:103], v[20:23]
  buffer_load_dwordx4 v7, s[8:11], s60 offen offset:0 nt lds
  v_mfma_f32_16x16x32_bf16 v[20:23], a[176:179], a[104:107], v[20:23]
  v_exp_f32_e32 v30, v30
  v_mfma_f32_16x16x32_bf16 v[20:23], a[180:183], a[108:111], v[20:23]
  ds_read_b128 a[148:151], v2 offset:0
  v_cvt_pk_bf16_f32 v44, v28, v29
  v_mfma_f32_16x16x32_bf16 v[20:23], a[184:187], a[112:115], v[20:23]
  v_exp_f32_e32 v31, v31
  v_mfma_f32_16x16x32_bf16 v[20:23], a[188:191], a[116:119], v[20:23]
  ds_read_b64_tr_b16 a[196:197], v6 offset:49280
  v_cvt_pk_bf16_f32 v45, v30, v31
  v_mfma_f32_16x16x32_bf16 v[140:143], a[248:251], v[60:63], v[140:143]
  s_waitcnt lgkmcnt(2)
  ds_read_b64_tr_b16 a[198:199], v6 offset:55424
  v_add_f32_e32 v10, v10, v12
  v_mfma_f32_16x16x32_bf16 v[144:147], a[252:255], v[48:51], v[144:147]
  v_rcp_f32_e32 v10, v10
  v_mfma_f32_16x16x32_bf16 v[148:151], a[252:255], v[52:55], v[148:151]
  v_accvgpr_read_b32 v12, a210
  v_accvgpr_read_b32 v14, a211
  v_mfma_f32_16x16x32_bf16 v[152:155], a[252:255], v[56:59], v[152:155]
  buffer_load_dwordx4 v8, s[8:11], s60 offen offset:1024 nt lds
  v_mfma_f32_16x16x32_bf16 v[156:159], a[252:255], v[60:63], v[156:159]
  ds_read_b128 a[152:155], v1 offset:128
  v_mul_f32_e32 v20, s25, v20
  v_mfma_f32_16x16x32_bf16 v[160:163], a[192:195], v[48:51], v[160:163]
  v_mul_f32_e32 v21, s25, v21
  v_mul_f32_e32 v22, s25, v22
  v_mfma_f32_16x16x32_bf16 v[24:27], a[168:171], a[120:123], 0
  v_exp_f32_e32 v20, v20
  v_mfma_f32_16x16x32_bf16 v[24:27], a[172:175], a[124:127], v[24:27]
  v_exp_f32_e32 v21, v21
  v_mfma_f32_16x16x32_bf16 v[24:27], a[176:179], a[128:131], v[24:27]
  ds_read_b64_tr_b16 a[200:201], v3 offset:49408
  v_mul_f32_e32 v23, s25, v23
  v_mfma_f32_16x16x32_bf16 v[24:27], a[180:183], a[132:135], v[24:27]
  v_exp_f32_e32 v22, v22
  v_mfma_f32_16x16x32_bf16 v[24:27], a[184:187], a[136:139], v[24:27]
  ds_read_b64_tr_b16 a[202:203], v3 offset:55552
  v_cvt_pk_bf16_f32 v34, v20, v21
  v_mfma_f32_16x16x32_bf16 v[24:27], a[188:191], a[140:143], v[24:27]
  buffer_load_dwordx4 v9, s[8:11], s60 offen offset:2048 nt lds
  v_mfma_f32_16x16x32_bf16 v[164:167], a[192:195], v[52:55], v[164:167]
  v_exp_f32_e32 v23, v23
  v_mfma_f32_16x16x32_bf16 v[168:171], a[192:195], v[56:59], v[168:171]
  ds_read_b64_tr_b16 a[204:205], v4 offset:49408
  v_cvt_pk_bf16_f32 v35, v22, v23
  v_mfma_f32_16x16x32_bf16 v[172:175], a[192:195], v[60:63], v[172:175]
  s_waitcnt lgkmcnt(3)
  ds_read_b128 a[156:159], v2 offset:128
  ds_read_b64_tr_b16 a[206:207], v4 offset:55552
  v_mfma_f32_16x16x32_bf16 v[176:179], a[196:199], v[48:51], v[176:179]
  v_mul_f32_e32 v24, s25, v24
  v_mul_f32_e32 v25, s25, v25
  v_mfma_f32_16x16x32_bf16 v[180:183], a[196:199], v[52:55], v[180:183]
  v_exp_f32_e32 v24, v24
  v_mfma_f32_16x16x32_bf16 v[184:187], a[196:199], v[56:59], v[184:187]
  v_mul_f32_e32 v26, s25, v26
  v_mul_f32_e32 v27, s25, v27
  v_mfma_f32_16x16x32_bf16 v[188:191], a[196:199], v[60:63], v[188:191]
  v_exp_f32_e32 v25, v25
  v_mfma_f32_16x16x32_bf16 v[28:31], a[168:171], a[0:3], 0
  v_exp_f32_e32 v26, v26
  v_mfma_f32_16x16x32_bf16 v[28:31], a[172:175], a[4:7], v[28:31]
  ds_read_b128 a[160:163], v1 offset:256
  v_cvt_pk_bf16_f32 v38, v24, v25
  v_mfma_f32_16x16x32_bf16 v[28:31], a[176:179], a[8:11], v[28:31]
  v_exp_f32_e32 v27, v27
  v_mfma_f32_16x16x32_bf16 v[28:31], a[180:183], a[12:15], v[28:31]
  ds_read_b64_tr_b16 a[232:233], v5 offset:49408
  v_cvt_pk_bf16_f32 v39, v26, v27
  v_mfma_f32_16x16x32_bf16 v[28:31], a[184:187], a[16:19], v[28:31]
  v_add_f32_e32 v12, v12, v14
  v_accvgpr_read_b32 v14, a212
  v_mfma_f32_16x16x32_bf16 v[28:31], a[188:191], a[20:23], v[28:31]
  s_waitcnt lgkmcnt(2)
  ds_read_b64_tr_b16 a[234:235], v5 offset:55552
  v_accvgpr_read_b32 v16, a213
  v_mfma_f32_16x16x32_bf16 v[192:195], a[200:203], v[48:51], v[192:195]
  v_rcp_f32_e32 v12, v12
  v_mfma_f32_16x16x32_bf16 v[196:199], a[200:203], v[52:55], v[196:199]
  v_add_f32_e32 v14, v14, v16
  v_accvgpr_read_b32 v16, a214
  v_mfma_f32_16x16x32_bf16 v[200:203], a[200:203], v[56:59], v[200:203]
  v_rcp_f32_e32 v14, v14
  v_mfma_f32_16x16x32_bf16 v[204:207], a[200:203], v[60:63], v[204:207]
  ds_read_b128 a[164:167], v2 offset:256
  v_mul_f32_e32 v28, s25, v28
  v_mfma_f32_16x16x32_bf16 v[208:211], a[204:207], v[48:51], v[208:211]
  v_mul_f32_e32 v29, s25, v29
  v_mul_f32_e32 v30, s25, v30
  v_mfma_f32_16x16x32_bf16 v[212:215], a[204:207], v[52:55], v[212:215]
  v_exp_f32_e32 v28, v28
  v_mfma_f32_16x16x32_bf16 v[20:23], a[168:171], a[24:27], 0
  v_exp_f32_e32 v29, v29
  v_mfma_f32_16x16x32_bf16 v[20:23], a[172:175], a[28:31], v[20:23]
  ds_read_b64_tr_b16 a[236:237], v6 offset:49408
  v_mul_f32_e32 v31, s25, v31
  v_mfma_f32_16x16x32_bf16 v[20:23], a[176:179], a[32:35], v[20:23]
  v_exp_f32_e32 v30, v30
  v_mfma_f32_16x16x32_bf16 v[20:23], a[180:183], a[36:39], v[20:23]
  ds_read_b64_tr_b16 a[238:239], v6 offset:55552
  v_cvt_pk_bf16_f32 v42, v28, v29
  v_mfma_f32_16x16x32_bf16 v[20:23], a[184:187], a[40:43], v[20:23]
  v_exp_f32_e32 v31, v31
  v_mfma_f32_16x16x32_bf16 v[20:23], a[188:191], a[44:47], v[20:23]
  v_cvt_pk_bf16_f32 v43, v30, v31
  v_accvgpr_read_b32 v19, a215
  v_mfma_f32_16x16x32_bf16 v[216:219], a[204:207], v[56:59], v[216:219]
  ds_read_b128 a[168:171], v1 offset:6144
  v_add_f32_e32 v16, v16, v19
  v_mfma_f32_16x16x32_bf16 v[220:223], a[204:207], v[60:63], v[220:223]
  s_waitcnt lgkmcnt(3)
  v_rcp_f32_e32 v16, v16
  v_mfma_f32_16x16x32_bf16 v[224:227], a[232:235], v[48:51], v[224:227]
  s_waitcnt vmcnt(9) lgkmcnt(1)
  s_barrier
  v_pk_mul_f32 v[64:65], v[64:65], v[10:11] op_sel_hi:[1,0]
  v_pk_mul_f32 v[66:67], v[66:67], v[10:11] op_sel_hi:[1,0]
  v_pk_mul_f32 v[68:69], v[68:69], v[12:13] op_sel_hi:[1,0]
  v_pk_mul_f32 v[70:71], v[70:71], v[12:13] op_sel_hi:[1,0]
  v_pk_mul_f32 v[72:73], v[72:73], v[14:15] op_sel_hi:[1,0]
  v_pk_mul_f32 v[74:75], v[74:75], v[14:15] op_sel_hi:[1,0]
  v_pk_mul_f32 v[76:77], v[76:77], v[16:17] op_sel_hi:[1,0]
  v_pk_mul_f32 v[78:79], v[78:79], v[16:17] op_sel_hi:[1,0]
  v_cvt_pk_bf16_f32 v64, v64, v65
  v_cvt_pk_bf16_f32 v65, v66, v67
  v_cvt_pk_bf16_f32 v68, v68, v69
  v_cvt_pk_bf16_f32 v69, v70, v71
  v_cvt_pk_bf16_f32 v72, v72, v73
  v_cvt_pk_bf16_f32 v73, v74, v75
  v_cvt_pk_bf16_f32 v76, v76, v77
  v_cvt_pk_bf16_f32 v77, v78, v79
  v_mfma_f32_16x16x32_bf16 v[228:231], a[232:235], v[52:55], v[228:231]
  v_mul_f32_e32 v20, s25, v20
  v_mul_f32_e32 v21, s25, v21
  v_mfma_f32_16x16x32_bf16 v[232:235], a[232:235], v[56:59], v[232:235]
  v_exp_f32_e32 v20, v20
  v_mfma_f32_16x16x32_bf16 v[236:239], a[232:235], v[60:63], v[236:239]
  ds_read_b64_tr_b16 a[240:241], v3 offset:12288
  v_mul_f32_e32 v22, s25, v22
  v_mfma_f32_16x16x32_bf16 v[24:27], a[144:147], a[96:99], 0
  v_exp_f32_e32 v21, v21
  v_mfma_f32_16x16x32_bf16 v[24:27], a[148:151], a[100:103], v[24:27]
  s_add_u32 m0, s27, 135680
  v_mul_f32_e32 v23, s25, v23
  v_cvt_pk_bf16_f32 v46, v20, v21
  v_mfma_f32_16x16x32_bf16 v[24:27], a[152:155], a[104:107], v[24:27]
  buffer_load_dwordx4 v7, s[12:15], s58 offen offset:0 nt lds
  v_mfma_f32_16x16x32_bf16 v[24:27], a[156:159], a[108:111], v[24:27]
  v_exp_f32_e32 v22, v22
  v_mfma_f32_16x16x32_bf16 v[24:27], a[160:163], a[112:115], v[24:27]
  ds_read_b128 a[172:175], v2 offset:6144
  ds_read_b64_tr_b16 a[242:243], v3 offset:18432
  v_mfma_f32_16x16x32_bf16 v[24:27], a[164:167], a[116:119], v[24:27]
  v_exp_f32_e64 v23, v23
  v_mfma_f32_16x16x32_bf16 v[240:243], a[236:239], v[48:51], v[240:243]
  s_add_u32 m0, s27, 0
  ds_read_b64_tr_b16 a[244:245], v4 offset:12288
  ds_write_addtid_b32 v64 offset:0
  ds_write_addtid_b32 v65 offset:256
  ds_write_addtid_b32 v68 offset:24832
  ds_write_addtid_b32 v69 offset:25088
  v_accvgpr_write_b32 a48, v72
  v_accvgpr_write_b32 a49, v73
  v_accvgpr_write_b32 a56, v76
  v_accvgpr_write_b32 a57, v77
  v_pk_mul_f32 v[80:81], v[80:81], v[10:11] op_sel_hi:[1,0]
  v_pk_mul_f32 v[82:83], v[82:83], v[10:11] op_sel_hi:[1,0]
  v_pk_mul_f32 v[84:85], v[84:85], v[12:13] op_sel_hi:[1,0]
  v_pk_mul_f32 v[86:87], v[86:87], v[12:13] op_sel_hi:[1,0]
  v_pk_mul_f32 v[88:89], v[88:89], v[14:15] op_sel_hi:[1,0]
  v_pk_mul_f32 v[90:91], v[90:91], v[14:15] op_sel_hi:[1,0]
  v_pk_mul_f32 v[92:93], v[92:93], v[16:17] op_sel_hi:[1,0]
  v_pk_mul_f32 v[94:95], v[94:95], v[16:17] op_sel_hi:[1,0]
  v_cvt_pk_bf16_f32 v80, v80, v81
  v_cvt_pk_bf16_f32 v81, v82, v83
  v_cvt_pk_bf16_f32 v84, v84, v85
  v_cvt_pk_bf16_f32 v85, v86, v87
  v_cvt_pk_bf16_f32 v88, v88, v89
  v_cvt_pk_bf16_f32 v89, v90, v91
  v_cvt_pk_bf16_f32 v92, v92, v93
  v_cvt_pk_bf16_f32 v93, v94, v95
  v_mfma_f32_16x16x32_bf16 v[244:247], a[236:239], v[52:55], v[244:247]
  ds_read_b64_tr_b16 a[246:247], v4 offset:18432
  v_cvt_pk_bf16_f32 v47, v22, v23
  v_mfma_f32_16x16x32_bf16 v[248:251], a[236:239], v[56:59], v[248:251]
  v_accvgpr_write_b32 a50, v88
  v_accvgpr_write_b32 a51, v89
  v_mfma_f32_16x16x32_bf16 v[252:255], a[236:239], v[60:63], v[252:255]
  v_mul_f32_e32 v24, s25, v24
  v_mul_f32_e32 v25, s25, v25
  v_smfmac_f32_16x16x64_bf16 a[216:219], a[224:227], v[32:39], v0
  ds_write_addtid_b32 v80 offset:512
  ds_write_addtid_b32 v81 offset:768
  ds_write_addtid_b32 v84 offset:25344
  ds_write_addtid_b32 v85 offset:25600
  v_accvgpr_write_b32 a58, v92
  v_accvgpr_write_b32 a59, v93
  v_pk_mul_f32 v[96:97], v[96:97], v[10:11] op_sel_hi:[1,0]
  v_pk_mul_f32 v[98:99], v[98:99], v[10:11] op_sel_hi:[1,0]
  v_pk_mul_f32 v[100:101], v[100:101], v[12:13] op_sel_hi:[1,0]
  v_pk_mul_f32 v[102:103], v[102:103], v[12:13] op_sel_hi:[1,0]
  v_pk_mul_f32 v[104:105], v[104:105], v[14:15] op_sel_hi:[1,0]
  v_pk_mul_f32 v[106:107], v[106:107], v[14:15] op_sel_hi:[1,0]
  v_pk_mul_f32 v[108:109], v[108:109], v[16:17] op_sel_hi:[1,0]
  v_pk_mul_f32 v[110:111], v[110:111], v[16:17] op_sel_hi:[1,0]
  v_cvt_pk_bf16_f32 v96, v96, v97
  v_cvt_pk_bf16_f32 v97, v98, v99
  v_cvt_pk_bf16_f32 v100, v100, v101
  v_cvt_pk_bf16_f32 v101, v102, v103
  v_cvt_pk_bf16_f32 v104, v104, v105
  v_cvt_pk_bf16_f32 v105, v106, v107
  v_cvt_pk_bf16_f32 v108, v108, v109
  v_cvt_pk_bf16_f32 v109, v110, v111
  v_smfmac_f32_16x16x64_bf16 a[220:223], a[224:227], v[40:47], v0
  s_add_u32 m0, s27, 135680
  ds_read_b128 a[176:179], v1 offset:6272
  v_mfma_f32_16x16x32_bf16 v[28:31], a[144:147], a[120:123], 0
  buffer_load_dwordx4 v8, s[12:15], s58 offen offset:1024 nt lds
  v_mfma_f32_16x16x32_bf16 v[28:31], a[148:151], a[124:127], v[28:31]
  v_exp_f32_e32 v24, v24
  v_mfma_f32_16x16x32_bf16 v[28:31], a[152:155], a[128:131], v[28:31]
  ds_read_b64_tr_b16 a[248:249], v5 offset:12288
  v_mul_f32_e32 v26, s25, v26
  v_mfma_f32_16x16x32_bf16 v[28:31], a[156:159], a[132:135], v[28:31]
L_tr6:
  s_cbranch_execz L_tr10
  v_exp_f32_e32 v25, v25
  v_mfma_f32_16x16x32_bf16 v[28:31], a[160:163], a[136:139], v[28:31]
  v_mul_f32_e32 v27, s25, v27
  v_cvt_pk_bf16_f32 v48, v24, v25
  v_mfma_f32_16x16x32_bf16 v[28:31], a[164:167], a[140:143], v[28:31]
  s_waitcnt lgkmcnt(6)
  v_exp_f32_e32 v26, v26
  v_mfma_f32_16x16x32_bf16 v[64:67], a[240:243], v[32:35], 0
  v_exp_f32_e64 v27, v27
  v_mfma_f32_16x16x32_bf16 v[68:71], a[240:243], v[36:39], 0
  buffer_load_dwordx4 v9, s[12:15], s58 offen offset:2048 nt lds
  v_mfma_f32_16x16x32_bf16 v[72:75], a[240:243], v[40:43], 0
  s_add_u32 m0, s27, 0
  ds_read_b64_tr_b16 a[250:251], v5 offset:18432
  ds_write_addtid_b32 v96 offset:12320
  ds_write_addtid_b32 v97 offset:12576
  ds_write_addtid_b32 v100 offset:37152
  ds_write_addtid_b32 v101 offset:37408
  v_accvgpr_write_b32 a52, v104
  v_accvgpr_write_b32 a53, v105
  v_accvgpr_write_b32 a60, v108
  v_accvgpr_write_b32 a61, v109
  v_pk_mul_f32 v[112:113], v[112:113], v[10:11] op_sel_hi:[1,0]
  v_pk_mul_f32 v[114:115], v[114:115], v[10:11] op_sel_hi:[1,0]
  v_pk_mul_f32 v[116:117], v[116:117], v[12:13] op_sel_hi:[1,0]
  v_pk_mul_f32 v[118:119], v[118:119], v[12:13] op_sel_hi:[1,0]
  v_pk_mul_f32 v[120:121], v[120:121], v[14:15] op_sel_hi:[1,0]
  v_pk_mul_f32 v[122:123], v[122:123], v[14:15] op_sel_hi:[1,0]
  v_pk_mul_f32 v[124:125], v[124:125], v[16:17] op_sel_hi:[1,0]
  v_pk_mul_f32 v[126:127], v[126:127], v[16:17] op_sel_hi:[1,0]
  v_cvt_pk_bf16_f32 v112, v112, v113
  v_cvt_pk_bf16_f32 v113, v114, v115
  v_cvt_pk_bf16_f32 v116, v116, v117
  v_cvt_pk_bf16_f32 v117, v118, v119
  v_cvt_pk_bf16_f32 v120, v120, v121
  v_cvt_pk_bf16_f32 v121, v122, v123
  v_cvt_pk_bf16_f32 v124, v124, v125
  v_cvt_pk_bf16_f32 v125, v126, v127
  v_mfma_f32_16x16x32_bf16 v[76:79], a[240:243], v[44:47], 0
  ds_read_b64_tr_b16 a[252:253], v6 offset:12288
  v_cvt_pk_bf16_f32 v49, v26, v27
  v_mfma_f32_16x16x32_bf16 v[80:83], a[244:247], v[32:35], 0
  ds_read_b128 a[180:183], v2 offset:6272
  v_mul_f32_e32 v28, s25, v28
  v_mfma_f32_16x16x32_bf16 v[84:87], a[244:247], v[36:39], 0
  ds_read_b64_tr_b16 a[254:255], v6 offset:18432
  v_mul_f32_e32 v29, s25, v29
  v_mfma_f32_16x16x32_bf16 v[88:91], a[244:247], v[40:43], 0
  v_exp_f32_e32 v28, v28
  v_mfma_f32_16x16x32_bf16 v[20:23], a[144:147], a[0:3], 0
  v_mul_f32_e32 v30, s25, v30
  v_mul_f32_e32 v31, s25, v31
  v_mfma_f32_16x16x32_bf16 v[20:23], a[148:151], a[4:7], v[20:23]
  s_add_u32 m0, s27, 147968
  v_exp_f32_e32 v29, v29
  v_mfma_f32_16x16x32_bf16 v[20:23], a[152:155], a[8:11], v[20:23]
  buffer_load_dwordx4 v7, s[12:15], s59 offen offset:0 nt lds
  v_mfma_f32_16x16x32_bf16 v[20:23], a[156:159], a[12:15], v[20:23]
  v_exp_f32_e32 v30, v30
  v_mfma_f32_16x16x32_bf16 v[20:23], a[160:163], a[16:19], v[20:23]
  ds_read_b128 a[184:187], v1 offset:6400
  v_cvt_pk_bf16_f32 v52, v28, v29
  v_mfma_f32_16x16x32_bf16 v[20:23], a[164:167], a[20:23], v[20:23]
  s_add_u32 m0, s27, 0
  ds_read_b64_tr_b16 a[192:193], v3 offset:12416
  ds_write_addtid_b32 v112 offset:12832
  ds_write_addtid_b32 v113 offset:13088
  ds_write_addtid_b32 v116 offset:37664
  ds_write_addtid_b32 v117 offset:37920
  v_accvgpr_write_b32 a54, v120
  v_accvgpr_write_b32 a55, v121
  v_accvgpr_write_b32 a62, v124
  v_accvgpr_write_b32 a63, v125
  v_pk_mul_f32 v[128:129], v[128:129], v[10:11] op_sel_hi:[1,0]
  v_pk_mul_f32 v[130:131], v[130:131], v[10:11] op_sel_hi:[1,0]
  v_pk_mul_f32 v[132:133], v[132:133], v[12:13] op_sel_hi:[1,0]
  v_pk_mul_f32 v[134:135], v[134:135], v[12:13] op_sel_hi:[1,0]
  v_pk_mul_f32 v[136:137], v[136:137], v[14:15] op_sel_hi:[1,0]
  v_pk_mul_f32 v[138:139], v[138:139], v[14:15] op_sel_hi:[1,0]
  v_pk_mul_f32 v[140:141], v[140:141], v[16:17] op_sel_hi:[1,0]
  v_pk_mul_f32 v[142:143], v[142:143], v[16:17] op_sel_hi:[1,0]
  v_cvt_pk_bf16_f32 v128, v128, v129
  v_cvt_pk_bf16_f32 v129, v130, v131
  v_cvt_pk_bf16_f32 v132, v132, v133
  v_cvt_pk_bf16_f32 v133, v134, v135
  v_cvt_pk_bf16_f32 v136, v136, v137
  v_cvt_pk_bf16_f32 v137, v138, v139
  v_cvt_pk_bf16_f32 v140, v140, v141
  v_cvt_pk_bf16_f32 v141, v142, v143
  v_mfma_f32_16x16x32_bf16 v[92:95], a[244:247], v[44:47], 0
  s_waitcnt lgkmcnt(6)
  v_exp_f32_e32 v31, v31
  v_mfma_f32_16x16x32_bf16 v[96:99], a[248:251], v[32:35], 0
  ds_read_b64_tr_b16 a[194:195], v3 offset:18560
  v_cvt_pk_bf16_f32 v53, v30, v31
  v_mfma_f32_16x16x32_bf16 v[100:103], a[248:251], v[36:39], 0
  v_accvgpr_write_b32 a64, v136
  v_accvgpr_write_b32 a65, v137
  v_mfma_f32_16x16x32_bf16 v[104:107], a[248:251], v[40:43], 0
  ds_read_b128 a[188:191], v2 offset:6400
  ds_write_addtid_b32 v128 offset:1024
  ds_write_addtid_b32 v129 offset:1280
  ds_write_addtid_b32 v132 offset:25856
  ds_write_addtid_b32 v133 offset:26112
  s_add_u32 m0, s27, 147968
  v_accvgpr_write_b32 a72, v140
  v_accvgpr_write_b32 a73, v141
  v_pk_mul_f32 v[144:145], v[144:145], v[10:11] op_sel_hi:[1,0]
  v_pk_mul_f32 v[146:147], v[146:147], v[10:11] op_sel_hi:[1,0]
  v_pk_mul_f32 v[148:149], v[148:149], v[12:13] op_sel_hi:[1,0]
  v_pk_mul_f32 v[150:151], v[150:151], v[12:13] op_sel_hi:[1,0]
  v_pk_mul_f32 v[152:153], v[152:153], v[14:15] op_sel_hi:[1,0]
  v_pk_mul_f32 v[154:155], v[154:155], v[14:15] op_sel_hi:[1,0]
  v_pk_mul_f32 v[156:157], v[156:157], v[16:17] op_sel_hi:[1,0]
  v_pk_mul_f32 v[158:159], v[158:159], v[16:17] op_sel_hi:[1,0]
  v_cvt_pk_bf16_f32 v144, v144, v145
  v_cvt_pk_bf16_f32 v145, v146, v147
  v_cvt_pk_bf16_f32 v148, v148, v149
  v_cvt_pk_bf16_f32 v149, v150, v151
  v_cvt_pk_bf16_f32 v152, v152, v153
  v_cvt_pk_bf16_f32 v153, v154, v155
  v_cvt_pk_bf16_f32 v156, v156, v157
  v_cvt_pk_bf16_f32 v157, v158, v159
  v_mfma_f32_16x16x32_bf16 v[108:111], a[248:251], v[44:47], 0
  buffer_load_dwordx4 v8, s[12:15], s59 offen offset:1024 nt lds
  v_mfma_f32_16x16x32_bf16 v[112:115], a[252:255], v[32:35], 0
  v_mul_f32_e32 v20, s25, v20
  v_mul_f32_e32 v21, s25, v21
  v_mfma_f32_16x16x32_bf16 v[24:27], a[144:147], a[24:27], 0
  v_exp_f32_e32 v20, v20
  v_mfma_f32_16x16x32_bf16 v[24:27], a[148:151], a[28:31], v[24:27]
  ds_read_b64_tr_b16 a[196:197], v4 offset:12416
  v_mul_f32_e32 v22, s25, v22
  v_mfma_f32_16x16x32_bf16 v[24:27], a[152:155], a[32:35], v[24:27]
  v_exp_f32_e32 v21, v21
  v_mfma_f32_16x16x32_bf16 v[24:27], a[156:159], a[36:39], v[24:27]
  v_mul_f32_e32 v23, s25, v23
  v_cvt_pk_bf16_f32 v56, v20, v21
  v_mfma_f32_16x16x32_bf16 v[24:27], a[160:163], a[40:43], v[24:27]
  v_exp_f32_e32 v22, v22
  v_mfma_f32_16x16x32_bf16 v[24:27], a[164:167], a[44:47], v[24:27]
  buffer_load_dwordx4 v9, s[12:15], s59 offen offset:2048 nt lds
  v_mfma_f32_16x16x32_bf16 v[116:119], a[252:255], v[36:39], 0
  v_exp_f32_e64 v23, v23
  v_mfma_f32_16x16x32_bf16 v[120:123], a[252:255], v[40:43], 0
  s_add_u32 m0, s27, 0
  ds_read_b64_tr_b16 a[198:199], v4 offset:18560
  ds_write_addtid_b32 v144 offset:1536
  ds_write_addtid_b32 v145 offset:1792
  ds_write_addtid_b32 v148 offset:26368
  ds_write_addtid_b32 v149 offset:26624
  v_accvgpr_write_b32 a66, v152
  v_accvgpr_write_b32 a67, v153
  v_accvgpr_write_b32 a74, v156
  v_accvgpr_write_b32 a75, v157
  v_pk_mul_f32 v[160:161], v[160:161], v[10:11] op_sel_hi:[1,0]
  v_pk_mul_f32 v[162:163], v[162:163], v[10:11] op_sel_hi:[1,0]
  v_pk_mul_f32 v[164:165], v[164:165], v[12:13] op_sel_hi:[1,0]
  v_pk_mul_f32 v[166:167], v[166:167], v[12:13] op_sel_hi:[1,0]
  v_pk_mul_f32 v[168:169], v[168:169], v[14:15] op_sel_hi:[1,0]
  v_pk_mul_f32 v[170:171], v[170:171], v[14:15] op_sel_hi:[1,0]
  v_pk_mul_f32 v[172:173], v[172:173], v[16:17] op_sel_hi:[1,0]
  v_pk_mul_f32 v[174:175], v[174:175], v[16:17] op_sel_hi:[1,0]
  v_cvt_pk_bf16_f32 v160, v160, v161
  v_cvt_pk_bf16_f32 v161, v162, v163
  v_cvt_pk_bf16_f32 v164, v164, v165
  v_cvt_pk_bf16_f32 v165, v166, v167
  v_cvt_pk_bf16_f32 v168, v168, v169
  v_cvt_pk_bf16_f32 v169, v170, v171
  v_cvt_pk_bf16_f32 v172, v172, v173
  v_cvt_pk_bf16_f32 v173, v174, v175
  v_mfma_f32_16x16x32_bf16 v[124:127], a[252:255], v[44:47], 0
  s_waitcnt lgkmcnt(6)
  ds_read_b64_tr_b16 a[200:201], v5 offset:12416
  v_cvt_pk_bf16_f32 v57, v22, v23
  v_mfma_f32_16x16x32_bf16 v[128:131], a[192:195], v[32:35], 0
  ds_read_b128 a[144:147], v1 offset:12288
  v_mul_f32_e32 v24, s25, v24
  v_mfma_f32_16x16x32_bf16 v[132:135], a[192:195], v[36:39], 0
  ds_read_b64_tr_b16 a[202:203], v5 offset:18560
  ds_read2st64_b32 a[228:229], v11 offset0:0 offset1:1
  v_mul_f32_e32 v25, s25, v25
  v_mfma_f32_16x16x32_bf16 v[136:139], a[192:195], v[40:43], 0
  ds_write_addtid_b32 v160 offset:13344
  ds_write_addtid_b32 v161 offset:13600
  ds_write_addtid_b32 v164 offset:38176
  ds_write_addtid_b32 v165 offset:38432
  ds_read2st64_b32 a[230:231], v13 offset0:0 offset1:1
  v_mul_f32_e32 v26, s25, v26
  v_accvgpr_write_b32 a68, v168
  v_accvgpr_write_b32 a69, v169
  v_accvgpr_write_b32 a76, v172
  v_accvgpr_write_b32 a77, v173
  v_pk_mul_f32 v[176:177], v[176:177], v[10:11] op_sel_hi:[1,0]
  v_pk_mul_f32 v[178:179], v[178:179], v[10:11] op_sel_hi:[1,0]
  v_pk_mul_f32 v[180:181], v[180:181], v[12:13] op_sel_hi:[1,0]
  v_pk_mul_f32 v[182:183], v[182:183], v[12:13] op_sel_hi:[1,0]
  v_pk_mul_f32 v[184:185], v[184:185], v[14:15] op_sel_hi:[1,0]
  v_pk_mul_f32 v[186:187], v[186:187], v[14:15] op_sel_hi:[1,0]
  v_pk_mul_f32 v[188:189], v[188:189], v[16:17] op_sel_hi:[1,0]
  v_pk_mul_f32 v[190:191], v[190:191], v[16:17] op_sel_hi:[1,0]
  v_cvt_pk_bf16_f32 v176, v176, v177
  v_cvt_pk_bf16_f32 v177, v178, v179
  v_cvt_pk_bf16_f32 v180, v180, v181
  v_cvt_pk_bf16_f32 v181, v182, v183
  v_cvt_pk_bf16_f32 v184, v184, v185
  v_cvt_pk_bf16_f32 v185, v186, v187
  v_cvt_pk_bf16_f32 v188, v188, v189
  v_cvt_pk_bf16_f32 v189, v190, v191
  v_mfma_f32_16x16x32_bf16 v[28:31], a[168:171], a[96:99], 0
  s_add_u32 m0, s27, 98816
  v_exp_f32_e32 v24, v24
  v_mfma_f32_16x16x32_bf16 v[28:31], a[172:175], a[100:103], v[28:31]
  buffer_load_dwordx4 v7, s[8:11], s61 offen offset:0 nt lds
  v_mfma_f32_16x16x32_bf16 v[28:31], a[176:179], a[104:107], v[28:31]
  v_exp_f32_e32 v25, v25
  v_mfma_f32_16x16x32_bf16 v[28:31], a[180:183], a[108:111], v[28:31]
  ds_read_b128 a[148:151], v2 offset:12288
  v_mul_f32_e32 v27, s25, v27
  v_mfma_f32_16x16x32_bf16 v[28:31], a[184:187], a[112:115], v[28:31]
  v_exp_f32_e32 v26, v26
  v_mfma_f32_16x16x32_bf16 v[28:31], a[188:191], a[116:119], v[28:31]
  ds_read_b64_tr_b16 a[204:205], v6 offset:12416
  v_cvt_pk_bf16_f32 v60, v24, v25
  v_mfma_f32_16x16x32_bf16 v[140:143], a[192:195], v[44:47], 0
  s_waitcnt lgkmcnt(7)
  v_exp_f32_e32 v27, v27
  v_mfma_f32_16x16x32_bf16 v[144:147], a[196:199], v[32:35], 0
  ds_read_b64_tr_b16 a[206:207], v6 offset:18560
  v_cvt_pk_bf16_f32 v61, v26, v27
  v_mfma_f32_16x16x32_bf16 v[148:151], a[196:199], v[36:39], 0
  s_add_u32 m0, s27, 0
  v_accvgpr_write_b32 a70, v184
  v_accvgpr_write_b32 a71, v185
  v_mfma_f32_16x16x32_bf16 v[152:155], a[196:199], v[40:43], 0
  ds_write_addtid_b32 v176 offset:13856
  ds_write_addtid_b32 v177 offset:14112
  ds_write_addtid_b32 v180 offset:38688
  ds_write_addtid_b32 v181 offset:38944
  s_add_u32 m0, s27, 98816
  v_mul_f32_e32 v28, s25, v28
  v_accvgpr_write_b32 a78, v188
  v_accvgpr_write_b32 a79, v189
  v_pk_mul_f32 v[192:193], v[192:193], v[10:11] op_sel_hi:[1,0]
  v_pk_mul_f32 v[194:195], v[194:195], v[10:11] op_sel_hi:[1,0]
  v_pk_mul_f32 v[196:197], v[196:197], v[12:13] op_sel_hi:[1,0]
  v_pk_mul_f32 v[198:199], v[198:199], v[12:13] op_sel_hi:[1,0]
  v_pk_mul_f32 v[200:201], v[200:201], v[14:15] op_sel_hi:[1,0]
  v_pk_mul_f32 v[202:203], v[202:203], v[14:15] op_sel_hi:[1,0]
  v_pk_mul_f32 v[204:205], v[204:205], v[16:17] op_sel_hi:[1,0]
  v_pk_mul_f32 v[206:207], v[206:207], v[16:17] op_sel_hi:[1,0]
  v_cvt_pk_bf16_f32 v192, v192, v193
  v_cvt_pk_bf16_f32 v193, v194, v195
  v_cvt_pk_bf16_f32 v196, v196, v197
  v_cvt_pk_bf16_f32 v197, v198, v199
  v_cvt_pk_bf16_f32 v200, v200, v201
  v_cvt_pk_bf16_f32 v201, v202, v203
  v_cvt_pk_bf16_f32 v204, v204, v205
  v_cvt_pk_bf16_f32 v205, v206, v207
  v_mfma_f32_16x16x32_bf16 v[156:159], a[196:199], v[44:47], 0
  buffer_load_dwordx4 v8, s[8:11], s61 offen offset:1024 nt lds
  ds_read2st64_b32 a[208:209], v15 offset0:0 offset1:1
  v_mfma_f32_16x16x32_bf16 v[160:163], a[200:203], v[32:35], 0
  ds_read_b128 a[152:155], v1 offset:12416
  ds_read2st64_b32 a[210:211], v17 offset0:0 offset1:1
  v_mul_f32_e32 v29, s25, v29
  v_mfma_f32_16x16x32_bf16 v[20:23], a[168:171], a[120:123], 0
  v_exp_f32_e32 v28, v28
  v_mfma_f32_16x16x32_bf16 v[20:23], a[172:175], a[124:127], v[20:23]
  ds_read_b64_tr_b16 a[232:233], v3 offset:12544
  v_mul_f32_e32 v30, s25, v30
  v_mfma_f32_16x16x32_bf16 v[20:23], a[176:179], a[128:131], v[20:23]
  v_exp_f32_e32 v29, v29
  v_mfma_f32_16x16x32_bf16 v[20:23], a[180:183], a[132:135], v[20:23]
  v_mul_f32_e32 v31, s25, v31
  v_cvt_pk_bf16_f32 v50, v28, v29
  v_mfma_f32_16x16x32_bf16 v[20:23], a[184:187], a[136:139], v[20:23]
  s_waitcnt lgkmcnt(8)
  buffer_store_dwordx4 a[228:231], v18, s[20:23], s72 offen offset:0 sc1 nt
  v_mfma_f32_16x16x32_bf16 v[20:23], a[188:191], a[140:143], v[20:23]
  v_exp_f32_e32 v30, v30
  v_mfma_f32_16x16x32_bf16 v[164:167], a[200:203], v[36:39], 0
  buffer_load_dwordx4 v9, s[8:11], s61 offen offset:2048 nt lds
  s_add_u32 m0, s27, 0
  v_mfma_f32_16x16x32_bf16 v[168:171], a[200:203], v[40:43], 0
  ds_write_addtid_b32 v192 offset:2048
  ds_write_addtid_b32 v193 offset:2304
  ds_write_addtid_b32 v196 offset:26880
  ds_write_addtid_b32 v197 offset:27136
  v_exp_f32_e64 v31, v31
  v_accvgpr_write_b32 a80, v200
  v_accvgpr_write_b32 a81, v201
  v_accvgpr_write_b32 a88, v204
  v_accvgpr_write_b32 a89, v205
  v_pk_mul_f32 v[208:209], v[208:209], v[10:11] op_sel_hi:[1,0]
  v_pk_mul_f32 v[210:211], v[210:211], v[10:11] op_sel_hi:[1,0]
  v_pk_mul_f32 v[212:213], v[212:213], v[12:13] op_sel_hi:[1,0]
  v_pk_mul_f32 v[214:215], v[214:215], v[12:13] op_sel_hi:[1,0]
  v_pk_mul_f32 v[216:217], v[216:217], v[14:15] op_sel_hi:[1,0]
  v_pk_mul_f32 v[218:219], v[218:219], v[14:15] op_sel_hi:[1,0]
  v_pk_mul_f32 v[220:221], v[220:221], v[16:17] op_sel_hi:[1,0]
  v_pk_mul_f32 v[222:223], v[222:223], v[16:17] op_sel_hi:[1,0]
  v_cvt_pk_bf16_f32 v208, v208, v209
  v_cvt_pk_bf16_f32 v209, v210, v211
  v_cvt_pk_bf16_f32 v212, v212, v213
  v_cvt_pk_bf16_f32 v213, v214, v215
  v_cvt_pk_bf16_f32 v216, v216, v217
  v_cvt_pk_bf16_f32 v217, v218, v219
  v_cvt_pk_bf16_f32 v220, v220, v221
  v_cvt_pk_bf16_f32 v221, v222, v223
  v_mfma_f32_16x16x32_bf16 v[172:175], a[200:203], v[44:47], 0
  ds_read_b64_tr_b16 a[234:235], v3 offset:18688
  v_cvt_pk_bf16_f32 v51, v30, v31
  v_mfma_f32_16x16x32_bf16 v[176:179], a[204:207], v[32:35], 0
  ds_read_b64_tr_b16 a[236:237], v4 offset:12544
  v_mul_f32_e32 v20, s25, v20
  v_mfma_f32_16x16x32_bf16 v[180:183], a[204:207], v[36:39], 0
  ds_read_b128 a[156:159], v2 offset:12416
  v_mul_f32_e32 v21, s25, v21
  v_mfma_f32_16x16x32_bf16 v[184:187], a[204:207], v[40:43], 0
  ds_read_b64_tr_b16 a[238:239], v4 offset:18688
  ds_write_addtid_b32 v208 offset:2560
  ds_write_addtid_b32 v209 offset:2816
  ds_write_addtid_b32 v212 offset:27392
  ds_write_addtid_b32 v213 offset:27648
  v_accvgpr_write_b32 a82, v216
  v_accvgpr_write_b32 a83, v217
  v_accvgpr_write_b32 a90, v220
  v_accvgpr_write_b32 a91, v221
  v_pk_mul_f32 v[224:225], v[224:225], v[10:11] op_sel_hi:[1,0]
  v_pk_mul_f32 v[226:227], v[226:227], v[10:11] op_sel_hi:[1,0]
  v_pk_mul_f32 v[228:229], v[228:229], v[12:13] op_sel_hi:[1,0]
  v_pk_mul_f32 v[230:231], v[230:231], v[12:13] op_sel_hi:[1,0]
  v_pk_mul_f32 v[232:233], v[232:233], v[14:15] op_sel_hi:[1,0]
  v_pk_mul_f32 v[234:235], v[234:235], v[14:15] op_sel_hi:[1,0]
  v_pk_mul_f32 v[236:237], v[236:237], v[16:17] op_sel_hi:[1,0]
  v_pk_mul_f32 v[238:239], v[238:239], v[16:17] op_sel_hi:[1,0]
  v_cvt_pk_bf16_f32 v224, v224, v225
  v_cvt_pk_bf16_f32 v225, v226, v227
  v_cvt_pk_bf16_f32 v228, v228, v229
  v_cvt_pk_bf16_f32 v229, v230, v231
  v_cvt_pk_bf16_f32 v232, v232, v233
  v_cvt_pk_bf16_f32 v233, v234, v235
  v_cvt_pk_bf16_f32 v236, v236, v237
  v_cvt_pk_bf16_f32 v237, v238, v239
  v_mfma_f32_16x16x32_bf16 v[188:191], a[204:207], v[44:47], 0
  v_exp_f32_e32 v20, v20
  v_mfma_f32_16x16x32_bf16 v[24:27], a[168:171], a[0:3], 0
  v_mul_f32_e32 v22, s25, v22
  v_mul_f32_e32 v23, s25, v23
  v_mfma_f32_16x16x32_bf16 v[24:27], a[172:175], a[4:7], v[24:27]
  v_exp_f32_e32 v21, v21
  v_mfma_f32_16x16x32_bf16 v[24:27], a[176:179], a[8:11], v[24:27]
  v_exp_f32_e32 v22, v22
  v_mfma_f32_16x16x32_bf16 v[24:27], a[180:183], a[12:15], v[24:27]
  s_waitcnt lgkmcnt(7)
  buffer_store_dwordx4 a[208:211], v18, s[20:23], s72 offen offset:3072 sc1 nt
  v_mfma_f32_16x16x32_bf16 v[24:27], a[184:187], a[16:19], v[24:27]
  ds_read_b128 a[160:163], v1 offset:12544
  v_cvt_pk_bf16_f32 v54, v20, v21
  v_mfma_f32_16x16x32_bf16 v[24:27], a[188:191], a[20:23], v[24:27]
  ds_read_b64_tr_b16 a[240:241], v5 offset:12544
  ds_read_b64_tr_b16 a[242:243], v5 offset:18688
  v_mfma_f32_16x16x32_bf16 v[192:195], a[232:235], v[32:35], 0
  v_exp_f32_e64 v23, v23
  v_mfma_f32_16x16x32_bf16 v[196:199], a[232:235], v[36:39], 0
  v_cvt_pk_bf16_f32 v55, v22, v23
  v_accvgpr_write_b32 a84, v232
  v_mfma_f32_16x16x32_bf16 v[200:203], a[232:235], v[40:43], 0
  ds_write_addtid_b32 v224 offset:14368
  ds_write_addtid_b32 v225 offset:14624
  ds_write_addtid_b32 v228 offset:39200
  ds_write_addtid_b32 v229 offset:39456
  v_accvgpr_write_b32 a85, v233
  v_accvgpr_write_b32 a92, v236
  v_accvgpr_write_b32 a93, v237
  v_pk_mul_f32 v[240:241], v[240:241], v[10:11] op_sel_hi:[1,0]
  v_pk_mul_f32 v[242:243], v[242:243], v[10:11] op_sel_hi:[1,0]
  v_pk_mul_f32 v[244:245], v[244:245], v[12:13] op_sel_hi:[1,0]
  v_pk_mul_f32 v[246:247], v[246:247], v[12:13] op_sel_hi:[1,0]
  v_pk_mul_f32 v[248:249], v[248:249], v[14:15] op_sel_hi:[1,0]
  v_pk_mul_f32 v[250:251], v[250:251], v[14:15] op_sel_hi:[1,0]
  v_pk_mul_f32 v[252:253], v[252:253], v[16:17] op_sel_hi:[1,0]
  v_pk_mul_f32 v[254:255], v[254:255], v[16:17] op_sel_hi:[1,0]
  v_cvt_pk_bf16_f32 v240, v240, v241
  v_cvt_pk_bf16_f32 v241, v242, v243
  v_cvt_pk_bf16_f32 v244, v244, v245
  v_cvt_pk_bf16_f32 v245, v246, v247
  v_cvt_pk_bf16_f32 v248, v248, v249
  v_cvt_pk_bf16_f32 v249, v250, v251
  v_cvt_pk_bf16_f32 v252, v252, v253
  v_cvt_pk_bf16_f32 v253, v254, v255
  v_mfma_f32_16x16x32_bf16 v[204:207], a[232:235], v[44:47], 0
  s_waitcnt lgkmcnt(7)
  ds_read_b128 a[164:167], v2 offset:12544
  ds_write_addtid_b32 v240 offset:14880
  ds_write_addtid_b32 v241 offset:15136
  ds_write_addtid_b32 v244 offset:39712
  ds_write_addtid_b32 v245 offset:39968
  v_accvgpr_write_b32 a86, v248
  v_accvgpr_write_b32 a87, v249
  v_accvgpr_write_b32 a94, v252
  v_accvgpr_write_b32 a95, v253
  v_mfma_f32_16x16x32_bf16 v[208:211], a[236:239], v[32:35], 0
  v_mul_f32_e32 v24, s25, v24
  v_mul_f32_e32 v25, s25, v25
  v_mfma_f32_16x16x32_bf16 v[212:215], a[236:239], v[36:39], 0
  v_exp_f32_e32 v24, v24
  v_mfma_f32_16x16x32_bf16 v[28:31], a[168:171], a[24:27], 0
  ds_read_b64_tr_b16 a[244:245], v6 offset:12544
  v_mul_f32_e32 v26, s25, v26
  v_mfma_f32_16x16x32_bf16 v[28:31], a[172:175], a[28:31], v[28:31]
  v_exp_f32_e32 v25, v25
  v_mfma_f32_16x16x32_bf16 v[28:31], a[176:179], a[32:35], v[28:31]
  ds_read_b64_tr_b16 a[246:247], v6 offset:18688
  v_mul_f32_e32 v27, s25, v27
  v_mfma_f32_16x16x32_bf16 v[28:31], a[180:183], a[36:39], v[28:31]
  v_exp_f32_e32 v26, v26
  v_mfma_f32_16x16x32_bf16 v[28:31], a[184:187], a[40:43], v[28:31]
  v_exp_f32_e32 v27, v27
  v_mfma_f32_16x16x32_bf16 v[28:31], a[188:191], a[44:47], v[28:31]
  v_cvt_pk_bf16_f32 v58, v24, v25
  v_cvt_pk_bf16_f32 v59, v26, v27
  v_mfma_f32_16x16x32_bf16 v[216:219], a[236:239], v[40:43], 0
  ds_read_b128 a[168:171], v1 offset:18432
  v_cmp_nle_f32_e32 vcc, 0x33800000, v10
  v_mfma_f32_16x16x32_bf16 v[220:223], a[236:239], v[44:47], 0
  s_waitcnt lgkmcnt(3)
  s_or_b64 s[34:35], s[34:35], vcc
  ds_read2st64_b32 a[212:213], v11 offset0:97 offset1:98
  v_cmp_lt_f32_e32 vcc, 0x49800000, v10
  v_mfma_f32_16x16x32_bf16 v[224:227], a[240:243], v[32:35], 0
  s_waitcnt vmcnt(14) lgkmcnt(2)
  s_barrier
  ds_read2st64_b32 a[214:215], v13 offset0:97 offset1:98
  v_mfma_f32_16x16x32_bf16 v[228:231], a[240:243], v[36:39], 0
  s_or_b64 s[34:35], s[34:35], vcc
  v_mul_f32_e32 v28, s25, v28
  v_mul_f32_e32 v29, s25, v29
  v_mfma_f32_16x16x32_bf16 v[232:235], a[240:243], v[40:43], 0
  v_exp_f32_e32 v28, v28
  v_mfma_f32_16x16x32_bf16 v[236:239], a[240:243], v[44:47], 0
  ds_read_b64_tr_b16 a[248:249], v3 offset:24576
  v_mul_f32_e32 v30, s25, v30
  v_mfma_f32_16x16x32_bf16 v[20:23], a[144:147], a[96:99], 0
  v_exp_f32_e32 v29, v29
  v_mfma_f32_16x16x32_bf16 v[20:23], a[148:151], a[100:103], v[20:23]
  s_add_u32 m0, s27, 111104
  v_mul_f32_e32 v31, s25, v31
  v_cvt_pk_bf16_f32 v62, v28, v29
  v_mfma_f32_16x16x32_bf16 v[20:23], a[152:155], a[104:107], v[20:23]
  buffer_load_dwordx4 v7, s[12:15], s60 offen offset:0 nt lds
  v_mfma_f32_16x16x32_bf16 v[20:23], a[156:159], a[108:111], v[20:23]
  v_exp_f32_e32 v30, v30
  v_mfma_f32_16x16x32_bf16 v[20:23], a[160:163], a[112:115], v[20:23]
  ds_read_b128 a[172:175], v2 offset:18432
  ds_read_b64_tr_b16 a[250:251], v3 offset:30720
  v_mfma_f32_16x16x32_bf16 v[20:23], a[164:167], a[116:119], v[20:23]
  v_exp_f32_e32 v31, v31
  v_mfma_f32_16x16x32_bf16 v[240:243], a[244:247], v[32:35], 0
  ds_read_b64_tr_b16 a[252:253], v4 offset:24576
  v_cvt_pk_bf16_f32 v63, v30, v31
  v_mfma_f32_16x16x32_bf16 v[244:247], a[244:247], v[36:39], 0
  ds_read_b64_tr_b16 a[254:255], v4 offset:30720
  v_cmp_nle_f32_e32 vcc, 0x33800000, v12
  v_mfma_f32_16x16x32_bf16 v[248:251], a[244:247], v[40:43], 0
  s_or_b64 s[34:35], s[34:35], vcc
  ds_read2st64_b32 a[228:229], v15 offset0:97 offset1:98
  v_cmp_lt_f32_e32 vcc, 0x49800000, v12
  v_mfma_f32_16x16x32_bf16 v[252:255], a[244:247], v[44:47], 0
  s_or_b64 s[34:35], s[34:35], vcc
  v_mul_f32_e32 v20, s25, v20
  v_mul_f32_e32 v21, s25, v21
  v_smfmac_f32_16x16x64_bf16 a[216:219], a[224:227], v[48:55], v0
  ds_read_b128 a[176:179], v1 offset:18560
  v_smfmac_f32_16x16x64_bf16 a[220:223], a[224:227], v[56:63], v0
  v_mul_f32_e32 v22, s25, v22
  v_mfma_f32_16x16x32_bf16 v[24:27], a[144:147], a[120:123], 0
  buffer_load_dwordx4 v8, s[12:15], s60 offen offset:1024 nt lds
  v_mfma_f32_16x16x32_bf16 v[24:27], a[148:151], a[124:127], v[24:27]
  v_exp_f32_e32 v20, v20
  v_mfma_f32_16x16x32_bf16 v[24:27], a[152:155], a[128:131], v[24:27]
  v_exp_f32_e32 v21, v21
  v_mfma_f32_16x16x32_bf16 v[24:27], a[156:159], a[132:135], v[24:27]
  ds_read_b64_tr_b16 a[192:193], v5 offset:24576
  v_mul_f32_e32 v23, s25, v23
  v_mfma_f32_16x16x32_bf16 v[24:27], a[160:163], a[136:139], v[24:27]
  v_exp_f32_e32 v22, v22
  v_mfma_f32_16x16x32_bf16 v[24:27], a[164:167], a[140:143], v[24:27]
  s_waitcnt lgkmcnt(2)
  ds_read_b64_tr_b16 a[194:195], v5 offset:30720
  v_cvt_pk_bf16_f32 v32, v20, v21
  v_mfma_f32_16x16x32_bf16 v[64:67], a[248:251], v[48:51], v[64:67]
  v_exp_f32_e32 v23, v23
  v_mfma_f32_16x16x32_bf16 v[68:71], a[248:251], v[52:55], v[68:71]
  buffer_load_dwordx4 v9, s[12:15], s60 offen offset:2048 nt lds
  v_mfma_f32_16x16x32_bf16 v[72:75], a[248:251], v[56:59], v[72:75]
  ds_read_b64_tr_b16 a[196:197], v6 offset:24576
  v_cvt_pk_bf16_f32 v33, v22, v23
  v_mfma_f32_16x16x32_bf16 v[76:79], a[248:251], v[60:63], v[76:79]
  ds_read_b128 a[180:183], v2 offset:18560
  v_mul_f32_e32 v24, s25, v24
  v_mfma_f32_16x16x32_bf16 v[80:83], a[252:255], v[48:51], v[80:83]
  ds_read_b64_tr_b16 a[198:199], v6 offset:30720
  v_mul_f32_e32 v25, s25, v25
  v_mfma_f32_16x16x32_bf16 v[84:87], a[252:255], v[52:55], v[84:87]
  v_exp_f32_e32 v24, v24
  v_mfma_f32_16x16x32_bf16 v[88:91], a[252:255], v[56:59], v[88:91]
  v_mul_f32_e32 v26, s25, v26
  v_mul_f32_e32 v27, s25, v27
  v_mfma_f32_16x16x32_bf16 v[28:31], a[144:147], a[0:3], 0
  s_add_u32 m0, s27, 49664
  v_exp_f32_e32 v25, v25
  v_mfma_f32_16x16x32_bf16 v[28:31], a[148:151], a[4:7], v[28:31]
  buffer_load_dwordx4 v7, s[8:11], s62 offen offset:0 nt lds
  v_mfma_f32_16x16x32_bf16 v[28:31], a[152:155], a[8:11], v[28:31]
  v_exp_f32_e32 v26, v26
  v_mfma_f32_16x16x32_bf16 v[28:31], a[156:159], a[12:15], v[28:31]
  ds_read_b128 a[184:187], v1 offset:18688
  v_cvt_pk_bf16_f32 v36, v24, v25
  v_mfma_f32_16x16x32_bf16 v[28:31], a[160:163], a[16:19], v[28:31]
  v_exp_f32_e32 v27, v27
  v_mfma_f32_16x16x32_bf16 v[28:31], a[164:167], a[20:23], v[28:31]
  ds_read_b64_tr_b16 a[200:201], v3 offset:24704
  v_cvt_pk_bf16_f32 v37, v26, v27
  v_mfma_f32_16x16x32_bf16 v[92:95], a[252:255], v[60:63], v[92:95]
  s_waitcnt lgkmcnt(2)
  ds_read_b64_tr_b16 a[202:203], v3 offset:30848
  v_cmp_nle_f32_e32 vcc, 0x33800000, v14
  v_mfma_f32_16x16x32_bf16 v[96:99], a[192:195], v[48:51], v[96:99]
  s_or_b64 s[34:35], s[34:35], vcc
  ds_read2st64_b32 a[230:231], v17 offset0:97 offset1:98
  v_cmp_lt_f32_e32 vcc, 0x49800000, v14
  v_mfma_f32_16x16x32_bf16 v[100:103], a[192:195], v[52:55], v[100:103]
  s_or_b64 s[34:35], s[34:35], vcc
  ds_read2st64_b32 a[208:209], v11 offset0:101 offset1:102
  v_cmp_nle_f32_e32 vcc, 0x33800000, v16
  v_mfma_f32_16x16x32_bf16 v[104:107], a[192:195], v[56:59], v[104:107]
  s_or_b64 s[34:35], s[34:35], vcc
  buffer_load_dwordx4 v8, s[8:11], s62 offen offset:1024 nt lds
  v_mfma_f32_16x16x32_bf16 v[108:111], a[192:195], v[60:63], v[108:111]
  ds_read_b128 a[188:191], v2 offset:18688
  v_mul_f32_e32 v28, s25, v28
  v_mfma_f32_16x16x32_bf16 v[112:115], a[196:199], v[48:51], v[112:115]
  v_mul_f32_e32 v29, s25, v29
  v_mul_f32_e32 v30, s25, v30
  v_mfma_f32_16x16x32_bf16 v[20:23], a[144:147], a[24:27], 0
  v_exp_f32_e32 v28, v28
  v_mfma_f32_16x16x32_bf16 v[20:23], a[148:151], a[28:31], v[20:23]
  v_exp_f32_e32 v29, v29
  v_mfma_f32_16x16x32_bf16 v[20:23], a[152:155], a[32:35], v[20:23]
  ds_read_b64_tr_b16 a[204:205], v4 offset:24704
  v_mul_f32_e32 v31, s25, v31
  v_mfma_f32_16x16x32_bf16 v[20:23], a[156:159], a[36:39], v[20:23]
  v_exp_f32_e32 v30, v30
  v_mfma_f32_16x16x32_bf16 v[20:23], a[160:163], a[40:43], v[20:23]
  ds_read_b64_tr_b16 a[206:207], v4 offset:30848
  v_cvt_pk_bf16_f32 v40, v28, v29
  v_mfma_f32_16x16x32_bf16 v[20:23], a[164:167], a[44:47], v[20:23]
  buffer_load_dwordx4 v9, s[8:11], s62 offen offset:2048 nt lds
  v_mfma_f32_16x16x32_bf16 v[116:119], a[196:199], v[52:55], v[116:119]
L_tr7:
  s_cbranch_execz L_tr11
  v_exp_f32_e32 v31, v31
  v_mfma_f32_16x16x32_bf16 v[120:123], a[196:199], v[56:59], v[120:123]
  ds_read_b64_tr_b16 a[232:233], v5 offset:24704
  v_cvt_pk_bf16_f32 v41, v30, v31
  v_mfma_f32_16x16x32_bf16 v[124:127], a[196:199], v[60:63], v[124:127]
  s_waitcnt lgkmcnt(3)
  ds_read_b128 a[144:147], v1 offset:24576
  ds_read_b64_tr_b16 a[234:235], v5 offset:30848
  v_mfma_f32_16x16x32_bf16 v[128:131], a[200:203], v[48:51], v[128:131]
  v_mul_f32_e32 v20, s25, v20
  v_mul_f32_e32 v21, s25, v21
  v_mfma_f32_16x16x32_bf16 v[132:135], a[200:203], v[52:55], v[132:135]
  v_exp_f32_e32 v20, v20
  v_mfma_f32_16x16x32_bf16 v[136:139], a[200:203], v[56:59], v[136:139]
  v_mul_f32_e32 v22, s25, v22
  v_mul_f32_e32 v23, s25, v23
  v_mfma_f32_16x16x32_bf16 v[24:27], a[168:171], a[96:99], 0
  v_exp_f32_e32 v21, v21
  v_mfma_f32_16x16x32_bf16 v[24:27], a[172:175], a[100:103], v[24:27]
  v_exp_f32_e32 v22, v22
  v_mfma_f32_16x16x32_bf16 v[24:27], a[176:179], a[104:107], v[24:27]
  ds_read_b128 a[148:151], v2 offset:24576
  v_cvt_pk_bf16_f32 v44, v20, v21
  v_mfma_f32_16x16x32_bf16 v[24:27], a[180:183], a[108:111], v[24:27]
  v_exp_f32_e32 v23, v23
  v_mfma_f32_16x16x32_bf16 v[24:27], a[184:187], a[112:115], v[24:27]
  ds_read_b64_tr_b16 a[236:237], v6 offset:24704
  v_cvt_pk_bf16_f32 v45, v22, v23
  v_mfma_f32_16x16x32_bf16 v[24:27], a[188:191], a[116:119], v[24:27]
  ds_read2st64_b32 a[210:211], v13 offset0:101 offset1:102
  v_cmp_lt_f32_e32 vcc, 0x49800000, v16
  v_mfma_f32_16x16x32_bf16 v[140:143], a[200:203], v[60:63], v[140:143]
  s_waitcnt lgkmcnt(3)
  s_or_b64 s[34:35], s[34:35], vcc
  ds_read_b64_tr_b16 a[238:239], v6 offset:30848
  v_mfma_f32_16x16x32_bf16 v[144:147], a[204:207], v[48:51], v[144:147]
  buffer_store_dwordx4 a[212:215], v18, s[20:23], s73 offen offset:0 sc1 nt
  v_mfma_f32_16x16x32_bf16 v[148:151], a[204:207], v[52:55], v[148:151]
  v_accvgpr_read_b32 v10, a48
  v_accvgpr_read_b32 v12, a49
  v_mfma_f32_16x16x32_bf16 v[152:155], a[204:207], v[56:59], v[152:155]
  v_mul_f32_e32 v24, s25, v24
  v_mul_f32_e32 v25, s25, v25
  v_mfma_f32_16x16x32_bf16 v[156:159], a[204:207], v[60:63], v[156:159]
  v_exp_f32_e32 v24, v24
  v_mfma_f32_16x16x32_bf16 v[160:163], a[232:235], v[48:51], v[160:163]
  ds_read_b128 a[152:155], v1 offset:24704
  v_mul_f32_e32 v26, s25, v26
  v_mfma_f32_16x16x32_bf16 v[28:31], a[168:171], a[120:123], 0
  v_exp_f32_e32 v25, v25
  v_mfma_f32_16x16x32_bf16 v[28:31], a[172:175], a[124:127], v[28:31]
  ds_read_b64_tr_b16 a[240:241], v3 offset:24832
  v_mul_f32_e32 v27, s25, v27
  v_mfma_f32_16x16x32_bf16 v[28:31], a[176:179], a[128:131], v[28:31]
  v_exp_f32_e32 v26, v26
  v_mfma_f32_16x16x32_bf16 v[28:31], a[180:183], a[132:135], v[28:31]
  v_exp_f32_e32 v27, v27
  v_mfma_f32_16x16x32_bf16 v[28:31], a[184:187], a[136:139], v[28:31]
  ds_read_b64_tr_b16 a[242:243], v3 offset:30976
  v_cvt_pk_bf16_f32 v34, v24, v25
  v_mfma_f32_16x16x32_bf16 v[28:31], a[188:191], a[140:143], v[28:31]
  ds_read_b64_tr_b16 a[244:245], v4 offset:24832
  v_cvt_pk_bf16_f32 v35, v26, v27
  v_mfma_f32_16x16x32_bf16 v[164:167], a[232:235], v[52:55], v[164:167]
  ds_read_b128 a[156:159], v2 offset:24704
  v_accvgpr_read_b32 v14, a50
  v_mfma_f32_16x16x32_bf16 v[168:171], a[232:235], v[56:59], v[168:171]
  ds_read2st64_b32 a[212:213], v15 offset0:101 offset1:102
  v_accvgpr_read_b32 v16, a51
  v_mfma_f32_16x16x32_bf16 v[172:175], a[232:235], v[60:63], v[172:175]
  s_waitcnt lgkmcnt(5)
  ds_read_b64_tr_b16 a[246:247], v4 offset:30976
  v_mfma_f32_16x16x32_bf16 v[176:179], a[236:239], v[48:51], v[176:179]
  v_mul_f32_e32 v28, s25, v28
  v_mul_f32_e32 v29, s25, v29
  v_mfma_f32_16x16x32_bf16 v[180:183], a[236:239], v[52:55], v[180:183]
  v_exp_f32_e32 v28, v28
  v_mfma_f32_16x16x32_bf16 v[184:187], a[236:239], v[56:59], v[184:187]
  v_mul_f32_e32 v30, s25, v30
  v_mul_f32_e32 v31, s25, v31
  v_mfma_f32_16x16x32_bf16 v[188:191], a[236:239], v[60:63], v[188:191]
  v_exp_f32_e32 v29, v29
  v_mfma_f32_16x16x32_bf16 v[20:23], a[168:171], a[0:3], 0
  v_exp_f32_e32 v30, v30
  v_mfma_f32_16x16x32_bf16 v[20:23], a[172:175], a[4:7], v[20:23]
  ds_read_b128 a[160:163], v1 offset:24832
  v_cvt_pk_bf16_f32 v38, v28, v29
  v_mfma_f32_16x16x32_bf16 v[20:23], a[176:179], a[8:11], v[20:23]
  v_exp_f32_e32 v31, v31
  v_mfma_f32_16x16x32_bf16 v[20:23], a[180:183], a[12:15], v[20:23]
  ds_read_b64_tr_b16 a[248:249], v5 offset:24832
  v_cvt_pk_bf16_f32 v39, v30, v31
  v_mfma_f32_16x16x32_bf16 v[20:23], a[184:187], a[16:19], v[20:23]
  ds_read2st64_b32 a[214:215], v17 offset0:101 offset1:102
  v_mfma_f32_16x16x32_bf16 v[20:23], a[188:191], a[20:23], v[20:23]
  s_waitcnt lgkmcnt(3)
  ds_read_b64_tr_b16 a[250:251], v5 offset:30976
  v_mfma_f32_16x16x32_bf16 v[192:195], a[240:243], v[48:51], v[192:195]
  v_mfma_f32_16x16x32_bf16 v[196:199], a[240:243], v[52:55], v[196:199]
  v_mfma_f32_16x16x32_bf16 v[200:203], a[240:243], v[56:59], v[200:203]
  v_mfma_f32_16x16x32_bf16 v[204:207], a[240:243], v[60:63], v[204:207]
  ds_read_b128 a[164:167], v2 offset:24832
  s_nop 0
  v_mul_f32_e32 v20, s25, v20
  v_mfma_f32_16x16x32_bf16 v[208:211], a[244:247], v[48:51], v[208:211]
  v_mul_f32_e32 v21, s25, v21
  v_mul_f32_e32 v22, s25, v22
  v_mfma_f32_16x16x32_bf16 v[212:215], a[244:247], v[52:55], v[212:215]
  v_exp_f32_e32 v20, v20
  v_mfma_f32_16x16x32_bf16 v[24:27], a[168:171], a[24:27], 0
  v_exp_f32_e32 v21, v21
  v_mfma_f32_16x16x32_bf16 v[24:27], a[172:175], a[28:31], v[24:27]
  ds_read_b64_tr_b16 a[252:253], v6 offset:24832
  v_mul_f32_e32 v23, s25, v23
  v_mfma_f32_16x16x32_bf16 v[24:27], a[176:179], a[32:35], v[24:27]
  v_exp_f32_e32 v22, v22
  v_mfma_f32_16x16x32_bf16 v[24:27], a[180:183], a[36:39], v[24:27]
  ds_read_b64_tr_b16 a[254:255], v6 offset:30976
  v_cvt_pk_bf16_f32 v42, v20, v21
  v_mfma_f32_16x16x32_bf16 v[24:27], a[184:187], a[40:43], v[24:27]
  v_exp_f32_e32 v23, v23
  v_mfma_f32_16x16x32_bf16 v[24:27], a[188:191], a[44:47], v[24:27]
  v_cvt_pk_bf16_f32 v43, v22, v23
  v_mfma_f32_16x16x32_bf16 v[216:219], a[244:247], v[56:59], v[216:219]
  ds_read_b128 a[168:171], v1 offset:30720
  v_mfma_f32_16x16x32_bf16 v[220:223], a[244:247], v[60:63], v[220:223]
  s_waitcnt lgkmcnt(3)
  v_mfma_f32_16x16x32_bf16 v[224:227], a[248:251], v[48:51], v[224:227]
  s_waitcnt vmcnt(15) lgkmcnt(1)
  s_barrier
  v_mfma_f32_16x16x32_bf16 v[228:231], a[248:251], v[52:55], v[228:231]
  v_mul_f32_e32 v24, s25, v24
  v_mul_f32_e32 v25, s25, v25
  v_mfma_f32_16x16x32_bf16 v[232:235], a[248:251], v[56:59], v[232:235]
  v_exp_f32_e32 v24, v24
  v_mfma_f32_16x16x32_bf16 v[236:239], a[248:251], v[60:63], v[236:239]
  ds_read_b64_tr_b16 a[192:193], v3 offset:36864
  v_mul_f32_e32 v26, s25, v26
  v_mfma_f32_16x16x32_bf16 v[28:31], a[144:147], a[96:99], 0
  v_exp_f32_e32 v25, v25
  v_mfma_f32_16x16x32_bf16 v[28:31], a[148:151], a[100:103], v[28:31]
  s_add_u32 m0, s27, 123392
  v_mul_f32_e32 v27, s25, v27
  v_cvt_pk_bf16_f32 v46, v24, v25
  v_mfma_f32_16x16x32_bf16 v[28:31], a[152:155], a[104:107], v[28:31]
  buffer_load_dwordx4 v7, s[12:15], s61 offen offset:0 nt lds
  v_mfma_f32_16x16x32_bf16 v[28:31], a[156:159], a[108:111], v[28:31]
  v_exp_f32_e32 v26, v26
  v_mfma_f32_16x16x32_bf16 v[28:31], a[160:163], a[112:115], v[28:31]
  ds_read_b128 a[172:175], v2 offset:30720
  ds_read_b64_tr_b16 a[194:195], v3 offset:43008
  v_mfma_f32_16x16x32_bf16 v[28:31], a[164:167], a[116:119], v[28:31]
  v_exp_f32_e32 v27, v27
  v_mfma_f32_16x16x32_bf16 v[240:243], a[252:255], v[48:51], v[240:243]
  ds_read_b64_tr_b16 a[196:197], v4 offset:36864
  v_cvt_pk_bf16_f32 v47, v26, v27
  v_mfma_f32_16x16x32_bf16 v[244:247], a[252:255], v[52:55], v[244:247]
  ds_read_b64_tr_b16 a[198:199], v4 offset:43008
  v_mfma_f32_16x16x32_bf16 v[248:251], a[252:255], v[56:59], v[248:251]
  v_mfma_f32_16x16x32_bf16 v[252:255], a[252:255], v[60:63], v[252:255]
  v_mul_f32_e32 v28, s25, v28
  v_mul_f32_e32 v29, s25, v29
  v_smfmac_f32_16x16x64_bf16 a[216:219], a[224:227], v[32:39], v0
  ds_read_b128 a[176:179], v1 offset:30848
  v_smfmac_f32_16x16x64_bf16 a[220:223], a[224:227], v[40:47], v0
  v_mul_f32_e32 v30, s25, v30
  v_mfma_f32_16x16x32_bf16 v[20:23], a[144:147], a[120:123], 0
  buffer_load_dwordx4 v8, s[12:15], s61 offen offset:1024 nt lds
  v_mfma_f32_16x16x32_bf16 v[20:23], a[148:151], a[124:127], v[20:23]
  v_exp_f32_e32 v28, v28
  v_mfma_f32_16x16x32_bf16 v[20:23], a[152:155], a[128:131], v[20:23]
  v_exp_f32_e32 v29, v29
  v_mfma_f32_16x16x32_bf16 v[20:23], a[156:159], a[132:135], v[20:23]
  ds_read_b64_tr_b16 a[200:201], v5 offset:36864
  v_mul_f32_e32 v31, s25, v31
  v_mfma_f32_16x16x32_bf16 v[20:23], a[160:163], a[136:139], v[20:23]
  v_exp_f32_e32 v30, v30
  v_mfma_f32_16x16x32_bf16 v[20:23], a[164:167], a[140:143], v[20:23]
  s_waitcnt lgkmcnt(2)
  ds_read_b64_tr_b16 a[202:203], v5 offset:43008
  v_cvt_pk_bf16_f32 v48, v28, v29
  v_mfma_f32_16x16x32_bf16 v[64:67], a[192:195], v[32:35], v[64:67]
  v_exp_f32_e32 v31, v31
  v_mfma_f32_16x16x32_bf16 v[68:71], a[192:195], v[36:39], v[68:71]
  buffer_load_dwordx4 v9, s[12:15], s61 offen offset:2048 nt lds
  v_mfma_f32_16x16x32_bf16 v[72:75], a[192:195], v[40:43], v[72:75]
  ds_read_b64_tr_b16 a[204:205], v6 offset:36864
  v_cvt_pk_bf16_f32 v49, v30, v31
  v_mfma_f32_16x16x32_bf16 v[76:79], a[192:195], v[44:47], v[76:79]
  ds_read_b128 a[180:183], v2 offset:30848
  v_mul_f32_e32 v20, s25, v20
  v_mfma_f32_16x16x32_bf16 v[80:83], a[196:199], v[32:35], v[80:83]
  ds_read_b64_tr_b16 a[206:207], v6 offset:43008
  v_mul_f32_e32 v21, s25, v21
  v_mfma_f32_16x16x32_bf16 v[84:87], a[196:199], v[36:39], v[84:87]
  v_exp_f32_e32 v20, v20
  v_mfma_f32_16x16x32_bf16 v[88:91], a[196:199], v[40:43], v[88:91]
  v_mul_f32_e32 v22, s25, v22
  v_mul_f32_e32 v23, s25, v23
  v_mfma_f32_16x16x32_bf16 v[24:27], a[144:147], a[0:3], 0
  s_add_u32 m0, s27, 61952
  v_exp_f32_e32 v21, v21
  v_mfma_f32_16x16x32_bf16 v[24:27], a[148:151], a[4:7], v[24:27]
  buffer_load_dwordx4 v7, s[8:11], s63 offen offset:0 nt lds
  v_mfma_f32_16x16x32_bf16 v[24:27], a[152:155], a[8:11], v[24:27]
  v_exp_f32_e32 v22, v22
  v_mfma_f32_16x16x32_bf16 v[24:27], a[156:159], a[12:15], v[24:27]
  ds_read_b128 a[184:187], v1 offset:30976
  v_cvt_pk_bf16_f32 v52, v20, v21
  v_mfma_f32_16x16x32_bf16 v[24:27], a[160:163], a[16:19], v[24:27]
  v_exp_f32_e32 v23, v23
  v_mfma_f32_16x16x32_bf16 v[24:27], a[164:167], a[20:23], v[24:27]
  ds_read_b64_tr_b16 a[232:233], v3 offset:36992
  v_cvt_pk_bf16_f32 v53, v22, v23
  v_mfma_f32_16x16x32_bf16 v[92:95], a[196:199], v[44:47], v[92:95]
  s_waitcnt lgkmcnt(2)
  s_add_u32 m0, s27, 0
  ds_read_b64_tr_b16 a[234:235], v3 offset:43136
  v_mfma_f32_16x16x32_bf16 v[96:99], a[200:203], v[32:35], v[96:99]
  ds_write_addtid_b32 v10 offset:0
  ds_write_addtid_b32 v12 offset:256
  ds_write_addtid_b32 v14 offset:512
  ds_write_addtid_b32 v16 offset:768
  v_mfma_f32_16x16x32_bf16 v[100:103], a[200:203], v[36:39], v[100:103]
  s_add_u32 m0, s27, 61952
  v_accvgpr_read_b32 v10, a52
  v_accvgpr_read_b32 v12, a53
  v_mfma_f32_16x16x32_bf16 v[104:107], a[200:203], v[40:43], v[104:107]
  buffer_load_dwordx4 v8, s[8:11], s63 offen offset:1024 nt lds
  v_mfma_f32_16x16x32_bf16 v[108:111], a[200:203], v[44:47], v[108:111]
  ds_read_b128 a[188:191], v2 offset:30976
  v_mul_f32_e32 v24, s25, v24
  v_mfma_f32_16x16x32_bf16 v[112:115], a[204:207], v[32:35], v[112:115]
  v_mul_f32_e32 v25, s25, v25
  v_mul_f32_e32 v26, s25, v26
  v_mfma_f32_16x16x32_bf16 v[28:31], a[144:147], a[24:27], 0
  v_exp_f32_e32 v24, v24
  v_mfma_f32_16x16x32_bf16 v[28:31], a[148:151], a[28:31], v[28:31]
  v_exp_f32_e32 v25, v25
  v_mfma_f32_16x16x32_bf16 v[28:31], a[152:155], a[32:35], v[28:31]
  ds_read_b64_tr_b16 a[236:237], v4 offset:36992
  v_mul_f32_e32 v27, s25, v27
  v_mfma_f32_16x16x32_bf16 v[28:31], a[156:159], a[36:39], v[28:31]
  v_exp_f32_e32 v26, v26
  v_mfma_f32_16x16x32_bf16 v[28:31], a[160:163], a[40:43], v[28:31]
  ds_read_b64_tr_b16 a[238:239], v4 offset:43136
  v_cvt_pk_bf16_f32 v56, v24, v25
  v_mfma_f32_16x16x32_bf16 v[28:31], a[164:167], a[44:47], v[28:31]
  buffer_load_dwordx4 v9, s[8:11], s63 offen offset:2048 nt lds
  v_mfma_f32_16x16x32_bf16 v[116:119], a[204:207], v[36:39], v[116:119]
  v_exp_f32_e32 v27, v27
  v_mfma_f32_16x16x32_bf16 v[120:123], a[204:207], v[40:43], v[120:123]
  ds_read_b64_tr_b16 a[240:241], v5 offset:36992
  v_cvt_pk_bf16_f32 v57, v26, v27
  v_mfma_f32_16x16x32_bf16 v[124:127], a[204:207], v[44:47], v[124:127]
  s_waitcnt lgkmcnt(3)
  ds_read_b128 a[144:147], v1 offset:36864
  ds_read_b64_tr_b16 a[242:243], v5 offset:43136
  v_mfma_f32_16x16x32_bf16 v[128:131], a[232:235], v[32:35], v[128:131]
  v_mul_f32_e32 v28, s25, v28
  v_mul_f32_e32 v29, s25, v29
  v_mfma_f32_16x16x32_bf16 v[132:135], a[232:235], v[36:39], v[132:135]
  v_exp_f32_e32 v28, v28
  v_mfma_f32_16x16x32_bf16 v[136:139], a[232:235], v[40:43], v[136:139]
  v_mul_f32_e32 v30, s25, v30
  v_mul_f32_e32 v31, s25, v31
  v_mfma_f32_16x16x32_bf16 v[20:23], a[168:171], a[96:99], 0
  v_exp_f32_e32 v29, v29
  v_mfma_f32_16x16x32_bf16 v[20:23], a[172:175], a[100:103], v[20:23]
  v_exp_f32_e32 v30, v30
  v_mfma_f32_16x16x32_bf16 v[20:23], a[176:179], a[104:107], v[20:23]
  ds_read_b128 a[148:151], v2 offset:36864
  v_cvt_pk_bf16_f32 v60, v28, v29
  v_mfma_f32_16x16x32_bf16 v[20:23], a[180:183], a[108:111], v[20:23]
  v_exp_f32_e32 v31, v31
  v_mfma_f32_16x16x32_bf16 v[20:23], a[184:187], a[112:115], v[20:23]
  ds_read_b64_tr_b16 a[244:245], v6 offset:36992
  v_cvt_pk_bf16_f32 v61, v30, v31
  v_mfma_f32_16x16x32_bf16 v[20:23], a[188:191], a[116:119], v[20:23]
  buffer_store_dwordx4 a[228:231], v18, s[20:23], s73 offen offset:3072 sc1 nt
  v_mfma_f32_16x16x32_bf16 v[140:143], a[232:235], v[44:47], v[140:143]
  s_waitcnt lgkmcnt(2)
  ds_read_b64_tr_b16 a[246:247], v6 offset:43136
  v_accvgpr_read_b32 v14, a54
  v_mfma_f32_16x16x32_bf16 v[144:147], a[236:239], v[32:35], v[144:147]
  s_add_u32 m0, s27, 0
  v_accvgpr_read_b32 v16, a55
  v_mfma_f32_16x16x32_bf16 v[148:151], a[236:239], v[36:39], v[148:151]
  ds_write_addtid_b32 v10 offset:12320
  ds_write_addtid_b32 v12 offset:12576
  ds_write_addtid_b32 v14 offset:12832
  ds_write_addtid_b32 v16 offset:13088
  v_mfma_f32_16x16x32_bf16 v[152:155], a[236:239], v[40:43], v[152:155]
  v_mul_f32_e32 v20, s25, v20
  v_mul_f32_e32 v21, s25, v21
  v_mfma_f32_16x16x32_bf16 v[156:159], a[236:239], v[44:47], v[156:159]
  v_exp_f32_e32 v20, v20
  v_mfma_f32_16x16x32_bf16 v[160:163], a[240:243], v[32:35], v[160:163]
  ds_read_b128 a[152:155], v1 offset:36992
  v_mul_f32_e32 v22, s25, v22
  v_mfma_f32_16x16x32_bf16 v[24:27], a[168:171], a[120:123], 0
  v_exp_f32_e32 v21, v21
  v_mfma_f32_16x16x32_bf16 v[24:27], a[172:175], a[124:127], v[24:27]
  ds_read_b64_tr_b16 a[248:249], v3 offset:37120
  v_mul_f32_e32 v23, s25, v23
  v_mfma_f32_16x16x32_bf16 v[24:27], a[176:179], a[128:131], v[24:27]
  v_exp_f32_e32 v22, v22
  v_mfma_f32_16x16x32_bf16 v[24:27], a[180:183], a[132:135], v[24:27]
  v_exp_f32_e32 v23, v23
  v_mfma_f32_16x16x32_bf16 v[24:27], a[184:187], a[136:139], v[24:27]
  ds_read_b64_tr_b16 a[250:251], v3 offset:43264
  v_cvt_pk_bf16_f32 v50, v20, v21
  v_mfma_f32_16x16x32_bf16 v[24:27], a[188:191], a[140:143], v[24:27]
  ds_read_b64_tr_b16 a[252:253], v4 offset:37120
  v_cvt_pk_bf16_f32 v51, v22, v23
  v_mfma_f32_16x16x32_bf16 v[164:167], a[240:243], v[36:39], v[164:167]
  ds_read_b128 a[156:159], v2 offset:36992
  v_accvgpr_read_b32 v10, a56
  v_mfma_f32_16x16x32_bf16 v[168:171], a[240:243], v[40:43], v[168:171]
  ds_read2st64_b32 a[228:229], v11 offset0:105 offset1:106
  v_accvgpr_read_b32 v12, a57
  v_mfma_f32_16x16x32_bf16 v[172:175], a[240:243], v[44:47], v[172:175]
  s_waitcnt lgkmcnt(5)
  ds_read_b64_tr_b16 a[254:255], v4 offset:43264
  v_accvgpr_read_b32 v14, a58
  v_mfma_f32_16x16x32_bf16 v[176:179], a[244:247], v[32:35], v[176:179]
  v_mul_f32_e32 v24, s25, v24
  v_mul_f32_e32 v25, s25, v25
  v_mfma_f32_16x16x32_bf16 v[180:183], a[244:247], v[36:39], v[180:183]
  v_exp_f32_e32 v24, v24
  v_mfma_f32_16x16x32_bf16 v[184:187], a[244:247], v[40:43], v[184:187]
  v_mul_f32_e32 v26, s25, v26
  v_mul_f32_e32 v27, s25, v27
  v_mfma_f32_16x16x32_bf16 v[188:191], a[244:247], v[44:47], v[188:191]
  v_exp_f32_e32 v25, v25
  v_mfma_f32_16x16x32_bf16 v[28:31], a[168:171], a[0:3], 0
  v_exp_f32_e32 v26, v26
  v_mfma_f32_16x16x32_bf16 v[28:31], a[172:175], a[4:7], v[28:31]
  ds_read_b128 a[160:163], v1 offset:37120
  v_cvt_pk_bf16_f32 v54, v24, v25
  v_mfma_f32_16x16x32_bf16 v[28:31], a[176:179], a[8:11], v[28:31]
  v_exp_f32_e32 v27, v27
  v_mfma_f32_16x16x32_bf16 v[28:31], a[180:183], a[12:15], v[28:31]
  ds_read_b64_tr_b16 a[192:193], v5 offset:37120
  v_cvt_pk_bf16_f32 v55, v26, v27
  v_mfma_f32_16x16x32_bf16 v[28:31], a[184:187], a[16:19], v[28:31]
  ds_read2st64_b32 a[230:231], v13 offset0:105 offset1:106
  v_accvgpr_read_b32 v16, a59
  v_mfma_f32_16x16x32_bf16 v[28:31], a[188:191], a[20:23], v[28:31]
  s_waitcnt lgkmcnt(3)
  ds_read_b64_tr_b16 a[194:195], v5 offset:43264
  v_mfma_f32_16x16x32_bf16 v[192:195], a[248:251], v[32:35], v[192:195]
  ds_read2st64_b32 a[48:49], v11 offset0:0 offset1:1
  v_mfma_f32_16x16x32_bf16 v[196:199], a[248:251], v[36:39], v[196:199]
  ds_read2st64_b32 a[50:51], v13 offset0:0 offset1:1
  v_mfma_f32_16x16x32_bf16 v[200:203], a[248:251], v[40:43], v[200:203]
  ds_read2st64_b32 a[52:53], v15 offset0:0 offset1:1
  v_mfma_f32_16x16x32_bf16 v[204:207], a[248:251], v[44:47], v[204:207]
  ds_read_b128 a[164:167], v2 offset:37120
  v_mul_f32_e32 v28, s25, v28
  v_mfma_f32_16x16x32_bf16 v[208:211], a[252:255], v[32:35], v[208:211]
  v_mul_f32_e32 v29, s25, v29
  v_mul_f32_e32 v30, s25, v30
  v_mfma_f32_16x16x32_bf16 v[212:215], a[252:255], v[36:39], v[212:215]
  v_exp_f32_e32 v28, v28
  v_mfma_f32_16x16x32_bf16 v[20:23], a[168:171], a[24:27], 0
  v_exp_f32_e32 v29, v29
  v_mfma_f32_16x16x32_bf16 v[20:23], a[172:175], a[28:31], v[20:23]
  ds_read_b64_tr_b16 a[196:197], v6 offset:37120
  v_mul_f32_e32 v31, s25, v31
  v_mfma_f32_16x16x32_bf16 v[20:23], a[176:179], a[32:35], v[20:23]
  v_exp_f32_e32 v30, v30
  v_mfma_f32_16x16x32_bf16 v[20:23], a[180:183], a[36:39], v[20:23]
  ds_read_b64_tr_b16 a[198:199], v6 offset:43264
  v_cvt_pk_bf16_f32 v58, v28, v29
  v_mfma_f32_16x16x32_bf16 v[20:23], a[184:187], a[40:43], v[20:23]
  v_exp_f32_e32 v31, v31
  v_mfma_f32_16x16x32_bf16 v[20:23], a[188:191], a[44:47], v[20:23]
  ds_read2st64_b32 a[54:55], v17 offset0:0 offset1:1
  v_cvt_pk_bf16_f32 v59, v30, v31
  v_mfma_f32_16x16x32_bf16 v[216:219], a[252:255], v[40:43], v[216:219]
  ds_read_b128 a[168:171], v1 offset:43008
  v_mfma_f32_16x16x32_bf16 v[220:223], a[252:255], v[44:47], v[220:223]
  s_waitcnt lgkmcnt(4)
  v_mfma_f32_16x16x32_bf16 v[224:227], a[192:195], v[32:35], v[224:227]
  s_waitcnt vmcnt(15) lgkmcnt(2)
  s_barrier
  v_mfma_f32_16x16x32_bf16 v[228:231], a[192:195], v[36:39], v[228:231]
  v_mul_f32_e32 v20, s25, v20
  v_mul_f32_e32 v21, s25, v21
  v_mfma_f32_16x16x32_bf16 v[232:235], a[192:195], v[40:43], v[232:235]
  v_exp_f32_e32 v20, v20
  v_mfma_f32_16x16x32_bf16 v[236:239], a[192:195], v[44:47], v[236:239]
  ds_read_b64_tr_b16 a[200:201], v3 offset:49152
  v_mul_f32_e32 v22, s25, v22
  v_mfma_f32_16x16x32_bf16 v[24:27], a[144:147], a[96:99], 0
  v_exp_f32_e32 v21, v21
  v_mfma_f32_16x16x32_bf16 v[24:27], a[148:151], a[100:103], v[24:27]
  s_add_u32 m0, s27, 135680
  v_mul_f32_e32 v23, s25, v23
  v_cvt_pk_bf16_f32 v62, v20, v21
  v_mfma_f32_16x16x32_bf16 v[24:27], a[152:155], a[104:107], v[24:27]
  buffer_load_dwordx4 v7, s[12:15], s62 offen offset:0 nt lds
  v_mfma_f32_16x16x32_bf16 v[24:27], a[156:159], a[108:111], v[24:27]
  v_exp_f32_e32 v22, v22
  v_mfma_f32_16x16x32_bf16 v[24:27], a[160:163], a[112:115], v[24:27]
  ds_read_b128 a[172:175], v2 offset:43008
  ds_read_b64_tr_b16 a[202:203], v3 offset:55296
  v_mfma_f32_16x16x32_bf16 v[24:27], a[164:167], a[116:119], v[24:27]
  v_exp_f32_e32 v23, v23
  v_mfma_f32_16x16x32_bf16 v[240:243], a[196:199], v[32:35], v[240:243]
  ds_read_b64_tr_b16 a[204:205], v4 offset:49152
  v_cvt_pk_bf16_f32 v63, v22, v23
  v_mfma_f32_16x16x32_bf16 v[244:247], a[196:199], v[36:39], v[244:247]
  ds_read_b64_tr_b16 a[206:207], v4 offset:55296
  v_mfma_f32_16x16x32_bf16 v[248:251], a[196:199], v[40:43], v[248:251]
  v_mfma_f32_16x16x32_bf16 v[252:255], a[196:199], v[44:47], v[252:255]
  v_mul_f32_e32 v24, s25, v24
  v_mul_f32_e32 v25, s25, v25
  v_smfmac_f32_16x16x64_bf16 a[216:219], a[224:227], v[48:55], v0
  ds_read_b128 a[176:179], v1 offset:43136
  v_smfmac_f32_16x16x64_bf16 a[220:223], a[224:227], v[56:63], v0
  v_mul_f32_e32 v26, s25, v26
  v_mfma_f32_16x16x32_bf16 v[28:31], a[144:147], a[120:123], 0
  buffer_load_dwordx4 v8, s[12:15], s62 offen offset:1024 nt lds
  v_mfma_f32_16x16x32_bf16 v[28:31], a[148:151], a[124:127], v[28:31]
  v_exp_f32_e32 v24, v24
  v_mfma_f32_16x16x32_bf16 v[28:31], a[152:155], a[128:131], v[28:31]
  v_exp_f32_e32 v25, v25
  v_mfma_f32_16x16x32_bf16 v[28:31], a[156:159], a[132:135], v[28:31]
  ds_read_b64_tr_b16 a[232:233], v5 offset:49152
  v_mul_f32_e32 v27, s25, v27
  v_mfma_f32_16x16x32_bf16 v[28:31], a[160:163], a[136:139], v[28:31]
  v_exp_f32_e32 v26, v26
  v_mfma_f32_16x16x32_bf16 v[28:31], a[164:167], a[140:143], v[28:31]
  s_waitcnt lgkmcnt(2)
  ds_read_b64_tr_b16 a[234:235], v5 offset:55296
  v_cvt_pk_bf16_f32 v32, v24, v25
  v_mfma_f32_16x16x32_bf16 v[64:67], a[200:203], v[48:51], v[64:67]
  v_exp_f32_e32 v27, v27
  v_mfma_f32_16x16x32_bf16 v[68:71], a[200:203], v[52:55], v[68:71]
  buffer_load_dwordx4 v9, s[12:15], s62 offen offset:2048 nt lds
  v_mfma_f32_16x16x32_bf16 v[72:75], a[200:203], v[56:59], v[72:75]
  ds_read_b64_tr_b16 a[236:237], v6 offset:49152
  v_cvt_pk_bf16_f32 v33, v26, v27
  v_mfma_f32_16x16x32_bf16 v[76:79], a[200:203], v[60:63], v[76:79]
  ds_read_b128 a[180:183], v2 offset:43136
  v_mul_f32_e32 v28, s25, v28
  v_mfma_f32_16x16x32_bf16 v[80:83], a[204:207], v[48:51], v[80:83]
  ds_read_b64_tr_b16 a[238:239], v6 offset:55296
  v_mul_f32_e32 v29, s25, v29
  v_mfma_f32_16x16x32_bf16 v[84:87], a[204:207], v[52:55], v[84:87]
  v_exp_f32_e32 v28, v28
  v_mfma_f32_16x16x32_bf16 v[88:91], a[204:207], v[56:59], v[88:91]
  v_mul_f32_e32 v30, s25, v30
  v_mul_f32_e32 v31, s25, v31
  v_mfma_f32_16x16x32_bf16 v[20:23], a[144:147], a[0:3], 0
  s_add_u32 m0, s27, 74240
  v_exp_f32_e32 v29, v29
  v_mfma_f32_16x16x32_bf16 v[20:23], a[148:151], a[4:7], v[20:23]
  buffer_load_dwordx4 v7, s[8:11], s64 offen offset:0 nt lds
  v_mfma_f32_16x16x32_bf16 v[20:23], a[152:155], a[8:11], v[20:23]
  v_exp_f32_e32 v30, v30
  v_mfma_f32_16x16x32_bf16 v[20:23], a[156:159], a[12:15], v[20:23]
  ds_read_b128 a[184:187], v1 offset:43264
  v_cvt_pk_bf16_f32 v36, v28, v29
  v_mfma_f32_16x16x32_bf16 v[20:23], a[160:163], a[16:19], v[20:23]
  v_exp_f32_e32 v31, v31
  v_mfma_f32_16x16x32_bf16 v[20:23], a[164:167], a[20:23], v[20:23]
  ds_read_b64_tr_b16 a[240:241], v3 offset:49280
  v_cvt_pk_bf16_f32 v37, v30, v31
  v_mfma_f32_16x16x32_bf16 v[92:95], a[204:207], v[60:63], v[92:95]
  s_waitcnt lgkmcnt(2)
  s_add_u32 m0, s27, 0
  ds_read_b64_tr_b16 a[242:243], v3 offset:55424
  v_mfma_f32_16x16x32_bf16 v[96:99], a[232:235], v[48:51], v[96:99]
  ds_write_addtid_b32 v10 offset:0
  ds_write_addtid_b32 v12 offset:256
  ds_write_addtid_b32 v14 offset:512
  ds_write_addtid_b32 v16 offset:768
  v_mfma_f32_16x16x32_bf16 v[100:103], a[232:235], v[52:55], v[100:103]
  s_add_u32 m0, s27, 74240
  v_accvgpr_read_b32 v10, a60
  v_accvgpr_read_b32 v12, a61
  v_mfma_f32_16x16x32_bf16 v[104:107], a[232:235], v[56:59], v[104:107]
  buffer_load_dwordx4 v8, s[8:11], s64 offen offset:1024 nt lds
  v_mfma_f32_16x16x32_bf16 v[108:111], a[232:235], v[60:63], v[108:111]
  ds_read_b128 a[188:191], v2 offset:43264
  v_mul_f32_e32 v20, s25, v20
  v_mfma_f32_16x16x32_bf16 v[112:115], a[236:239], v[48:51], v[112:115]
  v_mul_f32_e32 v21, s25, v21
  v_mul_f32_e32 v22, s25, v22
  v_mfma_f32_16x16x32_bf16 v[24:27], a[144:147], a[24:27], 0
  v_exp_f32_e32 v20, v20
  v_mfma_f32_16x16x32_bf16 v[24:27], a[148:151], a[28:31], v[24:27]
  v_exp_f32_e32 v21, v21
  v_mfma_f32_16x16x32_bf16 v[24:27], a[152:155], a[32:35], v[24:27]
  ds_read_b64_tr_b16 a[244:245], v4 offset:49280
  v_mul_f32_e32 v23, s25, v23
  v_mfma_f32_16x16x32_bf16 v[24:27], a[156:159], a[36:39], v[24:27]
  v_exp_f32_e32 v22, v22
  v_mfma_f32_16x16x32_bf16 v[24:27], a[160:163], a[40:43], v[24:27]
  ds_read_b64_tr_b16 a[246:247], v4 offset:55424
  v_cvt_pk_bf16_f32 v40, v20, v21
  v_mfma_f32_16x16x32_bf16 v[24:27], a[164:167], a[44:47], v[24:27]
  buffer_load_dwordx4 v9, s[8:11], s64 offen offset:2048 nt lds
  v_mfma_f32_16x16x32_bf16 v[116:119], a[236:239], v[52:55], v[116:119]
  v_exp_f32_e32 v23, v23
  v_mfma_f32_16x16x32_bf16 v[120:123], a[236:239], v[56:59], v[120:123]
  ds_read_b64_tr_b16 a[248:249], v5 offset:49280
  v_cvt_pk_bf16_f32 v41, v22, v23
  v_mfma_f32_16x16x32_bf16 v[124:127], a[236:239], v[60:63], v[124:127]
  s_waitcnt lgkmcnt(3)
  ds_read_b128 a[144:147], v1 offset:49152
  ds_read_b64_tr_b16 a[250:251], v5 offset:55424
  v_mfma_f32_16x16x32_bf16 v[128:131], a[240:243], v[48:51], v[128:131]
  v_mul_f32_e32 v24, s25, v24
  v_mul_f32_e32 v25, s25, v25
  v_mfma_f32_16x16x32_bf16 v[132:135], a[240:243], v[52:55], v[132:135]
  v_exp_f32_e32 v24, v24
  v_mfma_f32_16x16x32_bf16 v[136:139], a[240:243], v[56:59], v[136:139]
  v_mul_f32_e32 v26, s25, v26
  v_mul_f32_e32 v27, s25, v27
  v_mfma_f32_16x16x32_bf16 v[28:31], a[168:171], a[96:99], 0
  v_exp_f32_e32 v25, v25
  v_mfma_f32_16x16x32_bf16 v[28:31], a[172:175], a[100:103], v[28:31]
  v_exp_f32_e32 v26, v26
  v_mfma_f32_16x16x32_bf16 v[28:31], a[176:179], a[104:107], v[28:31]
  ds_read_b128 a[148:151], v2 offset:49152
  v_cvt_pk_bf16_f32 v44, v24, v25
  v_mfma_f32_16x16x32_bf16 v[28:31], a[180:183], a[108:111], v[28:31]
  v_exp_f32_e32 v27, v27
  v_mfma_f32_16x16x32_bf16 v[28:31], a[184:187], a[112:115], v[28:31]
  ds_read_b64_tr_b16 a[252:253], v6 offset:49280
  v_cvt_pk_bf16_f32 v45, v26, v27
  v_mfma_f32_16x16x32_bf16 v[28:31], a[188:191], a[116:119], v[28:31]
  buffer_store_dwordx4 a[208:211], v18, s[20:23], s73 offen offset:128 sc1 nt
  v_mfma_f32_16x16x32_bf16 v[140:143], a[240:243], v[60:63], v[140:143]
  s_waitcnt lgkmcnt(2)
  ds_read_b64_tr_b16 a[254:255], v6 offset:55424
  v_accvgpr_read_b32 v14, a62
  v_mfma_f32_16x16x32_bf16 v[144:147], a[244:247], v[48:51], v[144:147]
  s_add_u32 m0, s27, 0
  v_accvgpr_read_b32 v16, a63
  v_mfma_f32_16x16x32_bf16 v[148:151], a[244:247], v[52:55], v[148:151]
  ds_write_addtid_b32 v10 offset:12320
  ds_write_addtid_b32 v12 offset:12576
  ds_write_addtid_b32 v14 offset:12832
  ds_write_addtid_b32 v16 offset:13088
  v_mfma_f32_16x16x32_bf16 v[152:155], a[244:247], v[56:59], v[152:155]
  v_mul_f32_e32 v28, s25, v28
  v_mul_f32_e32 v29, s25, v29
  v_mfma_f32_16x16x32_bf16 v[156:159], a[244:247], v[60:63], v[156:159]
  v_exp_f32_e32 v28, v28
  v_mfma_f32_16x16x32_bf16 v[160:163], a[248:251], v[48:51], v[160:163]
  ds_read_b128 a[152:155], v1 offset:49280
  v_mul_f32_e32 v30, s25, v30
  v_mfma_f32_16x16x32_bf16 v[20:23], a[168:171], a[120:123], 0
  v_exp_f32_e32 v29, v29
  v_mfma_f32_16x16x32_bf16 v[20:23], a[172:175], a[124:127], v[20:23]
  ds_read_b64_tr_b16 a[192:193], v3 offset:49408
  v_mul_f32_e32 v31, s25, v31
  v_mfma_f32_16x16x32_bf16 v[20:23], a[176:179], a[128:131], v[20:23]
  v_exp_f32_e32 v30, v30
  v_mfma_f32_16x16x32_bf16 v[20:23], a[180:183], a[132:135], v[20:23]
  v_exp_f32_e32 v31, v31
  v_mfma_f32_16x16x32_bf16 v[20:23], a[184:187], a[136:139], v[20:23]
  ds_read_b64_tr_b16 a[194:195], v3 offset:55552
  v_cvt_pk_bf16_f32 v34, v28, v29
  v_mfma_f32_16x16x32_bf16 v[20:23], a[188:191], a[140:143], v[20:23]
  ds_read_b64_tr_b16 a[196:197], v4 offset:49408
  v_cvt_pk_bf16_f32 v35, v30, v31
  v_mfma_f32_16x16x32_bf16 v[164:167], a[248:251], v[52:55], v[164:167]
  ds_read_b128 a[156:159], v2 offset:49280
  v_accvgpr_read_b32 v10, a64
  v_mfma_f32_16x16x32_bf16 v[168:171], a[248:251], v[56:59], v[168:171]
  ds_read2st64_b32 a[208:209], v15 offset0:105 offset1:106
  v_accvgpr_read_b32 v12, a65
  v_mfma_f32_16x16x32_bf16 v[172:175], a[248:251], v[60:63], v[172:175]
  s_waitcnt lgkmcnt(5)
  ds_read_b64_tr_b16 a[198:199], v4 offset:55552
  v_accvgpr_read_b32 v14, a66
  v_mfma_f32_16x16x32_bf16 v[176:179], a[252:255], v[48:51], v[176:179]
  v_mul_f32_e32 v20, s25, v20
  v_mul_f32_e32 v21, s25, v21
  v_mfma_f32_16x16x32_bf16 v[180:183], a[252:255], v[52:55], v[180:183]
  v_exp_f32_e32 v20, v20
  v_mfma_f32_16x16x32_bf16 v[184:187], a[252:255], v[56:59], v[184:187]
  v_mul_f32_e32 v22, s25, v22
  v_mul_f32_e32 v23, s25, v23
  v_mfma_f32_16x16x32_bf16 v[188:191], a[252:255], v[60:63], v[188:191]
  v_exp_f32_e32 v21, v21
  v_mfma_f32_16x16x32_bf16 v[24:27], a[168:171], a[0:3], 0
  v_exp_f32_e32 v22, v22
  v_mfma_f32_16x16x32_bf16 v[24:27], a[172:175], a[4:7], v[24:27]
  ds_read_b128 a[160:163], v1 offset:49408
  v_cvt_pk_bf16_f32 v38, v20, v21
  v_mfma_f32_16x16x32_bf16 v[24:27], a[176:179], a[8:11], v[24:27]
  v_exp_f32_e32 v23, v23
  v_mfma_f32_16x16x32_bf16 v[24:27], a[180:183], a[12:15], v[24:27]
  ds_read_b64_tr_b16 a[200:201], v5 offset:49408
  v_cvt_pk_bf16_f32 v39, v22, v23
  v_mfma_f32_16x16x32_bf16 v[24:27], a[184:187], a[16:19], v[24:27]
L_tr8:
  s_cbranch_execz L_tr12
  ds_read2st64_b32 a[210:211], v17 offset0:105 offset1:106
  v_accvgpr_read_b32 v16, a67
  v_mfma_f32_16x16x32_bf16 v[24:27], a[188:191], a[20:23], v[24:27]
  s_waitcnt lgkmcnt(3)
  ds_read_b64_tr_b16 a[202:203], v5 offset:55552
  v_mfma_f32_16x16x32_bf16 v[192:195], a[192:195], v[48:51], v[192:195]
  ds_read2st64_b32 a[56:57], v11 offset0:0 offset1:1
  v_mfma_f32_16x16x32_bf16 v[196:199], a[192:195], v[52:55], v[196:199]
  ds_read2st64_b32 a[58:59], v13 offset0:0 offset1:1
  v_mfma_f32_16x16x32_bf16 v[200:203], a[192:195], v[56:59], v[200:203]
  ds_read2st64_b32 a[60:61], v15 offset0:0 offset1:1
  v_mfma_f32_16x16x32_bf16 v[204:207], a[192:195], v[60:63], v[204:207]
  ds_read_b128 a[164:167], v2 offset:49408
  v_mul_f32_e32 v24, s25, v24
  v_mfma_f32_16x16x32_bf16 v[208:211], a[196:199], v[48:51], v[208:211]
  v_mul_f32_e32 v25, s25, v25
  v_mul_f32_e32 v26, s25, v26
  v_mfma_f32_16x16x32_bf16 v[212:215], a[196:199], v[52:55], v[212:215]
  v_exp_f32_e32 v24, v24
  v_mfma_f32_16x16x32_bf16 v[28:31], a[168:171], a[24:27], 0
  v_exp_f32_e32 v25, v25
  v_mfma_f32_16x16x32_bf16 v[28:31], a[172:175], a[28:31], v[28:31]
  ds_read_b64_tr_b16 a[204:205], v6 offset:49408
  v_mul_f32_e32 v27, s25, v27
  v_mfma_f32_16x16x32_bf16 v[28:31], a[176:179], a[32:35], v[28:31]
  v_exp_f32_e32 v26, v26
  v_mfma_f32_16x16x32_bf16 v[28:31], a[180:183], a[36:39], v[28:31]
  ds_read_b64_tr_b16 a[206:207], v6 offset:55552
  v_cvt_pk_bf16_f32 v42, v24, v25
  v_mfma_f32_16x16x32_bf16 v[28:31], a[184:187], a[40:43], v[28:31]
  v_exp_f32_e32 v27, v27
  v_mfma_f32_16x16x32_bf16 v[28:31], a[188:191], a[44:47], v[28:31]
  ds_read2st64_b32 a[62:63], v17 offset0:0 offset1:1
  v_cvt_pk_bf16_f32 v43, v26, v27
  v_mfma_f32_16x16x32_bf16 v[216:219], a[196:199], v[56:59], v[216:219]
  ds_read_b128 a[168:171], v1 offset:55296
  v_mfma_f32_16x16x32_bf16 v[220:223], a[196:199], v[60:63], v[220:223]
  s_waitcnt lgkmcnt(4)
  v_mfma_f32_16x16x32_bf16 v[224:227], a[200:203], v[48:51], v[224:227]
  s_waitcnt vmcnt(15) lgkmcnt(2)
  s_barrier
  v_mfma_f32_16x16x32_bf16 v[228:231], a[200:203], v[52:55], v[228:231]
  v_mul_f32_e32 v28, s25, v28
  v_mul_f32_e32 v29, s25, v29
  v_mfma_f32_16x16x32_bf16 v[232:235], a[200:203], v[56:59], v[232:235]
  v_exp_f32_e32 v28, v28
  v_mfma_f32_16x16x32_bf16 v[236:239], a[200:203], v[60:63], v[236:239]
  ds_read_b64_tr_b16 a[232:233], v3 offset:12288
  v_mul_f32_e32 v30, s25, v30
  v_mfma_f32_16x16x32_bf16 v[20:23], a[144:147], a[96:99], 0
  v_exp_f32_e32 v29, v29
  v_mfma_f32_16x16x32_bf16 v[20:23], a[148:151], a[100:103], v[20:23]
  s_add_u32 m0, s27, 147968
  v_mul_f32_e32 v31, s25, v31
  v_cvt_pk_bf16_f32 v46, v28, v29
  v_mfma_f32_16x16x32_bf16 v[20:23], a[152:155], a[104:107], v[20:23]
  buffer_load_dwordx4 v7, s[12:15], s63 offen offset:0 nt lds
  v_mfma_f32_16x16x32_bf16 v[20:23], a[156:159], a[108:111], v[20:23]
  v_exp_f32_e32 v30, v30
  v_mfma_f32_16x16x32_bf16 v[20:23], a[160:163], a[112:115], v[20:23]
  ds_read_b128 a[172:175], v2 offset:55296
  ds_read_b64_tr_b16 a[234:235], v3 offset:18432
  v_mfma_f32_16x16x32_bf16 v[20:23], a[164:167], a[116:119], v[20:23]
  v_exp_f32_e32 v31, v31
  v_mfma_f32_16x16x32_bf16 v[240:243], a[204:207], v[48:51], v[240:243]
  ds_read_b64_tr_b16 a[236:237], v4 offset:12288
  v_cvt_pk_bf16_f32 v47, v30, v31
  v_mfma_f32_16x16x32_bf16 v[244:247], a[204:207], v[52:55], v[244:247]
  ds_read_b64_tr_b16 a[238:239], v4 offset:18432
  v_mfma_f32_16x16x32_bf16 v[248:251], a[204:207], v[56:59], v[248:251]
  v_mfma_f32_16x16x32_bf16 v[252:255], a[204:207], v[60:63], v[252:255]
  v_mul_f32_e32 v20, s25, v20
  v_mul_f32_e32 v21, s25, v21
  v_smfmac_f32_16x16x64_bf16 a[216:219], a[224:227], v[32:39], v0
  ds_read_b128 a[176:179], v1 offset:55424
  v_smfmac_f32_16x16x64_bf16 a[220:223], a[224:227], v[40:47], v0
  v_mul_f32_e32 v22, s25, v22
  v_mfma_f32_16x16x32_bf16 v[24:27], a[144:147], a[120:123], 0
  buffer_load_dwordx4 v8, s[12:15], s63 offen offset:1024 nt lds
  v_mfma_f32_16x16x32_bf16 v[24:27], a[148:151], a[124:127], v[24:27]
  v_exp_f32_e32 v20, v20
  v_mfma_f32_16x16x32_bf16 v[24:27], a[152:155], a[128:131], v[24:27]
  v_exp_f32_e32 v21, v21
  v_mfma_f32_16x16x32_bf16 v[24:27], a[156:159], a[132:135], v[24:27]
  ds_read_b64_tr_b16 a[240:241], v5 offset:12288
  v_mul_f32_e32 v23, s25, v23
  v_mfma_f32_16x16x32_bf16 v[24:27], a[160:163], a[136:139], v[24:27]
  v_exp_f32_e32 v22, v22
  v_mfma_f32_16x16x32_bf16 v[24:27], a[164:167], a[140:143], v[24:27]
  s_waitcnt lgkmcnt(2)
  ds_read_b64_tr_b16 a[242:243], v5 offset:18432
  v_cvt_pk_bf16_f32 v48, v20, v21
  v_mfma_f32_16x16x32_bf16 v[64:67], a[232:235], v[32:35], v[64:67]
  v_exp_f32_e32 v23, v23
  v_mfma_f32_16x16x32_bf16 v[68:71], a[232:235], v[36:39], v[68:71]
  buffer_load_dwordx4 v9, s[12:15], s63 offen offset:2048 nt lds
  v_mfma_f32_16x16x32_bf16 v[72:75], a[232:235], v[40:43], v[72:75]
  ds_read_b64_tr_b16 a[244:245], v6 offset:12288
  v_cvt_pk_bf16_f32 v49, v22, v23
  v_mfma_f32_16x16x32_bf16 v[76:79], a[232:235], v[44:47], v[76:79]
  ds_read_b128 a[180:183], v2 offset:55424
  v_mul_f32_e32 v24, s25, v24
  v_mfma_f32_16x16x32_bf16 v[80:83], a[236:239], v[32:35], v[80:83]
  ds_read_b64_tr_b16 a[246:247], v6 offset:18432
  v_mul_f32_e32 v25, s25, v25
  v_mfma_f32_16x16x32_bf16 v[84:87], a[236:239], v[36:39], v[84:87]
  v_exp_f32_e32 v24, v24
  v_mfma_f32_16x16x32_bf16 v[88:91], a[236:239], v[40:43], v[88:91]
  v_mul_f32_e32 v26, s25, v26
  v_mul_f32_e32 v27, s25, v27
  v_mfma_f32_16x16x32_bf16 v[28:31], a[144:147], a[0:3], 0
  s_add_u32 m0, s27, 86528
  v_exp_f32_e32 v25, v25
  v_mfma_f32_16x16x32_bf16 v[28:31], a[148:151], a[4:7], v[28:31]
  buffer_load_dwordx4 v7, s[8:11], s65 offen offset:0 nt lds
  v_mfma_f32_16x16x32_bf16 v[28:31], a[152:155], a[8:11], v[28:31]
  v_exp_f32_e32 v26, v26
  v_mfma_f32_16x16x32_bf16 v[28:31], a[156:159], a[12:15], v[28:31]
  ds_read_b128 a[184:187], v1 offset:55552
  v_cvt_pk_bf16_f32 v52, v24, v25
  v_mfma_f32_16x16x32_bf16 v[28:31], a[160:163], a[16:19], v[28:31]
  v_exp_f32_e32 v27, v27
  v_mfma_f32_16x16x32_bf16 v[28:31], a[164:167], a[20:23], v[28:31]
  ds_read_b64_tr_b16 a[248:249], v3 offset:12416
  v_cvt_pk_bf16_f32 v53, v26, v27
  v_mfma_f32_16x16x32_bf16 v[92:95], a[236:239], v[44:47], v[92:95]
  s_waitcnt lgkmcnt(2)
  s_add_u32 m0, s27, 0
  ds_read_b64_tr_b16 a[250:251], v3 offset:18560
  v_mfma_f32_16x16x32_bf16 v[96:99], a[240:243], v[32:35], v[96:99]
  ds_write_addtid_b32 v10 offset:0
  ds_write_addtid_b32 v12 offset:256
  ds_write_addtid_b32 v14 offset:512
  ds_write_addtid_b32 v16 offset:768
  v_mfma_f32_16x16x32_bf16 v[100:103], a[240:243], v[36:39], v[100:103]
  s_add_u32 m0, s27, 86528
  v_accvgpr_read_b32 v10, a68
  v_accvgpr_read_b32 v12, a69
  v_mfma_f32_16x16x32_bf16 v[104:107], a[240:243], v[40:43], v[104:107]
  buffer_load_dwordx4 v8, s[8:11], s65 offen offset:1024 nt lds
  v_mfma_f32_16x16x32_bf16 v[108:111], a[240:243], v[44:47], v[108:111]
  ds_read_b128 a[188:191], v2 offset:55552
  v_mul_f32_e32 v28, s25, v28
  v_mfma_f32_16x16x32_bf16 v[112:115], a[244:247], v[32:35], v[112:115]
  v_mul_f32_e32 v29, s25, v29
  v_mul_f32_e32 v30, s25, v30
  v_mfma_f32_16x16x32_bf16 v[20:23], a[144:147], a[24:27], 0
  v_exp_f32_e32 v28, v28
  v_mfma_f32_16x16x32_bf16 v[20:23], a[148:151], a[28:31], v[20:23]
  v_exp_f32_e32 v29, v29
  v_mfma_f32_16x16x32_bf16 v[20:23], a[152:155], a[32:35], v[20:23]
  ds_read_b64_tr_b16 a[252:253], v4 offset:12416
  v_mul_f32_e32 v31, s25, v31
  v_mfma_f32_16x16x32_bf16 v[20:23], a[156:159], a[36:39], v[20:23]
  v_exp_f32_e32 v30, v30
  v_mfma_f32_16x16x32_bf16 v[20:23], a[160:163], a[40:43], v[20:23]
  ds_read_b64_tr_b16 a[254:255], v4 offset:18560
  v_cvt_pk_bf16_f32 v56, v28, v29
  v_mfma_f32_16x16x32_bf16 v[20:23], a[164:167], a[44:47], v[20:23]
  buffer_load_dwordx4 v9, s[8:11], s65 offen offset:2048 nt lds
  v_mfma_f32_16x16x32_bf16 v[116:119], a[244:247], v[36:39], v[116:119]
  v_exp_f32_e32 v31, v31
  v_mfma_f32_16x16x32_bf16 v[120:123], a[244:247], v[40:43], v[120:123]
  ds_read_b64_tr_b16 a[192:193], v5 offset:12416
  v_cvt_pk_bf16_f32 v57, v30, v31
  v_mfma_f32_16x16x32_bf16 v[124:127], a[244:247], v[44:47], v[124:127]
  s_waitcnt lgkmcnt(3)
  ds_read_b128 a[144:147], v1 offset:0
  ds_read_b64_tr_b16 a[194:195], v5 offset:18560
  v_mfma_f32_16x16x32_bf16 v[128:131], a[248:251], v[32:35], v[128:131]
  v_mul_f32_e32 v20, s25, v20
  v_mul_f32_e32 v21, s25, v21
  v_mfma_f32_16x16x32_bf16 v[132:135], a[248:251], v[36:39], v[132:135]
  v_exp_f32_e32 v20, v20
  v_mfma_f32_16x16x32_bf16 v[136:139], a[248:251], v[40:43], v[136:139]
  v_mul_f32_e32 v22, s25, v22
  v_mul_f32_e32 v23, s25, v23
  v_mfma_f32_16x16x32_bf16 v[24:27], a[168:171], a[96:99], 0
  v_exp_f32_e32 v21, v21
  v_mfma_f32_16x16x32_bf16 v[24:27], a[172:175], a[100:103], v[24:27]
  v_exp_f32_e32 v22, v22
  v_mfma_f32_16x16x32_bf16 v[24:27], a[176:179], a[104:107], v[24:27]
  ds_read_b128 a[148:151], v2 offset:0
  v_cvt_pk_bf16_f32 v60, v20, v21
  v_mfma_f32_16x16x32_bf16 v[24:27], a[180:183], a[108:111], v[24:27]
  v_exp_f32_e32 v23, v23
  v_mfma_f32_16x16x32_bf16 v[24:27], a[184:187], a[112:115], v[24:27]
  ds_read_b64_tr_b16 a[196:197], v6 offset:12416
  v_cvt_pk_bf16_f32 v61, v22, v23
  v_mfma_f32_16x16x32_bf16 v[24:27], a[188:191], a[116:119], v[24:27]
  buffer_store_dwordx4 a[212:215], v18, s[20:23], s73 offen offset:3200 sc1 nt
  v_mfma_f32_16x16x32_bf16 v[140:143], a[248:251], v[44:47], v[140:143]
  s_waitcnt lgkmcnt(2)
  ds_read_b64_tr_b16 a[198:199], v6 offset:18560
  v_accvgpr_read_b32 v14, a70
  v_mfma_f32_16x16x32_bf16 v[144:147], a[252:255], v[32:35], v[144:147]
  s_add_u32 m0, s27, 0
  v_accvgpr_read_b32 v16, a71
  v_mfma_f32_16x16x32_bf16 v[148:151], a[252:255], v[36:39], v[148:151]
  ds_write_addtid_b32 v10 offset:12320
  ds_write_addtid_b32 v12 offset:12576
  ds_write_addtid_b32 v14 offset:12832
  ds_write_addtid_b32 v16 offset:13088
  v_mfma_f32_16x16x32_bf16 v[152:155], a[252:255], v[40:43], v[152:155]
  v_mul_f32_e32 v24, s25, v24
  v_mul_f32_e32 v25, s25, v25
  v_mfma_f32_16x16x32_bf16 v[156:159], a[252:255], v[44:47], v[156:159]
  v_exp_f32_e32 v24, v24
  v_mfma_f32_16x16x32_bf16 v[160:163], a[192:195], v[32:35], v[160:163]
  ds_read_b128 a[152:155], v1 offset:128
  v_mul_f32_e32 v26, s25, v26
  v_mfma_f32_16x16x32_bf16 v[28:31], a[168:171], a[120:123], 0
  v_exp_f32_e32 v25, v25
  v_mfma_f32_16x16x32_bf16 v[28:31], a[172:175], a[124:127], v[28:31]
  ds_read_b64_tr_b16 a[200:201], v3 offset:12544
  v_mul_f32_e32 v27, s25, v27
  v_mfma_f32_16x16x32_bf16 v[28:31], a[176:179], a[128:131], v[28:31]
  v_exp_f32_e32 v26, v26
  v_mfma_f32_16x16x32_bf16 v[28:31], a[180:183], a[132:135], v[28:31]
  v_exp_f32_e32 v27, v27
  v_mfma_f32_16x16x32_bf16 v[28:31], a[184:187], a[136:139], v[28:31]
  ds_read_b64_tr_b16 a[202:203], v3 offset:18688
  v_cvt_pk_bf16_f32 v50, v24, v25
  v_mfma_f32_16x16x32_bf16 v[28:31], a[188:191], a[140:143], v[28:31]
  ds_read_b64_tr_b16 a[204:205], v4 offset:12544
  v_cvt_pk_bf16_f32 v51, v26, v27
  v_mfma_f32_16x16x32_bf16 v[164:167], a[192:195], v[36:39], v[164:167]
  ds_read_b128 a[156:159], v2 offset:128
  v_accvgpr_read_b32 v10, a72
  v_mfma_f32_16x16x32_bf16 v[168:171], a[192:195], v[40:43], v[168:171]
  buffer_store_dwordx4 a[228:231], v18, s[20:23], s73 offen offset:256 sc1 nt
  v_mfma_f32_16x16x32_bf16 v[172:175], a[192:195], v[44:47], v[172:175]
  s_waitcnt lgkmcnt(4)
  ds_read_b64_tr_b16 a[206:207], v4 offset:18688
  v_accvgpr_read_b32 v12, a73
  v_mfma_f32_16x16x32_bf16 v[176:179], a[196:199], v[32:35], v[176:179]
  v_mul_f32_e32 v28, s25, v28
  v_mul_f32_e32 v29, s25, v29
  v_mfma_f32_16x16x32_bf16 v[180:183], a[196:199], v[36:39], v[180:183]
  v_exp_f32_e32 v28, v28
  v_mfma_f32_16x16x32_bf16 v[184:187], a[196:199], v[40:43], v[184:187]
  v_mul_f32_e32 v30, s25, v30
  v_mul_f32_e32 v31, s25, v31
  v_mfma_f32_16x16x32_bf16 v[188:191], a[196:199], v[44:47], v[188:191]
  v_exp_f32_e32 v29, v29
  v_mfma_f32_16x16x32_bf16 v[20:23], a[168:171], a[0:3], 0
  v_exp_f32_e32 v30, v30
  v_mfma_f32_16x16x32_bf16 v[20:23], a[172:175], a[4:7], v[20:23]
  ds_read_b128 a[160:163], v1 offset:256
  v_cvt_pk_bf16_f32 v54, v28, v29
  v_mfma_f32_16x16x32_bf16 v[20:23], a[176:179], a[8:11], v[20:23]
  v_exp_f32_e32 v31, v31
  v_mfma_f32_16x16x32_bf16 v[20:23], a[180:183], a[12:15], v[20:23]
  ds_read_b64_tr_b16 a[232:233], v5 offset:12544
  v_cvt_pk_bf16_f32 v55, v30, v31
  v_mfma_f32_16x16x32_bf16 v[20:23], a[184:187], a[16:19], v[20:23]
  ds_read2st64_b32 a[212:213], v11 offset0:4 offset1:5
  v_accvgpr_read_b32 v14, a74
  v_mfma_f32_16x16x32_bf16 v[20:23], a[188:191], a[20:23], v[20:23]
  s_waitcnt lgkmcnt(3)
  ds_read_b64_tr_b16 a[234:235], v5 offset:18688
  v_accvgpr_read_b32 v16, a75
  v_mfma_f32_16x16x32_bf16 v[192:195], a[200:203], v[32:35], v[192:195]
  ds_read2st64_b32 a[214:215], v13 offset0:4 offset1:5
  v_mfma_f32_16x16x32_bf16 v[196:199], a[200:203], v[36:39], v[196:199]
  ds_read2st64_b32 a[228:229], v15 offset0:4 offset1:5
  v_mfma_f32_16x16x32_bf16 v[200:203], a[200:203], v[40:43], v[200:203]
  ds_read2st64_b32 a[230:231], v17 offset0:4 offset1:5
  v_mfma_f32_16x16x32_bf16 v[204:207], a[200:203], v[44:47], v[204:207]
  ds_read_b128 a[164:167], v2 offset:256
  v_mul_f32_e32 v20, s25, v20
  v_mfma_f32_16x16x32_bf16 v[208:211], a[204:207], v[32:35], v[208:211]
  v_mul_f32_e32 v21, s25, v21
  v_mul_f32_e32 v22, s25, v22
  v_mfma_f32_16x16x32_bf16 v[212:215], a[204:207], v[36:39], v[212:215]
  v_exp_f32_e32 v20, v20
  v_mfma_f32_16x16x32_bf16 v[24:27], a[168:171], a[24:27], 0
  v_exp_f32_e32 v21, v21
  v_mfma_f32_16x16x32_bf16 v[24:27], a[172:175], a[28:31], v[24:27]
  ds_read_b64_tr_b16 a[236:237], v6 offset:12544
  v_mul_f32_e32 v23, s25, v23
  v_mfma_f32_16x16x32_bf16 v[24:27], a[176:179], a[32:35], v[24:27]
  v_exp_f32_e32 v22, v22
  v_mfma_f32_16x16x32_bf16 v[24:27], a[180:183], a[36:39], v[24:27]
  ds_read_b64_tr_b16 a[238:239], v6 offset:18688
  v_cvt_pk_bf16_f32 v58, v20, v21
  v_mfma_f32_16x16x32_bf16 v[24:27], a[184:187], a[40:43], v[24:27]
  v_exp_f32_e32 v23, v23
  v_mfma_f32_16x16x32_bf16 v[24:27], a[188:191], a[44:47], v[24:27]
  ds_read2st64_b32 a[64:65], v11 offset0:0 offset1:1
  v_cvt_pk_bf16_f32 v59, v22, v23
  v_mfma_f32_16x16x32_bf16 v[216:219], a[204:207], v[40:43], v[216:219]
  ds_read_b128 a[168:171], v1 offset:6144
  v_mfma_f32_16x16x32_bf16 v[220:223], a[204:207], v[44:47], v[220:223]
  s_waitcnt lgkmcnt(4)
  ds_read2st64_b32 a[66:67], v13 offset0:0 offset1:1
  v_mfma_f32_16x16x32_bf16 v[224:227], a[232:235], v[32:35], v[224:227]
  s_waitcnt vmcnt(16) lgkmcnt(3)
  s_barrier
  ds_read2st64_b32 a[68:69], v15 offset0:0 offset1:1
  v_mfma_f32_16x16x32_bf16 v[228:231], a[232:235], v[36:39], v[228:231]
  v_mul_f32_e32 v24, s25, v24
  v_mul_f32_e32 v25, s25, v25
  v_mfma_f32_16x16x32_bf16 v[232:235], a[232:235], v[40:43], v[232:235]
  v_exp_f32_e32 v24, v24
  v_mfma_f32_16x16x32_bf16 v[236:239], a[232:235], v[44:47], v[236:239]
  ds_read_b64_tr_b16 a[240:241], v3 offset:24576
  v_mul_f32_e32 v26, s25, v26
  v_mfma_f32_16x16x32_bf16 v[28:31], a[144:147], a[96:99], 0
  v_exp_f32_e32 v25, v25
  v_mfma_f32_16x16x32_bf16 v[28:31], a[148:151], a[100:103], v[28:31]
  s_add_u32 m0, s27, 111104
  v_mul_f32_e32 v27, s25, v27
  v_cvt_pk_bf16_f32 v62, v24, v25
  v_mfma_f32_16x16x32_bf16 v[28:31], a[152:155], a[104:107], v[28:31]
  buffer_load_dwordx4 v7, s[12:15], s64 offen offset:0 nt lds
  v_mfma_f32_16x16x32_bf16 v[28:31], a[156:159], a[108:111], v[28:31]
  v_exp_f32_e32 v26, v26
  v_mfma_f32_16x16x32_bf16 v[28:31], a[160:163], a[112:115], v[28:31]
  ds_read_b128 a[172:175], v2 offset:6144
  ds_read_b64_tr_b16 a[242:243], v3 offset:30720
  v_mfma_f32_16x16x32_bf16 v[28:31], a[164:167], a[116:119], v[28:31]
  v_exp_f32_e32 v27, v27
  v_mfma_f32_16x16x32_bf16 v[240:243], a[236:239], v[32:35], v[240:243]
  ds_read_b64_tr_b16 a[244:245], v4 offset:24576
  v_cvt_pk_bf16_f32 v63, v26, v27
  v_mfma_f32_16x16x32_bf16 v[244:247], a[236:239], v[36:39], v[244:247]
  ds_read_b64_tr_b16 a[246:247], v4 offset:30720
  v_mfma_f32_16x16x32_bf16 v[248:251], a[236:239], v[40:43], v[248:251]
  ds_read2st64_b32 a[70:71], v17 offset0:0 offset1:1
  v_mfma_f32_16x16x32_bf16 v[252:255], a[236:239], v[44:47], v[252:255]
  v_mul_f32_e32 v28, s25, v28
  v_mul_f32_e32 v29, s25, v29
  v_smfmac_f32_16x16x64_bf16 a[216:219], a[224:227], v[48:55], v0
  ds_read_b128 a[176:179], v1 offset:6272
  v_smfmac_f32_16x16x64_bf16 a[220:223], a[224:227], v[56:63], v0
  v_mul_f32_e32 v30, s25, v30
  v_mfma_f32_16x16x32_bf16 v[20:23], a[144:147], a[120:123], 0
  buffer_load_dwordx4 v8, s[12:15], s64 offen offset:1024 nt lds
  v_mfma_f32_16x16x32_bf16 v[20:23], a[148:151], a[124:127], v[20:23]
  v_exp_f32_e32 v28, v28
  v_mfma_f32_16x16x32_bf16 v[20:23], a[152:155], a[128:131], v[20:23]
  v_exp_f32_e32 v29, v29
  v_mfma_f32_16x16x32_bf16 v[20:23], a[156:159], a[132:135], v[20:23]
  ds_read_b64_tr_b16 a[248:249], v5 offset:24576
  v_mul_f32_e32 v31, s25, v31
  v_mfma_f32_16x16x32_bf16 v[20:23], a[160:163], a[136:139], v[20:23]
  v_exp_f32_e32 v30, v30
  v_mfma_f32_16x16x32_bf16 v[20:23], a[164:167], a[140:143], v[20:23]
  s_waitcnt lgkmcnt(2)
  ds_read_b64_tr_b16 a[250:251], v5 offset:30720
  v_cvt_pk_bf16_f32 v32, v28, v29
  v_mfma_f32_16x16x32_bf16 v[64:67], a[240:243], v[48:51], v[64:67]
  v_exp_f32_e32 v31, v31
  v_mfma_f32_16x16x32_bf16 v[68:71], a[240:243], v[52:55], v[68:71]
  buffer_load_dwordx4 v9, s[12:15], s64 offen offset:2048 nt lds
  v_mfma_f32_16x16x32_bf16 v[72:75], a[240:243], v[56:59], v[72:75]
  ds_read_b64_tr_b16 a[252:253], v6 offset:24576
  v_cvt_pk_bf16_f32 v33, v30, v31
  v_mfma_f32_16x16x32_bf16 v[76:79], a[240:243], v[60:63], v[76:79]
  ds_read_b128 a[180:183], v2 offset:6272
  v_mul_f32_e32 v20, s25, v20
  v_mfma_f32_16x16x32_bf16 v[80:83], a[244:247], v[48:51], v[80:83]
  ds_read_b64_tr_b16 a[254:255], v6 offset:30720
  v_mul_f32_e32 v21, s25, v21
  v_mfma_f32_16x16x32_bf16 v[84:87], a[244:247], v[52:55], v[84:87]
  v_exp_f32_e32 v20, v20
  v_mfma_f32_16x16x32_bf16 v[88:91], a[244:247], v[56:59], v[88:91]
  v_mul_f32_e32 v22, s25, v22
  v_mul_f32_e32 v23, s25, v23
  v_mfma_f32_16x16x32_bf16 v[24:27], a[144:147], a[0:3], 0
  s_add_u32 m0, s27, 98816
  v_exp_f32_e32 v21, v21
  v_mfma_f32_16x16x32_bf16 v[24:27], a[148:151], a[4:7], v[24:27]
  buffer_load_dwordx4 v7, s[8:11], s66 offen offset:0 nt lds
  v_mfma_f32_16x16x32_bf16 v[24:27], a[152:155], a[8:11], v[24:27]
  v_exp_f32_e32 v22, v22
  v_mfma_f32_16x16x32_bf16 v[24:27], a[156:159], a[12:15], v[24:27]
  ds_read_b128 a[184:187], v1 offset:6400
  v_cvt_pk_bf16_f32 v36, v20, v21
  v_mfma_f32_16x16x32_bf16 v[24:27], a[160:163], a[16:19], v[24:27]
  v_exp_f32_e32 v23, v23
  v_mfma_f32_16x16x32_bf16 v[24:27], a[164:167], a[20:23], v[24:27]
  ds_read_b64_tr_b16 a[192:193], v3 offset:24704
  v_cvt_pk_bf16_f32 v37, v22, v23
  v_mfma_f32_16x16x32_bf16 v[92:95], a[244:247], v[60:63], v[92:95]
  s_waitcnt lgkmcnt(2)
  s_add_u32 m0, s27, 0
  ds_read_b64_tr_b16 a[194:195], v3 offset:30848
  v_mfma_f32_16x16x32_bf16 v[96:99], a[248:251], v[48:51], v[96:99]
  ds_write_addtid_b32 v10 offset:0
  ds_write_addtid_b32 v12 offset:256
  ds_write_addtid_b32 v14 offset:512
  ds_write_addtid_b32 v16 offset:768
  v_mfma_f32_16x16x32_bf16 v[100:103], a[248:251], v[52:55], v[100:103]
  s_add_u32 m0, s27, 98816
  v_accvgpr_read_b32 v10, a76
  v_accvgpr_read_b32 v12, a77
  v_mfma_f32_16x16x32_bf16 v[104:107], a[248:251], v[56:59], v[104:107]
  buffer_load_dwordx4 v8, s[8:11], s66 offen offset:1024 nt lds
  v_mfma_f32_16x16x32_bf16 v[108:111], a[248:251], v[60:63], v[108:111]
  ds_read_b128 a[188:191], v2 offset:6400
  v_mul_f32_e32 v24, s25, v24
  v_mfma_f32_16x16x32_bf16 v[112:115], a[252:255], v[48:51], v[112:115]
  v_mul_f32_e32 v25, s25, v25
  v_mul_f32_e32 v26, s25, v26
  v_mfma_f32_16x16x32_bf16 v[28:31], a[144:147], a[24:27], 0
  v_exp_f32_e32 v24, v24
  v_mfma_f32_16x16x32_bf16 v[28:31], a[148:151], a[28:31], v[28:31]
  v_exp_f32_e32 v25, v25
  v_mfma_f32_16x16x32_bf16 v[28:31], a[152:155], a[32:35], v[28:31]
  ds_read_b64_tr_b16 a[196:197], v4 offset:24704
  v_mul_f32_e32 v27, s25, v27
  v_mfma_f32_16x16x32_bf16 v[28:31], a[156:159], a[36:39], v[28:31]
  v_exp_f32_e32 v26, v26
  v_mfma_f32_16x16x32_bf16 v[28:31], a[160:163], a[40:43], v[28:31]
  ds_read_b64_tr_b16 a[198:199], v4 offset:30848
  v_cvt_pk_bf16_f32 v40, v24, v25
  v_mfma_f32_16x16x32_bf16 v[28:31], a[164:167], a[44:47], v[28:31]
  buffer_load_dwordx4 v9, s[8:11], s66 offen offset:2048 nt lds
  v_mfma_f32_16x16x32_bf16 v[116:119], a[252:255], v[52:55], v[116:119]
  v_exp_f32_e32 v27, v27
  v_mfma_f32_16x16x32_bf16 v[120:123], a[252:255], v[56:59], v[120:123]
  ds_read_b64_tr_b16 a[200:201], v5 offset:24704
  v_cvt_pk_bf16_f32 v41, v26, v27
  v_mfma_f32_16x16x32_bf16 v[124:127], a[252:255], v[60:63], v[124:127]
  s_waitcnt lgkmcnt(3)
  ds_read_b128 a[144:147], v1 offset:12288
  ds_read_b64_tr_b16 a[202:203], v5 offset:30848
  v_mfma_f32_16x16x32_bf16 v[128:131], a[192:195], v[48:51], v[128:131]
  v_mul_f32_e32 v28, s25, v28
  v_mul_f32_e32 v29, s25, v29
  v_mfma_f32_16x16x32_bf16 v[132:135], a[192:195], v[52:55], v[132:135]
  v_exp_f32_e32 v28, v28
  v_mfma_f32_16x16x32_bf16 v[136:139], a[192:195], v[56:59], v[136:139]
  v_mul_f32_e32 v30, s25, v30
  v_mul_f32_e32 v31, s25, v31
  v_mfma_f32_16x16x32_bf16 v[20:23], a[168:171], a[96:99], 0
  s_add_u32 m0, s27, 24832
  v_exp_f32_e32 v29, v29
  v_mfma_f32_16x16x32_bf16 v[20:23], a[172:175], a[100:103], v[20:23]
  buffer_load_dwordx4 v7, s[8:11], s70 offen offset:0 nt lds
  v_mfma_f32_16x16x32_bf16 v[20:23], a[176:179], a[104:107], v[20:23]
  v_exp_f32_e32 v30, v30
  v_mfma_f32_16x16x32_bf16 v[20:23], a[180:183], a[108:111], v[20:23]
  ds_read_b128 a[148:151], v2 offset:12288
  v_cvt_pk_bf16_f32 v44, v28, v29
  v_mfma_f32_16x16x32_bf16 v[20:23], a[184:187], a[112:115], v[20:23]
  v_exp_f32_e32 v31, v31
  v_mfma_f32_16x16x32_bf16 v[20:23], a[188:191], a[116:119], v[20:23]
  ds_read_b64_tr_b16 a[204:205], v6 offset:24704
  v_cvt_pk_bf16_f32 v45, v30, v31
  v_mfma_f32_16x16x32_bf16 v[140:143], a[192:195], v[60:63], v[140:143]
  s_waitcnt lgkmcnt(2)
  ds_read_b64_tr_b16 a[206:207], v6 offset:30848
  v_accvgpr_read_b32 v14, a78
  v_mfma_f32_16x16x32_bf16 v[144:147], a[196:199], v[48:51], v[144:147]
  buffer_store_dwordx4 a[208:211], v18, s[20:23], s73 offen offset:3328 sc1 nt
  v_mfma_f32_16x16x32_bf16 v[148:151], a[196:199], v[52:55], v[148:151]
  v_accvgpr_read_b32 v16, a79
  v_mfma_f32_16x16x32_bf16 v[152:155], a[196:199], v[56:59], v[152:155]
  buffer_load_dwordx4 v8, s[8:11], s70 offen offset:1024 nt lds
  v_mfma_f32_16x16x32_bf16 v[156:159], a[196:199], v[60:63], v[156:159]
  ds_read_b128 a[152:155], v1 offset:12416
  v_mul_f32_e32 v20, s25, v20
  v_mfma_f32_16x16x32_bf16 v[160:163], a[200:203], v[48:51], v[160:163]
  v_mul_f32_e32 v21, s25, v21
  v_mul_f32_e32 v22, s25, v22
  v_mfma_f32_16x16x32_bf16 v[24:27], a[168:171], a[120:123], 0
  v_exp_f32_e32 v20, v20
  v_mfma_f32_16x16x32_bf16 v[24:27], a[172:175], a[124:127], v[24:27]
  v_exp_f32_e32 v21, v21
  v_mfma_f32_16x16x32_bf16 v[24:27], a[176:179], a[128:131], v[24:27]
  ds_read_b64_tr_b16 a[232:233], v3 offset:24832
  v_mul_f32_e32 v23, s25, v23
  v_mfma_f32_16x16x32_bf16 v[24:27], a[180:183], a[132:135], v[24:27]
  v_exp_f32_e32 v22, v22
  v_mfma_f32_16x16x32_bf16 v[24:27], a[184:187], a[136:139], v[24:27]
  ds_read_b64_tr_b16 a[234:235], v3 offset:30976
  v_cvt_pk_bf16_f32 v34, v20, v21
  v_mfma_f32_16x16x32_bf16 v[24:27], a[188:191], a[140:143], v[24:27]
  buffer_load_dwordx4 v9, s[8:11], s70 offen offset:2048 nt lds
  v_mfma_f32_16x16x32_bf16 v[164:167], a[200:203], v[52:55], v[164:167]
  v_exp_f32_e32 v23, v23
  v_mfma_f32_16x16x32_bf16 v[168:171], a[200:203], v[56:59], v[168:171]
  ds_read_b64_tr_b16 a[236:237], v4 offset:24832
  v_cvt_pk_bf16_f32 v35, v22, v23
  v_mfma_f32_16x16x32_bf16 v[172:175], a[200:203], v[60:63], v[172:175]
  s_waitcnt lgkmcnt(3)
  ds_read_b128 a[156:159], v2 offset:12416
  ds_read_b64_tr_b16 a[238:239], v4 offset:30976
  v_mfma_f32_16x16x32_bf16 v[176:179], a[204:207], v[48:51], v[176:179]
  v_mul_f32_e32 v24, s25, v24
  v_mul_f32_e32 v25, s25, v25
  v_mfma_f32_16x16x32_bf16 v[180:183], a[204:207], v[52:55], v[180:183]
  v_exp_f32_e32 v24, v24
  v_mfma_f32_16x16x32_bf16 v[184:187], a[204:207], v[56:59], v[184:187]
  v_mul_f32_e32 v26, s25, v26
  v_mul_f32_e32 v27, s25, v27
  v_mfma_f32_16x16x32_bf16 v[188:191], a[204:207], v[60:63], v[188:191]
  v_exp_f32_e32 v25, v25
  v_mfma_f32_16x16x32_bf16 v[28:31], a[168:171], a[0:3], 0
  v_exp_f32_e32 v26, v26
  v_mfma_f32_16x16x32_bf16 v[28:31], a[172:175], a[4:7], v[28:31]
  ds_read_b128 a[160:163], v1 offset:12544
  v_cvt_pk_bf16_f32 v38, v24, v25
  v_mfma_f32_16x16x32_bf16 v[28:31], a[176:179], a[8:11], v[28:31]
  v_exp_f32_e32 v27, v27
  v_mfma_f32_16x16x32_bf16 v[28:31], a[180:183], a[12:15], v[28:31]
  ds_read_b64_tr_b16 a[240:241], v5 offset:24832
  v_cvt_pk_bf16_f32 v39, v26, v27
  v_mfma_f32_16x16x32_bf16 v[28:31], a[184:187], a[16:19], v[28:31]
  ds_read2st64_b32 a[208:209], v11 offset0:8 offset1:9
  v_mfma_f32_16x16x32_bf16 v[28:31], a[188:191], a[20:23], v[28:31]
  s_waitcnt lgkmcnt(3)
  ds_read_b64_tr_b16 a[242:243], v5 offset:30976
  v_mfma_f32_16x16x32_bf16 v[192:195], a[232:235], v[48:51], v[192:195]
  ds_read2st64_b32 a[210:211], v13 offset0:8 offset1:9
  v_mfma_f32_16x16x32_bf16 v[196:199], a[232:235], v[52:55], v[196:199]
  v_mfma_f32_16x16x32_bf16 v[200:203], a[232:235], v[56:59], v[200:203]
  v_mfma_f32_16x16x32_bf16 v[204:207], a[232:235], v[60:63], v[204:207]
  ds_read_b128 a[164:167], v2 offset:12544
  v_mul_f32_e32 v28, s25, v28
  v_mfma_f32_16x16x32_bf16 v[208:211], a[236:239], v[48:51], v[208:211]
  v_mul_f32_e32 v29, s25, v29
  v_mul_f32_e32 v30, s25, v30
  v_mfma_f32_16x16x32_bf16 v[212:215], a[236:239], v[52:55], v[212:215]
  v_exp_f32_e32 v28, v28
  v_mfma_f32_16x16x32_bf16 v[20:23], a[168:171], a[24:27], 0
  v_exp_f32_e32 v29, v29
  v_mfma_f32_16x16x32_bf16 v[20:23], a[172:175], a[28:31], v[20:23]
  ds_read_b64_tr_b16 a[244:245], v6 offset:24832
  v_mul_f32_e32 v31, s25, v31
  v_mfma_f32_16x16x32_bf16 v[20:23], a[176:179], a[32:35], v[20:23]
  v_exp_f32_e32 v30, v30
  v_mfma_f32_16x16x32_bf16 v[20:23], a[180:183], a[36:39], v[20:23]
  ds_read_b64_tr_b16 a[246:247], v6 offset:30976
  v_cvt_pk_bf16_f32 v42, v28, v29
  v_mfma_f32_16x16x32_bf16 v[20:23], a[184:187], a[40:43], v[20:23]
  v_exp_f32_e32 v31, v31
  v_mfma_f32_16x16x32_bf16 v[20:23], a[188:191], a[44:47], v[20:23]
  v_cvt_pk_bf16_f32 v43, v30, v31
  v_mfma_f32_16x16x32_bf16 v[216:219], a[236:239], v[56:59], v[216:219]
  ds_read_b128 a[168:171], v1 offset:18432
  v_mfma_f32_16x16x32_bf16 v[220:223], a[236:239], v[60:63], v[220:223]
  s_waitcnt lgkmcnt(3)
  v_mfma_f32_16x16x32_bf16 v[224:227], a[240:243], v[48:51], v[224:227]
  s_waitcnt vmcnt(19) lgkmcnt(1)
  s_barrier
  v_mfma_f32_16x16x32_bf16 v[228:231], a[240:243], v[52:55], v[228:231]
  v_mul_f32_e32 v20, s25, v20
  v_mul_f32_e32 v21, s25, v21
  v_mfma_f32_16x16x32_bf16 v[232:235], a[240:243], v[56:59], v[232:235]
  v_exp_f32_e32 v20, v20
  v_mfma_f32_16x16x32_bf16 v[236:239], a[240:243], v[60:63], v[236:239]
  ds_read_b64_tr_b16 a[248:249], v3 offset:36864
  v_mul_f32_e32 v22, s25, v22
  v_mfma_f32_16x16x32_bf16 v[24:27], a[144:147], a[96:99], 0
  v_exp_f32_e32 v21, v21
  v_mfma_f32_16x16x32_bf16 v[24:27], a[148:151], a[100:103], v[24:27]
  s_add_u32 m0, s27, 123392
  v_mul_f32_e32 v23, s25, v23
  v_cvt_pk_bf16_f32 v46, v20, v21
  v_mfma_f32_16x16x32_bf16 v[24:27], a[152:155], a[104:107], v[24:27]
  buffer_load_dwordx4 v7, s[12:15], s65 offen offset:0 nt lds
  v_mfma_f32_16x16x32_bf16 v[24:27], a[156:159], a[108:111], v[24:27]
  v_exp_f32_e32 v22, v22
  v_mfma_f32_16x16x32_bf16 v[24:27], a[160:163], a[112:115], v[24:27]
  ds_read_b128 a[172:175], v2 offset:18432
  ds_read_b64_tr_b16 a[250:251], v3 offset:43008
  v_mfma_f32_16x16x32_bf16 v[24:27], a[164:167], a[116:119], v[24:27]
  v_exp_f32_e32 v23, v23
  v_mfma_f32_16x16x32_bf16 v[240:243], a[244:247], v[48:51], v[240:243]
  ds_read_b64_tr_b16 a[252:253], v4 offset:36864
  v_cvt_pk_bf16_f32 v47, v22, v23
  v_mfma_f32_16x16x32_bf16 v[244:247], a[244:247], v[52:55], v[244:247]
  ds_read_b64_tr_b16 a[254:255], v4 offset:43008
  v_mfma_f32_16x16x32_bf16 v[248:251], a[244:247], v[56:59], v[248:251]
  v_mfma_f32_16x16x32_bf16 v[252:255], a[244:247], v[60:63], v[252:255]
  v_mul_f32_e32 v24, s25, v24
  v_mul_f32_e32 v25, s25, v25
  v_smfmac_f32_16x16x64_bf16 a[216:219], a[224:227], v[32:39], v0
  ds_read_b128 a[176:179], v1 offset:18560
  v_smfmac_f32_16x16x64_bf16 a[220:223], a[224:227], v[40:47], v0
  v_mul_f32_e32 v26, s25, v26
  v_mfma_f32_16x16x32_bf16 v[28:31], a[144:147], a[120:123], 0
  buffer_load_dwordx4 v8, s[12:15], s65 offen offset:1024 nt lds
  v_mfma_f32_16x16x32_bf16 v[28:31], a[148:151], a[124:127], v[28:31]
  v_exp_f32_e32 v24, v24
  v_mfma_f32_16x16x32_bf16 v[28:31], a[152:155], a[128:131], v[28:31]
  v_exp_f32_e32 v25, v25
  v_mfma_f32_16x16x32_bf16 v[28:31], a[156:159], a[132:135], v[28:31]
  ds_read_b64_tr_b16 a[192:193], v5 offset:36864
  v_mul_f32_e32 v27, s25, v27
  v_mfma_f32_16x16x32_bf16 v[28:31], a[160:163], a[136:139], v[28:31]
  v_exp_f32_e32 v26, v26
  v_mfma_f32_16x16x32_bf16 v[28:31], a[164:167], a[140:143], v[28:31]
  s_waitcnt lgkmcnt(2)
  ds_read_b64_tr_b16 a[194:195], v5 offset:43008
  v_cvt_pk_bf16_f32 v48, v24, v25
  v_mfma_f32_16x16x32_bf16 v[64:67], a[248:251], v[32:35], v[64:67]
L_tr9:
  s_cbranch_execz L_tr13
  v_exp_f32_e32 v27, v27
  v_mfma_f32_16x16x32_bf16 v[68:71], a[248:251], v[36:39], v[68:71]
  buffer_load_dwordx4 v9, s[12:15], s65 offen offset:2048 nt lds
  v_mfma_f32_16x16x32_bf16 v[72:75], a[248:251], v[40:43], v[72:75]
  ds_read_b64_tr_b16 a[196:197], v6 offset:36864
  v_cvt_pk_bf16_f32 v49, v26, v27
  v_mfma_f32_16x16x32_bf16 v[76:79], a[248:251], v[44:47], v[76:79]
  ds_read_b128 a[180:183], v2 offset:18560
  v_mul_f32_e32 v28, s25, v28
  v_mfma_f32_16x16x32_bf16 v[80:83], a[252:255], v[32:35], v[80:83]
  ds_read_b64_tr_b16 a[198:199], v6 offset:43008
  v_mul_f32_e32 v29, s25, v29
  v_mfma_f32_16x16x32_bf16 v[84:87], a[252:255], v[36:39], v[84:87]
  v_exp_f32_e32 v28, v28
  v_mfma_f32_16x16x32_bf16 v[88:91], a[252:255], v[40:43], v[88:91]
  v_mul_f32_e32 v30, s25, v30
  v_mul_f32_e32 v31, s25, v31
  v_mfma_f32_16x16x32_bf16 v[20:23], a[144:147], a[0:3], 0
  s_add_u32 m0, s27, 49664
  v_exp_f32_e32 v29, v29
  v_mfma_f32_16x16x32_bf16 v[20:23], a[148:151], a[4:7], v[20:23]
  buffer_load_dwordx4 v7, s[8:11], s67 offen offset:0 nt lds
  v_mfma_f32_16x16x32_bf16 v[20:23], a[152:155], a[8:11], v[20:23]
  v_exp_f32_e32 v30, v30
  v_mfma_f32_16x16x32_bf16 v[20:23], a[156:159], a[12:15], v[20:23]
  ds_read_b128 a[184:187], v1 offset:18688
  v_cvt_pk_bf16_f32 v52, v28, v29
  v_mfma_f32_16x16x32_bf16 v[20:23], a[160:163], a[16:19], v[20:23]
  v_exp_f32_e32 v31, v31
  v_mfma_f32_16x16x32_bf16 v[20:23], a[164:167], a[20:23], v[20:23]
  ds_read_b64_tr_b16 a[200:201], v3 offset:36992
  v_cvt_pk_bf16_f32 v53, v30, v31
  v_mfma_f32_16x16x32_bf16 v[92:95], a[252:255], v[44:47], v[92:95]
  s_waitcnt lgkmcnt(2)
  s_add_u32 m0, s27, 0
  ds_read_b64_tr_b16 a[202:203], v3 offset:43136
  v_mfma_f32_16x16x32_bf16 v[96:99], a[192:195], v[32:35], v[96:99]
  ds_write_addtid_b32 v10 offset:12320
  ds_write_addtid_b32 v12 offset:12576
  ds_write_addtid_b32 v14 offset:12832
  ds_write_addtid_b32 v16 offset:13088
  v_mfma_f32_16x16x32_bf16 v[100:103], a[192:195], v[36:39], v[100:103]
  s_add_u32 m0, s27, 49664
  ds_read2st64_b32 a[72:73], v11 offset0:0 offset1:1
  v_accvgpr_read_b32 v10, a80
  v_mfma_f32_16x16x32_bf16 v[104:107], a[192:195], v[40:43], v[104:107]
  buffer_load_dwordx4 v8, s[8:11], s67 offen offset:1024 nt lds
  v_mfma_f32_16x16x32_bf16 v[108:111], a[192:195], v[44:47], v[108:111]
  ds_read_b128 a[188:191], v2 offset:18688
  v_mul_f32_e32 v20, s25, v20
  v_mfma_f32_16x16x32_bf16 v[112:115], a[196:199], v[32:35], v[112:115]
  v_mul_f32_e32 v21, s25, v21
  v_mul_f32_e32 v22, s25, v22
  v_mfma_f32_16x16x32_bf16 v[24:27], a[144:147], a[24:27], 0
  v_exp_f32_e32 v20, v20
  v_mfma_f32_16x16x32_bf16 v[24:27], a[148:151], a[28:31], v[24:27]
  v_exp_f32_e32 v21, v21
  v_mfma_f32_16x16x32_bf16 v[24:27], a[152:155], a[32:35], v[24:27]
  ds_read_b64_tr_b16 a[204:205], v4 offset:36992
  v_mul_f32_e32 v23, s25, v23
  v_mfma_f32_16x16x32_bf16 v[24:27], a[156:159], a[36:39], v[24:27]
  v_exp_f32_e32 v22, v22
  v_mfma_f32_16x16x32_bf16 v[24:27], a[160:163], a[40:43], v[24:27]
  ds_read_b64_tr_b16 a[206:207], v4 offset:43136
  v_cvt_pk_bf16_f32 v56, v20, v21
  v_mfma_f32_16x16x32_bf16 v[24:27], a[164:167], a[44:47], v[24:27]
  buffer_load_dwordx4 v9, s[8:11], s67 offen offset:2048 nt lds
  v_mfma_f32_16x16x32_bf16 v[116:119], a[196:199], v[36:39], v[116:119]
  v_exp_f32_e32 v23, v23
  v_mfma_f32_16x16x32_bf16 v[120:123], a[196:199], v[40:43], v[120:123]
  ds_read_b64_tr_b16 a[232:233], v5 offset:36992
  v_cvt_pk_bf16_f32 v57, v22, v23
  v_mfma_f32_16x16x32_bf16 v[124:127], a[196:199], v[44:47], v[124:127]
  s_waitcnt lgkmcnt(3)
  ds_read_b128 a[144:147], v1 offset:24576
  ds_read_b64_tr_b16 a[234:235], v5 offset:43136
  v_mfma_f32_16x16x32_bf16 v[128:131], a[200:203], v[32:35], v[128:131]
  v_mul_f32_e32 v24, s25, v24
  v_mul_f32_e32 v25, s25, v25
  v_mfma_f32_16x16x32_bf16 v[132:135], a[200:203], v[36:39], v[132:135]
  v_exp_f32_e32 v24, v24
  v_mfma_f32_16x16x32_bf16 v[136:139], a[200:203], v[40:43], v[136:139]
  v_mul_f32_e32 v26, s25, v26
  v_mul_f32_e32 v27, s25, v27
  v_mfma_f32_16x16x32_bf16 v[28:31], a[168:171], a[96:99], 0
  v_exp_f32_e32 v25, v25
  v_mfma_f32_16x16x32_bf16 v[28:31], a[172:175], a[100:103], v[28:31]
  v_exp_f32_e32 v26, v26
  v_mfma_f32_16x16x32_bf16 v[28:31], a[176:179], a[104:107], v[28:31]
  ds_read_b128 a[148:151], v2 offset:24576
  v_cvt_pk_bf16_f32 v60, v24, v25
  v_mfma_f32_16x16x32_bf16 v[28:31], a[180:183], a[108:111], v[28:31]
  v_exp_f32_e32 v27, v27
  v_mfma_f32_16x16x32_bf16 v[28:31], a[184:187], a[112:115], v[28:31]
  ds_read_b64_tr_b16 a[236:237], v6 offset:36992
  v_cvt_pk_bf16_f32 v61, v26, v27
  v_mfma_f32_16x16x32_bf16 v[28:31], a[188:191], a[116:119], v[28:31]
  buffer_store_dwordx4 a[212:215], v18, s[20:23], s72 offen offset:128 sc1 nt
  v_mfma_f32_16x16x32_bf16 v[140:143], a[200:203], v[44:47], v[140:143]
  s_waitcnt lgkmcnt(2)
  ds_read_b64_tr_b16 a[238:239], v6 offset:43136
  v_accvgpr_read_b32 v12, a81
  v_mfma_f32_16x16x32_bf16 v[144:147], a[204:207], v[32:35], v[144:147]
  v_accvgpr_read_b32 v14, a82
  v_accvgpr_read_b32 v16, a83
  v_mfma_f32_16x16x32_bf16 v[148:151], a[204:207], v[36:39], v[148:151]
  ds_read2st64_b32 a[74:75], v13 offset0:0 offset1:1
  v_mfma_f32_16x16x32_bf16 v[152:155], a[204:207], v[40:43], v[152:155]
  v_mul_f32_e32 v28, s25, v28
  v_mul_f32_e32 v29, s25, v29
  v_mfma_f32_16x16x32_bf16 v[156:159], a[204:207], v[44:47], v[156:159]
  v_exp_f32_e32 v28, v28
  v_mfma_f32_16x16x32_bf16 v[160:163], a[232:235], v[32:35], v[160:163]
  ds_read_b128 a[152:155], v1 offset:24704
  v_mul_f32_e32 v30, s25, v30
  v_mfma_f32_16x16x32_bf16 v[20:23], a[168:171], a[120:123], 0
  v_exp_f32_e32 v29, v29
  v_mfma_f32_16x16x32_bf16 v[20:23], a[172:175], a[124:127], v[20:23]
  ds_read_b64_tr_b16 a[240:241], v3 offset:37120
  v_mul_f32_e32 v31, s25, v31
  v_mfma_f32_16x16x32_bf16 v[20:23], a[176:179], a[128:131], v[20:23]
  v_exp_f32_e32 v30, v30
  v_mfma_f32_16x16x32_bf16 v[20:23], a[180:183], a[132:135], v[20:23]
  v_exp_f32_e32 v31, v31
  v_mfma_f32_16x16x32_bf16 v[20:23], a[184:187], a[136:139], v[20:23]
  ds_read_b64_tr_b16 a[242:243], v3 offset:43264
  v_cvt_pk_bf16_f32 v50, v28, v29
  v_mfma_f32_16x16x32_bf16 v[20:23], a[188:191], a[140:143], v[20:23]
  ds_read_b64_tr_b16 a[244:245], v4 offset:37120
  v_cvt_pk_bf16_f32 v51, v30, v31
  v_mfma_f32_16x16x32_bf16 v[164:167], a[232:235], v[36:39], v[164:167]
  ds_read_b128 a[156:159], v2 offset:24704
  v_mfma_f32_16x16x32_bf16 v[168:171], a[232:235], v[40:43], v[168:171]
  buffer_store_dwordx4 a[228:231], v18, s[20:23], s72 offen offset:3200 sc1 nt
  v_mfma_f32_16x16x32_bf16 v[172:175], a[232:235], v[44:47], v[172:175]
  s_waitcnt lgkmcnt(4)
  ds_read_b64_tr_b16 a[246:247], v4 offset:43264
  v_mfma_f32_16x16x32_bf16 v[176:179], a[236:239], v[32:35], v[176:179]
  v_mul_f32_e32 v20, s25, v20
  v_mul_f32_e32 v21, s25, v21
  v_mfma_f32_16x16x32_bf16 v[180:183], a[236:239], v[36:39], v[180:183]
  v_exp_f32_e32 v20, v20
  v_mfma_f32_16x16x32_bf16 v[184:187], a[236:239], v[40:43], v[184:187]
  v_mul_f32_e32 v22, s25, v22
  v_mul_f32_e32 v23, s25, v23
  v_mfma_f32_16x16x32_bf16 v[188:191], a[236:239], v[44:47], v[188:191]
  v_exp_f32_e32 v21, v21
  v_mfma_f32_16x16x32_bf16 v[24:27], a[168:171], a[0:3], 0
  v_exp_f32_e32 v22, v22
  v_mfma_f32_16x16x32_bf16 v[24:27], a[172:175], a[4:7], v[24:27]
  ds_read_b128 a[160:163], v1 offset:24832
  v_cvt_pk_bf16_f32 v54, v20, v21
  v_mfma_f32_16x16x32_bf16 v[24:27], a[176:179], a[8:11], v[24:27]
  v_exp_f32_e32 v23, v23
  v_mfma_f32_16x16x32_bf16 v[24:27], a[180:183], a[12:15], v[24:27]
  ds_read_b64_tr_b16 a[248:249], v5 offset:37120
  v_cvt_pk_bf16_f32 v55, v22, v23
  v_mfma_f32_16x16x32_bf16 v[24:27], a[184:187], a[16:19], v[24:27]
  ds_read2st64_b32 a[212:213], v15 offset0:8 offset1:9
  v_mfma_f32_16x16x32_bf16 v[24:27], a[188:191], a[20:23], v[24:27]
  s_waitcnt lgkmcnt(3)
  ds_read_b64_tr_b16 a[250:251], v5 offset:43264
  v_mfma_f32_16x16x32_bf16 v[192:195], a[240:243], v[32:35], v[192:195]
  ds_read2st64_b32 a[214:215], v17 offset0:8 offset1:9
  v_mfma_f32_16x16x32_bf16 v[196:199], a[240:243], v[36:39], v[196:199]
  ds_read2st64_b32 a[76:77], v15 offset0:0 offset1:1
  v_mfma_f32_16x16x32_bf16 v[200:203], a[240:243], v[40:43], v[200:203]
  ds_read2st64_b32 a[78:79], v17 offset0:0 offset1:1
  v_mfma_f32_16x16x32_bf16 v[204:207], a[240:243], v[44:47], v[204:207]
  ds_read_b128 a[164:167], v2 offset:24832
  v_mul_f32_e32 v24, s25, v24
  v_mfma_f32_16x16x32_bf16 v[208:211], a[244:247], v[32:35], v[208:211]
  v_mul_f32_e32 v25, s25, v25
  v_mul_f32_e32 v26, s25, v26
  v_mfma_f32_16x16x32_bf16 v[212:215], a[244:247], v[36:39], v[212:215]
  v_exp_f32_e32 v24, v24
  v_mfma_f32_16x16x32_bf16 v[28:31], a[168:171], a[24:27], 0
  v_exp_f32_e32 v25, v25
  v_mfma_f32_16x16x32_bf16 v[28:31], a[172:175], a[28:31], v[28:31]
  ds_read_b64_tr_b16 a[252:253], v6 offset:37120
  v_mul_f32_e32 v27, s25, v27
  v_mfma_f32_16x16x32_bf16 v[28:31], a[176:179], a[32:35], v[28:31]
  v_exp_f32_e32 v26, v26
  v_mfma_f32_16x16x32_bf16 v[28:31], a[180:183], a[36:39], v[28:31]
  ds_read_b64_tr_b16 a[254:255], v6 offset:43264
  v_cvt_pk_bf16_f32 v58, v24, v25
  v_mfma_f32_16x16x32_bf16 v[28:31], a[184:187], a[40:43], v[28:31]
  v_exp_f32_e32 v27, v27
  v_mfma_f32_16x16x32_bf16 v[28:31], a[188:191], a[44:47], v[28:31]
  v_cvt_pk_bf16_f32 v59, v26, v27
  v_mfma_f32_16x16x32_bf16 v[216:219], a[244:247], v[40:43], v[216:219]
  ds_read_b128 a[168:171], v1 offset:30720
  v_mfma_f32_16x16x32_bf16 v[220:223], a[244:247], v[44:47], v[220:223]
  s_waitcnt lgkmcnt(3)
  v_mfma_f32_16x16x32_bf16 v[224:227], a[248:251], v[32:35], v[224:227]
  s_waitcnt vmcnt(20) lgkmcnt(1)
  s_barrier
  v_mfma_f32_16x16x32_bf16 v[228:231], a[248:251], v[36:39], v[228:231]
  v_mul_f32_e32 v28, s25, v28
  v_mul_f32_e32 v29, s25, v29
  v_mfma_f32_16x16x32_bf16 v[232:235], a[248:251], v[40:43], v[232:235]
  v_exp_f32_e32 v28, v28
  v_mfma_f32_16x16x32_bf16 v[236:239], a[248:251], v[44:47], v[236:239]
  ds_read_b64_tr_b16 a[192:193], v3 offset:49152
  v_mul_f32_e32 v30, s25, v30
  v_mfma_f32_16x16x32_bf16 v[20:23], a[144:147], a[96:99], 0
  v_exp_f32_e32 v29, v29
  v_mfma_f32_16x16x32_bf16 v[20:23], a[148:151], a[100:103], v[20:23]
  s_add_u32 m0, s27, 135680
  v_mul_f32_e32 v31, s25, v31
  v_cvt_pk_bf16_f32 v62, v28, v29
  v_mfma_f32_16x16x32_bf16 v[20:23], a[152:155], a[104:107], v[20:23]
  buffer_load_dwordx4 v7, s[12:15], s66 offen offset:0 nt lds
  v_mfma_f32_16x16x32_bf16 v[20:23], a[156:159], a[108:111], v[20:23]
  v_exp_f32_e32 v30, v30
  v_mfma_f32_16x16x32_bf16 v[20:23], a[160:163], a[112:115], v[20:23]
  ds_read_b128 a[172:175], v2 offset:30720
  ds_read_b64_tr_b16 a[194:195], v3 offset:55296
  v_mfma_f32_16x16x32_bf16 v[20:23], a[164:167], a[116:119], v[20:23]
  v_exp_f32_e32 v31, v31
  v_mfma_f32_16x16x32_bf16 v[240:243], a[252:255], v[32:35], v[240:243]
  ds_read_b64_tr_b16 a[196:197], v4 offset:49152
  v_cvt_pk_bf16_f32 v63, v30, v31
  v_mfma_f32_16x16x32_bf16 v[244:247], a[252:255], v[36:39], v[244:247]
  ds_read_b64_tr_b16 a[198:199], v4 offset:55296
  v_mfma_f32_16x16x32_bf16 v[248:251], a[252:255], v[40:43], v[248:251]
  v_mfma_f32_16x16x32_bf16 v[252:255], a[252:255], v[44:47], v[252:255]
  v_mul_f32_e32 v20, s25, v20
  v_mul_f32_e32 v21, s25, v21
  v_smfmac_f32_16x16x64_bf16 a[216:219], a[224:227], v[48:55], v0
  ds_read_b128 a[176:179], v1 offset:30848
  v_smfmac_f32_16x16x64_bf16 a[220:223], a[224:227], v[56:63], v0
  v_mul_f32_e32 v22, s25, v22
  v_mfma_f32_16x16x32_bf16 v[24:27], a[144:147], a[120:123], 0
  buffer_load_dwordx4 v8, s[12:15], s66 offen offset:1024 nt lds
  v_mfma_f32_16x16x32_bf16 v[24:27], a[148:151], a[124:127], v[24:27]
  v_exp_f32_e32 v20, v20
  v_mfma_f32_16x16x32_bf16 v[24:27], a[152:155], a[128:131], v[24:27]
  v_exp_f32_e32 v21, v21
  v_mfma_f32_16x16x32_bf16 v[24:27], a[156:159], a[132:135], v[24:27]
  ds_read_b64_tr_b16 a[200:201], v5 offset:49152
  v_mul_f32_e32 v23, s25, v23
  v_mfma_f32_16x16x32_bf16 v[24:27], a[160:163], a[136:139], v[24:27]
  v_exp_f32_e32 v22, v22
  v_mfma_f32_16x16x32_bf16 v[24:27], a[164:167], a[140:143], v[24:27]
  s_waitcnt lgkmcnt(2)
  ds_read_b64_tr_b16 a[202:203], v5 offset:55296
  v_cvt_pk_bf16_f32 v32, v20, v21
  v_mfma_f32_16x16x32_bf16 v[64:67], a[192:195], v[48:51], v[64:67]
  v_exp_f32_e32 v23, v23
  v_mfma_f32_16x16x32_bf16 v[68:71], a[192:195], v[52:55], v[68:71]
  buffer_load_dwordx4 v9, s[12:15], s66 offen offset:2048 nt lds
  v_mfma_f32_16x16x32_bf16 v[72:75], a[192:195], v[56:59], v[72:75]
  ds_read_b64_tr_b16 a[204:205], v6 offset:49152
  v_cvt_pk_bf16_f32 v33, v22, v23
  v_mfma_f32_16x16x32_bf16 v[76:79], a[192:195], v[60:63], v[76:79]
  ds_read_b128 a[180:183], v2 offset:30848
  v_mul_f32_e32 v24, s25, v24
  v_mfma_f32_16x16x32_bf16 v[80:83], a[196:199], v[48:51], v[80:83]
  ds_read_b64_tr_b16 a[206:207], v6 offset:55296
  v_mul_f32_e32 v25, s25, v25
  v_mfma_f32_16x16x32_bf16 v[84:87], a[196:199], v[52:55], v[84:87]
  v_exp_f32_e32 v24, v24
  v_mfma_f32_16x16x32_bf16 v[88:91], a[196:199], v[56:59], v[88:91]
  v_mul_f32_e32 v26, s25, v26
  v_mul_f32_e32 v27, s25, v27
  v_mfma_f32_16x16x32_bf16 v[28:31], a[144:147], a[0:3], 0
  s_add_u32 m0, s27, 61952
  v_exp_f32_e32 v25, v25
  v_mfma_f32_16x16x32_bf16 v[28:31], a[148:151], a[4:7], v[28:31]
  buffer_load_dwordx4 v7, s[8:11], s68 offen offset:0 nt lds
  v_mfma_f32_16x16x32_bf16 v[28:31], a[152:155], a[8:11], v[28:31]
  v_exp_f32_e32 v26, v26
  v_mfma_f32_16x16x32_bf16 v[28:31], a[156:159], a[12:15], v[28:31]
  ds_read_b128 a[184:187], v1 offset:30976
  v_cvt_pk_bf16_f32 v36, v24, v25
  v_mfma_f32_16x16x32_bf16 v[28:31], a[160:163], a[16:19], v[28:31]
  v_exp_f32_e32 v27, v27
  v_mfma_f32_16x16x32_bf16 v[28:31], a[164:167], a[20:23], v[28:31]
  ds_read_b64_tr_b16 a[232:233], v3 offset:49280
  v_cvt_pk_bf16_f32 v37, v26, v27
  v_mfma_f32_16x16x32_bf16 v[92:95], a[196:199], v[60:63], v[92:95]
  s_waitcnt lgkmcnt(2)
  s_add_u32 m0, s27, 0
  ds_read_b64_tr_b16 a[234:235], v3 offset:55424
  v_mfma_f32_16x16x32_bf16 v[96:99], a[200:203], v[48:51], v[96:99]
  ds_write_addtid_b32 v10 offset:0
  ds_write_addtid_b32 v12 offset:256
  ds_write_addtid_b32 v14 offset:512
  ds_write_addtid_b32 v16 offset:768
  v_mfma_f32_16x16x32_bf16 v[100:103], a[200:203], v[52:55], v[100:103]
  s_add_u32 m0, s27, 61952
  v_accvgpr_read_b32 v10, a84
  v_accvgpr_read_b32 v12, a85
  v_mfma_f32_16x16x32_bf16 v[104:107], a[200:203], v[56:59], v[104:107]
  buffer_load_dwordx4 v8, s[8:11], s68 offen offset:1024 nt lds
  v_mfma_f32_16x16x32_bf16 v[108:111], a[200:203], v[60:63], v[108:111]
  ds_read_b128 a[188:191], v2 offset:30976
  v_mul_f32_e32 v28, s25, v28
  v_mfma_f32_16x16x32_bf16 v[112:115], a[204:207], v[48:51], v[112:115]
  v_mul_f32_e32 v29, s25, v29
  v_mul_f32_e32 v30, s25, v30
  v_mfma_f32_16x16x32_bf16 v[20:23], a[144:147], a[24:27], 0
  v_exp_f32_e32 v28, v28
  v_mfma_f32_16x16x32_bf16 v[20:23], a[148:151], a[28:31], v[20:23]
  v_exp_f32_e32 v29, v29
  v_mfma_f32_16x16x32_bf16 v[20:23], a[152:155], a[32:35], v[20:23]
  ds_read_b64_tr_b16 a[236:237], v4 offset:49280
  v_mul_f32_e32 v31, s25, v31
  v_mfma_f32_16x16x32_bf16 v[20:23], a[156:159], a[36:39], v[20:23]
  v_exp_f32_e32 v30, v30
  v_mfma_f32_16x16x32_bf16 v[20:23], a[160:163], a[40:43], v[20:23]
  ds_read_b64_tr_b16 a[238:239], v4 offset:55424
  v_cvt_pk_bf16_f32 v40, v28, v29
  v_mfma_f32_16x16x32_bf16 v[20:23], a[164:167], a[44:47], v[20:23]
  buffer_load_dwordx4 v9, s[8:11], s68 offen offset:2048 nt lds
  v_mfma_f32_16x16x32_bf16 v[116:119], a[204:207], v[52:55], v[116:119]
  v_exp_f32_e32 v31, v31
  v_mfma_f32_16x16x32_bf16 v[120:123], a[204:207], v[56:59], v[120:123]
  ds_read_b64_tr_b16 a[240:241], v5 offset:49280
  v_cvt_pk_bf16_f32 v41, v30, v31
  v_mfma_f32_16x16x32_bf16 v[124:127], a[204:207], v[60:63], v[124:127]
  s_waitcnt lgkmcnt(3)
  ds_read_b128 a[144:147], v1 offset:36864
  ds_read_b64_tr_b16 a[242:243], v5 offset:55424
  v_mfma_f32_16x16x32_bf16 v[128:131], a[232:235], v[48:51], v[128:131]
  v_mul_f32_e32 v20, s25, v20
  v_mul_f32_e32 v21, s25, v21
  v_mfma_f32_16x16x32_bf16 v[132:135], a[232:235], v[52:55], v[132:135]
  v_exp_f32_e32 v20, v20
  v_mfma_f32_16x16x32_bf16 v[136:139], a[232:235], v[56:59], v[136:139]
  v_mul_f32_e32 v22, s25, v22
  v_mul_f32_e32 v23, s25, v23
  v_mfma_f32_16x16x32_bf16 v[24:27], a[168:171], a[96:99], 0
  s_add_u32 m0, s27, 37120
  v_exp_f32_e32 v21, v21
  v_mfma_f32_16x16x32_bf16 v[24:27], a[172:175], a[100:103], v[24:27]
  buffer_load_dwordx4 v7, s[8:11], s71 offen offset:0 nt lds
  v_mfma_f32_16x16x32_bf16 v[24:27], a[176:179], a[104:107], v[24:27]
  v_exp_f32_e32 v22, v22
  v_mfma_f32_16x16x32_bf16 v[24:27], a[180:183], a[108:111], v[24:27]
  ds_read_b128 a[148:151], v2 offset:36864
  v_cvt_pk_bf16_f32 v44, v20, v21
  v_mfma_f32_16x16x32_bf16 v[24:27], a[184:187], a[112:115], v[24:27]
  v_exp_f32_e32 v23, v23
  v_mfma_f32_16x16x32_bf16 v[24:27], a[188:191], a[116:119], v[24:27]
  ds_read_b64_tr_b16 a[244:245], v6 offset:49280
  v_cvt_pk_bf16_f32 v45, v22, v23
  v_mfma_f32_16x16x32_bf16 v[140:143], a[232:235], v[60:63], v[140:143]
  s_waitcnt lgkmcnt(2)
  ds_read_b64_tr_b16 a[246:247], v6 offset:55424
  v_accvgpr_read_b32 v14, a86
  v_mfma_f32_16x16x32_bf16 v[144:147], a[236:239], v[48:51], v[144:147]
  buffer_store_dwordx4 a[208:211], v18, s[20:23], s72 offen offset:256 sc1 nt
  v_mfma_f32_16x16x32_bf16 v[148:151], a[236:239], v[52:55], v[148:151]
  v_accvgpr_read_b32 v16, a87
  v_mfma_f32_16x16x32_bf16 v[152:155], a[236:239], v[56:59], v[152:155]
  buffer_load_dwordx4 v8, s[8:11], s71 offen offset:1024 nt lds
  v_mfma_f32_16x16x32_bf16 v[156:159], a[236:239], v[60:63], v[156:159]
  ds_read_b128 a[152:155], v1 offset:36992
  v_mul_f32_e32 v24, s25, v24
  v_mfma_f32_16x16x32_bf16 v[160:163], a[240:243], v[48:51], v[160:163]
  v_mul_f32_e32 v25, s25, v25
  v_mul_f32_e32 v26, s25, v26
  v_mfma_f32_16x16x32_bf16 v[28:31], a[168:171], a[120:123], 0
  v_exp_f32_e32 v24, v24
  v_mfma_f32_16x16x32_bf16 v[28:31], a[172:175], a[124:127], v[28:31]
  v_exp_f32_e32 v25, v25
  v_mfma_f32_16x16x32_bf16 v[28:31], a[176:179], a[128:131], v[28:31]
  ds_read_b64_tr_b16 a[248:249], v3 offset:49408
  v_mul_f32_e32 v27, s25, v27
  v_mfma_f32_16x16x32_bf16 v[28:31], a[180:183], a[132:135], v[28:31]
  v_exp_f32_e32 v26, v26
  v_mfma_f32_16x16x32_bf16 v[28:31], a[184:187], a[136:139], v[28:31]
  ds_read_b64_tr_b16 a[250:251], v3 offset:55552
  v_cvt_pk_bf16_f32 v34, v24, v25
  v_mfma_f32_16x16x32_bf16 v[28:31], a[188:191], a[140:143], v[28:31]
  buffer_load_dwordx4 v9, s[8:11], s71 offen offset:2048 nt lds
  v_mfma_f32_16x16x32_bf16 v[164:167], a[240:243], v[52:55], v[164:167]
  v_exp_f32_e32 v27, v27
  v_mfma_f32_16x16x32_bf16 v[168:171], a[240:243], v[56:59], v[168:171]
  ds_read_b64_tr_b16 a[252:253], v4 offset:49408
  v_cvt_pk_bf16_f32 v35, v26, v27
  v_mfma_f32_16x16x32_bf16 v[172:175], a[240:243], v[60:63], v[172:175]
  s_waitcnt lgkmcnt(3)
  ds_read_b128 a[156:159], v2 offset:36992
  ds_read_b64_tr_b16 a[254:255], v4 offset:55552
  v_mfma_f32_16x16x32_bf16 v[176:179], a[244:247], v[48:51], v[176:179]
  v_mul_f32_e32 v28, s25, v28
  v_mul_f32_e32 v29, s25, v29
  v_mfma_f32_16x16x32_bf16 v[180:183], a[244:247], v[52:55], v[180:183]
  v_exp_f32_e32 v28, v28
  v_mfma_f32_16x16x32_bf16 v[184:187], a[244:247], v[56:59], v[184:187]
  v_mul_f32_e32 v30, s25, v30
  v_mul_f32_e32 v31, s25, v31
  v_mfma_f32_16x16x32_bf16 v[188:191], a[244:247], v[60:63], v[188:191]
  v_exp_f32_e32 v29, v29
  v_mfma_f32_16x16x32_bf16 v[20:23], a[168:171], a[0:3], 0
  v_exp_f32_e32 v30, v30
  v_mfma_f32_16x16x32_bf16 v[20:23], a[172:175], a[4:7], v[20:23]
  ds_read_b128 a[160:163], v1 offset:37120
  v_cvt_pk_bf16_f32 v38, v28, v29
  v_mfma_f32_16x16x32_bf16 v[20:23], a[176:179], a[8:11], v[20:23]
  v_exp_f32_e32 v31, v31
  v_mfma_f32_16x16x32_bf16 v[20:23], a[180:183], a[12:15], v[20:23]
  ds_read_b64_tr_b16 a[192:193], v5 offset:49408
  v_cvt_pk_bf16_f32 v39, v30, v31
  v_mfma_f32_16x16x32_bf16 v[20:23], a[184:187], a[16:19], v[20:23]
  v_mfma_f32_16x16x32_bf16 v[20:23], a[188:191], a[20:23], v[20:23]
  s_waitcnt lgkmcnt(2)
  ds_read_b64_tr_b16 a[194:195], v5 offset:55552
  v_mfma_f32_16x16x32_bf16 v[192:195], a[248:251], v[48:51], v[192:195]
  v_mfma_f32_16x16x32_bf16 v[196:199], a[248:251], v[52:55], v[196:199]
  v_mfma_f32_16x16x32_bf16 v[200:203], a[248:251], v[56:59], v[200:203]
  v_mfma_f32_16x16x32_bf16 v[204:207], a[248:251], v[60:63], v[204:207]
  ds_read_b128 a[164:167], v2 offset:37120
  s_nop 0
  v_mul_f32_e32 v20, s25, v20
  v_mfma_f32_16x16x32_bf16 v[208:211], a[252:255], v[48:51], v[208:211]
  v_mul_f32_e32 v21, s25, v21
  v_mul_f32_e32 v22, s25, v22
  v_mfma_f32_16x16x32_bf16 v[212:215], a[252:255], v[52:55], v[212:215]
  v_exp_f32_e32 v20, v20
  v_mfma_f32_16x16x32_bf16 v[24:27], a[168:171], a[24:27], 0
  v_exp_f32_e32 v21, v21
  v_mfma_f32_16x16x32_bf16 v[24:27], a[172:175], a[28:31], v[24:27]
  ds_read_b64_tr_b16 a[196:197], v6 offset:49408
  v_mul_f32_e32 v23, s25, v23
  v_mfma_f32_16x16x32_bf16 v[24:27], a[176:179], a[32:35], v[24:27]
  v_exp_f32_e32 v22, v22
  v_mfma_f32_16x16x32_bf16 v[24:27], a[180:183], a[36:39], v[24:27]
  ds_read_b64_tr_b16 a[198:199], v6 offset:55552
  v_cvt_pk_bf16_f32 v42, v20, v21
  v_mfma_f32_16x16x32_bf16 v[24:27], a[184:187], a[40:43], v[24:27]
  v_exp_f32_e32 v23, v23
  v_mfma_f32_16x16x32_bf16 v[24:27], a[188:191], a[44:47], v[24:27]
  v_cvt_pk_bf16_f32 v43, v22, v23
  v_mfma_f32_16x16x32_bf16 v[216:219], a[252:255], v[56:59], v[216:219]
  ds_read_b128 a[168:171], v1 offset:43008
  v_mfma_f32_16x16x32_bf16 v[220:223], a[252:255], v[60:63], v[220:223]
  s_waitcnt lgkmcnt(3)
  v_mfma_f32_16x16x32_bf16 v[224:227], a[192:195], v[48:51], v[224:227]
  s_waitcnt vmcnt(22) lgkmcnt(1)
  s_barrier
  v_mfma_f32_16x16x32_bf16 v[228:231], a[192:195], v[52:55], v[228:231]
  v_mul_f32_e32 v24, s25, v24
  v_mul_f32_e32 v25, s25, v25
  v_mfma_f32_16x16x32_bf16 v[232:235], a[192:195], v[56:59], v[232:235]
  v_exp_f32_e32 v24, v24
  v_mfma_f32_16x16x32_bf16 v[236:239], a[192:195], v[60:63], v[236:239]
  ds_read_b64_tr_b16 a[200:201], v3 offset:12288
  v_mul_f32_e32 v26, s25, v26
  v_mfma_f32_16x16x32_bf16 v[28:31], a[144:147], a[96:99], 0
  v_exp_f32_e32 v25, v25
  v_mfma_f32_16x16x32_bf16 v[28:31], a[148:151], a[100:103], v[28:31]
  s_add_u32 m0, s27, 147968
  v_mul_f32_e32 v27, s25, v27
  v_cvt_pk_bf16_f32 v46, v24, v25
  v_mfma_f32_16x16x32_bf16 v[28:31], a[152:155], a[104:107], v[28:31]
  buffer_load_dwordx4 v7, s[12:15], s67 offen offset:0 nt lds
  v_mfma_f32_16x16x32_bf16 v[28:31], a[156:159], a[108:111], v[28:31]
  v_exp_f32_e32 v26, v26
  v_mfma_f32_16x16x32_bf16 v[28:31], a[160:163], a[112:115], v[28:31]
  ds_read_b128 a[172:175], v2 offset:43008
  ds_read_b64_tr_b16 a[202:203], v3 offset:18432
  v_mfma_f32_16x16x32_bf16 v[28:31], a[164:167], a[116:119], v[28:31]
  v_exp_f32_e32 v27, v27
  v_mfma_f32_16x16x32_bf16 v[240:243], a[196:199], v[48:51], v[240:243]
  ds_read_b64_tr_b16 a[204:205], v4 offset:12288
  v_cvt_pk_bf16_f32 v47, v26, v27
  v_mfma_f32_16x16x32_bf16 v[244:247], a[196:199], v[52:55], v[244:247]
  ds_read_b64_tr_b16 a[206:207], v4 offset:18432
  v_mfma_f32_16x16x32_bf16 v[248:251], a[196:199], v[56:59], v[248:251]
  v_mfma_f32_16x16x32_bf16 v[252:255], a[196:199], v[60:63], v[252:255]
  v_mul_f32_e32 v28, s25, v28
  v_mul_f32_e32 v29, s25, v29
  v_smfmac_f32_16x16x64_bf16 a[216:219], a[224:227], v[32:39], v0
  ds_read_b128 a[176:179], v1 offset:43136
  v_smfmac_f32_16x16x64_bf16 a[220:223], a[224:227], v[40:47], v0
  v_mul_f32_e32 v30, s25, v30
  v_mfma_f32_16x16x32_bf16 v[20:23], a[144:147], a[120:123], 0
  buffer_load_dwordx4 v8, s[12:15], s67 offen offset:1024 nt lds
  v_mfma_f32_16x16x32_bf16 v[20:23], a[148:151], a[124:127], v[20:23]
  v_exp_f32_e32 v28, v28
  v_mfma_f32_16x16x32_bf16 v[20:23], a[152:155], a[128:131], v[20:23]
  v_exp_f32_e32 v29, v29
  v_mfma_f32_16x16x32_bf16 v[20:23], a[156:159], a[132:135], v[20:23]
  ds_read_b64_tr_b16 a[232:233], v5 offset:12288
  v_mul_f32_e32 v31, s25, v31
  v_mfma_f32_16x16x32_bf16 v[20:23], a[160:163], a[136:139], v[20:23]
  v_exp_f32_e32 v30, v30
  v_mfma_f32_16x16x32_bf16 v[20:23], a[164:167], a[140:143], v[20:23]
  s_waitcnt lgkmcnt(2)
  ds_read_b64_tr_b16 a[234:235], v5 offset:18432
  v_cvt_pk_bf16_f32 v48, v28, v29
  v_mfma_f32_16x16x32_bf16 v[64:67], a[200:203], v[32:35], v[64:67]
  v_exp_f32_e32 v31, v31
  v_mfma_f32_16x16x32_bf16 v[68:71], a[200:203], v[36:39], v[68:71]
  buffer_load_dwordx4 v9, s[12:15], s67 offen offset:2048 nt lds
  v_mfma_f32_16x16x32_bf16 v[72:75], a[200:203], v[40:43], v[72:75]
  ds_read_b64_tr_b16 a[236:237], v6 offset:12288
  v_cvt_pk_bf16_f32 v49, v30, v31
  v_mfma_f32_16x16x32_bf16 v[76:79], a[200:203], v[44:47], v[76:79]
  ds_read_b128 a[180:183], v2 offset:43136
  v_mul_f32_e32 v20, s25, v20
  v_mfma_f32_16x16x32_bf16 v[80:83], a[204:207], v[32:35], v[80:83]
  ds_read_b64_tr_b16 a[238:239], v6 offset:18432
  v_mul_f32_e32 v21, s25, v21
  v_mfma_f32_16x16x32_bf16 v[84:87], a[204:207], v[36:39], v[84:87]
  v_exp_f32_e32 v20, v20
  v_mfma_f32_16x16x32_bf16 v[88:91], a[204:207], v[40:43], v[88:91]
  v_mul_f32_e32 v22, s25, v22
  v_mul_f32_e32 v23, s25, v23
  v_mfma_f32_16x16x32_bf16 v[24:27], a[144:147], a[0:3], 0
  s_add_u32 m0, s27, 74240
  v_exp_f32_e32 v21, v21
  v_mfma_f32_16x16x32_bf16 v[24:27], a[148:151], a[4:7], v[24:27]
  buffer_load_dwordx4 v7, s[8:11], s69 offen offset:0 nt lds
  v_mfma_f32_16x16x32_bf16 v[24:27], a[152:155], a[8:11], v[24:27]
  v_exp_f32_e32 v22, v22
  v_mfma_f32_16x16x32_bf16 v[24:27], a[156:159], a[12:15], v[24:27]
  ds_read_b128 a[184:187], v1 offset:43264
  v_cvt_pk_bf16_f32 v52, v20, v21
  v_mfma_f32_16x16x32_bf16 v[24:27], a[160:163], a[16:19], v[24:27]
  v_exp_f32_e32 v23, v23
  v_mfma_f32_16x16x32_bf16 v[24:27], a[164:167], a[20:23], v[24:27]
  ds_read_b64_tr_b16 a[240:241], v3 offset:12416
  v_cvt_pk_bf16_f32 v53, v22, v23
  v_mfma_f32_16x16x32_bf16 v[92:95], a[204:207], v[44:47], v[92:95]
  s_waitcnt lgkmcnt(2)
  s_add_u32 m0, s27, 0
  ds_read_b64_tr_b16 a[242:243], v3 offset:18560
  v_mfma_f32_16x16x32_bf16 v[96:99], a[232:235], v[32:35], v[96:99]
  ds_write_addtid_b32 v10 offset:12320
  ds_write_addtid_b32 v12 offset:12576
  ds_write_addtid_b32 v14 offset:12832
  ds_write_addtid_b32 v16 offset:13088
  v_mfma_f32_16x16x32_bf16 v[100:103], a[232:235], v[36:39], v[100:103]
  s_add_u32 m0, s27, 74240
  ds_read2st64_b32 a[80:81], v11 offset0:0 offset1:1
  v_accvgpr_read_b32 v10, a88
  v_mfma_f32_16x16x32_bf16 v[104:107], a[232:235], v[40:43], v[104:107]
  buffer_load_dwordx4 v8, s[8:11], s69 offen offset:1024 nt lds
  v_mfma_f32_16x16x32_bf16 v[108:111], a[232:235], v[44:47], v[108:111]
  ds_read_b128 a[188:191], v2 offset:43264
  v_mul_f32_e32 v24, s25, v24
  v_mfma_f32_16x16x32_bf16 v[112:115], a[236:239], v[32:35], v[112:115]
  v_mul_f32_e32 v25, s25, v25
  v_mul_f32_e32 v26, s25, v26
  v_mfma_f32_16x16x32_bf16 v[28:31], a[144:147], a[24:27], 0
  v_exp_f32_e32 v24, v24
  v_mfma_f32_16x16x32_bf16 v[28:31], a[148:151], a[28:31], v[28:31]
  v_exp_f32_e32 v25, v25
  v_mfma_f32_16x16x32_bf16 v[28:31], a[152:155], a[32:35], v[28:31]
  ds_read_b64_tr_b16 a[244:245], v4 offset:12416
  v_mul_f32_e32 v27, s25, v27
  v_mfma_f32_16x16x32_bf16 v[28:31], a[156:159], a[36:39], v[28:31]
  v_exp_f32_e32 v26, v26
  v_mfma_f32_16x16x32_bf16 v[28:31], a[160:163], a[40:43], v[28:31]
  ds_read_b64_tr_b16 a[246:247], v4 offset:18560
  v_cvt_pk_bf16_f32 v56, v24, v25
  v_mfma_f32_16x16x32_bf16 v[28:31], a[164:167], a[44:47], v[28:31]
  buffer_load_dwordx4 v9, s[8:11], s69 offen offset:2048 nt lds
  v_mfma_f32_16x16x32_bf16 v[116:119], a[236:239], v[36:39], v[116:119]
  v_exp_f32_e32 v27, v27
  v_mfma_f32_16x16x32_bf16 v[120:123], a[236:239], v[40:43], v[120:123]
  ds_read_b64_tr_b16 a[248:249], v5 offset:12416
  v_cvt_pk_bf16_f32 v57, v26, v27
  v_mfma_f32_16x16x32_bf16 v[124:127], a[236:239], v[44:47], v[124:127]
  s_waitcnt lgkmcnt(3)
  ds_read_b128 a[144:147], v1 offset:49152
  ds_read_b64_tr_b16 a[250:251], v5 offset:18560
  v_mfma_f32_16x16x32_bf16 v[128:131], a[240:243], v[32:35], v[128:131]
  v_mul_f32_e32 v28, s25, v28
  v_mul_f32_e32 v29, s25, v29
  v_mfma_f32_16x16x32_bf16 v[132:135], a[240:243], v[36:39], v[132:135]
  v_exp_f32_e32 v28, v28
  v_mfma_f32_16x16x32_bf16 v[136:139], a[240:243], v[40:43], v[136:139]
  v_mul_f32_e32 v30, s25, v30
  v_mul_f32_e32 v31, s25, v31
  v_mfma_f32_16x16x32_bf16 v[20:23], a[168:171], a[96:99], 0
  v_exp_f32_e32 v29, v29
  v_mfma_f32_16x16x32_bf16 v[20:23], a[172:175], a[100:103], v[20:23]
  v_exp_f32_e32 v30, v30
  v_mfma_f32_16x16x32_bf16 v[20:23], a[176:179], a[104:107], v[20:23]
  ds_read_b128 a[148:151], v2 offset:49152
  v_cvt_pk_bf16_f32 v60, v28, v29
  v_mfma_f32_16x16x32_bf16 v[20:23], a[180:183], a[108:111], v[20:23]
  v_exp_f32_e32 v31, v31
  v_mfma_f32_16x16x32_bf16 v[20:23], a[184:187], a[112:115], v[20:23]
  ds_read_b64_tr_b16 a[252:253], v6 offset:12416
  v_cvt_pk_bf16_f32 v61, v30, v31
  v_mfma_f32_16x16x32_bf16 v[20:23], a[188:191], a[116:119], v[20:23]
  buffer_store_dwordx4 a[212:215], v18, s[20:23], s72 offen offset:3328 sc1 nt
  v_mfma_f32_16x16x32_bf16 v[140:143], a[240:243], v[44:47], v[140:143]
  s_waitcnt lgkmcnt(2)
  ds_read_b64_tr_b16 a[254:255], v6 offset:18560
  v_accvgpr_read_b32 v12, a89
  v_mfma_f32_16x16x32_bf16 v[144:147], a[244:247], v[32:35], v[144:147]
L_tr10:
  s_cbranch_execz L_tr14
  v_accvgpr_read_b32 v14, a90
  v_accvgpr_read_b32 v16, a91
  v_mfma_f32_16x16x32_bf16 v[148:151], a[244:247], v[36:39], v[148:151]
  ds_read2st64_b32 a[82:83], v13 offset0:0 offset1:1
  v_mfma_f32_16x16x32_bf16 v[152:155], a[244:247], v[40:43], v[152:155]
  v_mul_f32_e32 v20, s25, v20
  v_mul_f32_e32 v21, s25, v21
  v_mfma_f32_16x16x32_bf16 v[156:159], a[244:247], v[44:47], v[156:159]
  v_exp_f32_e32 v20, v20
  v_mfma_f32_16x16x32_bf16 v[160:163], a[248:251], v[32:35], v[160:163]
  ds_read_b128 a[152:155], v1 offset:49280
  v_mul_f32_e32 v22, s25, v22
  v_mfma_f32_16x16x32_bf16 v[24:27], a[168:171], a[120:123], 0
  v_exp_f32_e32 v21, v21
  v_mfma_f32_16x16x32_bf16 v[24:27], a[172:175], a[124:127], v[24:27]
  ds_read_b64_tr_b16 a[192:193], v3 offset:12544
  v_mul_f32_e32 v23, s25, v23
  v_mfma_f32_16x16x32_bf16 v[24:27], a[176:179], a[128:131], v[24:27]
  v_exp_f32_e32 v22, v22
  v_mfma_f32_16x16x32_bf16 v[24:27], a[180:183], a[132:135], v[24:27]
  v_exp_f32_e32 v23, v23
  v_mfma_f32_16x16x32_bf16 v[24:27], a[184:187], a[136:139], v[24:27]
  ds_read_b64_tr_b16 a[194:195], v3 offset:18688
  v_cvt_pk_bf16_f32 v50, v20, v21
  v_mfma_f32_16x16x32_bf16 v[24:27], a[188:191], a[140:143], v[24:27]
  ds_read_b64_tr_b16 a[196:197], v4 offset:12544
  v_cvt_pk_bf16_f32 v51, v22, v23
  v_mfma_f32_16x16x32_bf16 v[164:167], a[248:251], v[36:39], v[164:167]
  ds_read_b128 a[156:159], v2 offset:49280
  v_mfma_f32_16x16x32_bf16 v[168:171], a[248:251], v[40:43], v[168:171]
  buffer_store_dwordx4 a[48:51], v18, s[20:23], s74 offen offset:0 sc1 nt
  v_mfma_f32_16x16x32_bf16 v[172:175], a[248:251], v[44:47], v[172:175]
  s_waitcnt lgkmcnt(4)
  ds_read_b64_tr_b16 a[198:199], v4 offset:18688
  v_mfma_f32_16x16x32_bf16 v[176:179], a[252:255], v[32:35], v[176:179]
  v_mul_f32_e32 v24, s25, v24
  v_mul_f32_e32 v25, s25, v25
  v_mfma_f32_16x16x32_bf16 v[180:183], a[252:255], v[36:39], v[180:183]
  v_exp_f32_e32 v24, v24
  v_mfma_f32_16x16x32_bf16 v[184:187], a[252:255], v[40:43], v[184:187]
  v_mul_f32_e32 v26, s25, v26
  v_mul_f32_e32 v27, s25, v27
  v_mfma_f32_16x16x32_bf16 v[188:191], a[252:255], v[44:47], v[188:191]
  v_exp_f32_e32 v25, v25
  v_mfma_f32_16x16x32_bf16 v[28:31], a[168:171], a[0:3], 0
  v_exp_f32_e32 v26, v26
  v_mfma_f32_16x16x32_bf16 v[28:31], a[172:175], a[4:7], v[28:31]
  ds_read_b128 a[160:163], v1 offset:49408
  v_cvt_pk_bf16_f32 v54, v24, v25
  v_mfma_f32_16x16x32_bf16 v[28:31], a[176:179], a[8:11], v[28:31]
  v_exp_f32_e32 v27, v27
  v_mfma_f32_16x16x32_bf16 v[28:31], a[180:183], a[12:15], v[28:31]
  ds_read_b64_tr_b16 a[200:201], v5 offset:12544
  v_cvt_pk_bf16_f32 v55, v26, v27
  v_mfma_f32_16x16x32_bf16 v[28:31], a[184:187], a[16:19], v[28:31]
  ds_read2st64_b32 a[84:85], v15 offset0:0 offset1:1
  v_mfma_f32_16x16x32_bf16 v[28:31], a[188:191], a[20:23], v[28:31]
  s_waitcnt lgkmcnt(3)
  ds_read_b64_tr_b16 a[202:203], v5 offset:18688
  v_mfma_f32_16x16x32_bf16 v[192:195], a[192:195], v[32:35], v[192:195]
  ds_read2st64_b32 a[86:87], v17 offset0:0 offset1:1
  v_mfma_f32_16x16x32_bf16 v[196:199], a[192:195], v[36:39], v[196:199]
  v_mfma_f32_16x16x32_bf16 v[200:203], a[192:195], v[40:43], v[200:203]
  v_mfma_f32_16x16x32_bf16 v[204:207], a[192:195], v[44:47], v[204:207]
  ds_read_b128 a[164:167], v2 offset:49408
  v_mul_f32_e32 v28, s25, v28
  v_mfma_f32_16x16x32_bf16 v[208:211], a[196:199], v[32:35], v[208:211]
  v_mul_f32_e32 v29, s25, v29
  v_mul_f32_e32 v30, s25, v30
  v_mfma_f32_16x16x32_bf16 v[212:215], a[196:199], v[36:39], v[212:215]
  v_exp_f32_e32 v28, v28
  v_mfma_f32_16x16x32_bf16 v[20:23], a[168:171], a[24:27], 0
  v_exp_f32_e32 v29, v29
  v_mfma_f32_16x16x32_bf16 v[20:23], a[172:175], a[28:31], v[20:23]
  ds_read_b64_tr_b16 a[204:205], v6 offset:12544
  v_mul_f32_e32 v31, s25, v31
  v_mfma_f32_16x16x32_bf16 v[20:23], a[176:179], a[32:35], v[20:23]
  v_exp_f32_e32 v30, v30
  v_mfma_f32_16x16x32_bf16 v[20:23], a[180:183], a[36:39], v[20:23]
  ds_read_b64_tr_b16 a[206:207], v6 offset:18688
  v_cvt_pk_bf16_f32 v58, v28, v29
  v_mfma_f32_16x16x32_bf16 v[20:23], a[184:187], a[40:43], v[20:23]
  v_exp_f32_e32 v31, v31
  v_mfma_f32_16x16x32_bf16 v[20:23], a[188:191], a[44:47], v[20:23]
  v_cvt_pk_bf16_f32 v59, v30, v31
  v_mfma_f32_16x16x32_bf16 v[216:219], a[196:199], v[40:43], v[216:219]
  ds_read_b128 a[168:171], v1 offset:55296
  v_mfma_f32_16x16x32_bf16 v[220:223], a[196:199], v[44:47], v[220:223]
  s_waitcnt lgkmcnt(3)
  v_mfma_f32_16x16x32_bf16 v[224:227], a[200:203], v[32:35], v[224:227]
  s_waitcnt vmcnt(20) lgkmcnt(1)
  s_barrier
  v_mfma_f32_16x16x32_bf16 v[228:231], a[200:203], v[36:39], v[228:231]
  v_mul_f32_e32 v20, s25, v20
  v_mul_f32_e32 v21, s25, v21
  v_mfma_f32_16x16x32_bf16 v[232:235], a[200:203], v[40:43], v[232:235]
  v_exp_f32_e32 v20, v20
  v_mfma_f32_16x16x32_bf16 v[236:239], a[200:203], v[44:47], v[236:239]
  ds_read_b64_tr_b16 a[232:233], v3 offset:24576
  v_mul_f32_e32 v22, s25, v22
  v_mfma_f32_16x16x32_bf16 v[24:27], a[144:147], a[96:99], 0
  v_exp_f32_e32 v21, v21
  v_mfma_f32_16x16x32_bf16 v[24:27], a[148:151], a[100:103], v[24:27]
  s_add_u32 m0, s27, 111104
  v_mul_f32_e32 v23, s25, v23
  v_cvt_pk_bf16_f32 v62, v20, v21
  v_mfma_f32_16x16x32_bf16 v[24:27], a[152:155], a[104:107], v[24:27]
  buffer_load_dwordx4 v7, s[12:15], s68 offen offset:0 nt lds
  v_mfma_f32_16x16x32_bf16 v[24:27], a[156:159], a[108:111], v[24:27]
  v_exp_f32_e32 v22, v22
  v_mfma_f32_16x16x32_bf16 v[24:27], a[160:163], a[112:115], v[24:27]
  ds_read_b128 a[172:175], v2 offset:55296
  ds_read_b64_tr_b16 a[234:235], v3 offset:30720
  v_mfma_f32_16x16x32_bf16 v[24:27], a[164:167], a[116:119], v[24:27]
  v_exp_f32_e32 v23, v23
  v_mfma_f32_16x16x32_bf16 v[240:243], a[204:207], v[32:35], v[240:243]
  ds_read_b64_tr_b16 a[236:237], v4 offset:24576
  v_cvt_pk_bf16_f32 v63, v22, v23
  v_mfma_f32_16x16x32_bf16 v[244:247], a[204:207], v[36:39], v[244:247]
  ds_read_b64_tr_b16 a[238:239], v4 offset:30720
  v_mfma_f32_16x16x32_bf16 v[248:251], a[204:207], v[40:43], v[248:251]
  v_mfma_f32_16x16x32_bf16 v[252:255], a[204:207], v[44:47], v[252:255]
  v_mul_f32_e32 v24, s25, v24
  v_mul_f32_e32 v25, s25, v25
  v_smfmac_f32_16x16x64_bf16 a[216:219], a[224:227], v[48:55], v0
  ds_read_b128 a[176:179], v1 offset:55424
  v_smfmac_f32_16x16x64_bf16 a[220:223], a[224:227], v[56:63], v0
  v_mul_f32_e32 v26, s25, v26
  v_mfma_f32_16x16x32_bf16 v[28:31], a[144:147], a[120:123], 0
  buffer_load_dwordx4 v8, s[12:15], s68 offen offset:1024 nt lds
  v_mfma_f32_16x16x32_bf16 v[28:31], a[148:151], a[124:127], v[28:31]
  v_exp_f32_e32 v24, v24
  v_mfma_f32_16x16x32_bf16 v[28:31], a[152:155], a[128:131], v[28:31]
  v_exp_f32_e32 v25, v25
  v_mfma_f32_16x16x32_bf16 v[28:31], a[156:159], a[132:135], v[28:31]
  ds_read_b64_tr_b16 a[240:241], v5 offset:24576
  v_mul_f32_e32 v27, s25, v27
  v_mfma_f32_16x16x32_bf16 v[28:31], a[160:163], a[136:139], v[28:31]
  v_exp_f32_e32 v26, v26
  v_mfma_f32_16x16x32_bf16 v[28:31], a[164:167], a[140:143], v[28:31]
  s_waitcnt lgkmcnt(2)
  ds_read_b64_tr_b16 a[242:243], v5 offset:30720
  v_cvt_pk_bf16_f32 v32, v24, v25
  v_mfma_f32_16x16x32_bf16 v[64:67], a[232:235], v[48:51], v[64:67]
  v_exp_f32_e32 v27, v27
  v_mfma_f32_16x16x32_bf16 v[68:71], a[232:235], v[52:55], v[68:71]
  buffer_load_dwordx4 v9, s[12:15], s68 offen offset:2048 nt lds
  v_mfma_f32_16x16x32_bf16 v[72:75], a[232:235], v[56:59], v[72:75]
  ds_read_b64_tr_b16 a[244:245], v6 offset:24576
  v_cvt_pk_bf16_f32 v33, v26, v27
  v_mfma_f32_16x16x32_bf16 v[76:79], a[232:235], v[60:63], v[76:79]
  ds_read_b128 a[180:183], v2 offset:55424
  v_mul_f32_e32 v28, s25, v28
  v_mfma_f32_16x16x32_bf16 v[80:83], a[236:239], v[48:51], v[80:83]
  ds_read_b64_tr_b16 a[246:247], v6 offset:30720
  v_mul_f32_e32 v29, s25, v29
  v_mfma_f32_16x16x32_bf16 v[84:87], a[236:239], v[52:55], v[84:87]
  v_exp_f32_e32 v28, v28
  v_mfma_f32_16x16x32_bf16 v[88:91], a[236:239], v[56:59], v[88:91]
  v_mul_f32_e32 v30, s25, v30
  v_mul_f32_e32 v31, s25, v31
  v_mfma_f32_16x16x32_bf16 v[20:23], a[144:147], a[0:3], 0
  s_add_u32 m0, s27, 86528
  v_exp_f32_e32 v29, v29
  v_mfma_f32_16x16x32_bf16 v[20:23], a[148:151], a[4:7], v[20:23]
  buffer_load_dwordx4 v7, s[12:15], s69 offen offset:0 nt lds
  v_mfma_f32_16x16x32_bf16 v[20:23], a[152:155], a[8:11], v[20:23]
  v_exp_f32_e32 v30, v30
  v_mfma_f32_16x16x32_bf16 v[20:23], a[156:159], a[12:15], v[20:23]
  ds_read_b128 a[184:187], v1 offset:55552
  v_cvt_pk_bf16_f32 v36, v28, v29
  v_mfma_f32_16x16x32_bf16 v[20:23], a[160:163], a[16:19], v[20:23]
  v_exp_f32_e32 v31, v31
  v_mfma_f32_16x16x32_bf16 v[20:23], a[164:167], a[20:23], v[20:23]
  ds_read_b64_tr_b16 a[248:249], v3 offset:24704
  v_cvt_pk_bf16_f32 v37, v30, v31
  v_mfma_f32_16x16x32_bf16 v[92:95], a[236:239], v[60:63], v[92:95]
  s_waitcnt lgkmcnt(2)
  s_add_u32 m0, s27, 0
  ds_read_b64_tr_b16 a[250:251], v3 offset:30848
  v_mfma_f32_16x16x32_bf16 v[96:99], a[240:243], v[48:51], v[96:99]
  ds_write_addtid_b32 v10 offset:0
  ds_write_addtid_b32 v12 offset:256
  ds_write_addtid_b32 v14 offset:512
  ds_write_addtid_b32 v16 offset:768
  v_mfma_f32_16x16x32_bf16 v[100:103], a[240:243], v[52:55], v[100:103]
  s_add_u32 m0, s27, 86528
  v_accvgpr_read_b32 v10, a92
  v_accvgpr_read_b32 v12, a93
  v_mfma_f32_16x16x32_bf16 v[104:107], a[240:243], v[56:59], v[104:107]
  buffer_load_dwordx4 v8, s[12:15], s69 offen offset:1024 nt lds
  v_mfma_f32_16x16x32_bf16 v[108:111], a[240:243], v[60:63], v[108:111]
  ds_read_b128 a[188:191], v2 offset:55552
  v_mul_f32_e32 v20, s25, v20
  v_mfma_f32_16x16x32_bf16 v[112:115], a[244:247], v[48:51], v[112:115]
  v_mul_f32_e32 v21, s25, v21
  v_mul_f32_e32 v22, s25, v22
  v_mfma_f32_16x16x32_bf16 v[24:27], a[144:147], a[24:27], 0
  v_exp_f32_e32 v20, v20
  v_mfma_f32_16x16x32_bf16 v[24:27], a[148:151], a[28:31], v[24:27]
  v_exp_f32_e32 v21, v21
  v_mfma_f32_16x16x32_bf16 v[24:27], a[152:155], a[32:35], v[24:27]
  ds_read_b64_tr_b16 a[252:253], v4 offset:24704
  v_mul_f32_e32 v23, s25, v23
  v_mfma_f32_16x16x32_bf16 v[24:27], a[156:159], a[36:39], v[24:27]
  v_exp_f32_e32 v22, v22
  v_mfma_f32_16x16x32_bf16 v[24:27], a[160:163], a[40:43], v[24:27]
  ds_read_b64_tr_b16 a[254:255], v4 offset:30848
  v_cvt_pk_bf16_f32 v40, v20, v21
  v_mfma_f32_16x16x32_bf16 v[24:27], a[164:167], a[44:47], v[24:27]
  buffer_load_dwordx4 v9, s[12:15], s69 offen offset:2048 nt lds
  v_mfma_f32_16x16x32_bf16 v[116:119], a[244:247], v[52:55], v[116:119]
  v_exp_f32_e32 v23, v23
  v_mfma_f32_16x16x32_bf16 v[120:123], a[244:247], v[56:59], v[120:123]
  ds_read_b64_tr_b16 a[192:193], v5 offset:24704
  v_cvt_pk_bf16_f32 v41, v22, v23
  v_mfma_f32_16x16x32_bf16 v[124:127], a[244:247], v[60:63], v[124:127]
  s_waitcnt lgkmcnt(3)
  ds_read_b128 a[144:147], v1 offset:0
  ds_read_b64_tr_b16 a[194:195], v5 offset:30848
  v_mfma_f32_16x16x32_bf16 v[128:131], a[248:251], v[48:51], v[128:131]
  v_mul_f32_e32 v24, s25, v24
  v_mul_f32_e32 v25, s25, v25
  v_mfma_f32_16x16x32_bf16 v[132:135], a[248:251], v[52:55], v[132:135]
  v_exp_f32_e32 v24, v24
  v_mfma_f32_16x16x32_bf16 v[136:139], a[248:251], v[56:59], v[136:139]
  v_mul_f32_e32 v26, s25, v26
  v_mul_f32_e32 v27, s25, v27
  v_mfma_f32_16x16x32_bf16 v[28:31], a[168:171], a[96:99], 0
  v_exp_f32_e32 v25, v25
  v_mfma_f32_16x16x32_bf16 v[28:31], a[172:175], a[100:103], v[28:31]
  v_exp_f32_e32 v26, v26
  v_mfma_f32_16x16x32_bf16 v[28:31], a[176:179], a[104:107], v[28:31]
  ds_read_b128 a[148:151], v2 offset:0
  v_cvt_pk_bf16_f32 v44, v24, v25
  v_mfma_f32_16x16x32_bf16 v[28:31], a[180:183], a[108:111], v[28:31]
  v_exp_f32_e32 v27, v27
  v_mfma_f32_16x16x32_bf16 v[28:31], a[184:187], a[112:115], v[28:31]
  ds_read_b64_tr_b16 a[196:197], v6 offset:24704
  v_cvt_pk_bf16_f32 v45, v26, v27
  v_mfma_f32_16x16x32_bf16 v[28:31], a[188:191], a[116:119], v[28:31]
  buffer_store_dwordx4 a[52:55], v18, s[20:23], s74 offen offset:3072 sc1 nt
  v_mfma_f32_16x16x32_bf16 v[140:143], a[248:251], v[60:63], v[140:143]
  s_waitcnt lgkmcnt(2)
  ds_read_b64_tr_b16 a[198:199], v6 offset:30848
  v_accvgpr_read_b32 v14, a94
  v_mfma_f32_16x16x32_bf16 v[144:147], a[252:255], v[48:51], v[144:147]
  s_add_u32 m0, s27, 0
  v_accvgpr_read_b32 v16, a95
  v_mfma_f32_16x16x32_bf16 v[148:151], a[252:255], v[52:55], v[148:151]
  ds_write_addtid_b32 v10 offset:12320
  ds_write_addtid_b32 v12 offset:12576
  ds_write_addtid_b32 v14 offset:12832
  ds_write_addtid_b32 v16 offset:13088
  v_mfma_f32_16x16x32_bf16 v[152:155], a[252:255], v[56:59], v[152:155]
  v_mul_f32_e32 v28, s25, v28
  v_mul_f32_e32 v29, s25, v29
  v_mfma_f32_16x16x32_bf16 v[156:159], a[252:255], v[60:63], v[156:159]
  v_exp_f32_e32 v28, v28
  v_mfma_f32_16x16x32_bf16 v[160:163], a[192:195], v[48:51], v[160:163]
  ds_read_b128 a[152:155], v1 offset:128
  v_mul_f32_e32 v30, s25, v30
  v_mfma_f32_16x16x32_bf16 v[20:23], a[168:171], a[120:123], 0
  v_exp_f32_e32 v29, v29
  v_mfma_f32_16x16x32_bf16 v[20:23], a[172:175], a[124:127], v[20:23]
  ds_read_b64_tr_b16 a[200:201], v3 offset:24832
  v_mul_f32_e32 v31, s25, v31
  v_mfma_f32_16x16x32_bf16 v[20:23], a[176:179], a[128:131], v[20:23]
  v_exp_f32_e32 v30, v30
  v_mfma_f32_16x16x32_bf16 v[20:23], a[180:183], a[132:135], v[20:23]
  v_exp_f32_e32 v31, v31
  v_mfma_f32_16x16x32_bf16 v[20:23], a[184:187], a[136:139], v[20:23]
  ds_read_b64_tr_b16 a[202:203], v3 offset:30976
  v_cvt_pk_bf16_f32 v34, v28, v29
  v_mfma_f32_16x16x32_bf16 v[20:23], a[188:191], a[140:143], v[20:23]
  ds_read_b64_tr_b16 a[204:205], v4 offset:24832
  v_cvt_pk_bf16_f32 v35, v30, v31
  v_mfma_f32_16x16x32_bf16 v[164:167], a[192:195], v[52:55], v[164:167]
  ds_read_b128 a[156:159], v2 offset:128
  v_mfma_f32_16x16x32_bf16 v[168:171], a[192:195], v[56:59], v[168:171]
  buffer_store_dwordx4 a[56:59], v18, s[20:23], s75 offen offset:0 sc1 nt
  v_mfma_f32_16x16x32_bf16 v[172:175], a[192:195], v[60:63], v[172:175]
  s_waitcnt lgkmcnt(4)
  ds_read_b64_tr_b16 a[206:207], v4 offset:30976
  v_mfma_f32_16x16x32_bf16 v[176:179], a[196:199], v[48:51], v[176:179]
  v_mul_f32_e32 v20, s25, v20
  v_mul_f32_e32 v21, s25, v21
  v_mfma_f32_16x16x32_bf16 v[180:183], a[196:199], v[52:55], v[180:183]
  v_exp_f32_e32 v20, v20
  v_mfma_f32_16x16x32_bf16 v[184:187], a[196:199], v[56:59], v[184:187]
  v_mul_f32_e32 v22, s25, v22
  v_mul_f32_e32 v23, s25, v23
  v_mfma_f32_16x16x32_bf16 v[188:191], a[196:199], v[60:63], v[188:191]
  v_exp_f32_e32 v21, v21
  v_mfma_f32_16x16x32_bf16 v[24:27], a[168:171], a[0:3], 0
  v_exp_f32_e32 v22, v22
  v_mfma_f32_16x16x32_bf16 v[24:27], a[172:175], a[4:7], v[24:27]
  ds_read_b128 a[160:163], v1 offset:256
  v_cvt_pk_bf16_f32 v38, v20, v21
  v_mfma_f32_16x16x32_bf16 v[24:27], a[176:179], a[8:11], v[24:27]
  v_exp_f32_e32 v23, v23
  v_mfma_f32_16x16x32_bf16 v[24:27], a[180:183], a[12:15], v[24:27]
  ds_read_b64_tr_b16 a[232:233], v5 offset:24832
  v_cvt_pk_bf16_f32 v39, v22, v23
  v_mfma_f32_16x16x32_bf16 v[24:27], a[184:187], a[16:19], v[24:27]
  ds_read2st64_b32 a[88:89], v11 offset0:0 offset1:1
  v_mfma_f32_16x16x32_bf16 v[24:27], a[188:191], a[20:23], v[24:27]
  s_waitcnt lgkmcnt(3)
  ds_read_b64_tr_b16 a[234:235], v5 offset:30976
  v_mfma_f32_16x16x32_bf16 v[192:195], a[200:203], v[48:51], v[192:195]
  ds_read2st64_b32 a[90:91], v13 offset0:0 offset1:1
  v_mfma_f32_16x16x32_bf16 v[196:199], a[200:203], v[52:55], v[196:199]
  ds_read2st64_b32 a[92:93], v15 offset0:0 offset1:1
  v_mfma_f32_16x16x32_bf16 v[200:203], a[200:203], v[56:59], v[200:203]
  ds_read2st64_b32 a[94:95], v17 offset0:0 offset1:1
  v_mfma_f32_16x16x32_bf16 v[204:207], a[200:203], v[60:63], v[204:207]
  ds_read_b128 a[164:167], v2 offset:256
  v_mul_f32_e32 v24, s25, v24
  v_mfma_f32_16x16x32_bf16 v[208:211], a[204:207], v[48:51], v[208:211]
  v_mul_f32_e32 v25, s25, v25
  v_mul_f32_e32 v26, s25, v26
  v_mfma_f32_16x16x32_bf16 v[212:215], a[204:207], v[52:55], v[212:215]
  v_exp_f32_e32 v24, v24
  v_mfma_f32_16x16x32_bf16 v[28:31], a[168:171], a[24:27], 0
  v_exp_f32_e32 v25, v25
  v_mfma_f32_16x16x32_bf16 v[28:31], a[172:175], a[28:31], v[28:31]
  ds_read_b64_tr_b16 a[236:237], v6 offset:24832
  v_mul_f32_e32 v27, s25, v27
  v_mfma_f32_16x16x32_bf16 v[28:31], a[176:179], a[32:35], v[28:31]
  v_exp_f32_e32 v26, v26
  v_mfma_f32_16x16x32_bf16 v[28:31], a[180:183], a[36:39], v[28:31]
  ds_read_b64_tr_b16 a[238:239], v6 offset:30976
  v_cvt_pk_bf16_f32 v42, v24, v25
  v_mfma_f32_16x16x32_bf16 v[28:31], a[184:187], a[40:43], v[28:31]
  v_exp_f32_e32 v27, v27
  v_mfma_f32_16x16x32_bf16 v[28:31], a[188:191], a[44:47], v[28:31]
  v_cvt_pk_bf16_f32 v43, v26, v27
  v_mfma_f32_16x16x32_bf16 v[216:219], a[204:207], v[56:59], v[216:219]
  ds_read_b128 a[168:171], v1 offset:6144
  v_mfma_f32_16x16x32_bf16 v[220:223], a[204:207], v[60:63], v[220:223]
  s_waitcnt lgkmcnt(3)
  v_mfma_f32_16x16x32_bf16 v[224:227], a[232:235], v[48:51], v[224:227]
  s_waitcnt vmcnt(20) lgkmcnt(1)
  s_barrier
  v_mfma_f32_16x16x32_bf16 v[228:231], a[232:235], v[52:55], v[228:231]
  v_mul_f32_e32 v28, s25, v28
  v_mul_f32_e32 v29, s25, v29
  v_mfma_f32_16x16x32_bf16 v[232:235], a[232:235], v[56:59], v[232:235]
  v_exp_f32_e32 v28, v28
  v_mfma_f32_16x16x32_bf16 v[236:239], a[232:235], v[60:63], v[236:239]
  ds_read_b64_tr_b16 a[240:241], v3 offset:36864
  v_mul_f32_e32 v30, s25, v30
  v_mfma_f32_16x16x32_bf16 v[20:23], a[144:147], a[96:99], 0
  v_exp_f32_e32 v29, v29
  v_mfma_f32_16x16x32_bf16 v[20:23], a[148:151], a[100:103], v[20:23]
  s_add_u32 m0, s27, 123392
  v_mul_f32_e32 v31, s25, v31
  v_cvt_pk_bf16_f32 v46, v28, v29
  v_mfma_f32_16x16x32_bf16 v[20:23], a[152:155], a[104:107], v[20:23]
  buffer_load_dwordx4 v7, s[12:15], s70 offen offset:0 nt lds
  v_mfma_f32_16x16x32_bf16 v[20:23], a[156:159], a[108:111], v[20:23]
  v_exp_f32_e32 v30, v30
  v_mfma_f32_16x16x32_bf16 v[20:23], a[160:163], a[112:115], v[20:23]
  ds_read_b128 a[172:175], v2 offset:6144
  ds_read_b64_tr_b16 a[242:243], v3 offset:43008
  v_mfma_f32_16x16x32_bf16 v[20:23], a[164:167], a[116:119], v[20:23]
  v_exp_f32_e32 v31, v31
  v_mfma_f32_16x16x32_bf16 v[240:243], a[236:239], v[48:51], v[240:243]
  ds_read_b64_tr_b16 a[244:245], v4 offset:36864
  v_cvt_pk_bf16_f32 v47, v30, v31
  v_mfma_f32_16x16x32_bf16 v[244:247], a[236:239], v[52:55], v[244:247]
  ds_read_b64_tr_b16 a[246:247], v4 offset:43008
  v_mfma_f32_16x16x32_bf16 v[248:251], a[236:239], v[56:59], v[248:251]
  v_mfma_f32_16x16x32_bf16 v[252:255], a[236:239], v[60:63], v[252:255]
  v_mul_f32_e32 v20, s25, v20
  v_mul_f32_e32 v21, s25, v21
  v_smfmac_f32_16x16x64_bf16 a[216:219], a[224:227], v[32:39], v0
  ds_read_b128 a[176:179], v1 offset:6272
  v_smfmac_f32_16x16x64_bf16 a[220:223], a[224:227], v[40:47], v0
  v_mul_f32_e32 v22, s25, v22
  v_mfma_f32_16x16x32_bf16 v[24:27], a[144:147], a[120:123], 0
  buffer_load_dwordx4 v8, s[12:15], s70 offen offset:1024 nt lds
  v_mfma_f32_16x16x32_bf16 v[24:27], a[148:151], a[124:127], v[24:27]
  v_exp_f32_e32 v20, v20
  v_mfma_f32_16x16x32_bf16 v[24:27], a[152:155], a[128:131], v[24:27]
  v_exp_f32_e32 v21, v21
  v_mfma_f32_16x16x32_bf16 v[24:27], a[156:159], a[132:135], v[24:27]
  ds_read_b64_tr_b16 a[248:249], v5 offset:36864
  v_mul_f32_e32 v23, s25, v23
  v_mfma_f32_16x16x32_bf16 v[24:27], a[160:163], a[136:139], v[24:27]
  v_exp_f32_e32 v22, v22
  v_mfma_f32_16x16x32_bf16 v[24:27], a[164:167], a[140:143], v[24:27]
  s_waitcnt lgkmcnt(2)
  ds_read_b64_tr_b16 a[250:251], v5 offset:43008
  v_cvt_pk_bf16_f32 v48, v20, v21
  v_mfma_f32_16x16x32_bf16 v[64:67], a[240:243], v[32:35], v[64:67]
  v_exp_f32_e32 v23, v23
  v_mfma_f32_16x16x32_bf16 v[68:71], a[240:243], v[36:39], v[68:71]
  buffer_load_dwordx4 v9, s[12:15], s70 offen offset:2048 nt lds
  v_mfma_f32_16x16x32_bf16 v[72:75], a[240:243], v[40:43], v[72:75]
  ds_read_b64_tr_b16 a[252:253], v6 offset:36864
  v_cvt_pk_bf16_f32 v49, v22, v23
  v_mfma_f32_16x16x32_bf16 v[76:79], a[240:243], v[44:47], v[76:79]
  ds_read_b128 a[180:183], v2 offset:6272
  v_mul_f32_e32 v24, s25, v24
  v_mfma_f32_16x16x32_bf16 v[80:83], a[244:247], v[32:35], v[80:83]
  ds_read_b64_tr_b16 a[254:255], v6 offset:43008
  v_mul_f32_e32 v25, s25, v25
  v_mfma_f32_16x16x32_bf16 v[84:87], a[244:247], v[36:39], v[84:87]
  v_exp_f32_e32 v24, v24
  v_mfma_f32_16x16x32_bf16 v[88:91], a[244:247], v[40:43], v[88:91]
  v_mul_f32_e32 v26, s25, v26
  v_mul_f32_e32 v27, s25, v27
  v_mfma_f32_16x16x32_bf16 v[28:31], a[144:147], a[0:3], 0
  s_add_u32 m0, s27, 98816
  v_exp_f32_e32 v25, v25
  v_mfma_f32_16x16x32_bf16 v[28:31], a[148:151], a[4:7], v[28:31]
  buffer_load_dwordx4 v7, s[12:15], s71 offen offset:0 nt lds
  v_mfma_f32_16x16x32_bf16 v[28:31], a[152:155], a[8:11], v[28:31]
  v_exp_f32_e32 v26, v26
  v_mfma_f32_16x16x32_bf16 v[28:31], a[156:159], a[12:15], v[28:31]
  ds_read_b128 a[184:187], v1 offset:6400
  v_cvt_pk_bf16_f32 v52, v24, v25
  v_mfma_f32_16x16x32_bf16 v[28:31], a[160:163], a[16:19], v[28:31]
  v_exp_f32_e32 v27, v27
  v_mfma_f32_16x16x32_bf16 v[28:31], a[164:167], a[20:23], v[28:31]
  ds_read_b64_tr_b16 a[192:193], v3 offset:36992
  v_cvt_pk_bf16_f32 v53, v26, v27
  v_mfma_f32_16x16x32_bf16 v[92:95], a[244:247], v[44:47], v[92:95]
  s_waitcnt lgkmcnt(2)
  ds_read_b64_tr_b16 a[194:195], v3 offset:43136
  v_mfma_f32_16x16x32_bf16 v[96:99], a[248:251], v[32:35], v[96:99]
  v_mfma_f32_16x16x32_bf16 v[100:103], a[248:251], v[36:39], v[100:103]
  v_mfma_f32_16x16x32_bf16 v[104:107], a[248:251], v[40:43], v[104:107]
  buffer_load_dwordx4 v8, s[12:15], s71 offen offset:1024 nt lds
  v_mfma_f32_16x16x32_bf16 v[108:111], a[248:251], v[44:47], v[108:111]
  ds_read_b128 a[188:191], v2 offset:6400
  v_subrev_u32_e32 v1, 0x6100, v1
  v_mfma_f32_16x16x32_bf16 v[112:115], a[252:255], v[32:35], v[112:115]
  v_subrev_u32_e32 v2, 0x6100, v2
  v_mul_f32_e32 v28, s25, v28
  v_mfma_f32_16x16x32_bf16 v[20:23], a[144:147], a[24:27], 0
  ds_read_b64_tr_b16 a[196:197], v4 offset:36992
  v_mul_f32_e32 v29, s25, v29
  v_mfma_f32_16x16x32_bf16 v[20:23], a[148:151], a[28:31], v[20:23]
  v_exp_f32_e32 v28, v28
  v_mfma_f32_16x16x32_bf16 v[20:23], a[152:155], a[32:35], v[20:23]
  v_mul_f32_e32 v30, s25, v30
  v_mul_f32_e32 v31, s25, v31
  v_mfma_f32_16x16x32_bf16 v[20:23], a[156:159], a[36:39], v[20:23]
  v_exp_f32_e32 v29, v29
  v_mfma_f32_16x16x32_bf16 v[20:23], a[160:163], a[40:43], v[20:23]
  v_exp_f32_e32 v30, v30
  v_mfma_f32_16x16x32_bf16 v[20:23], a[164:167], a[44:47], v[20:23]
  ds_read_b64_tr_b16 a[198:199], v4 offset:43136
  v_cvt_pk_bf16_f32 v56, v28, v29
  v_mfma_f32_16x16x32_bf16 v[116:119], a[252:255], v[36:39], v[116:119]
  buffer_load_dwordx4 v9, s[12:15], s71 offen offset:2048 nt lds
  v_mfma_f32_16x16x32_bf16 v[120:123], a[252:255], v[40:43], v[120:123]
  v_exp_f32_e32 v31, v31
  v_mfma_f32_16x16x32_bf16 v[124:127], a[252:255], v[44:47], v[124:127]
  s_waitcnt lgkmcnt(1)
  ds_read_b64_tr_b16 a[200:201], v5 offset:36992
  v_cvt_pk_bf16_f32 v57, v30, v31
  v_mfma_f32_16x16x32_bf16 v[128:131], a[192:195], v[32:35], v[128:131]
  ds_read_b128 a[144:147], v1 offset:37120
  v_mul_f32_e32 v20, s25, v20
  v_mfma_f32_16x16x32_bf16 v[132:135], a[192:195], v[36:39], v[132:135]
  ds_read_b64_tr_b16 a[202:203], v5 offset:43136
  v_mul_f32_e32 v21, s25, v21
  v_mfma_f32_16x16x32_bf16 v[136:139], a[192:195], v[40:43], v[136:139]
  v_exp_f32_e32 v20, v20
  v_mfma_f32_16x16x32_bf16 v[24:27], a[168:171], a[96:99], 0
  v_mul_f32_e32 v22, s25, v22
  v_mul_f32_e32 v23, s25, v23
  v_mfma_f32_16x16x32_bf16 v[24:27], a[172:175], a[100:103], v[24:27]
  v_exp_f32_e32 v21, v21
  v_mfma_f32_16x16x32_bf16 v[24:27], a[176:179], a[104:107], v[24:27]
  v_exp_f32_e32 v22, v22
  v_mfma_f32_16x16x32_bf16 v[24:27], a[180:183], a[108:111], v[24:27]
  ds_read_b128 a[148:151], v2 offset:37120
  v_cvt_pk_bf16_f32 v60, v20, v21
  v_mfma_f32_16x16x32_bf16 v[24:27], a[184:187], a[112:115], v[24:27]
  v_exp_f32_e32 v23, v23
  v_mfma_f32_16x16x32_bf16 v[24:27], a[188:191], a[116:119], v[24:27]
  ds_read_b64_tr_b16 a[204:205], v6 offset:36992
  v_cvt_pk_bf16_f32 v61, v22, v23
  v_mfma_f32_16x16x32_bf16 v[140:143], a[192:195], v[44:47], v[140:143]
  s_waitcnt lgkmcnt(2)
  ds_read_b64_tr_b16 a[206:207], v6 offset:43136
  v_mfma_f32_16x16x32_bf16 v[144:147], a[196:199], v[32:35], v[144:147]
  buffer_store_dwordx4 a[60:63], v18, s[20:23], s75 offen offset:3072 sc1 nt
  v_mfma_f32_16x16x32_bf16 v[148:151], a[196:199], v[36:39], v[148:151]
  v_mfma_f32_16x16x32_bf16 v[152:155], a[196:199], v[40:43], v[152:155]
  v_mul_f32_e32 v24, s25, v24
  v_mul_f32_e32 v25, s25, v25
  v_mfma_f32_16x16x32_bf16 v[156:159], a[196:199], v[44:47], v[156:159]
  v_exp_f32_e32 v24, v24
  v_mfma_f32_16x16x32_bf16 v[160:163], a[200:203], v[32:35], v[160:163]
  ds_read_b128 a[152:155], v1 offset:37248
  v_mul_f32_e32 v26, s25, v26
  v_mfma_f32_16x16x32_bf16 v[28:31], a[168:171], a[120:123], 0
  v_exp_f32_e32 v25, v25
  v_mfma_f32_16x16x32_bf16 v[28:31], a[172:175], a[124:127], v[28:31]
  ds_read_b64_tr_b16 a[232:233], v3 offset:37120
  v_mul_f32_e32 v27, s25, v27
  v_mfma_f32_16x16x32_bf16 v[28:31], a[176:179], a[128:131], v[28:31]
  v_exp_f32_e32 v26, v26
  v_mfma_f32_16x16x32_bf16 v[28:31], a[180:183], a[132:135], v[28:31]
  v_exp_f32_e32 v27, v27
  v_mfma_f32_16x16x32_bf16 v[28:31], a[184:187], a[136:139], v[28:31]
  ds_read_b64_tr_b16 a[234:235], v3 offset:43264
  v_cvt_pk_bf16_f32 v50, v24, v25
  v_mfma_f32_16x16x32_bf16 v[28:31], a[188:191], a[140:143], v[28:31]
  ds_read_b64_tr_b16 a[236:237], v4 offset:37120
  v_cvt_pk_bf16_f32 v51, v26, v27
  v_mfma_f32_16x16x32_bf16 v[164:167], a[200:203], v[36:39], v[164:167]
  ds_read_b128 a[156:159], v2 offset:37248
  v_mfma_f32_16x16x32_bf16 v[168:171], a[200:203], v[40:43], v[168:171]
  buffer_store_dwordx4 a[64:67], v18, s[20:23], s74 offen offset:128 sc1 nt
  v_mfma_f32_16x16x32_bf16 v[172:175], a[200:203], v[44:47], v[172:175]
  s_waitcnt lgkmcnt(4)
  ds_read_b64_tr_b16 a[238:239], v4 offset:43264
  v_mfma_f32_16x16x32_bf16 v[176:179], a[204:207], v[32:35], v[176:179]
  v_mul_f32_e32 v28, s25, v28
  v_mul_f32_e32 v29, s25, v29
  v_mfma_f32_16x16x32_bf16 v[180:183], a[204:207], v[36:39], v[180:183]
  v_exp_f32_e32 v28, v28
  v_mfma_f32_16x16x32_bf16 v[184:187], a[204:207], v[40:43], v[184:187]
  v_mul_f32_e32 v30, s25, v30
  v_mul_f32_e32 v31, s25, v31
  v_mfma_f32_16x16x32_bf16 v[188:191], a[204:207], v[44:47], v[188:191]
  v_exp_f32_e32 v29, v29
  v_mfma_f32_16x16x32_bf16 v[20:23], a[168:171], a[0:3], 0
  v_exp_f32_e32 v30, v30
  v_mfma_f32_16x16x32_bf16 v[20:23], a[172:175], a[4:7], v[20:23]
  ds_read_b128 a[160:163], v1 offset:37376
  v_cvt_pk_bf16_f32 v54, v28, v29
  v_mfma_f32_16x16x32_bf16 v[20:23], a[176:179], a[8:11], v[20:23]
  v_exp_f32_e32 v31, v31
  v_mfma_f32_16x16x32_bf16 v[20:23], a[180:183], a[12:15], v[20:23]
  ds_read_b64_tr_b16 a[240:241], v5 offset:37120
  v_cvt_pk_bf16_f32 v55, v30, v31
  v_mfma_f32_16x16x32_bf16 v[20:23], a[184:187], a[16:19], v[20:23]
  v_mfma_f32_16x16x32_bf16 v[20:23], a[188:191], a[20:23], v[20:23]
  s_waitcnt lgkmcnt(2)
  ds_read_b64_tr_b16 a[242:243], v5 offset:43264
  v_mfma_f32_16x16x32_bf16 v[192:195], a[232:235], v[32:35], v[192:195]
  v_mfma_f32_16x16x32_bf16 v[196:199], a[232:235], v[36:39], v[196:199]
  v_mfma_f32_16x16x32_bf16 v[200:203], a[232:235], v[40:43], v[200:203]
  v_mfma_f32_16x16x32_bf16 v[204:207], a[232:235], v[44:47], v[204:207]
  ds_read_b128 a[164:167], v2 offset:37376
  s_nop 0
  v_mul_f32_e32 v20, s25, v20
  v_mfma_f32_16x16x32_bf16 v[208:211], a[236:239], v[32:35], v[208:211]
  v_mul_f32_e32 v21, s25, v21
  v_mul_f32_e32 v22, s25, v22
  v_mfma_f32_16x16x32_bf16 v[212:215], a[236:239], v[36:39], v[212:215]
  v_exp_f32_e32 v20, v20
  v_mfma_f32_16x16x32_bf16 v[24:27], a[168:171], a[24:27], 0
  v_exp_f32_e32 v21, v21
  v_mfma_f32_16x16x32_bf16 v[24:27], a[172:175], a[28:31], v[24:27]
  ds_read_b64_tr_b16 a[244:245], v6 offset:37120
  v_mul_f32_e32 v23, s25, v23
  v_mfma_f32_16x16x32_bf16 v[24:27], a[176:179], a[32:35], v[24:27]
  v_exp_f32_e32 v22, v22
  v_mfma_f32_16x16x32_bf16 v[24:27], a[180:183], a[36:39], v[24:27]
  ds_read_b64_tr_b16 a[246:247], v6 offset:43264
  v_cvt_pk_bf16_f32 v58, v20, v21
  v_mfma_f32_16x16x32_bf16 v[24:27], a[184:187], a[40:43], v[24:27]
  v_exp_f32_e32 v23, v23
  v_mfma_f32_16x16x32_bf16 v[24:27], a[188:191], a[44:47], v[24:27]
  ds_read_b128 a[168:171], v1 offset:43264
  v_cvt_pk_bf16_f32 v59, v22, v23
  v_mfma_f32_16x16x32_bf16 v[216:219], a[236:239], v[40:43], v[216:219]
  v_mfma_f32_16x16x32_bf16 v[220:223], a[236:239], v[44:47], v[220:223]
  s_waitcnt lgkmcnt(3)
  v_mfma_f32_16x16x32_bf16 v[224:227], a[240:243], v[32:35], v[224:227]
  s_waitcnt vmcnt(18)
  s_barrier
  ds_read_b128 a[172:175], v2 offset:43264
  v_mfma_f32_16x16x32_bf16 v[228:231], a[240:243], v[36:39], v[228:231]
  v_mul_f32_e32 v24, s25, v24
  v_mul_f32_e32 v25, s25, v25
  v_mfma_f32_16x16x32_bf16 v[232:235], a[240:243], v[40:43], v[232:235]
  v_exp_f32_e32 v24, v24
  v_mfma_f32_16x16x32_bf16 v[236:239], a[240:243], v[44:47], v[236:239]
  ds_read_b64_tr_b16 a[248:249], v3 offset:49152
  v_mul_f32_e32 v26, s25, v26
  v_mfma_f32_16x16x32_bf16 v[28:31], a[144:147], a[96:99], 0
  v_exp_f32_e32 v25, v25
  v_mfma_f32_16x16x32_bf16 v[28:31], a[148:151], a[100:103], v[28:31]
  ds_read_b128 a[176:179], v1 offset:43392
  v_mul_f32_e32 v27, s25, v27
  v_mfma_f32_16x16x32_bf16 v[28:31], a[152:155], a[104:107], v[28:31]
  v_exp_f32_e32 v26, v26
  v_mfma_f32_16x16x32_bf16 v[28:31], a[156:159], a[108:111], v[28:31]
  ds_read_b64_tr_b16 a[250:251], v3 offset:55296
  v_cvt_pk_bf16_f32 v62, v24, v25
  v_mfma_f32_16x16x32_bf16 v[28:31], a[160:163], a[112:115], v[28:31]
  v_exp_f32_e32 v27, v27
  v_mfma_f32_16x16x32_bf16 v[28:31], a[164:167], a[116:119], v[28:31]
  s_waitcnt lgkmcnt(3)
  ds_read_b64_tr_b16 a[252:253], v4 offset:49152
  v_cvt_pk_bf16_f32 v63, v26, v27
  v_mfma_f32_16x16x32_bf16 v[240:243], a[244:247], v[32:35], v[240:243]
L_tr11:
  s_cbranch_execz L_tr15
  ds_read_b128 a[180:183], v2 offset:43392
  v_mfma_f32_16x16x32_bf16 v[244:247], a[244:247], v[36:39], v[244:247]
  ds_read_b64_tr_b16 a[254:255], v4 offset:55296
  v_mfma_f32_16x16x32_bf16 v[248:251], a[244:247], v[40:43], v[248:251]
  ds_read_b128 a[184:187], v1 offset:43520
  v_mfma_f32_16x16x32_bf16 v[252:255], a[244:247], v[44:47], v[252:255]
  v_mul_f32_e32 v28, s25, v28
  v_mul_f32_e32 v29, s25, v29
  v_smfmac_f32_16x16x64_bf16 a[216:219], a[224:227], v[48:55], v0
  v_mul_f32_e32 v30, s25, v30
  v_smfmac_f32_16x16x64_bf16 a[220:223], a[224:227], v[56:63], v0
  v_mul_f32_e32 v31, s25, v31
  v_mfma_f32_16x16x32_bf16 v[20:23], a[144:147], a[120:123], 0
  v_exp_f32_e32 v28, v28
  v_mfma_f32_16x16x32_bf16 v[20:23], a[148:151], a[124:127], v[20:23]
  v_exp_f32_e32 v29, v29
  v_mfma_f32_16x16x32_bf16 v[20:23], a[152:155], a[128:131], v[20:23]
  ds_read_b128 a[188:191], v2 offset:43520
  v_cvt_pk_bf16_f32 v32, v28, v29
  v_mfma_f32_16x16x32_bf16 v[20:23], a[156:159], a[132:135], v[20:23]
  v_exp_f32_e32 v30, v30
  v_mfma_f32_16x16x32_bf16 v[20:23], a[160:163], a[136:139], v[20:23]
  ds_read_b128 a[144:147], v1 offset:49408
  ds_read_b64_tr_b16 a[192:193], v5 offset:49152
  v_mfma_f32_16x16x32_bf16 v[20:23], a[164:167], a[140:143], v[20:23]
  s_waitcnt lgkmcnt(3)
  v_exp_f32_e32 v31, v31
  v_mfma_f32_16x16x32_bf16 v[64:67], a[248:251], v[48:51], v[64:67]
  ds_read_b64_tr_b16 a[194:195], v5 offset:55296
  v_cvt_pk_bf16_f32 v33, v30, v31
  v_mfma_f32_16x16x32_bf16 v[68:71], a[248:251], v[52:55], v[68:71]
  ds_read_b64_tr_b16 a[196:197], v6 offset:49152
  v_mfma_f32_16x16x32_bf16 v[72:75], a[248:251], v[56:59], v[72:75]
  ds_read_b128 a[148:151], v2 offset:49408
  v_mfma_f32_16x16x32_bf16 v[76:79], a[248:251], v[60:63], v[76:79]
  ds_read_b64_tr_b16 a[198:199], v6 offset:55296
  v_mul_f32_e32 v20, s25, v20
  v_mfma_f32_16x16x32_bf16 v[80:83], a[252:255], v[48:51], v[80:83]
  v_mul_f32_e32 v21, s25, v21
  v_mul_f32_e32 v22, s25, v22
  v_mfma_f32_16x16x32_bf16 v[84:87], a[252:255], v[52:55], v[84:87]
  v_exp_f32_e32 v20, v20
  v_mfma_f32_16x16x32_bf16 v[88:91], a[252:255], v[56:59], v[88:91]
  v_exp_f32_e32 v21, v21
  v_mfma_f32_16x16x32_bf16 v[24:27], a[168:171], a[96:99], 0
  ds_read_b128 a[152:155], v1 offset:49536
  v_mul_f32_e32 v23, s25, v23
  v_mfma_f32_16x16x32_bf16 v[24:27], a[172:175], a[100:103], v[24:27]
  v_exp_f32_e32 v22, v22
  v_mfma_f32_16x16x32_bf16 v[24:27], a[176:179], a[104:107], v[24:27]
  ds_read_b64_tr_b16 a[200:201], v3 offset:49280
  v_cvt_pk_bf16_f32 v36, v20, v21
  v_mfma_f32_16x16x32_bf16 v[24:27], a[180:183], a[108:111], v[24:27]
  v_exp_f32_e32 v23, v23
  v_mfma_f32_16x16x32_bf16 v[24:27], a[184:187], a[112:115], v[24:27]
  s_waitcnt lgkmcnt(2)
  ds_read_b128 a[156:159], v2 offset:49536
  v_cvt_pk_bf16_f32 v37, v22, v23
  v_mfma_f32_16x16x32_bf16 v[24:27], a[188:191], a[116:119], v[24:27]
  v_mfma_f32_16x16x32_bf16 v[92:95], a[252:255], v[60:63], v[92:95]
  ds_read_b64_tr_b16 a[202:203], v3 offset:55424
  v_mfma_f32_16x16x32_bf16 v[96:99], a[192:195], v[48:51], v[96:99]
  ds_read_b128 a[160:163], v1 offset:49664
  v_mfma_f32_16x16x32_bf16 v[100:103], a[192:195], v[52:55], v[100:103]
  v_mfma_f32_16x16x32_bf16 v[104:107], a[192:195], v[56:59], v[104:107]
  s_nop 1
  v_mul_f32_e32 v24, s25, v24
  v_mul_f32_e32 v25, s25, v25
  v_mfma_f32_16x16x32_bf16 v[108:111], a[192:195], v[60:63], v[108:111]
  v_exp_f32_e32 v24, v24
  v_mfma_f32_16x16x32_bf16 v[112:115], a[196:199], v[48:51], v[112:115]
  ds_read_b128 a[164:167], v2 offset:49664
  v_mul_f32_e32 v26, s25, v26
  v_mfma_f32_16x16x32_bf16 v[28:31], a[168:171], a[120:123], 0
  v_exp_f32_e32 v25, v25
  v_mfma_f32_16x16x32_bf16 v[28:31], a[172:175], a[124:127], v[28:31]
  ds_read_b64_tr_b16 a[204:205], v4 offset:49280
  v_mul_f32_e32 v27, s25, v27
  v_mfma_f32_16x16x32_bf16 v[28:31], a[176:179], a[128:131], v[28:31]
  v_exp_f32_e32 v26, v26
  v_mfma_f32_16x16x32_bf16 v[28:31], a[180:183], a[132:135], v[28:31]
  v_exp_f32_e32 v27, v27
  v_mfma_f32_16x16x32_bf16 v[28:31], a[184:187], a[136:139], v[28:31]
  ds_read_b128 a[168:171], v1 offset:55552
  v_cvt_pk_bf16_f32 v34, v24, v25
  v_mfma_f32_16x16x32_bf16 v[28:31], a[188:191], a[140:143], v[28:31]
  ds_read_b64_tr_b16 a[206:207], v4 offset:55424
  v_cvt_pk_bf16_f32 v35, v26, v27
  v_mfma_f32_16x16x32_bf16 v[116:119], a[196:199], v[52:55], v[116:119]
  ds_read_b64_tr_b16 a[232:233], v5 offset:49280
  v_mfma_f32_16x16x32_bf16 v[120:123], a[196:199], v[56:59], v[120:123]
  v_mfma_f32_16x16x32_bf16 v[124:127], a[196:199], v[60:63], v[124:127]
  s_waitcnt lgkmcnt(4)
  ds_read_b128 a[172:175], v2 offset:55552
  ds_read_b64_tr_b16 a[234:235], v5 offset:55424
  v_mfma_f32_16x16x32_bf16 v[128:131], a[200:203], v[48:51], v[128:131]
  v_mul_f32_e32 v28, s25, v28
  v_mul_f32_e32 v29, s25, v29
  v_mfma_f32_16x16x32_bf16 v[132:135], a[200:203], v[52:55], v[132:135]
  v_exp_f32_e32 v28, v28
  v_mfma_f32_16x16x32_bf16 v[136:139], a[200:203], v[56:59], v[136:139]
  v_mul_f32_e32 v30, s25, v30
  v_mul_f32_e32 v31, s25, v31
  v_mfma_f32_16x16x32_bf16 v[20:23], a[144:147], a[96:99], 0
  v_exp_f32_e32 v29, v29
  v_mfma_f32_16x16x32_bf16 v[20:23], a[148:151], a[100:103], v[20:23]
  ds_read_b128 a[176:179], v1 offset:55680
  v_cvt_pk_bf16_f32 v38, v28, v29
  v_mfma_f32_16x16x32_bf16 v[20:23], a[152:155], a[104:107], v[20:23]
  v_exp_f32_e32 v30, v30
  v_mfma_f32_16x16x32_bf16 v[20:23], a[156:159], a[108:111], v[20:23]
  v_exp_f32_e32 v31, v31
  v_mfma_f32_16x16x32_bf16 v[20:23], a[160:163], a[112:115], v[20:23]
  ds_read_b64_tr_b16 a[236:237], v6 offset:49280
  v_cvt_pk_bf16_f32 v39, v30, v31
  v_mfma_f32_16x16x32_bf16 v[20:23], a[164:167], a[116:119], v[20:23]
  ds_read_b128 a[180:183], v2 offset:55680
  v_mfma_f32_16x16x32_bf16 v[140:143], a[200:203], v[60:63], v[140:143]
  s_waitcnt lgkmcnt(3)
  ds_read_b64_tr_b16 a[238:239], v6 offset:55424
  v_mfma_f32_16x16x32_bf16 v[144:147], a[204:207], v[48:51], v[144:147]
  buffer_store_dwordx4 a[68:71], v18, s[20:23], s74 offen offset:3200 sc1 nt
  v_mfma_f32_16x16x32_bf16 v[148:151], a[204:207], v[52:55], v[148:151]
  ds_read_b128 a[184:187], v1 offset:55808
  v_mfma_f32_16x16x32_bf16 v[152:155], a[204:207], v[56:59], v[152:155]
  v_mul_f32_e32 v20, s25, v20
  v_mul_f32_e32 v21, s25, v21
  v_mfma_f32_16x16x32_bf16 v[156:159], a[204:207], v[60:63], v[156:159]
  v_exp_f32_e32 v20, v20
  v_mfma_f32_16x16x32_bf16 v[160:163], a[232:235], v[48:51], v[160:163]
  v_mul_f32_e32 v22, s25, v22
  v_mul_f32_e32 v23, s25, v23
  v_mfma_f32_16x16x32_bf16 v[24:27], a[144:147], a[120:123], 0
  v_exp_f32_e32 v21, v21
  v_mfma_f32_16x16x32_bf16 v[24:27], a[148:151], a[124:127], v[24:27]
  ds_read_b128 a[188:191], v2 offset:55808
  v_cvt_pk_bf16_f32 v40, v20, v21
  v_mfma_f32_16x16x32_bf16 v[24:27], a[152:155], a[128:131], v[24:27]
  v_exp_f32_e32 v22, v22
  v_mfma_f32_16x16x32_bf16 v[24:27], a[156:159], a[132:135], v[24:27]
  v_exp_f32_e32 v23, v23
  v_mfma_f32_16x16x32_bf16 v[24:27], a[160:163], a[136:139], v[24:27]
  ds_read_b64_tr_b16 a[240:241], v3 offset:49408
  v_cvt_pk_bf16_f32 v41, v22, v23
  v_mfma_f32_16x16x32_bf16 v[24:27], a[164:167], a[140:143], v[24:27]
  ds_read_b128 a[144:147], v1 offset:0
  ds_read_b64_tr_b16 a[242:243], v3 offset:55552
  v_mfma_f32_16x16x32_bf16 v[164:167], a[232:235], v[52:55], v[164:167]
  ds_read_b64_tr_b16 a[244:245], v4 offset:49408
  v_mfma_f32_16x16x32_bf16 v[168:171], a[232:235], v[56:59], v[168:171]
  buffer_store_dwordx4 a[72:75], v18, s[20:23], s75 offen offset:128 sc1 nt
  v_mfma_f32_16x16x32_bf16 v[172:175], a[232:235], v[60:63], v[172:175]
  s_waitcnt lgkmcnt(5)
  ds_read_b128 a[148:151], v2 offset:0
  ds_read_b64_tr_b16 a[246:247], v4 offset:55552
  v_mfma_f32_16x16x32_bf16 v[176:179], a[236:239], v[48:51], v[176:179]
  v_mul_f32_e32 v24, s25, v24
  v_mul_f32_e32 v25, s25, v25
  v_mfma_f32_16x16x32_bf16 v[180:183], a[236:239], v[52:55], v[180:183]
  v_exp_f32_e32 v24, v24
  v_mfma_f32_16x16x32_bf16 v[184:187], a[236:239], v[56:59], v[184:187]
  v_mul_f32_e32 v26, s25, v26
  v_mul_f32_e32 v27, s25, v27
  v_mfma_f32_16x16x32_bf16 v[188:191], a[236:239], v[60:63], v[188:191]
  v_exp_f32_e32 v25, v25
  v_mfma_f32_16x16x32_bf16 v[28:31], a[168:171], a[96:99], 0
  ds_read_b128 a[152:155], v1 offset:128
  v_cvt_pk_bf16_f32 v44, v24, v25
  v_mfma_f32_16x16x32_bf16 v[28:31], a[172:175], a[100:103], v[28:31]
  v_exp_f32_e32 v26, v26
  v_mfma_f32_16x16x32_bf16 v[28:31], a[176:179], a[104:107], v[28:31]
  v_exp_f32_e32 v27, v27
  v_mfma_f32_16x16x32_bf16 v[28:31], a[180:183], a[108:111], v[28:31]
  ds_read_b64_tr_b16 a[248:249], v5 offset:49408
  v_cvt_pk_bf16_f32 v45, v26, v27
  v_mfma_f32_16x16x32_bf16 v[28:31], a[184:187], a[112:115], v[28:31]
  s_waitcnt lgkmcnt(2)
  ds_read_b128 a[156:159], v2 offset:128
  v_mfma_f32_16x16x32_bf16 v[28:31], a[188:191], a[116:119], v[28:31]
  ds_read_b64_tr_b16 a[250:251], v5 offset:55552
  v_mfma_f32_16x16x32_bf16 v[192:195], a[240:243], v[48:51], v[192:195]
  buffer_store_dwordx4 a[76:79], v18, s[20:23], s75 offen offset:3200 sc1 nt
  v_mfma_f32_16x16x32_bf16 v[196:199], a[240:243], v[52:55], v[196:199]
  ds_read_b128 a[160:163], v1 offset:256
  v_mfma_f32_16x16x32_bf16 v[200:203], a[240:243], v[56:59], v[200:203]
  v_mfma_f32_16x16x32_bf16 v[204:207], a[240:243], v[60:63], v[204:207]
  s_nop 0
  v_mul_f32_e32 v28, s25, v28
  v_mul_f32_e32 v29, s25, v29
  v_mfma_f32_16x16x32_bf16 v[208:211], a[244:247], v[48:51], v[208:211]
  v_exp_f32_e32 v28, v28
  v_mfma_f32_16x16x32_bf16 v[212:215], a[244:247], v[52:55], v[212:215]
  ds_read_b128 a[164:167], v2 offset:256
  v_mul_f32_e32 v30, s25, v30
  v_mfma_f32_16x16x32_bf16 v[20:23], a[168:171], a[120:123], 0
  v_exp_f32_e32 v29, v29
  v_mfma_f32_16x16x32_bf16 v[20:23], a[172:175], a[124:127], v[20:23]
  ds_read_b64_tr_b16 a[252:253], v6 offset:49408
  v_mul_f32_e32 v31, s25, v31
  v_mfma_f32_16x16x32_bf16 v[20:23], a[176:179], a[128:131], v[20:23]
  v_exp_f32_e32 v30, v30
  v_mfma_f32_16x16x32_bf16 v[20:23], a[180:183], a[132:135], v[20:23]
  ds_read_b64_tr_b16 a[254:255], v6 offset:55552
  v_subrev_u32_e32 v3, 0x3000, v3
  v_mfma_f32_16x16x32_bf16 v[20:23], a[184:187], a[136:139], v[20:23]
  ds_read_b128 a[168:171], v1 offset:6144
  v_subrev_u32_e32 v4, 0x3000, v4
  v_mfma_f32_16x16x32_bf16 v[20:23], a[188:191], a[140:143], v[20:23]
  v_subrev_u32_e32 v5, 0x3000, v5
  v_subrev_u32_e32 v6, 0x3000, v6
  v_mfma_f32_16x16x32_bf16 v[216:219], a[244:247], v[56:59], v[216:219]
  v_exp_f32_e32 v31, v31
  v_mfma_f32_16x16x32_bf16 v[220:223], a[244:247], v[60:63], v[220:223]
  s_waitcnt lgkmcnt(3)
  v_cvt_pk_bf16_f32 v42, v28, v29
  v_cvt_pk_bf16_f32 v43, v30, v31
  v_mfma_f32_16x16x32_bf16 v[224:227], a[248:251], v[48:51], v[224:227]
  s_waitcnt vmcnt(13)
  s_barrier
  ds_read_b128 a[172:175], v2 offset:6144
  v_mfma_f32_16x16x32_bf16 v[228:231], a[248:251], v[52:55], v[228:231]
  v_mul_f32_e32 v20, s25, v20
  v_mul_f32_e32 v21, s25, v21
  v_mfma_f32_16x16x32_bf16 v[232:235], a[248:251], v[56:59], v[232:235]
  v_exp_f32_e32 v20, v20
  v_mfma_f32_16x16x32_bf16 v[236:239], a[248:251], v[60:63], v[236:239]
  ds_read_b64_tr_b16 a[192:193], v3 offset:24576
  v_mul_f32_e32 v22, s25, v22
  v_mfma_f32_16x16x32_bf16 v[24:27], a[144:147], a[96:99], 0
  v_exp_f32_e32 v21, v21
  v_mfma_f32_16x16x32_bf16 v[24:27], a[148:151], a[100:103], v[24:27]
  ds_read_b128 a[176:179], v1 offset:6272
  v_mul_f32_e32 v23, s25, v23
  v_mfma_f32_16x16x32_bf16 v[24:27], a[152:155], a[104:107], v[24:27]
  v_exp_f32_e32 v22, v22
  v_mfma_f32_16x16x32_bf16 v[24:27], a[156:159], a[108:111], v[24:27]
  ds_read_b64_tr_b16 a[194:195], v3 offset:30720
  v_cvt_pk_bf16_f32 v46, v20, v21
  v_mfma_f32_16x16x32_bf16 v[24:27], a[160:163], a[112:115], v[24:27]
  ds_read_b64_tr_b16 a[196:197], v3 offset:0
  ds_read_b64_tr_b16 a[198:199], v3 offset:6144
  v_mfma_f32_16x16x32_bf16 v[24:27], a[164:167], a[116:119], v[24:27]
  s_waitcnt lgkmcnt(5)
  v_exp_f32_e32 v23, v23
  v_mfma_f32_16x16x32_bf16 v[240:243], a[252:255], v[48:51], v[240:243]
  ds_read_b64_tr_b16 a[200:201], v4 offset:24576
  v_cvt_pk_bf16_f32 v47, v22, v23
  v_mfma_f32_16x16x32_bf16 v[244:247], a[252:255], v[52:55], v[244:247]
  ds_read_b128 a[180:183], v2 offset:6272
  ds_read_b64_tr_b16 a[202:203], v4 offset:30720
  v_mfma_f32_16x16x32_bf16 v[248:251], a[252:255], v[56:59], v[248:251]
  ds_read_b128 a[184:187], v1 offset:6400
  ds_read_b64_tr_b16 a[204:205], v4 offset:0
  v_mfma_f32_16x16x32_bf16 v[252:255], a[252:255], v[60:63], v[252:255]
  ds_read_b64_tr_b16 a[206:207], v4 offset:6144
  v_mul_f32_e32 v24, s25, v24
  v_smfmac_f32_16x16x64_bf16 a[216:219], a[224:227], v[32:39], v0
  v_mul_f32_e32 v25, s25, v25
  v_smfmac_f32_16x16x64_bf16 a[216:219], a[224:227], v[40:47], v0
  v_mul_f32_e32 v26, s25, v26
  v_mfma_f32_16x16x32_bf16 v[28:31], a[144:147], a[120:123], 0
  v_exp_f32_e32 v24, v24
  v_mfma_f32_16x16x32_bf16 v[28:31], a[148:151], a[124:127], v[28:31]
  v_exp_f32_e32 v25, v25
  v_mfma_f32_16x16x32_bf16 v[28:31], a[152:155], a[128:131], v[28:31]
  ds_read_b128 a[188:191], v2 offset:6400
  v_mul_f32_e32 v27, s25, v27
  v_mfma_f32_16x16x32_bf16 v[28:31], a[156:159], a[132:135], v[28:31]
  v_exp_f32_e32 v26, v26
  v_mfma_f32_16x16x32_bf16 v[28:31], a[160:163], a[136:139], v[28:31]
  ds_read_b64_tr_b16 a[232:233], v5 offset:24576
  v_cvt_pk_bf16_f32 v48, v24, v25
  v_mfma_f32_16x16x32_bf16 v[28:31], a[164:167], a[140:143], v[28:31]
  s_waitcnt lgkmcnt(2)
  v_exp_f32_e32 v27, v27
  v_mfma_f32_16x16x32_bf16 v[64:67], a[192:195], v[32:35], v[64:67]
  ds_read_b64_tr_b16 a[234:235], v5 offset:30720
  v_cvt_pk_bf16_f32 v49, v26, v27
  v_mfma_f32_16x16x32_bf16 v[68:71], a[192:195], v[36:39], v[68:71]
  ds_read_b128 a[144:147], v1 offset:12288
  ds_read_b64_tr_b16 a[236:237], v5 offset:0
  v_mfma_f32_16x16x32_bf16 v[64:67], a[196:199], v[40:43], v[64:67]
  ds_read_b64_tr_b16 a[238:239], v5 offset:6144
  ds_read_b64_tr_b16 a[240:241], v6 offset:24576
  v_mfma_f32_16x16x32_bf16 v[68:71], a[196:199], v[44:47], v[68:71]
  ds_read_b128 a[148:151], v2 offset:12288
  v_mul_f32_e32 v28, s25, v28
  v_mfma_f32_16x16x32_bf16 v[80:83], a[200:203], v[32:35], v[80:83]
  ds_read_b64_tr_b16 a[242:243], v6 offset:30720
  v_mul_f32_e32 v29, s25, v29
  v_mfma_f32_16x16x32_bf16 v[84:87], a[200:203], v[36:39], v[84:87]
  v_exp_f32_e32 v28, v28
  v_mfma_f32_16x16x32_bf16 v[80:83], a[204:207], v[40:43], v[80:83]
  ds_read_b128 a[152:155], v1 offset:12416
  v_mul_f32_e32 v30, s25, v30
  v_mfma_f32_16x16x32_bf16 v[20:23], a[168:171], a[96:99], 0
  v_exp_f32_e32 v29, v29
  v_mfma_f32_16x16x32_bf16 v[20:23], a[172:175], a[100:103], v[20:23]
  ds_read_b64_tr_b16 a[244:245], v6 offset:0
  v_mul_f32_e32 v31, s25, v31
  v_mfma_f32_16x16x32_bf16 v[20:23], a[176:179], a[104:107], v[20:23]
  v_exp_f32_e32 v30, v30
  v_mfma_f32_16x16x32_bf16 v[20:23], a[180:183], a[108:111], v[20:23]
  ds_read_b64_tr_b16 a[246:247], v6 offset:6144
  v_cvt_pk_bf16_f32 v52, v28, v29
  v_mfma_f32_16x16x32_bf16 v[20:23], a[184:187], a[112:115], v[20:23]
  s_waitcnt lgkmcnt(4)
  v_exp_f32_e32 v31, v31
  v_mfma_f32_16x16x32_bf16 v[20:23], a[188:191], a[116:119], v[20:23]
  ds_read_b64_tr_b16 a[248:249], v3 offset:24704
  v_cvt_pk_bf16_f32 v53, v30, v31
  v_mfma_f32_16x16x32_bf16 v[84:87], a[204:207], v[44:47], v[84:87]
  ds_read_b128 a[156:159], v2 offset:12416
  ds_read_b64_tr_b16 a[250:251], v3 offset:30848
  v_mfma_f32_16x16x32_bf16 v[96:99], a[232:235], v[32:35], v[96:99]
  ds_read_b128 a[160:163], v1 offset:12544
  ds_read_b64_tr_b16 a[252:253], v3 offset:128
  v_mfma_f32_16x16x32_bf16 v[100:103], a[232:235], v[36:39], v[100:103]
  ds_read_b64_tr_b16 a[254:255], v3 offset:6272
  v_mfma_f32_16x16x32_bf16 v[96:99], a[236:239], v[40:43], v[96:99]
  v_mul_f32_e32 v20, s25, v20
  v_mul_f32_e32 v21, s25, v21
  v_mfma_f32_16x16x32_bf16 v[100:103], a[236:239], v[44:47], v[100:103]
  s_waitcnt lgkmcnt(7)
  v_exp_f32_e32 v20, v20
  v_mfma_f32_16x16x32_bf16 v[112:115], a[240:243], v[32:35], v[112:115]
  ds_read_b128 a[164:167], v2 offset:12544
  v_mul_f32_e32 v22, s25, v22
  v_mfma_f32_16x16x32_bf16 v[24:27], a[168:171], a[120:123], 0
  v_exp_f32_e32 v21, v21
  v_mfma_f32_16x16x32_bf16 v[24:27], a[172:175], a[124:127], v[24:27]
  ds_read_b64_tr_b16 a[192:193], v4 offset:24704
  v_mul_f32_e32 v23, s25, v23
  v_mfma_f32_16x16x32_bf16 v[24:27], a[176:179], a[128:131], v[24:27]
  v_exp_f32_e32 v22, v22
  v_mfma_f32_16x16x32_bf16 v[24:27], a[180:183], a[132:135], v[24:27]
  ds_read_b64_tr_b16 a[194:195], v4 offset:30848
  v_cvt_pk_bf16_f32 v50, v20, v21
  v_mfma_f32_16x16x32_bf16 v[24:27], a[184:187], a[136:139], v[24:27]
  ds_read_b128 a[168:171], v1 offset:18432
  ds_read_b64_tr_b16 a[196:197], v4 offset:128
  v_mfma_f32_16x16x32_bf16 v[24:27], a[188:191], a[140:143], v[24:27]
  v_exp_f32_e32 v23, v23
  v_mfma_f32_16x16x32_bf16 v[116:119], a[240:243], v[36:39], v[116:119]
  s_waitcnt lgkmcnt(5)
  ds_read_b64_tr_b16 a[198:199], v4 offset:6272
  v_cvt_pk_bf16_f32 v51, v22, v23
  v_mfma_f32_16x16x32_bf16 v[112:115], a[244:247], v[40:43], v[112:115]
  ds_read_b64_tr_b16 a[200:201], v5 offset:24704
  v_mfma_f32_16x16x32_bf16 v[116:119], a[244:247], v[44:47], v[116:119]
  ds_read_b128 a[172:175], v2 offset:18432
  ds_read_b64_tr_b16 a[202:203], v5 offset:30848
  v_mfma_f32_16x16x32_bf16 v[128:131], a[248:251], v[32:35], v[128:131]
  v_mul_f32_e32 v24, s25, v24
  v_mul_f32_e32 v25, s25, v25
  v_mfma_f32_16x16x32_bf16 v[132:135], a[248:251], v[36:39], v[132:135]
  v_exp_f32_e32 v24, v24
  v_mfma_f32_16x16x32_bf16 v[128:131], a[252:255], v[40:43], v[128:131]
  v_mul_f32_e32 v26, s25, v26
  v_mul_f32_e32 v27, s25, v27
  v_mfma_f32_16x16x32_bf16 v[28:31], a[144:147], a[96:99], 0
  v_exp_f32_e32 v25, v25
  v_mfma_f32_16x16x32_bf16 v[28:31], a[148:151], a[100:103], v[28:31]
  ds_read_b128 a[176:179], v1 offset:18560
  v_cvt_pk_bf16_f32 v54, v24, v25
  v_mfma_f32_16x16x32_bf16 v[28:31], a[152:155], a[104:107], v[28:31]
  ds_read_b64_tr_b16 a[204:205], v5 offset:128
  ds_read_b64_tr_b16 a[206:207], v5 offset:6272
  v_mfma_f32_16x16x32_bf16 v[28:31], a[156:159], a[108:111], v[28:31]
  v_exp_f32_e32 v26, v26
  v_mfma_f32_16x16x32_bf16 v[28:31], a[160:163], a[112:115], v[28:31]
  s_waitcnt lgkmcnt(3)
  ds_read_b128 a[180:183], v2 offset:18560
  ds_read_b64_tr_b16 a[232:233], v6 offset:24704
  v_mfma_f32_16x16x32_bf16 v[28:31], a[164:167], a[116:119], v[28:31]
  v_exp_f32_e32 v27, v27
  v_mfma_f32_16x16x32_bf16 v[132:135], a[252:255], v[44:47], v[132:135]
  ds_read_b64_tr_b16 a[234:235], v6 offset:30848
  v_cvt_pk_bf16_f32 v55, v26, v27
  v_mfma_f32_16x16x32_bf16 v[144:147], a[192:195], v[32:35], v[144:147]
  ds_read_b64_tr_b16 a[236:237], v6 offset:128
  ds_read_b64_tr_b16 a[238:239], v6 offset:6272
  v_mfma_f32_16x16x32_bf16 v[148:151], a[192:195], v[36:39], v[148:151]
  ds_read_b128 a[184:187], v1 offset:18688
  v_mfma_f32_16x16x32_bf16 v[144:147], a[196:199], v[40:43], v[144:147]
  v_mul_f32_e32 v28, s25, v28
  v_mul_f32_e32 v29, s25, v29
  v_mfma_f32_16x16x32_bf16 v[148:151], a[196:199], v[44:47], v[148:151]
  v_exp_f32_e32 v28, v28
  v_mfma_f32_16x16x32_bf16 v[160:163], a[200:203], v[32:35], v[160:163]
  v_mul_f32_e32 v30, s25, v30
  v_mul_f32_e32 v31, s25, v31
  v_mfma_f32_16x16x32_bf16 v[20:23], a[144:147], a[120:123], 0
  v_exp_f32_e32 v29, v29
  v_mfma_f32_16x16x32_bf16 v[20:23], a[148:151], a[124:127], v[20:23]
  ds_read_b128 a[188:191], v2 offset:18688
  v_cvt_pk_bf16_f32 v56, v28, v29
  v_mfma_f32_16x16x32_bf16 v[20:23], a[152:155], a[128:131], v[20:23]
  ds_read_b64_tr_b16 a[240:241], v3 offset:24832
  ds_read_b64_tr_b16 a[242:243], v3 offset:30976
  v_mfma_f32_16x16x32_bf16 v[20:23], a[156:159], a[132:135], v[20:23]
  v_exp_f32_e32 v30, v30
  v_mfma_f32_16x16x32_bf16 v[20:23], a[160:163], a[136:139], v[20:23]
  buffer_store_dwordx4 a[80:83], v18, s[20:23], s74 offen offset:256 sc1 nt
  v_mfma_f32_16x16x32_bf16 v[20:23], a[164:167], a[140:143], v[20:23]
  ds_read_b128 a[144:147], v1 offset:37120
  ds_read_b64_tr_b16 a[244:245], v3 offset:256
  v_mfma_f32_16x16x32_bf16 v[164:167], a[200:203], v[36:39], v[164:167]
  s_waitcnt lgkmcnt(5)
  v_exp_f32_e32 v31, v31
  v_mfma_f32_16x16x32_bf16 v[160:163], a[204:207], v[40:43], v[160:163]
  ds_read_b64_tr_b16 a[246:247], v3 offset:6400
  v_cvt_pk_bf16_f32 v57, v30, v31
  v_mfma_f32_16x16x32_bf16 v[164:167], a[204:207], v[44:47], v[164:167]
  ds_read_b64_tr_b16 a[248:249], v4 offset:24832
  ds_read_b64_tr_b16 a[250:251], v4 offset:30976
  v_mfma_f32_16x16x32_bf16 v[176:179], a[232:235], v[32:35], v[176:179]
  ds_read_b128 a[148:151], v2 offset:37120
  v_mul_f32_e32 v20, s25, v20
  v_mfma_f32_16x16x32_bf16 v[180:183], a[232:235], v[36:39], v[180:183]
  v_mul_f32_e32 v21, s25, v21
  v_mul_f32_e32 v22, s25, v22
  v_mfma_f32_16x16x32_bf16 v[176:179], a[236:239], v[40:43], v[176:179]
  v_exp_f32_e32 v20, v20
  v_mfma_f32_16x16x32_bf16 v[180:183], a[236:239], v[44:47], v[180:183]
  v_exp_f32_e32 v21, v21
  v_mfma_f32_16x16x32_bf16 v[24:27], a[168:171], a[96:99], 0
  ds_read_b128 a[152:155], v1 offset:37248
  v_mul_f32_e32 v23, s25, v23
  v_mfma_f32_16x16x32_bf16 v[24:27], a[172:175], a[100:103], v[24:27]
  ds_read_b64_tr_b16 a[252:253], v4 offset:256
  v_cvt_pk_bf16_f32 v60, v20, v21
  v_mfma_f32_16x16x32_bf16 v[24:27], a[176:179], a[104:107], v[24:27]
  v_exp_f32_e32 v22, v22
  v_mfma_f32_16x16x32_bf16 v[24:27], a[180:183], a[108:111], v[24:27]
  buffer_store_dwordx4 a[84:87], v18, s[20:23], s74 offen offset:3328 sc1 nt
  v_mfma_f32_16x16x32_bf16 v[24:27], a[184:187], a[112:115], v[24:27]
  s_waitcnt lgkmcnt(2)
  ds_read_b64_tr_b16 a[254:255], v4 offset:6400
  ds_read_b64_tr_b16 a[192:193], v5 offset:24832
  v_mfma_f32_16x16x32_bf16 v[24:27], a[188:191], a[116:119], v[24:27]
  v_exp_f32_e32 v23, v23
  v_mfma_f32_16x16x32_bf16 v[192:195], a[240:243], v[32:35], v[192:195]
  ds_read_b128 a[156:159], v2 offset:37248
  v_cvt_pk_bf16_f32 v61, v22, v23
  v_mfma_f32_16x16x32_bf16 v[196:199], a[240:243], v[36:39], v[196:199]
  ds_read_b64_tr_b16 a[194:195], v5 offset:30976
  ds_read_b64_tr_b16 a[196:197], v5 offset:256
  v_mfma_f32_16x16x32_bf16 v[192:195], a[244:247], v[40:43], v[192:195]
  ds_read_b128 a[160:163], v1 offset:37376
  ds_read_b64_tr_b16 a[198:199], v5 offset:6400
  v_mfma_f32_16x16x32_bf16 v[196:199], a[244:247], v[44:47], v[196:199]
  v_mul_f32_e32 v24, s25, v24
  v_mul_f32_e32 v25, s25, v25
  v_mfma_f32_16x16x32_bf16 v[208:211], a[248:251], v[32:35], v[208:211]
  v_exp_f32_e32 v24, v24
  v_mfma_f32_16x16x32_bf16 v[212:215], a[248:251], v[36:39], v[212:215]
  ds_read_b128 a[164:167], v2 offset:37376
  v_mul_f32_e32 v26, s25, v26
  v_mfma_f32_16x16x32_bf16 v[28:31], a[168:171], a[120:123], 0
  v_exp_f32_e32 v25, v25
  v_mfma_f32_16x16x32_bf16 v[28:31], a[172:175], a[124:127], v[28:31]
  ds_read_b64_tr_b16 a[200:201], v6 offset:24832
  v_mul_f32_e32 v27, s25, v27
  v_mfma_f32_16x16x32_bf16 v[28:31], a[176:179], a[128:131], v[28:31]
  v_exp_f32_e32 v26, v26
  v_mfma_f32_16x16x32_bf16 v[28:31], a[180:183], a[132:135], v[28:31]
  buffer_store_dwordx4 a[88:91], v18, s[20:23], s75 offen offset:256 sc1 nt
  v_mfma_f32_16x16x32_bf16 v[28:31], a[184:187], a[136:139], v[28:31]
  ds_read_b64_tr_b16 a[202:203], v6 offset:30976
  v_cvt_pk_bf16_f32 v58, v24, v25
  v_mfma_f32_16x16x32_bf16 v[28:31], a[188:191], a[140:143], v[28:31]
  s_waitcnt lgkmcnt(3)
  ds_read_b64_tr_b16 a[204:205], v6 offset:256
  ds_read_b64_tr_b16 a[206:207], v6 offset:6400
  v_mfma_f32_16x16x32_bf16 v[208:211], a[252:255], v[40:43], v[208:211]
  v_exp_f32_e32 v27, v27
  v_mfma_f32_16x16x32_bf16 v[212:215], a[252:255], v[44:47], v[212:215]
  ds_read_b128 a[168:171], v1 offset:43264
  v_cvt_pk_bf16_f32 v59, v26, v27
  v_mfma_f32_16x16x32_bf16 v[224:227], a[192:195], v[32:35], v[224:227]
  s_waitcnt vmcnt(8)
  s_barrier
  ds_read_b128 a[172:175], v2 offset:43264
  v_mfma_f32_16x16x32_bf16 v[228:231], a[192:195], v[36:39], v[228:231]
  v_mul_f32_e32 v28, s25, v28
  v_mul_f32_e32 v29, s25, v29
  v_mfma_f32_16x16x32_bf16 v[224:227], a[196:199], v[40:43], v[224:227]
  v_exp_f32_e32 v28, v28
  v_mfma_f32_16x16x32_bf16 v[228:231], a[196:199], v[44:47], v[228:231]
  ds_read_b64_tr_b16 a[232:233], v3 offset:36864
  v_mul_f32_e32 v30, s25, v30
  v_mfma_f32_16x16x32_bf16 v[20:23], a[144:147], a[0:3], 0
  v_exp_f32_e32 v29, v29
  v_mfma_f32_16x16x32_bf16 v[20:23], a[148:151], a[4:7], v[20:23]
  ds_read_b128 a[176:179], v1 offset:43392
  v_mul_f32_e32 v31, s25, v31
  v_mfma_f32_16x16x32_bf16 v[20:23], a[152:155], a[8:11], v[20:23]
  v_exp_f32_e32 v30, v30
  v_mfma_f32_16x16x32_bf16 v[20:23], a[156:159], a[12:15], v[20:23]
  buffer_store_dwordx4 a[92:95], v18, s[20:23], s75 offen offset:3328 sc1 nt
  v_mfma_f32_16x16x32_bf16 v[20:23], a[160:163], a[16:19], v[20:23]
  s_waitcnt lgkmcnt(2)
  ds_read_b64_tr_b16 a[234:235], v3 offset:43008
  v_cvt_pk_bf16_f32 v62, v28, v29
  v_mfma_f32_16x16x32_bf16 v[20:23], a[164:167], a[20:23], v[20:23]
  ds_read_b64_tr_b16 a[236:237], v3 offset:12288
  ds_read_b64_tr_b16 a[238:239], v3 offset:18432
  v_mfma_f32_16x16x32_bf16 v[240:243], a[200:203], v[32:35], v[240:243]
  v_exp_f32_e32 v31, v31
  v_mfma_f32_16x16x32_bf16 v[244:247], a[200:203], v[36:39], v[244:247]
  ds_read_b64_tr_b16 a[240:241], v4 offset:36864
  v_cvt_pk_bf16_f32 v63, v30, v31
  v_mfma_f32_16x16x32_bf16 v[240:243], a[204:207], v[40:43], v[240:243]
  ds_read_b128 a[180:183], v2 offset:43392
  ds_read_b64_tr_b16 a[242:243], v4 offset:43008
  v_mfma_f32_16x16x32_bf16 v[244:247], a[204:207], v[44:47], v[244:247]
  ds_read_b64_tr_b16 a[244:245], v4 offset:12288
  v_mul_f32_e32 v20, s25, v20
  v_smfmac_f32_16x16x64_bf16 a[216:219], a[224:227], v[48:55], v0
  ds_read_b128 a[184:187], v1 offset:43520
  v_smfmac_f32_16x16x64_bf16 a[216:219], a[224:227], v[56:63], v0
  ds_read_b64_tr_b16 a[246:247], v4 offset:18432
  v_mfma_f32_16x16x32_bf16 v[24:27], a[144:147], a[24:27], 0
  ds_read_b128 a[188:191], v2 offset:43520
  v_mul_f32_e32 v21, s25, v21
  v_mfma_f32_16x16x32_bf16 v[24:27], a[148:151], a[28:31], v[24:27]
  v_exp_f32_e32 v20, v20
  v_mfma_f32_16x16x32_bf16 v[24:27], a[152:155], a[32:35], v[24:27]
  ds_read_b64_tr_b16 a[248:249], v5 offset:36864
  v_mul_f32_e32 v22, s25, v22
  v_mfma_f32_16x16x32_bf16 v[24:27], a[156:159], a[36:39], v[24:27]
  v_exp_f32_e32 v21, v21
  v_mfma_f32_16x16x32_bf16 v[24:27], a[160:163], a[40:43], v[24:27]
  ds_read_b64_tr_b16 a[250:251], v5 offset:43008
  v_mul_f32_e32 v23, s25, v23
  v_mfma_f32_16x16x32_bf16 v[24:27], a[164:167], a[44:47], v[24:27]
  s_waitcnt lgkmcnt(5)
  v_exp_f32_e32 v22, v22
  v_mfma_f32_16x16x32_bf16 v[64:67], a[232:235], v[48:51], v[64:67]
  ds_read_b64_tr_b16 a[252:253], v5 offset:12288
  v_cvt_pk_bf16_f32 v32, v20, v21
  v_mfma_f32_16x16x32_bf16 v[68:71], a[232:235], v[52:55], v[68:71]
  v_exp_f32_e32 v23, v23
  v_mfma_f32_16x16x32_bf16 v[64:67], a[236:239], v[56:59], v[64:67]
  ds_read_b128 a[144:147], v1 offset:49408
  v_cvt_pk_bf16_f32 v33, v22, v23
  v_mfma_f32_16x16x32_bf16 v[68:71], a[236:239], v[60:63], v[68:71]
  ds_read_b64_tr_b16 a[254:255], v5 offset:18432
  v_mul_f32_e32 v24, s25, v24
  v_mfma_f32_16x16x32_bf16 v[80:83], a[240:243], v[48:51], v[80:83]
  ds_read_b64_tr_b16 a[192:193], v6 offset:36864
  v_mul_f32_e32 v25, s25, v25
  v_mfma_f32_16x16x32_bf16 v[84:87], a[240:243], v[52:55], v[84:87]
  s_waitcnt lgkmcnt(5)
  ds_read_b128 a[148:151], v2 offset:49408
  v_mul_f32_e32 v26, s25, v26
  v_accvgpr_read_b32 v10, a216
  v_accvgpr_read_b32 v14, a217
  v_add_f32_e32 v10, v10, v14
  v_accvgpr_read_b32 v12, a218
  v_accvgpr_read_b32 v16, a219
  v_add_f32_e32 v12, v12, v16
  v_mfma_f32_16x16x32_bf16 v[80:83], a[244:247], v[56:59], v[80:83]
  v_exp_f32_e32 v24, v24
  v_rcp_f32_e32 v10, v10
  v_rcp_f32_e32 v12, v12
  v_pk_mul_f32 v[64:65], v[64:65], v[10:11] op_sel_hi:[1,0]
  v_pk_mul_f32 v[66:67], v[66:67], v[10:11] op_sel_hi:[1,0]
  v_pk_mul_f32 v[68:69], v[68:69], v[12:13] op_sel_hi:[1,0]
  v_pk_mul_f32 v[70:71], v[70:71], v[12:13] op_sel_hi:[1,0]
  v_cvt_pk_bf16_f32 v64, v64, v65
  v_cvt_pk_bf16_f32 v65, v66, v67
  v_cvt_pk_bf16_f32 v68, v68, v69
  v_cvt_pk_bf16_f32 v69, v70, v71
  v_mfma_f32_16x16x32_bf16 v[28:31], a[168:171], a[0:3], 0
  ds_read_b64_tr_b16 a[194:195], v6 offset:43008
  v_mul_f32_e32 v27, s25, v27
  v_mfma_f32_16x16x32_bf16 v[28:31], a[172:175], a[4:7], v[28:31]
  v_exp_f32_e32 v25, v25
  v_mfma_f32_16x16x32_bf16 v[28:31], a[176:179], a[8:11], v[28:31]
  ds_read_b128 a[152:155], v1 offset:49536
  v_cvt_pk_bf16_f32 v36, v24, v25
  v_mfma_f32_16x16x32_bf16 v[28:31], a[180:183], a[12:15], v[28:31]
  v_exp_f32_e32 v26, v26
  v_mfma_f32_16x16x32_bf16 v[28:31], a[184:187], a[16:19], v[28:31]
  ds_read_b64_tr_b16 a[196:197], v6 offset:12288
  ds_read_b64_tr_b16 a[198:199], v6 offset:18432
  v_mfma_f32_16x16x32_bf16 v[28:31], a[188:191], a[20:23], v[28:31]
  v_exp_f32_e64 v27, v27
  v_mfma_f32_16x16x32_bf16 v[84:87], a[244:247], v[60:63], v[84:87]
  s_waitcnt lgkmcnt(4)
  ds_read_b64_tr_b16 a[200:201], v3 offset:36992
  v_cvt_pk_bf16_f32 v37, v26, v27
  v_mfma_f32_16x16x32_bf16 v[96:99], a[248:251], v[48:51], v[96:99]
  ds_read_b128 a[156:159], v2 offset:49536
  ds_read_b64_tr_b16 a[202:203], v3 offset:43136
  v_mfma_f32_16x16x32_bf16 v[100:103], a[248:251], v[52:55], v[100:103]
L_tr12:
  s_cbranch_execz L_tr16
  ds_read_b128 a[160:163], v1 offset:49664
  ds_read_b64_tr_b16 a[204:205], v3 offset:12416
  v_mfma_f32_16x16x32_bf16 v[96:99], a[252:255], v[56:59], v[96:99]
  s_add_u32 m0, s27, 0
  ds_read_b64_tr_b16 a[206:207], v3 offset:18560
  ds_write_addtid_b32 v64 offset:0
  ds_write_addtid_b32 v65 offset:256
  ds_write_addtid_b32 v68 offset:1024
  ds_write_addtid_b32 v69 offset:1280
  v_pk_mul_f32 v[80:81], v[80:81], v[10:11] op_sel_hi:[1,0]
  v_pk_mul_f32 v[82:83], v[82:83], v[10:11] op_sel_hi:[1,0]
  v_pk_mul_f32 v[84:85], v[84:85], v[12:13] op_sel_hi:[1,0]
  v_pk_mul_f32 v[86:87], v[86:87], v[12:13] op_sel_hi:[1,0]
  v_cvt_pk_bf16_f32 v80, v80, v81
  v_cvt_pk_bf16_f32 v81, v82, v83
  v_cvt_pk_bf16_f32 v84, v84, v85
  v_cvt_pk_bf16_f32 v85, v86, v87
  v_mfma_f32_16x16x32_bf16 v[100:103], a[252:255], v[60:63], v[100:103]
  s_waitcnt lgkmcnt(12)
  v_mul_f32_e32 v28, s25, v28
  v_mul_f32_e32 v29, s25, v29
  v_mfma_f32_16x16x32_bf16 v[112:115], a[192:195], v[48:51], v[112:115]
  v_exp_f32_e32 v28, v28
  v_mfma_f32_16x16x32_bf16 v[20:23], a[168:171], a[24:27], 0
  ds_read_b128 a[164:167], v2 offset:49664
  v_mul_f32_e64 v30, s25, v30
  v_mfma_f32_16x16x32_bf16 v[20:23], a[172:175], a[28:31], v[20:23]
  ds_read_b64_tr_b16 a[232:233], v4 offset:36992
  ds_write_addtid_b32 v80 offset:512
  ds_write_addtid_b32 v81 offset:768
  ds_write_addtid_b32 v84 offset:1536
  ds_write_addtid_b32 v85 offset:1792
  v_pk_mul_f32 v[96:97], v[96:97], v[10:11] op_sel_hi:[1,0]
  v_pk_mul_f32 v[98:99], v[98:99], v[10:11] op_sel_hi:[1,0]
  v_pk_mul_f32 v[100:101], v[100:101], v[12:13] op_sel_hi:[1,0]
  v_pk_mul_f32 v[102:103], v[102:103], v[12:13] op_sel_hi:[1,0]
  v_cvt_pk_bf16_f32 v96, v96, v97
  v_cvt_pk_bf16_f32 v97, v98, v99
  v_cvt_pk_bf16_f32 v100, v100, v101
  v_cvt_pk_bf16_f32 v101, v102, v103
  v_mfma_f32_16x16x32_bf16 v[20:23], a[176:179], a[32:35], v[20:23]
  v_exp_f32_e32 v29, v29
  v_mfma_f32_16x16x32_bf16 v[20:23], a[180:183], a[36:39], v[20:23]
  ds_read_b64_tr_b16 a[234:235], v4 offset:43136
  v_mul_f32_e32 v31, s25, v31
  v_mfma_f32_16x16x32_bf16 v[20:23], a[184:187], a[40:43], v[20:23]
  v_exp_f32_e32 v30, v30
  v_mfma_f32_16x16x32_bf16 v[20:23], a[188:191], a[44:47], v[20:23]
  ds_read_b64_tr_b16 a[236:237], v4 offset:12416
  v_cvt_pk_bf16_f32 v34, v28, v29
  v_mfma_f32_16x16x32_bf16 v[116:119], a[192:195], v[52:55], v[116:119]
  s_waitcnt lgkmcnt(8)
  v_exp_f32_e32 v31, v31
  v_mfma_f32_16x16x32_bf16 v[112:115], a[196:199], v[56:59], v[112:115]
  ds_read_b128 a[168:171], v1 offset:55552
  v_cvt_pk_bf16_f32 v35, v30, v31
  v_mfma_f32_16x16x32_bf16 v[116:119], a[196:199], v[60:63], v[116:119]
  ds_read_b64_tr_b16 a[238:239], v4 offset:18560
  ds_read_b64_tr_b16 a[240:241], v5 offset:36992
  v_mfma_f32_16x16x32_bf16 v[128:131], a[200:203], v[48:51], v[128:131]
  ds_read_b128 a[172:175], v2 offset:55552
  v_mul_f32_e32 v20, s25, v20
  v_mfma_f32_16x16x32_bf16 v[132:135], a[200:203], v[52:55], v[132:135]
  ds_read_b64_tr_b16 a[242:243], v5 offset:43136
  v_mul_f32_e32 v21, s25, v21
  v_mfma_f32_16x16x32_bf16 v[128:131], a[204:207], v[56:59], v[128:131]
  ds_write_addtid_b32 v96 offset:12320
  ds_write_addtid_b32 v97 offset:12576
  ds_write_addtid_b32 v100 offset:13344
  ds_write_addtid_b32 v101 offset:13600
  v_mul_f32_e32 v22, s25, v22
  v_pk_mul_f32 v[112:113], v[112:113], v[10:11] op_sel_hi:[1,0]
  v_pk_mul_f32 v[114:115], v[114:115], v[10:11] op_sel_hi:[1,0]
  v_pk_mul_f32 v[116:117], v[116:117], v[12:13] op_sel_hi:[1,0]
  v_pk_mul_f32 v[118:119], v[118:119], v[12:13] op_sel_hi:[1,0]
  v_cvt_pk_bf16_f32 v112, v112, v113
  v_cvt_pk_bf16_f32 v113, v114, v115
  v_cvt_pk_bf16_f32 v116, v116, v117
  v_cvt_pk_bf16_f32 v117, v118, v119
  v_mfma_f32_16x16x32_bf16 v[24:27], a[144:147], a[0:3], 0
  ds_read_b128 a[176:179], v1 offset:55680
  ds_write_addtid_b32 v112 offset:12832
  ds_write_addtid_b32 v113 offset:13088
  ds_write_addtid_b32 v116 offset:13856
  ds_write_addtid_b32 v117 offset:14112
  ds_read2st64_b32 a[96:97], v11 offset0:0 offset1:1
  v_mfma_f32_16x16x32_bf16 v[24:27], a[148:151], a[4:7], v[24:27]
  v_exp_f32_e32 v20, v20
  v_mfma_f32_16x16x32_bf16 v[24:27], a[152:155], a[8:11], v[24:27]
  ds_read2st64_b32 a[98:99], v13 offset0:0 offset1:1
  v_exp_f32_e32 v21, v21
  v_mfma_f32_16x16x32_bf16 v[24:27], a[156:159], a[12:15], v[24:27]
  ds_read_b64_tr_b16 a[244:245], v5 offset:12416
  v_mul_f32_e32 v23, s25, v23
  v_mfma_f32_16x16x32_bf16 v[24:27], a[160:163], a[16:19], v[24:27]
  s_waitcnt lgkmcnt(14)
  ds_read2st64_b32 a[100:101], v15 offset0:0 offset1:1
  v_exp_f32_e32 v22, v22
  v_mfma_f32_16x16x32_bf16 v[24:27], a[164:167], a[20:23], v[24:27]
  ds_read_b64_tr_b16 a[246:247], v5 offset:18560
  v_cvt_pk_bf16_f32 v38, v20, v21
  v_mfma_f32_16x16x32_bf16 v[132:135], a[204:207], v[60:63], v[132:135]
  ds_read_b128 a[180:183], v2 offset:55680
  ds_read_b64_tr_b16 a[248:249], v6 offset:36992
  ds_read2st64_b32 a[102:103], v17 offset0:0 offset1:1
  v_mfma_f32_16x16x32_bf16 v[144:147], a[232:235], v[48:51], v[144:147]
  v_exp_f32_e64 v23, v23
  v_mfma_f32_16x16x32_bf16 v[148:151], a[232:235], v[52:55], v[148:151]
  s_waitcnt lgkmcnt(6)
  buffer_store_dwordx4 a[96:99], v18, s[20:23], s76 offen offset:0 sc1 nt
  ds_read2st64_b32 a[104:105], v11 offset0:4 offset1:5
  v_mfma_f32_16x16x32_bf16 v[144:147], a[236:239], v[56:59], v[144:147]
  ds_read_b64_tr_b16 a[250:251], v6 offset:43136
  v_cvt_pk_bf16_f32 v39, v22, v23
  v_pk_mul_f32 v[128:129], v[128:129], v[10:11] op_sel_hi:[1,0]
  v_pk_mul_f32 v[130:131], v[130:131], v[10:11] op_sel_hi:[1,0]
  v_pk_mul_f32 v[132:133], v[132:133], v[12:13] op_sel_hi:[1,0]
  v_pk_mul_f32 v[134:135], v[134:135], v[12:13] op_sel_hi:[1,0]
  v_cvt_pk_bf16_f32 v128, v128, v129
  v_cvt_pk_bf16_f32 v129, v130, v131
  v_cvt_pk_bf16_f32 v132, v132, v133
  v_cvt_pk_bf16_f32 v133, v134, v135
  v_mfma_f32_16x16x32_bf16 v[148:151], a[236:239], v[60:63], v[148:151]
  ds_read_b64_tr_b16 a[252:253], v6 offset:12416
  ds_read2st64_b32 a[106:107], v13 offset0:4 offset1:5
  v_mul_f32_e32 v24, s25, v24
  v_mfma_f32_16x16x32_bf16 v[160:163], a[240:243], v[48:51], v[160:163]
  ds_read_b64_tr_b16 a[254:255], v6 offset:18560
  v_mul_f32_e64 v25, s25, v25
  v_mfma_f32_16x16x32_bf16 v[28:31], a[144:147], a[24:27], 0
  s_waitcnt lgkmcnt(5)
  buffer_store_dwordx4 a[100:103], v18, s[20:23], s76 offen offset:3072 sc1 nt
  ds_read2st64_b32 a[108:109], v15 offset0:4 offset1:5
  v_mfma_f32_16x16x32_bf16 v[28:31], a[148:151], a[28:31], v[28:31]
  ds_read_b128 a[184:187], v1 offset:55808
  ds_read2st64_b32 a[110:111], v17 offset0:4 offset1:5
  ds_write_addtid_b32 v128 offset:2048
  ds_write_addtid_b32 v129 offset:2304
  ds_write_addtid_b32 v132 offset:0
  ds_write_addtid_b32 v133 offset:256
  v_mul_f32_e64 v26, s25, v26
  v_pk_mul_f32 v[144:145], v[144:145], v[10:11] op_sel_hi:[1,0]
  v_pk_mul_f32 v[146:147], v[146:147], v[10:11] op_sel_hi:[1,0]
  v_pk_mul_f32 v[148:149], v[148:149], v[12:13] op_sel_hi:[1,0]
  v_pk_mul_f32 v[150:151], v[150:151], v[12:13] op_sel_hi:[1,0]
  v_cvt_pk_bf16_f32 v144, v144, v145
  v_cvt_pk_bf16_f32 v145, v146, v147
  v_cvt_pk_bf16_f32 v148, v148, v149
  v_cvt_pk_bf16_f32 v149, v150, v151
  v_mfma_f32_16x16x32_bf16 v[28:31], a[152:155], a[32:35], v[28:31]
  v_exp_f32_e32 v24, v24
  v_mfma_f32_16x16x32_bf16 v[28:31], a[156:159], a[36:39], v[28:31]
  v_exp_f32_e32 v25, v25
  v_mfma_f32_16x16x32_bf16 v[28:31], a[160:163], a[40:43], v[28:31]
  s_waitcnt lgkmcnt(8)
  buffer_store_dwordx4 a[104:107], v18, s[20:23], s77 offen offset:0 sc1 nt
  ds_read_b128 a[188:191], v2 offset:55808
  v_mul_f32_e32 v27, s25, v27
  v_mfma_f32_16x16x32_bf16 v[28:31], a[164:167], a[44:47], v[28:31]
  ds_read_b64_tr_b16 a[192:193], v3 offset:37120
  v_cvt_pk_bf16_f32 v40, v24, v25
  v_mfma_f32_16x16x32_bf16 v[164:167], a[240:243], v[52:55], v[164:167]
  v_exp_f32_e32 v26, v26
  v_mfma_f32_16x16x32_bf16 v[160:163], a[244:247], v[56:59], v[160:163]
  ds_read_b64_tr_b16 a[194:195], v3 offset:43264
  ds_read_b64_tr_b16 a[196:197], v3 offset:12544
  v_mfma_f32_16x16x32_bf16 v[164:167], a[244:247], v[60:63], v[164:167]
  s_waitcnt lgkmcnt(8)
  buffer_store_dwordx4 a[108:111], v18, s[20:23], s77 offen offset:3072 sc1 nt
  v_exp_f32_e32 v27, v27
  v_mfma_f32_16x16x32_bf16 v[176:179], a[248:251], v[48:51], v[176:179]
  ds_read_b128 a[144:147], v1 offset:0
  v_cvt_pk_bf16_f32 v41, v26, v27
  v_mfma_f32_16x16x32_bf16 v[180:183], a[248:251], v[52:55], v[180:183]
  ds_read_b64_tr_b16 a[198:199], v3 offset:18688
  v_mul_f32_e32 v28, s25, v28
  v_mfma_f32_16x16x32_bf16 v[176:179], a[252:255], v[56:59], v[176:179]
  ds_read_b64_tr_b16 a[200:201], v4 offset:37120
  ds_write_addtid_b32 v144 offset:2560
  ds_write_addtid_b32 v145 offset:2816
  ds_write_addtid_b32 v148 offset:512
  ds_write_addtid_b32 v149 offset:768
  v_mul_f32_e64 v29, s25, v29
  v_pk_mul_f32 v[160:161], v[160:161], v[10:11] op_sel_hi:[1,0]
  v_pk_mul_f32 v[162:163], v[162:163], v[10:11] op_sel_hi:[1,0]
  v_pk_mul_f32 v[164:165], v[164:165], v[12:13] op_sel_hi:[1,0]
  v_pk_mul_f32 v[166:167], v[166:167], v[12:13] op_sel_hi:[1,0]
  v_cvt_pk_bf16_f32 v160, v160, v161
  v_cvt_pk_bf16_f32 v161, v162, v163
  v_cvt_pk_bf16_f32 v164, v164, v165
  v_cvt_pk_bf16_f32 v165, v166, v167
  v_mfma_f32_16x16x32_bf16 v[180:183], a[252:255], v[60:63], v[180:183]
  ds_read_b64_tr_b16 a[202:203], v4 offset:43264
  v_mul_f32_e32 v30, s25, v30
  v_mfma_f32_16x16x32_bf16 v[20:23], a[168:171], a[0:3], 0
  ds_read_b128 a[148:151], v2 offset:0
  v_mul_f32_e32 v31, s25, v31
  v_mfma_f32_16x16x32_bf16 v[20:23], a[172:175], a[4:7], v[20:23]
  v_exp_f32_e32 v28, v28
  v_mfma_f32_16x16x32_bf16 v[20:23], a[176:179], a[8:11], v[20:23]
  ds_write_addtid_b32 v160 offset:14368
  ds_write_addtid_b32 v161 offset:14624
  ds_write_addtid_b32 v164 offset:12320
  ds_write_addtid_b32 v165 offset:12576
  v_exp_f32_e32 v29, v29
  v_pk_mul_f32 v[176:177], v[176:177], v[10:11] op_sel_hi:[1,0]
  v_pk_mul_f32 v[178:179], v[178:179], v[10:11] op_sel_hi:[1,0]
  v_pk_mul_f32 v[180:181], v[180:181], v[12:13] op_sel_hi:[1,0]
  v_pk_mul_f32 v[182:183], v[182:183], v[12:13] op_sel_hi:[1,0]
  v_cvt_pk_bf16_f32 v176, v176, v177
  v_cvt_pk_bf16_f32 v177, v178, v179
  v_cvt_pk_bf16_f32 v180, v180, v181
  v_cvt_pk_bf16_f32 v181, v182, v183
  v_mfma_f32_16x16x32_bf16 v[20:23], a[180:183], a[12:15], v[20:23]
  ds_read_b128 a[152:155], v1 offset:128
  ds_write_addtid_b32 v176 offset:14880
  ds_write_addtid_b32 v177 offset:15136
  ds_write_addtid_b32 v180 offset:12832
  ds_write_addtid_b32 v181 offset:13088
  ds_read2st64_b32 a[112:113], v11 offset0:8 offset1:9
  v_mfma_f32_16x16x32_bf16 v[20:23], a[184:187], a[16:19], v[20:23]
  s_waitcnt lgkmcnt(15)
  ds_read_b64_tr_b16 a[204:205], v4 offset:12544
  v_cvt_pk_bf16_f32 v44, v28, v29
  v_mfma_f32_16x16x32_bf16 v[20:23], a[188:191], a[20:23], v[20:23]
  ds_read2st64_b32 a[114:115], v13 offset0:8 offset1:9
  v_exp_f32_e32 v30, v30
  v_mfma_f32_16x16x32_bf16 v[192:195], a[192:195], v[48:51], v[192:195]
  ds_read_b64_tr_b16 a[206:207], v4 offset:18688
  ds_read_b64_tr_b16 a[232:233], v5 offset:37120
  v_mfma_f32_16x16x32_bf16 v[196:199], a[192:195], v[52:55], v[196:199]
  ds_read2st64_b32 a[116:117], v15 offset0:8 offset1:9
  v_exp_f32_e32 v31, v31
  v_mfma_f32_16x16x32_bf16 v[192:195], a[196:199], v[56:59], v[192:195]
  ds_read_b128 a[156:159], v2 offset:128
  v_cvt_pk_bf16_f32 v45, v30, v31
  v_mfma_f32_16x16x32_bf16 v[196:199], a[196:199], v[60:63], v[196:199]
  s_waitcnt lgkmcnt(15)
  ds_read_b64_tr_b16 a[234:235], v5 offset:43264
  ds_read2st64_b32 a[118:119], v17 offset0:8 offset1:9
  v_mul_f32_e32 v20, s25, v20
  v_mfma_f32_16x16x32_bf16 v[208:211], a[200:203], v[48:51], v[208:211]
  ds_read_b64_tr_b16 a[236:237], v5 offset:12544
  v_mul_f32_e32 v21, s25, v21
  v_mfma_f32_16x16x32_bf16 v[212:215], a[200:203], v[52:55], v[212:215]
  s_waitcnt lgkmcnt(7)
  buffer_store_dwordx4 a[112:115], v18, s[20:23], s76 offen offset:128 sc1 nt
  ds_read_b64_tr_b16 a[238:239], v5 offset:18688
  ds_read2st64_b32 a[120:121], v11 offset0:0 offset1:1
  v_mul_f32_e32 v22, s25, v22
  v_mfma_f32_16x16x32_bf16 v[24:27], a[168:171], a[24:27], 0
  ds_read_b128 a[160:163], v1 offset:256
  v_mul_f32_e64 v23, s25, v23
  v_pk_mul_f32 v[192:193], v[192:193], v[10:11] op_sel_hi:[1,0]
  v_pk_mul_f32 v[194:195], v[194:195], v[10:11] op_sel_hi:[1,0]
  v_pk_mul_f32 v[196:197], v[196:197], v[12:13] op_sel_hi:[1,0]
  v_pk_mul_f32 v[198:199], v[198:199], v[12:13] op_sel_hi:[1,0]
  v_cvt_pk_bf16_f32 v192, v192, v193
  v_cvt_pk_bf16_f32 v193, v194, v195
  v_cvt_pk_bf16_f32 v196, v196, v197
  v_cvt_pk_bf16_f32 v197, v198, v199
  v_mfma_f32_16x16x32_bf16 v[24:27], a[172:175], a[28:31], v[24:27]
  ds_read2st64_b32 a[122:123], v13 offset0:0 offset1:1
  v_exp_f32_e32 v20, v20
  v_mfma_f32_16x16x32_bf16 v[24:27], a[176:179], a[32:35], v[24:27]
  v_exp_f32_e32 v21, v21
  v_mfma_f32_16x16x32_bf16 v[24:27], a[180:183], a[36:39], v[24:27]
  s_waitcnt lgkmcnt(5)
  buffer_store_dwordx4 a[116:119], v18, s[20:23], s76 offen offset:3200 sc1 nt
  ds_read2st64_b32 a[124:125], v15 offset0:0 offset1:1
  v_mfma_f32_16x16x32_bf16 v[24:27], a[184:187], a[40:43], v[24:27]
  ds_read_b128 a[164:167], v2 offset:256
  v_cvt_pk_bf16_f32 v42, v20, v21
  v_mfma_f32_16x16x32_bf16 v[24:27], a[188:191], a[44:47], v[24:27]
  ds_read_b64_tr_b16 a[240:241], v6 offset:37120
  ds_read_b64_tr_b16 a[242:243], v6 offset:43264
  ds_read2st64_b32 a[126:127], v17 offset0:0 offset1:1
  v_mfma_f32_16x16x32_bf16 v[208:211], a[204:207], v[56:59], v[208:211]
  v_exp_f32_e32 v22, v22
  v_mfma_f32_16x16x32_bf16 v[212:215], a[204:207], v[60:63], v[212:215]
  s_waitcnt lgkmcnt(5)
  buffer_store_dwordx4 a[120:123], v18, s[20:23], s77 offen offset:128 sc1 nt
  v_exp_f32_e32 v23, v23
  v_mfma_f32_16x16x32_bf16 v[224:227], a[232:235], v[48:51], v[224:227]
  ds_read_b128 a[168:171], v1 offset:6144
  v_cvt_pk_bf16_f32 v43, v22, v23
  v_mfma_f32_16x16x32_bf16 v[228:231], a[232:235], v[52:55], v[228:231]
  ds_read_b128 a[172:175], v2 offset:6144
  v_mul_f32_e64 v24, s25, v24
  v_mfma_f32_16x16x32_bf16 v[224:227], a[236:239], v[56:59], v[224:227]
  ds_read_b64_tr_b16 a[244:245], v6 offset:12544
  ds_write_addtid_b32 v192 offset:1024
  ds_write_addtid_b32 v193 offset:1280
  ds_write_addtid_b32 v196 offset:2048
  ds_write_addtid_b32 v197 offset:2304
  v_pk_mul_f32 v[208:209], v[208:209], v[10:11] op_sel_hi:[1,0]
  v_pk_mul_f32 v[210:211], v[210:211], v[10:11] op_sel_hi:[1,0]
  v_pk_mul_f32 v[212:213], v[212:213], v[12:13] op_sel_hi:[1,0]
  v_pk_mul_f32 v[214:215], v[214:215], v[12:13] op_sel_hi:[1,0]
  v_cvt_pk_bf16_f32 v208, v208, v209
  v_cvt_pk_bf16_f32 v209, v210, v211
  v_cvt_pk_bf16_f32 v212, v212, v213
  v_cvt_pk_bf16_f32 v213, v214, v215
  v_mfma_f32_16x16x32_bf16 v[228:231], a[236:239], v[60:63], v[228:231]
  s_waitcnt lgkmcnt(7)
  buffer_store_dwordx4 a[124:127], v18, s[20:23], s77 offen offset:3200 sc1 nt
  v_mfma_f32_16x16x32_bf16 v[28:31], a[144:147], a[0:3], 0
  ds_read_b128 a[176:179], v1 offset:6272
  v_mul_f32_e32 v25, s25, v25
  v_mfma_f32_16x16x32_bf16 v[28:31], a[148:151], a[4:7], v[28:31]
  v_exp_f32_e32 v24, v24
  v_mfma_f32_16x16x32_bf16 v[28:31], a[152:155], a[8:11], v[28:31]
  ds_read_b64_tr_b16 a[246:247], v6 offset:18688
  ds_write_addtid_b32 v208 offset:1536
  ds_write_addtid_b32 v209 offset:1792
  ds_write_addtid_b32 v212 offset:2560
  ds_write_addtid_b32 v213 offset:2816
  v_mul_f32_e32 v26, s25, v26
  v_pk_mul_f32 v[224:225], v[224:225], v[10:11] op_sel_hi:[1,0]
  v_pk_mul_f32 v[226:227], v[226:227], v[10:11] op_sel_hi:[1,0]
  v_pk_mul_f32 v[228:229], v[228:229], v[12:13] op_sel_hi:[1,0]
  v_pk_mul_f32 v[230:231], v[230:231], v[12:13] op_sel_hi:[1,0]
  v_cvt_pk_bf16_f32 v224, v224, v225
  v_cvt_pk_bf16_f32 v225, v226, v227
  v_cvt_pk_bf16_f32 v228, v228, v229
  v_cvt_pk_bf16_f32 v229, v230, v231
  v_mfma_f32_16x16x32_bf16 v[28:31], a[156:159], a[12:15], v[28:31]
  v_exp_f32_e32 v25, v25
  v_mfma_f32_16x16x32_bf16 v[28:31], a[160:163], a[16:19], v[28:31]
  ds_read_b128 a[180:183], v2 offset:6272
  v_mul_f32_e32 v27, s25, v27
  v_mfma_f32_16x16x32_bf16 v[28:31], a[164:167], a[20:23], v[28:31]
  v_exp_f32_e32 v26, v26
  v_mfma_f32_16x16x32_bf16 v[240:243], a[240:243], v[48:51], v[240:243]
  ds_read_b128 a[184:187], v1 offset:6400
  v_cvt_pk_bf16_f32 v46, v24, v25
  v_mfma_f32_16x16x32_bf16 v[244:247], a[240:243], v[52:55], v[244:247]
  v_exp_f32_e32 v27, v27
  v_mfma_f32_16x16x32_bf16 v[20:23], a[144:147], a[24:27], 0
  ds_read_b128 a[188:191], v2 offset:6400
  v_cvt_pk_bf16_f32 v47, v26, v27
  v_mfma_f32_16x16x32_bf16 v[20:23], a[148:151], a[28:31], v[20:23]
  ds_read_b64_tr_b16 a[248:249], v3 offset:24576
  v_mul_f32_e32 v28, s25, v28
  v_mfma_f32_16x16x32_bf16 v[20:23], a[152:155], a[32:35], v[20:23]
  ds_read_b64_tr_b16 a[250:251], v3 offset:30720
  v_mul_f32_e32 v29, s25, v29
  v_mfma_f32_16x16x32_bf16 v[20:23], a[156:159], a[36:39], v[20:23]
  v_exp_f32_e32 v28, v28
  v_mfma_f32_16x16x32_bf16 v[20:23], a[160:163], a[40:43], v[20:23]
  ds_read_b128 a[144:147], v1 offset:12288
  v_mul_f32_e32 v30, s25, v30
  v_mfma_f32_16x16x32_bf16 v[20:23], a[164:167], a[44:47], v[20:23]
  s_waitcnt lgkmcnt(5)
  v_exp_f32_e32 v29, v29
  v_mfma_f32_16x16x32_bf16 v[240:243], a[244:247], v[56:59], v[240:243]
  ds_read_b128 a[148:151], v2 offset:12288
  v_mul_f32_e32 v31, s25, v31
  v_mfma_f32_16x16x32_bf16 v[244:247], a[244:247], v[60:63], v[244:247]
  v_exp_f32_e32 v30, v30
  v_smfmac_f32_16x16x64_bf16 a[220:223], a[224:227], v[32:39], v0
  ds_read_b64_tr_b16 a[252:253], v3 offset:0
  v_mfma_f32_16x16x32_bf16 v[24:27], a[168:171], a[0:3], 0
  ds_read_b128 a[152:155], v1 offset:12416
  v_cvt_pk_bf16_f32 v48, v28, v29
  v_mfma_f32_16x16x32_bf16 v[24:27], a[172:175], a[4:7], v[24:27]
  ds_read_b128 a[156:159], v2 offset:12416
  ds_write_addtid_b32 v224 offset:13344
  ds_write_addtid_b32 v225 offset:13600
  ds_write_addtid_b32 v228 offset:14368
  ds_write_addtid_b32 v229 offset:14624
  v_pk_mul_f32 v[240:241], v[240:241], v[10:11] op_sel_hi:[1,0]
  v_pk_mul_f32 v[242:243], v[242:243], v[10:11] op_sel_hi:[1,0]
  v_pk_mul_f32 v[244:245], v[244:245], v[12:13] op_sel_hi:[1,0]
  v_pk_mul_f32 v[246:247], v[246:247], v[12:13] op_sel_hi:[1,0]
  v_cvt_pk_bf16_f32 v240, v240, v241
  v_cvt_pk_bf16_f32 v241, v242, v243
  v_cvt_pk_bf16_f32 v244, v244, v245
  v_cvt_pk_bf16_f32 v245, v246, v247
  v_mfma_f32_16x16x32_bf16 v[24:27], a[176:179], a[8:11], v[24:27]
  ds_write_addtid_b32 v240 offset:13856
  ds_write_addtid_b32 v241 offset:14112
  ds_write_addtid_b32 v244 offset:14880
  ds_write_addtid_b32 v245 offset:15136
  ds_read2st64_b32 a[128:129], v11 offset0:4 offset1:5
  v_exp_f32_e32 v31, v31
  v_mfma_f32_16x16x32_bf16 v[24:27], a[180:183], a[12:15], v[24:27]
  s_waitcnt lgkmcnt(13)
  ds_read_b64_tr_b16 a[254:255], v3 offset:6144
  v_mul_f32_e32 v20, s25, v20
  v_mfma_f32_16x16x32_bf16 v[24:27], a[184:187], a[16:19], v[24:27]
  ds_read_b128 a[160:163], v1 offset:12544
  ds_read2st64_b32 a[130:131], v13 offset0:4 offset1:5
  v_mul_f32_e32 v21, s25, v21
  v_mfma_f32_16x16x32_bf16 v[24:27], a[188:191], a[20:23], v[24:27]
  ds_read_b128 a[164:167], v2 offset:12544
  v_cvt_pk_bf16_f32 v49, v30, v31
  v_smfmac_f32_16x16x64_bf16 a[220:223], a[224:227], v[40:47], v0
  ds_read_b64_tr_b16 a[192:193], v4 offset:24576
  ds_read2st64_b32 a[132:133], v15 offset0:4 offset1:5
  v_mfma_f32_16x16x32_bf16 v[72:75], a[248:251], v[32:35], v[72:75]
  v_exp_f32_e32 v20, v20
  v_mfma_f32_16x16x32_bf16 v[28:31], a[168:171], a[24:27], 0
  ds_read_b64_tr_b16 a[194:195], v4 offset:30720
  ds_read2st64_b32 a[134:135], v17 offset0:4 offset1:5
  v_mul_f32_e32 v22, s25, v22
  v_mfma_f32_16x16x32_bf16 v[28:31], a[172:175], a[28:31], v[28:31]
  v_exp_f32_e32 v21, v21
  v_mfma_f32_16x16x32_bf16 v[28:31], a[176:179], a[32:35], v[28:31]
  s_waitcnt lgkmcnt(5)
  buffer_store_dwordx4 a[128:131], v18, s[20:23], s76 offen offset:256 sc1 nt
  ds_read2st64_b32 a[136:137], v11 offset0:8 offset1:9
  v_mul_f32_e32 v23, s25, v23
  v_cvt_pk_bf16_f32 v52, v20, v21
  v_mfma_f32_16x16x32_bf16 v[28:31], a[180:183], a[36:39], v[28:31]
  v_exp_f32_e32 v22, v22
  v_mfma_f32_16x16x32_bf16 v[28:31], a[184:187], a[40:43], v[28:31]
  ds_read2st64_b32 a[138:139], v13 offset0:8 offset1:9
  v_exp_f32_e32 v23, v23
  v_mfma_f32_16x16x32_bf16 v[28:31], a[188:191], a[44:47], v[28:31]
  ds_read_b128 a[168:171], v1 offset:18432
  v_mul_f32_e32 v24, s25, v24
  v_mfma_f32_16x16x32_bf16 v[76:79], a[248:251], v[36:39], v[76:79]
  s_waitcnt lgkmcnt(3)
  buffer_store_dwordx4 a[132:135], v18, s[20:23], s76 offen offset:3328 sc1 nt
  ds_read_b64_tr_b16 a[196:197], v4 offset:0
  ds_read2st64_b32 a[140:141], v15 offset0:8 offset1:9
  v_cvt_pk_bf16_f32 v53, v22, v23
  v_mfma_f32_16x16x32_bf16 v[72:75], a[252:255], v[40:43], v[72:75]
  ds_read_b128 a[172:175], v2 offset:18432
  v_mul_f32_e32 v25, s25, v25
  v_mfma_f32_16x16x32_bf16 v[20:23], a[144:147], a[0:3], 0
  ds_read2st64_b32 a[142:143], v17 offset0:8 offset1:9
  v_exp_f32_e32 v24, v24
  v_mfma_f32_16x16x32_bf16 v[20:23], a[148:151], a[4:7], v[20:23]
  ds_read_b64_tr_b16 a[198:199], v4 offset:6144
  v_mul_f32_e32 v26, s25, v26
  v_mfma_f32_16x16x32_bf16 v[20:23], a[152:155], a[8:11], v[20:23]
  s_waitcnt lgkmcnt(6)
  buffer_store_dwordx4 a[136:139], v18, s[20:23], s77 offen offset:256 sc1 nt
  v_exp_f32_e32 v25, v25
  v_mfma_f32_16x16x32_bf16 v[20:23], a[156:159], a[12:15], v[20:23]
  ds_read_b128 a[176:179], v1 offset:18560
  v_mul_f32_e32 v27, s25, v27
  v_mfma_f32_16x16x32_bf16 v[20:23], a[160:163], a[16:19], v[20:23]
  v_exp_f32_e32 v26, v26
  v_mfma_f32_16x16x32_bf16 v[20:23], a[164:167], a[20:23], v[20:23]
  ds_read_b128 a[180:183], v2 offset:18560
  v_cvt_pk_bf16_f32 v50, v24, v25
  v_mfma_f32_16x16x32_bf16 v[76:79], a[252:255], v[44:47], v[76:79]
  s_waitcnt lgkmcnt(3)
  buffer_store_dwordx4 a[140:143], v18, s[20:23], s77 offen offset:3328 sc1 nt
  v_exp_f32_e32 v27, v27
  v_mfma_f32_16x16x32_bf16 v[88:91], a[192:195], v[32:35], v[88:91]
  ds_read_b128 a[184:187], v1 offset:18688
  v_cvt_pk_bf16_f32 v51, v26, v27
  v_mfma_f32_16x16x32_bf16 v[24:27], a[144:147], a[24:27], 0
  ds_read_b64_tr_b16 a[200:201], v5 offset:24576
  v_mul_f32_e32 v28, s25, v28
  v_mfma_f32_16x16x32_bf16 v[24:27], a[148:151], a[28:31], v[24:27]
  ds_read_b128 a[188:191], v2 offset:18688
  v_mul_f32_e32 v29, s25, v29
  v_mfma_f32_16x16x32_bf16 v[24:27], a[152:155], a[32:35], v[24:27]
  v_exp_f32_e32 v28, v28
  v_mfma_f32_16x16x32_bf16 v[24:27], a[156:159], a[36:39], v[24:27]
  ds_read_b64_tr_b16 a[202:203], v5 offset:30720
  v_mul_f32_e32 v30, s25, v30
  v_mfma_f32_16x16x32_bf16 v[24:27], a[160:163], a[40:43], v[24:27]
  v_exp_f32_e32 v29, v29
  v_mfma_f32_16x16x32_bf16 v[24:27], a[164:167], a[44:47], v[24:27]
  ds_read_b64_tr_b16 a[204:205], v5 offset:0
  v_mul_f32_e32 v31, s25, v31
  v_mfma_f32_16x16x32_bf16 v[92:95], a[192:195], v[36:39], v[92:95]
  s_waitcnt lgkmcnt(5)
  v_exp_f32_e32 v30, v30
  v_mfma_f32_16x16x32_bf16 v[88:91], a[196:199], v[40:43], v[88:91]
  v_exp_f32_e32 v31, v31
  v_mfma_f32_16x16x32_bf16 v[92:95], a[196:199], v[44:47], v[92:95]
  v_cvt_pk_bf16_f32 v54, v28, v29
  v_cvt_pk_bf16_f32 v55, v30, v31
  v_mfma_f32_16x16x32_bf16 v[28:31], a[168:171], a[0:3], 0
  ds_read_b64_tr_b16 a[206:207], v5 offset:6144
  v_mul_f32_e32 v20, s25, v20
  v_mfma_f32_16x16x32_bf16 v[28:31], a[172:175], a[4:7], v[28:31]
  ds_read_b64_tr_b16 a[232:233], v6 offset:24576
  v_mul_f32_e32 v21, s25, v21
  v_mfma_f32_16x16x32_bf16 v[28:31], a[176:179], a[8:11], v[28:31]
  v_exp_f32_e32 v20, v20
  v_mfma_f32_16x16x32_bf16 v[28:31], a[180:183], a[12:15], v[28:31]
  s_waitcnt lgkmcnt(3)
  ds_read_b64_tr_b16 a[234:235], v6 offset:30720
  v_mul_f32_e32 v22, s25, v22
  v_mfma_f32_16x16x32_bf16 v[28:31], a[184:187], a[16:19], v[28:31]
  v_exp_f32_e32 v21, v21
  v_mfma_f32_16x16x32_bf16 v[28:31], a[188:191], a[20:23], v[28:31]
  ds_read_b64_tr_b16 a[236:237], v6 offset:0
  v_mul_f32_e32 v23, s25, v23
  v_mfma_f32_16x16x32_bf16 v[104:107], a[200:203], v[32:35], v[104:107]
  v_exp_f32_e32 v22, v22
  v_exp_f32_e32 v23, v23
  v_mfma_f32_16x16x32_bf16 v[108:111], a[200:203], v[36:39], v[108:111]
  v_cvt_pk_bf16_f32 v56, v20, v21
  v_cvt_pk_bf16_f32 v57, v22, v23
  v_mfma_f32_16x16x32_bf16 v[20:23], a[168:171], a[24:27], 0
  ds_read_b64_tr_b16 a[238:239], v6 offset:6144
  v_mul_f32_e32 v24, s25, v24
  v_mfma_f32_16x16x32_bf16 v[20:23], a[172:175], a[28:31], v[20:23]
  ds_read_b64_tr_b16 a[240:241], v3 offset:36864
  v_mul_f32_e32 v25, s25, v25
  v_mfma_f32_16x16x32_bf16 v[20:23], a[176:179], a[32:35], v[20:23]
  v_exp_f32_e32 v24, v24
  v_mfma_f32_16x16x32_bf16 v[20:23], a[180:183], a[36:39], v[20:23]
  ds_read_b64_tr_b16 a[242:243], v3 offset:43008
  v_mul_f32_e32 v26, s25, v26
  v_mfma_f32_16x16x32_bf16 v[20:23], a[184:187], a[40:43], v[20:23]
  v_exp_f32_e32 v25, v25
  v_mfma_f32_16x16x32_bf16 v[20:23], a[188:191], a[44:47], v[20:23]
  s_waitcnt lgkmcnt(3)
  ds_read_b64_tr_b16 a[244:245], v3 offset:12288
  v_mul_f32_e32 v27, s25, v27
  v_mfma_f32_16x16x32_bf16 v[104:107], a[204:207], v[40:43], v[104:107]
  v_exp_f32_e32 v26, v26
  v_mfma_f32_16x16x32_bf16 v[108:111], a[204:207], v[44:47], v[108:111]
  ds_read_b64_tr_b16 a[246:247], v3 offset:18432
  v_cvt_pk_bf16_f32 v60, v24, v25
  v_mfma_f32_16x16x32_bf16 v[120:123], a[232:235], v[32:35], v[120:123]
  v_exp_f32_e32 v27, v27
  v_mfma_f32_16x16x32_bf16 v[124:127], a[232:235], v[36:39], v[124:127]
  s_waitcnt lgkmcnt(3)
  v_mul_f32_e32 v28, s25, v28
  v_mul_f32_e32 v29, s25, v29
  v_mul_f32_e32 v30, s25, v30
  v_mul_f32_e32 v31, s25, v31
  v_mul_f32_e32 v20, s25, v20
  v_mul_f32_e32 v21, s25, v21
  v_mul_f32_e32 v22, s25, v22
  v_mul_f32_e32 v23, s25, v23
  v_mfma_f32_16x16x32_bf16 v[120:123], a[236:239], v[40:43], v[120:123]
  v_exp_f32_e32 v28, v28
  v_exp_f32_e32 v29, v29
  v_exp_f32_e32 v30, v30
  v_exp_f32_e32 v31, v31
  v_exp_f32_e32 v20, v20
  v_exp_f32_e32 v21, v21
  v_exp_f32_e32 v22, v22
  v_exp_f32_e32 v23, v23
  v_mfma_f32_16x16x32_bf16 v[124:127], a[236:239], v[44:47], v[124:127]
  ds_read_b64_tr_b16 a[248:249], v4 offset:36864
  ds_read_b64_tr_b16 a[250:251], v4 offset:43008
  v_cvt_pk_bf16_f32 v61, v26, v27
  v_cvt_pk_bf16_f32 v58, v28, v29
  v_cvt_pk_bf16_f32 v59, v30, v31
  v_cvt_pk_bf16_f32 v62, v20, v21
  v_cvt_pk_bf16_f32 v63, v22, v23
  v_smfmac_f32_16x16x64_bf16 a[220:223], a[224:227], v[48:55], v0
  ds_read_b64_tr_b16 a[252:253], v4 offset:12288
  v_smfmac_f32_16x16x64_bf16 a[220:223], a[224:227], v[56:63], v0
  s_waitcnt lgkmcnt(4)
  ds_read_b64_tr_b16 a[254:255], v4 offset:18432
  v_mfma_f32_16x16x32_bf16 v[72:75], a[240:243], v[48:51], v[72:75]
  ds_read_b64_tr_b16 a[192:193], v5 offset:36864
  ds_read_b64_tr_b16 a[194:195], v5 offset:43008
  v_mfma_f32_16x16x32_bf16 v[76:79], a[240:243], v[52:55], v[76:79]
  s_waitcnt lgkmcnt(6)
  ds_read_b64_tr_b16 a[196:197], v5 offset:12288
  ds_read_b64_tr_b16 a[198:199], v5 offset:18432
  v_mfma_f32_16x16x32_bf16 v[72:75], a[244:247], v[56:59], v[72:75]
  ds_read_b64_tr_b16 a[200:201], v6 offset:36864
  ds_read_b64_tr_b16 a[202:203], v6 offset:43008
  v_mfma_f32_16x16x32_bf16 v[76:79], a[244:247], v[60:63], v[76:79]
  s_waitcnt lgkmcnt(8)
  ds_read_b64_tr_b16 a[204:205], v6 offset:12288
  ds_read_b64_tr_b16 a[206:207], v6 offset:18432
  v_mfma_f32_16x16x32_bf16 v[88:91], a[248:251], v[48:51], v[88:91]
  ds_read_b64_tr_b16 a[232:233], v3 offset:24704
  ds_read_b64_tr_b16 a[234:235], v3 offset:30848
  v_mfma_f32_16x16x32_bf16 v[92:95], a[248:251], v[52:55], v[92:95]
L_tr13:
  s_cbranch_execz L_tr17
  s_waitcnt lgkmcnt(10)
  ds_read_b64_tr_b16 a[236:237], v3 offset:128
  ds_read_b64_tr_b16 a[238:239], v3 offset:6272
  v_accvgpr_read_b32 v14, a220
  v_accvgpr_read_b32 v19, a221
  v_add_f32_e32 v14, v14, v19
  v_accvgpr_read_b32 v16, a222
  v_accvgpr_read_b32 v19, a223
  v_add_f32_e32 v16, v16, v19
  v_mfma_f32_16x16x32_bf16 v[88:91], a[252:255], v[56:59], v[88:91]
  ds_read_b64_tr_b16 a[240:241], v3 offset:36992
  ds_read_b64_tr_b16 a[242:243], v3 offset:43136
  v_rcp_f32_e32 v14, v14
  v_rcp_f32_e64 v16, v16
  v_pk_mul_f32 v[72:73], v[72:73], v[14:15] op_sel_hi:[1,0]
  v_pk_mul_f32 v[74:75], v[74:75], v[14:15] op_sel_hi:[1,0]
  v_pk_mul_f32 v[76:77], v[76:77], v[16:17] op_sel_hi:[1,0]
  v_pk_mul_f32 v[78:79], v[78:79], v[16:17] op_sel_hi:[1,0]
  v_cvt_pk_bf16_f32 v72, v72, v73
  v_cvt_pk_bf16_f32 v73, v74, v75
  v_mfma_f32_16x16x32_bf16 v[92:95], a[252:255], v[60:63], v[92:95]
  s_waitcnt lgkmcnt(12)
  ds_read_b64_tr_b16 a[244:245], v3 offset:12416
  ds_read_b64_tr_b16 a[246:247], v3 offset:18560
  v_mfma_f32_16x16x32_bf16 v[104:107], a[192:195], v[48:51], v[104:107]
  ds_read_b64_tr_b16 a[248:249], v4 offset:24704
  ds_read_b64_tr_b16 a[250:251], v4 offset:30848
  v_mfma_f32_16x16x32_bf16 v[108:111], a[192:195], v[52:55], v[108:111]
  s_waitcnt lgkmcnt(14)
  ds_read_b64_tr_b16 a[252:253], v4 offset:128
  ds_read_b64_tr_b16 a[254:255], v4 offset:6272
  v_cvt_pk_bf16_f32 v76, v76, v77
  v_cvt_pk_bf16_f32 v77, v78, v79
  v_mfma_f32_16x16x32_bf16 v[104:107], a[196:199], v[56:59], v[104:107]
  ds_read_b64_tr_b16 a[192:193], v4 offset:36992
  ds_write_addtid_b32 v72 offset:0
  ds_write_addtid_b32 v73 offset:256
  ds_write_addtid_b32 v76 offset:1024
  ds_write_addtid_b32 v77 offset:1280
  v_pk_mul_f32 v[88:89], v[88:89], v[14:15] op_sel_hi:[1,0]
  v_pk_mul_f32 v[90:91], v[90:91], v[14:15] op_sel_hi:[1,0]
  v_pk_mul_f32 v[92:93], v[92:93], v[16:17] op_sel_hi:[1,0]
  v_pk_mul_f32 v[94:95], v[94:95], v[16:17] op_sel_hi:[1,0]
  v_cvt_pk_bf16_f32 v88, v88, v89
  v_cvt_pk_bf16_f32 v89, v90, v91
  v_mfma_f32_16x16x32_bf16 v[108:111], a[196:199], v[60:63], v[108:111]
  s_waitcnt lgkmcnt(15)
  ds_read_b64_tr_b16 a[194:195], v4 offset:43136
  ds_read_b64_tr_b16 a[196:197], v4 offset:12416
  v_mfma_f32_16x16x32_bf16 v[120:123], a[200:203], v[48:51], v[120:123]
  ds_write_addtid_b32 v88 offset:512
  v_cmp_nle_f32_e32 vcc, 0x33800000, v10
  v_mfma_f32_16x16x32_bf16 v[124:127], a[200:203], v[52:55], v[124:127]
  s_or_b64 s[36:37], s[36:37], vcc
  ds_read_b64_tr_b16 a[198:199], v4 offset:18560
  ds_read_b64_tr_b16 a[200:201], v5 offset:24704
  v_cvt_pk_bf16_f32 v92, v92, v93
  v_cvt_pk_bf16_f32 v93, v94, v95
  v_mfma_f32_16x16x32_bf16 v[120:123], a[204:207], v[56:59], v[120:123]
  ds_write_addtid_b32 v89 offset:768
  ds_write_addtid_b32 v92 offset:1536
  ds_write_addtid_b32 v93 offset:1792
  v_pk_mul_f32 v[104:105], v[104:105], v[14:15] op_sel_hi:[1,0]
  v_pk_mul_f32 v[106:107], v[106:107], v[14:15] op_sel_hi:[1,0]
  v_pk_mul_f32 v[108:109], v[108:109], v[16:17] op_sel_hi:[1,0]
  v_pk_mul_f32 v[110:111], v[110:111], v[16:17] op_sel_hi:[1,0]
  v_cvt_pk_bf16_f32 v104, v104, v105
  v_cvt_pk_bf16_f32 v105, v106, v107
  v_mfma_f32_16x16x32_bf16 v[124:127], a[204:207], v[60:63], v[124:127]
  ds_read_b64_tr_b16 a[202:203], v5 offset:30848
  ds_read_b64_tr_b16 a[204:205], v5 offset:128
  v_mfma_f32_16x16x32_bf16 v[136:139], a[232:235], v[32:35], v[136:139]
  ds_write_addtid_b32 v104 offset:12320
  v_cmp_lt_f32_e32 vcc, 0x49800000, v10
  v_mfma_f32_16x16x32_bf16 v[140:143], a[232:235], v[36:39], v[140:143]
  s_waitcnt lgkmcnt(15)
  s_or_b64 s[36:37], s[36:37], vcc
  ds_read_b64_tr_b16 a[206:207], v5 offset:6272
  ds_read_b64_tr_b16 a[232:233], v5 offset:36992
  v_cvt_pk_bf16_f32 v108, v108, v109
  v_cvt_pk_bf16_f32 v109, v110, v111
  v_mfma_f32_16x16x32_bf16 v[136:139], a[236:239], v[40:43], v[136:139]
  ds_write_addtid_b32 v105 offset:12576
  ds_write_addtid_b32 v108 offset:13344
  ds_write_addtid_b32 v109 offset:13600
  v_pk_mul_f32 v[120:121], v[120:121], v[14:15] op_sel_hi:[1,0]
  v_pk_mul_f32 v[122:123], v[122:123], v[14:15] op_sel_hi:[1,0]
  v_pk_mul_f32 v[124:125], v[124:125], v[16:17] op_sel_hi:[1,0]
  v_pk_mul_f32 v[126:127], v[126:127], v[16:17] op_sel_hi:[1,0]
  v_cvt_pk_bf16_f32 v120, v120, v121
  v_cvt_pk_bf16_f32 v121, v122, v123
  v_cvt_pk_bf16_f32 v124, v124, v125
  v_cvt_pk_bf16_f32 v125, v126, v127
  v_mfma_f32_16x16x32_bf16 v[140:143], a[236:239], v[44:47], v[140:143]
  ds_read_b64_tr_b16 a[234:235], v5 offset:43136
  ds_write_addtid_b32 v120 offset:12832
  ds_write_addtid_b32 v121 offset:13088
  ds_write_addtid_b32 v124 offset:13856
  ds_write_addtid_b32 v125 offset:14112
  ds_read2st64_b32 a[0:1], v11 offset0:0 offset1:1
  v_mfma_f32_16x16x32_bf16 v[136:139], a[240:243], v[48:51], v[136:139]
  ds_read_b64_tr_b16 a[236:237], v5 offset:12416
  ds_read2st64_b32 a[2:3], v13 offset0:0 offset1:1
  v_mfma_f32_16x16x32_bf16 v[140:143], a[240:243], v[52:55], v[140:143]
  ds_read_b64_tr_b16 a[238:239], v5 offset:18560
  ds_read_b64_tr_b16 a[240:241], v6 offset:24704
  ds_read2st64_b32 a[4:5], v15 offset0:0 offset1:1
  v_mfma_f32_16x16x32_bf16 v[136:139], a[244:247], v[56:59], v[136:139]
  ds_read2st64_b32 a[6:7], v17 offset0:0 offset1:1
  v_cmp_nle_f32_e32 vcc, 0x33800000, v12
  v_mfma_f32_16x16x32_bf16 v[140:143], a[244:247], v[60:63], v[140:143]
  s_or_b64 s[36:37], s[36:37], vcc
  ds_read_b64_tr_b16 a[242:243], v6 offset:30848
  ds_read_b64_tr_b16 a[244:245], v6 offset:128
  ds_read2st64_b32 a[8:9], v11 offset0:4 offset1:5
  v_mfma_f32_16x16x32_bf16 v[152:155], a[248:251], v[32:35], v[152:155]
  ds_read2st64_b32 a[10:11], v13 offset0:4 offset1:5
  v_cmp_lt_f32_e32 vcc, 0x49800000, v12
  v_mfma_f32_16x16x32_bf16 v[156:159], a[248:251], v[36:39], v[156:159]
  s_or_b64 s[36:37], s[36:37], vcc
  ds_read_b64_tr_b16 a[246:247], v6 offset:6272
  ds_read_b64_tr_b16 a[248:249], v6 offset:36992
  ds_read2st64_b32 a[12:13], v15 offset0:4 offset1:5
  v_mfma_f32_16x16x32_bf16 v[152:155], a[252:255], v[40:43], v[152:155]
  s_waitcnt lgkmcnt(11)
  buffer_store_dwordx4 a[0:3], v18, s[20:23], s78 offen offset:0 sc1 nt
  ds_read2st64_b32 a[14:15], v17 offset0:4 offset1:5
  v_pk_mul_f32 v[136:137], v[136:137], v[14:15] op_sel_hi:[1,0]
  v_pk_mul_f32 v[138:139], v[138:139], v[14:15] op_sel_hi:[1,0]
  v_pk_mul_f32 v[140:141], v[140:141], v[16:17] op_sel_hi:[1,0]
  v_pk_mul_f32 v[142:143], v[142:143], v[16:17] op_sel_hi:[1,0]
  v_cvt_pk_bf16_f32 v136, v136, v137
  v_cvt_pk_bf16_f32 v137, v138, v139
  v_mfma_f32_16x16x32_bf16 v[156:159], a[252:255], v[44:47], v[156:159]
  ds_read_b64_tr_b16 a[250:251], v6 offset:43136
  ds_read_b64_tr_b16 a[252:253], v6 offset:12416
  v_mfma_f32_16x16x32_bf16 v[152:155], a[192:195], v[48:51], v[152:155]
  s_waitcnt lgkmcnt(10)
  buffer_store_dwordx4 a[4:7], v18, s[20:23], s78 offen offset:3072 sc1 nt
  v_mfma_f32_16x16x32_bf16 v[156:159], a[192:195], v[52:55], v[156:159]
  ds_read_b64_tr_b16 a[254:255], v6 offset:18560
  ds_read_b64_tr_b16 a[192:193], v3 offset:24832
  v_mfma_f32_16x16x32_bf16 v[152:155], a[196:199], v[56:59], v[152:155]
  s_waitcnt lgkmcnt(8)
  buffer_store_dwordx4 a[8:11], v18, s[20:23], s79 offen offset:0 sc1 nt
  v_mfma_f32_16x16x32_bf16 v[156:159], a[196:199], v[60:63], v[156:159]
  ds_read_b64_tr_b16 a[194:195], v3 offset:30976
  ds_read_b64_tr_b16 a[196:197], v3 offset:256
  v_mfma_f32_16x16x32_bf16 v[168:171], a[200:203], v[32:35], v[168:171]
  s_waitcnt lgkmcnt(6)
  buffer_store_dwordx4 a[12:15], v18, s[20:23], s79 offen offset:3072 sc1 nt
  v_mfma_f32_16x16x32_bf16 v[172:175], a[200:203], v[36:39], v[172:175]
  ds_read_b64_tr_b16 a[198:199], v3 offset:6400
  ds_read_b64_tr_b16 a[200:201], v3 offset:37120
  v_cvt_pk_bf16_f32 v140, v140, v141
  v_cvt_pk_bf16_f32 v141, v142, v143
  v_mfma_f32_16x16x32_bf16 v[168:171], a[204:207], v[40:43], v[168:171]
  ds_write_addtid_b32 v136 offset:2048
  ds_write_addtid_b32 v137 offset:2304
  ds_write_addtid_b32 v140 offset:0
  ds_write_addtid_b32 v141 offset:256
  v_pk_mul_f32 v[152:153], v[152:153], v[14:15] op_sel_hi:[1,0]
  v_pk_mul_f32 v[154:155], v[154:155], v[14:15] op_sel_hi:[1,0]
  v_pk_mul_f32 v[156:157], v[156:157], v[16:17] op_sel_hi:[1,0]
  v_pk_mul_f32 v[158:159], v[158:159], v[16:17] op_sel_hi:[1,0]
  v_cvt_pk_bf16_f32 v152, v152, v153
  v_cvt_pk_bf16_f32 v153, v154, v155
  v_mfma_f32_16x16x32_bf16 v[172:175], a[204:207], v[44:47], v[172:175]
  ds_read_b64_tr_b16 a[202:203], v3 offset:43264
  ds_read_b64_tr_b16 a[204:205], v3 offset:12544
  v_mfma_f32_16x16x32_bf16 v[168:171], a[232:235], v[48:51], v[168:171]
  ds_write_addtid_b32 v152 offset:2560
  ds_write_addtid_b32 v153 offset:2816
  v_mfma_f32_16x16x32_bf16 v[172:175], a[232:235], v[52:55], v[172:175]
  ds_read_b64_tr_b16 a[206:207], v3 offset:18688
  ds_read_b64_tr_b16 a[232:233], v4 offset:24832
  v_mfma_f32_16x16x32_bf16 v[168:171], a[236:239], v[56:59], v[168:171]
  v_cvt_pk_bf16_f32 v156, v156, v157
  v_cvt_pk_bf16_f32 v157, v158, v159
  v_mfma_f32_16x16x32_bf16 v[172:175], a[236:239], v[60:63], v[172:175]
  ds_read_b64_tr_b16 a[234:235], v4 offset:30976
  ds_read_b64_tr_b16 a[236:237], v4 offset:256
  v_mfma_f32_16x16x32_bf16 v[184:187], a[240:243], v[32:35], v[184:187]
  ds_write_addtid_b32 v156 offset:512
  ds_write_addtid_b32 v157 offset:768
  v_mfma_f32_16x16x32_bf16 v[188:191], a[240:243], v[36:39], v[188:191]
  ds_read_b64_tr_b16 a[238:239], v4 offset:6400
  ds_read_b64_tr_b16 a[240:241], v4 offset:37120
  v_mfma_f32_16x16x32_bf16 v[184:187], a[244:247], v[40:43], v[184:187]
  v_pk_mul_f32 v[168:169], v[168:169], v[14:15] op_sel_hi:[1,0]
  v_pk_mul_f32 v[170:171], v[170:171], v[14:15] op_sel_hi:[1,0]
  v_pk_mul_f32 v[172:173], v[172:173], v[16:17] op_sel_hi:[1,0]
  v_pk_mul_f32 v[174:175], v[174:175], v[16:17] op_sel_hi:[1,0]
  v_cvt_pk_bf16_f32 v168, v168, v169
  v_cvt_pk_bf16_f32 v169, v170, v171
  v_mfma_f32_16x16x32_bf16 v[188:191], a[244:247], v[44:47], v[188:191]
  s_waitcnt lgkmcnt(10)
  ds_read_b64_tr_b16 a[242:243], v4 offset:43264
  ds_read_b64_tr_b16 a[244:245], v4 offset:12544
  v_mfma_f32_16x16x32_bf16 v[184:187], a[248:251], v[48:51], v[184:187]
  ds_write_addtid_b32 v168 offset:14368
  ds_write_addtid_b32 v169 offset:14624
  v_mfma_f32_16x16x32_bf16 v[188:191], a[248:251], v[52:55], v[188:191]
  ds_read_b64_tr_b16 a[246:247], v4 offset:18688
  ds_read_b64_tr_b16 a[248:249], v5 offset:24832
  v_mfma_f32_16x16x32_bf16 v[184:187], a[252:255], v[56:59], v[184:187]
  v_cvt_pk_bf16_f32 v172, v172, v173
  v_cvt_pk_bf16_f32 v173, v174, v175
  v_mfma_f32_16x16x32_bf16 v[188:191], a[252:255], v[60:63], v[188:191]
  ds_read_b64_tr_b16 a[250:251], v5 offset:30976
  ds_read_b64_tr_b16 a[252:253], v5 offset:256
  v_mfma_f32_16x16x32_bf16 v[200:203], a[192:195], v[32:35], v[200:203]
  ds_write_addtid_b32 v172 offset:12320
  ds_write_addtid_b32 v173 offset:12576
  v_mfma_f32_16x16x32_bf16 v[204:207], a[192:195], v[36:39], v[204:207]
  ds_read_b64_tr_b16 a[254:255], v5 offset:6400
  ds_read_b64_tr_b16 a[192:193], v5 offset:37120
  v_mfma_f32_16x16x32_bf16 v[200:203], a[196:199], v[40:43], v[200:203]
  v_pk_mul_f32 v[184:185], v[184:185], v[14:15] op_sel_hi:[1,0]
  v_pk_mul_f32 v[186:187], v[186:187], v[14:15] op_sel_hi:[1,0]
  v_pk_mul_f32 v[188:189], v[188:189], v[16:17] op_sel_hi:[1,0]
  v_pk_mul_f32 v[190:191], v[190:191], v[16:17] op_sel_hi:[1,0]
  v_cvt_pk_bf16_f32 v184, v184, v185
  v_cvt_pk_bf16_f32 v185, v186, v187
  v_cvt_pk_bf16_f32 v188, v188, v189
  v_cvt_pk_bf16_f32 v189, v190, v191
  v_mfma_f32_16x16x32_bf16 v[204:207], a[196:199], v[44:47], v[204:207]
  ds_read_b64_tr_b16 a[194:195], v5 offset:43264
  ds_write_addtid_b32 v184 offset:14880
  ds_write_addtid_b32 v185 offset:15136
  ds_write_addtid_b32 v188 offset:12832
  ds_write_addtid_b32 v189 offset:13088
  ds_read2st64_b32 a[16:17], v11 offset0:8 offset1:9
  v_mfma_f32_16x16x32_bf16 v[200:203], a[200:203], v[48:51], v[200:203]
  ds_read_b64_tr_b16 a[196:197], v5 offset:12544
  ds_read2st64_b32 a[18:19], v13 offset0:8 offset1:9
  v_mfma_f32_16x16x32_bf16 v[204:207], a[200:203], v[52:55], v[204:207]
  s_waitcnt lgkmcnt(14)
  ds_read_b64_tr_b16 a[198:199], v5 offset:18688
  ds_read_b64_tr_b16 a[200:201], v6 offset:24832
  ds_read2st64_b32 a[20:21], v15 offset0:8 offset1:9
  v_mfma_f32_16x16x32_bf16 v[200:203], a[204:207], v[56:59], v[200:203]
  ds_read2st64_b32 a[22:23], v17 offset0:8 offset1:9
  ds_read2st64_b32 a[24:25], v11 offset0:0 offset1:1
  v_mfma_f32_16x16x32_bf16 v[204:207], a[204:207], v[60:63], v[204:207]
  ds_read_b64_tr_b16 a[202:203], v6 offset:30976
  ds_read_b64_tr_b16 a[204:205], v6 offset:256
  v_mfma_f32_16x16x32_bf16 v[216:219], a[232:235], v[32:35], v[216:219]
  ds_read2st64_b32 a[26:27], v13 offset0:0 offset1:1
  ds_read2st64_b32 a[28:29], v15 offset0:0 offset1:1
  v_mfma_f32_16x16x32_bf16 v[220:223], a[232:235], v[36:39], v[220:223]
  ds_read_b64_tr_b16 a[206:207], v6 offset:6400
  ds_read_b64_tr_b16 a[232:233], v6 offset:37120
  v_mfma_f32_16x16x32_bf16 v[216:219], a[236:239], v[40:43], v[216:219]
  s_waitcnt lgkmcnt(11)
  buffer_store_dwordx4 a[16:19], v18, s[20:23], s78 offen offset:128 sc1 nt
  ds_read2st64_b32 a[30:31], v17 offset0:0 offset1:1
  v_pk_mul_f32 v[200:201], v[200:201], v[14:15] op_sel_hi:[1,0]
  v_pk_mul_f32 v[202:203], v[202:203], v[14:15] op_sel_hi:[1,0]
  v_pk_mul_f32 v[204:205], v[204:205], v[16:17] op_sel_hi:[1,0]
  v_pk_mul_f32 v[206:207], v[206:207], v[16:17] op_sel_hi:[1,0]
  v_cvt_pk_bf16_f32 v200, v200, v201
  v_cvt_pk_bf16_f32 v201, v202, v203
  v_mfma_f32_16x16x32_bf16 v[220:223], a[236:239], v[44:47], v[220:223]
  ds_read_b64_tr_b16 a[234:235], v6 offset:43264
  ds_read_b64_tr_b16 a[236:237], v6 offset:12544
  v_mfma_f32_16x16x32_bf16 v[216:219], a[240:243], v[48:51], v[216:219]
  s_waitcnt lgkmcnt(10)
  buffer_store_dwordx4 a[20:23], v18, s[20:23], s78 offen offset:3200 sc1 nt
  v_mfma_f32_16x16x32_bf16 v[220:223], a[240:243], v[52:55], v[220:223]
  ds_read_b64_tr_b16 a[238:239], v6 offset:18688
  ds_write_addtid_b32 v200 offset:1024
  v_mfma_f32_16x16x32_bf16 v[216:219], a[244:247], v[56:59], v[216:219]
  s_waitcnt lgkmcnt(8)
  buffer_store_dwordx4 a[24:27], v18, s[20:23], s79 offen offset:128 sc1 nt
  v_mfma_f32_16x16x32_bf16 v[220:223], a[244:247], v[60:63], v[220:223]
  ds_write_addtid_b32 v201 offset:1280
  v_cvt_pk_bf16_f32 v204, v204, v205
  v_mfma_f32_16x16x32_bf16 v[232:235], a[248:251], v[32:35], v[232:235]
  s_waitcnt lgkmcnt(5)
  buffer_store_dwordx4 a[28:31], v18, s[20:23], s79 offen offset:3200 sc1 nt
  v_mfma_f32_16x16x32_bf16 v[236:239], a[248:251], v[36:39], v[236:239]
  ds_write_addtid_b32 v204 offset:2048
  v_cvt_pk_bf16_f32 v205, v206, v207
  v_mfma_f32_16x16x32_bf16 v[232:235], a[252:255], v[40:43], v[232:235]
  ds_write_addtid_b32 v205 offset:2304
  v_pk_mul_f32 v[216:217], v[216:217], v[14:15] op_sel_hi:[1,0]
  v_pk_mul_f32 v[218:219], v[218:219], v[14:15] op_sel_hi:[1,0]
  v_pk_mul_f32 v[220:221], v[220:221], v[16:17] op_sel_hi:[1,0]
  v_pk_mul_f32 v[222:223], v[222:223], v[16:17] op_sel_hi:[1,0]
  v_cvt_pk_bf16_f32 v216, v216, v217
  v_cvt_pk_bf16_f32 v217, v218, v219
  v_mfma_f32_16x16x32_bf16 v[236:239], a[252:255], v[44:47], v[236:239]
  ds_write_addtid_b32 v216 offset:1536
  v_cmp_nle_f32_e32 vcc, 0x33800000, v14
  v_mfma_f32_16x16x32_bf16 v[232:235], a[192:195], v[48:51], v[232:235]
  s_or_b64 s[36:37], s[36:37], vcc
  ds_write_addtid_b32 v217 offset:1792
  v_cmp_lt_f32_e32 vcc, 0x49800000, v14
  v_mfma_f32_16x16x32_bf16 v[236:239], a[192:195], v[52:55], v[236:239]
  s_or_b64 s[36:37], s[36:37], vcc
  v_cmp_nle_f32_e32 vcc, 0x33800000, v16
  v_cvt_pk_bf16_f32 v220, v220, v221
  v_mfma_f32_16x16x32_bf16 v[232:235], a[196:199], v[56:59], v[232:235]
  s_or_b64 s[36:37], s[36:37], vcc
  ds_write_addtid_b32 v220 offset:2560
  v_cmp_lt_f32_e32 vcc, 0x49800000, v16
  v_mfma_f32_16x16x32_bf16 v[236:239], a[196:199], v[60:63], v[236:239]
  s_or_b64 s[36:37], s[36:37], vcc
  v_cvt_pk_bf16_f32 v221, v222, v223
  v_mfma_f32_16x16x32_bf16 v[248:251], a[200:203], v[32:35], v[248:251]
  ds_write_addtid_b32 v221 offset:2816
  v_mfma_f32_16x16x32_bf16 v[252:255], a[200:203], v[36:39], v[252:255]
  v_mfma_f32_16x16x32_bf16 v[248:251], a[204:207], v[40:43], v[248:251]
  v_pk_mul_f32 v[232:233], v[232:233], v[14:15] op_sel_hi:[1,0]
  v_pk_mul_f32 v[234:235], v[234:235], v[14:15] op_sel_hi:[1,0]
  v_pk_mul_f32 v[236:237], v[236:237], v[16:17] op_sel_hi:[1,0]
  v_pk_mul_f32 v[238:239], v[238:239], v[16:17] op_sel_hi:[1,0]
  v_cvt_pk_bf16_f32 v232, v232, v233
  v_cvt_pk_bf16_f32 v233, v234, v235
  v_mfma_f32_16x16x32_bf16 v[252:255], a[204:207], v[44:47], v[252:255]
  s_waitcnt lgkmcnt(3)
  ds_write_addtid_b32 v232 offset:13344
  ds_write_addtid_b32 v233 offset:13600
  v_mfma_f32_16x16x32_bf16 v[248:251], a[232:235], v[48:51], v[248:251]
  v_cvt_pk_bf16_f32 v236, v236, v237
  v_cvt_pk_bf16_f32 v237, v238, v239
  v_mfma_f32_16x16x32_bf16 v[252:255], a[232:235], v[52:55], v[252:255]
  ds_write_addtid_b32 v236 offset:14368
  ds_write_addtid_b32 v237 offset:14624
  v_mfma_f32_16x16x32_bf16 v[248:251], a[236:239], v[56:59], v[248:251]
  v_mfma_f32_16x16x32_bf16 v[252:255], a[236:239], v[60:63], v[252:255]
  s_nop 6
  v_pk_mul_f32 v[248:249], v[248:249], v[14:15] op_sel_hi:[1,0]
  v_pk_mul_f32 v[250:251], v[250:251], v[14:15] op_sel_hi:[1,0]
  v_pk_mul_f32 v[252:253], v[252:253], v[16:17] op_sel_hi:[1,0]
  v_pk_mul_f32 v[254:255], v[254:255], v[16:17] op_sel_hi:[1,0]
  v_cvt_pk_bf16_f32 v248, v248, v249
  v_cvt_pk_bf16_f32 v249, v250, v251
  v_cvt_pk_bf16_f32 v252, v252, v253
  v_cvt_pk_bf16_f32 v253, v254, v255
  ds_write_addtid_b32 v248 offset:13856
  ds_write_addtid_b32 v249 offset:14112
  ds_write_addtid_b32 v252 offset:14880
  ds_write_addtid_b32 v253 offset:15136
  ds_read2st64_b32 a[32:33], v11 offset0:4 offset1:5
  ds_read2st64_b32 a[34:35], v13 offset0:4 offset1:5
  ds_read2st64_b32 a[36:37], v15 offset0:4 offset1:5
  ds_read2st64_b32 a[38:39], v17 offset0:4 offset1:5
  ds_read2st64_b32 a[40:41], v11 offset0:8 offset1:9
  ds_read2st64_b32 a[42:43], v13 offset0:8 offset1:9
  ds_read2st64_b32 a[44:45], v15 offset0:8 offset1:9
  ds_read2st64_b32 a[46:47], v17 offset0:8 offset1:9
  s_waitcnt lgkmcnt(6)
  buffer_store_dwordx4 a[32:35], v18, s[20:23], s78 offen offset:256 sc1 nt
  s_waitcnt lgkmcnt(4)
  buffer_store_dwordx4 a[36:39], v18, s[20:23], s78 offen offset:3328 sc1 nt
  s_waitcnt lgkmcnt(2)
  buffer_store_dwordx4 a[40:43], v18, s[20:23], s79 offen offset:256 sc1 nt
  s_waitcnt lgkmcnt(0)
  buffer_store_dwordx4 a[44:47], v18, s[20:23], s79 offen offset:3328 sc1 nt
  s_or_b64 s[4:5], s[34:35], s[36:37]
  s_cbranch_scc1 L_fb
L_end:
  s_endpgm
L_codeend:
L_fb:
  s_waitcnt vmcnt(0) lgkmcnt(0)
  v_mbcnt_lo_u32_b32 v6, -1, 0
  v_mbcnt_hi_u32_b32 v6, -1, v6
  v_and_b32_e32 v7, 15, v6
  v_lshrrev_b32_e32 v8, 4, v6
  v_mul_u32_u24_e32 v7, 0x180, v7
  v_lshl_add_u32 v1, v8, 4, v7
  v_add_u32_e32 v2, 0x1800, v1
  v_lshl_add_u32 v5, v8, 3, v7
  v_lshlrev_b32_e32 v3, 4, v6
  v_lshrrev_b32_e32 v7, 5, v6
  v_mul_u32_u24_e32 v7, 0x3020, v7
  v_bfe_u32 v8, v6, 2, 3
  v_mul_u32_u24_e32 v8, 0x180, v8
  v_add_u32_e32 v7, v7, v8
  v_and_b32_e32 v8, 3, v6
  v_lshl_add_u32 v7, v8, 3, v7
  v_add_u32_e32 v4, s27, v7
  v_add_u32_e32 v18, 0x21200, v4
  s_mov_b32 s40, 0
L_fb_blk:
  s_cmp_eq_u64 s[34:35], 0
  s_cbranch_scc1 L_fb_next
  s_lshl_b32 s43, s27, 3
  s_add_u32 s43, s43, s40
  buffer_load_dwordx4 a[0:3], v1, s[16:19], s43 offen offset:0
  buffer_load_dwordx4 a[4:7], v1, s[16:19], s43 offen offset:64
  buffer_load_dwordx4 a[8:11], v1, s[16:19], s43 offen offset:128
  buffer_load_dwordx4 a[12:15], v1, s[16:19], s43 offen offset:192
  buffer_load_dwordx4 a[16:19], v1, s[16:19], s43 offen offset:256
  buffer_load_dwordx4 a[20:23], v1, s[16:19], s43 offen offset:320
  buffer_load_dwordx4 a[24:27], v2, s[16:19], s43 offen offset:0
  buffer_load_dwordx4 a[28:31], v2, s[16:19], s43 offen offset:64
  buffer_load_dwordx4 a[32:35], v2, s[16:19], s43 offen offset:128
  buffer_load_dwordx4 a[36:39], v2, s[16:19], s43 offen offset:192
  buffer_load_dwordx4 a[40:43], v2, s[16:19], s43 offen offset:256
  buffer_load_dwordx4 a[44:47], v2, s[16:19], s43 offen offset:320
  s_add_u32 s41, s43, 12288
  buffer_load_dwordx4 a[48:51], v1, s[16:19], s41 offen offset:0
  buffer_load_dwordx4 a[52:55], v1, s[16:19], s41 offen offset:64
  buffer_load_dwordx4 a[56:59], v1, s[16:19], s41 offen offset:128
  buffer_load_dwordx4 a[60:63], v1, s[16:19], s41 offen offset:192
  buffer_load_dwordx4 a[64:67], v1, s[16:19], s41 offen offset:256
  buffer_load_dwordx4 a[68:71], v1, s[16:19], s41 offen offset:320
  buffer_load_dwordx4 a[72:75], v2, s[16:19], s41 offen offset:0
  buffer_load_dwordx4 a[76:79], v2, s[16:19], s41 offen offset:64
  buffer_load_dwordx4 a[80:83], v2, s[16:19], s41 offen offset:128
  buffer_load_dwordx4 a[84:87], v2, s[16:19], s41 offen offset:192
  buffer_load_dwordx4 a[88:91], v2, s[16:19], s41 offen offset:256
  buffer_load_dwordx4 a[92:95], v2, s[16:19], s41 offen offset:320
  v_mov_b32_e32 v10, 0xff800000
  v_mov_b32_e32 v11, 0xff800000
  v_mov_b32_e32 v12, 0xff800000
  v_mov_b32_e32 v13, 0xff800000
  s_mov_b32 s41, s40
  s_mov_b32 s42, 0
L_fb_p1:
  buffer_load_dwordx4 a[96:99], v1, s[8:11], s41 offen offset:0
  buffer_load_dwordx4 a[100:103], v1, s[8:11], s41 offen offset:64
  buffer_load_dwordx4 a[104:107], v1, s[8:11], s41 offen offset:128
  buffer_load_dwordx4 a[108:111], v1, s[8:11], s41 offen offset:192
  buffer_load_dwordx4 a[112:115], v1, s[8:11], s41 offen offset:256
  buffer_load_dwordx4 a[116:119], v1, s[8:11], s41 offen offset:320
  buffer_load_dwordx4 a[120:123], v2, s[8:11], s41 offen offset:0
  buffer_load_dwordx4 a[124:127], v2, s[8:11], s41 offen offset:64
  buffer_load_dwordx4 a[128:131], v2, s[8:11], s41 offen offset:128
  buffer_load_dwordx4 a[132:135], v2, s[8:11], s41 offen offset:192
  buffer_load_dwordx4 a[136:139], v2, s[8:11], s41 offen offset:256
  buffer_load_dwordx4 a[140:143], v2, s[8:11], s41 offen offset:320
  s_waitcnt vmcnt(0)
  v_mfma_f32_16x16x32_bf16 v[20:23], a[96:99], a[0:3], 0
  v_mfma_f32_16x16x32_bf16 v[20:23], a[100:103], a[4:7], v[20:23]
  v_mfma_f32_16x16x32_bf16 v[20:23], a[104:107], a[8:11], v[20:23]
  v_mfma_f32_16x16x32_bf16 v[20:23], a[108:111], a[12:15], v[20:23]
  v_mfma_f32_16x16x32_bf16 v[20:23], a[112:115], a[16:19], v[20:23]
  v_mfma_f32_16x16x32_bf16 v[20:23], a[116:119], a[20:23], v[20:23]
  v_mfma_f32_16x16x32_bf16 v[24:27], a[120:123], a[0:3], 0
  v_mfma_f32_16x16x32_bf16 v[24:27], a[124:127], a[4:7], v[24:27]
  v_mfma_f32_16x16x32_bf16 v[24:27], a[128:131], a[8:11], v[24:27]
  v_mfma_f32_16x16x32_bf16 v[24:27], a[132:135], a[12:15], v[24:27]
  v_mfma_f32_16x16x32_bf16 v[24:27], a[136:139], a[16:19], v[24:27]
  v_mfma_f32_16x16x32_bf16 v[24:27], a[140:143], a[20:23], v[24:27]
  v_mfma_f32_16x16x32_bf16 v[28:31], a[96:99], a[24:27], 0
  v_mfma_f32_16x16x32_bf16 v[28:31], a[100:103], a[28:31], v[28:31]
  v_mfma_f32_16x16x32_bf16 v[28:31], a[104:107], a[32:35], v[28:31]
  v_mfma_f32_16x16x32_bf16 v[28:31], a[108:111], a[36:39], v[28:31]
  v_mfma_f32_16x16x32_bf16 v[28:31], a[112:115], a[40:43], v[28:31]
  v_mfma_f32_16x16x32_bf16 v[28:31], a[116:119], a[44:47], v[28:31]
  v_mfma_f32_16x16x32_bf16 v[32:35], a[120:123], a[24:27], 0
  v_mfma_f32_16x16x32_bf16 v[32:35], a[124:127], a[28:31], v[32:35]
  v_mfma_f32_16x16x32_bf16 v[32:35], a[128:131], a[32:35], v[32:35]
  v_mfma_f32_16x16x32_bf16 v[32:35], a[132:135], a[36:39], v[32:35]
  v_mfma_f32_16x16x32_bf16 v[32:35], a[136:139], a[40:43], v[32:35]
  v_mfma_f32_16x16x32_bf16 v[32:35], a[140:143], a[44:47], v[32:35]
  v_mfma_f32_16x16x32_bf16 v[36:39], a[96:99], a[48:51], 0
  v_mfma_f32_16x16x32_bf16 v[36:39], a[100:103], a[52:55], v[36:39]
  v_mfma_f32_16x16x32_bf16 v[36:39], a[104:107], a[56:59], v[36:39]
  v_mfma_f32_16x16x32_bf16 v[36:39], a[108:111], a[60:63], v[36:39]
  v_mfma_f32_16x16x32_bf16 v[36:39], a[112:115], a[64:67], v[36:39]
  v_mfma_f32_16x16x32_bf16 v[36:39], a[116:119], a[68:71], v[36:39]
  v_mfma_f32_16x16x32_bf16 v[40:43], a[120:123], a[48:51], 0
  v_mfma_f32_16x16x32_bf16 v[40:43], a[124:127], a[52:55], v[40:43]
  v_mfma_f32_16x16x32_bf16 v[40:43], a[128:131], a[56:59], v[40:43]
  v_mfma_f32_16x16x32_bf16 v[40:43], a[132:135], a[60:63], v[40:43]
  v_mfma_f32_16x16x32_bf16 v[40:43], a[136:139], a[64:67], v[40:43]
  v_mfma_f32_16x16x32_bf16 v[40:43], a[140:143], a[68:71], v[40:43]
  v_mfma_f32_16x16x32_bf16 v[44:47], a[96:99], a[72:75], 0
  v_mfma_f32_16x16x32_bf16 v[44:47], a[100:103], a[76:79], v[44:47]
  v_mfma_f32_16x16x32_bf16 v[44:47], a[104:107], a[80:83], v[44:47]
  v_mfma_f32_16x16x32_bf16 v[44:47], a[108:111], a[84:87], v[44:47]
  v_mfma_f32_16x16x32_bf16 v[44:47], a[112:115], a[88:91], v[44:47]
  v_mfma_f32_16x16x32_bf16 v[44:47], a[116:119], a[92:95], v[44:47]
  v_mfma_f32_16x16x32_bf16 v[48:51], a[120:123], a[72:75], 0
  v_mfma_f32_16x16x32_bf16 v[48:51], a[124:127], a[76:79], v[48:51]
  v_mfma_f32_16x16x32_bf16 v[48:51], a[128:131], a[80:83], v[48:51]
  v_mfma_f32_16x16x32_bf16 v[48:51], a[132:135], a[84:87], v[48:51]
  v_mfma_f32_16x16x32_bf16 v[48:51], a[136:139], a[88:91], v[48:51]
  v_mfma_f32_16x16x32_bf16 v[48:51], a[140:143], a[92:95], v[48:51]
  s_nop 7
  v_max3_f32 v10, v10, v20, v21
  v_max3_f32 v10, v10, v22, v23
  v_max3_f32 v10, v10, v24, v25
  v_max3_f32 v10, v10, v26, v27
  v_max3_f32 v11, v11, v28, v29
  v_max3_f32 v11, v11, v30, v31
  v_max3_f32 v11, v11, v32, v33
  v_max3_f32 v11, v11, v34, v35
  v_max3_f32 v12, v12, v36, v37
  v_max3_f32 v12, v12, v38, v39
  v_max3_f32 v12, v12, v40, v41
  v_max3_f32 v12, v12, v42, v43
  v_max3_f32 v13, v13, v44, v45
  v_max3_f32 v13, v13, v46, v47
  v_max3_f32 v13, v13, v48, v49
  v_max3_f32 v13, v13, v50, v51
  s_add_u32 s41, s41, 12288
  s_add_u32 s42, s42, 1
  s_cmp_lt_u32 s42, 16
  s_nop 7
  s_cbranch_scc1 L_fb_p1
  v_mov_b32_e32 v6, v10
  s_nop 1
  v_permlane16_swap_b32_e32 v10, v6
  v_max_f32_e32 v10, v10, v6
  v_mov_b32_e32 v6, v10
  s_nop 1
  v_permlane32_swap_b32_e32 v10, v6
  v_max_f32_e32 v10, v10, v6
  v_mov_b32_e32 v14, 0
  v_mov_b32_e32 v6, v11
  s_nop 1
  v_permlane16_swap_b32_e32 v11, v6
  v_max_f32_e32 v11, v11, v6
  v_mov_b32_e32 v6, v11
  s_nop 1
  v_permlane32_swap_b32_e32 v11, v6
  v_max_f32_e32 v11, v11, v6
  v_mov_b32_e32 v15, 0
  v_mov_b32_e32 v6, v12
  s_nop 1
  v_permlane16_swap_b32_e32 v12, v6
  v_max_f32_e32 v12, v12, v6
  v_mov_b32_e32 v6, v12
  s_nop 1
  v_permlane32_swap_b32_e32 v12, v6
  v_max_f32_e32 v12, v12, v6
  v_mov_b32_e32 v16, 0
  v_mov_b32_e32 v6, v13
  s_nop 1
  v_permlane16_swap_b32_e32 v13, v6
  v_max_f32_e32 v13, v13, v6
  v_mov_b32_e32 v6, v13
  s_nop 1
  v_permlane32_swap_b32_e32 v13, v6
  v_max_f32_e32 v13, v13, v6
  v_mov_b32_e32 v17, 0
  v_mov_b32_e32 v64, 0
  v_mov_b32_e32 v65, 0
  v_mov_b32_e32 v66, 0
  v_mov_b32_e32 v67, 0
  v_mov_b32_e32 v68, 0
  v_mov_b32_e32 v69, 0
  v_mov_b32_e32 v70, 0
  v_mov_b32_e32 v71, 0
  v_mov_b32_e32 v72, 0
  v_mov_b32_e32 v73, 0
  v_mov_b32_e32 v74, 0
  v_mov_b32_e32 v75, 0
  v_mov_b32_e32 v76, 0
  v_mov_b32_e32 v77, 0
  v_mov_b32_e32 v78, 0
  v_mov_b32_e32 v79, 0
  v_mov_b32_e32 v80, 0
  v_mov_b32_e32 v81, 0
  v_mov_b32_e32 v82, 0
  v_mov_b32_e32 v83, 0
  v_mov_b32_e32 v84, 0
  v_mov_b32_e32 v85, 0
  v_mov_b32_e32 v86, 0
  v_mov_b32_e32 v87, 0
  v_mov_b32_e32 v88, 0
  v_mov_b32_e32 v89, 0
  v_mov_b32_e32 v90, 0
  v_mov_b32_e32 v91, 0
  v_mov_b32_e32 v92, 0
  v_mov_b32_e32 v93, 0
  v_mov_b32_e32 v94, 0
  v_mov_b32_e32 v95, 0
  v_mov_b32_e32 v96, 0
  v_mov_b32_e32 v97, 0
  v_mov_b32_e32 v98, 0
  v_mov_b32_e32 v99, 0
  v_mov_b32_e32 v100, 0
  v_mov_b32_e32 v101, 0
  v_mov_b32_e32 v102, 0
  v_mov_b32_e32 v103, 0
  v_mov_b32_e32 v104, 0
  v_mov_b32_e32 v105, 0
  v_mov_b32_e32 v106, 0
  v_mov_b32_e32 v107, 0
  v_mov_b32_e32 v108, 0
  v_mov_b32_e32 v109, 0
  v_mov_b32_e32 v110, 0
  v_mov_b32_e32 v111, 0
  v_mov_b32_e32 v112, 0
  v_mov_b32_e32 v113, 0
  v_mov_b32_e32 v114, 0
  v_mov_b32_e32 v115, 0
  v_mov_b32_e32 v116, 0
  v_mov_b32_e32 v117, 0
  v_mov_b32_e32 v118, 0
  v_mov_b32_e32 v119, 0
  v_mov_b32_e32 v120, 0
  v_mov_b32_e32 v121, 0
  v_mov_b32_e32 v122, 0
  v_mov_b32_e32 v123, 0
  v_mov_b32_e32 v124, 0
  v_mov_b32_e32 v125, 0
  v_mov_b32_e32 v126, 0
  v_mov_b32_e32 v127, 0
  v_mov_b32_e32 v128, 0
  v_mov_b32_e32 v129, 0
  v_mov_b32_e32 v130, 0
  v_mov_b32_e32 v131, 0
  v_mov_b32_e32 v132, 0
  v_mov_b32_e32 v133, 0
  v_mov_b32_e32 v134, 0
  v_mov_b32_e32 v135, 0
  v_mov_b32_e32 v136, 0
  v_mov_b32_e32 v137, 0
  v_mov_b32_e32 v138, 0
  v_mov_b32_e32 v139, 0
  v_mov_b32_e32 v140, 0
  v_mov_b32_e32 v141, 0
  v_mov_b32_e32 v142, 0
  v_mov_b32_e32 v143, 0
  v_mov_b32_e32 v144, 0
  v_mov_b32_e32 v145, 0
  v_mov_b32_e32 v146, 0
  v_mov_b32_e32 v147, 0
  v_mov_b32_e32 v148, 0
  v_mov_b32_e32 v149, 0
  v_mov_b32_e32 v150, 0
  v_mov_b32_e32 v151, 0
  v_mov_b32_e32 v152, 0
  v_mov_b32_e32 v153, 0
  v_mov_b32_e32 v154, 0
  v_mov_b32_e32 v155, 0
  v_mov_b32_e32 v156, 0
  v_mov_b32_e32 v157, 0
  v_mov_b32_e32 v158, 0
  v_mov_b32_e32 v159, 0
  v_mov_b32_e32 v160, 0
  v_mov_b32_e32 v161, 0
  v_mov_b32_e32 v162, 0
  v_mov_b32_e32 v163, 0
  v_mov_b32_e32 v164, 0
  v_mov_b32_e32 v165, 0
  v_mov_b32_e32 v166, 0
  v_mov_b32_e32 v167, 0
  v_mov_b32_e32 v168, 0
  v_mov_b32_e32 v169, 0
  v_mov_b32_e32 v170, 0
  v_mov_b32_e32 v171, 0
  v_mov_b32_e32 v172, 0
  v_mov_b32_e32 v173, 0
  v_mov_b32_e32 v174, 0
  v_mov_b32_e32 v175, 0
  v_mov_b32_e32 v176, 0
  v_mov_b32_e32 v177, 0
  v_mov_b32_e32 v178, 0
  v_mov_b32_e32 v179, 0
  v_mov_b32_e32 v180, 0
  v_mov_b32_e32 v181, 0
  v_mov_b32_e32 v182, 0
  v_mov_b32_e32 v183, 0
  v_mov_b32_e32 v184, 0
  v_mov_b32_e32 v185, 0
  v_mov_b32_e32 v186, 0
  v_mov_b32_e32 v187, 0
  v_mov_b32_e32 v188, 0
  v_mov_b32_e32 v189, 0
  v_mov_b32_e32 v190, 0
  v_mov_b32_e32 v191, 0
  v_mov_b32_e32 v192, 0
  v_mov_b32_e32 v193, 0
  v_mov_b32_e32 v194, 0
  v_mov_b32_e32 v195, 0
  v_mov_b32_e32 v196, 0
  v_mov_b32_e32 v197, 0
  v_mov_b32_e32 v198, 0
  v_mov_b32_e32 v199, 0
  v_mov_b32_e32 v200, 0
  v_mov_b32_e32 v201, 0
  v_mov_b32_e32 v202, 0
  v_mov_b32_e32 v203, 0
  v_mov_b32_e32 v204, 0
  v_mov_b32_e32 v205, 0
  v_mov_b32_e32 v206, 0
  v_mov_b32_e32 v207, 0
  v_mov_b32_e32 v208, 0
  v_mov_b32_e32 v209, 0
  v_mov_b32_e32 v210, 0
  v_mov_b32_e32 v211, 0
  v_mov_b32_e32 v212, 0
  v_mov_b32_e32 v213, 0
  v_mov_b32_e32 v214, 0
  v_mov_b32_e32 v215, 0
  v_mov_b32_e32 v216, 0
  v_mov_b32_e32 v217, 0
  v_mov_b32_e32 v218, 0
  v_mov_b32_e32 v219, 0
  v_mov_b32_e32 v220, 0
  v_mov_b32_e32 v221, 0
  v_mov_b32_e32 v222, 0
  v_mov_b32_e32 v223, 0
  v_mov_b32_e32 v224, 0
  v_mov_b32_e32 v225, 0
  v_mov_b32_e32 v226, 0
  v_mov_b32_e32 v227, 0
  v_mov_b32_e32 v228, 0
  v_mov_b32_e32 v229, 0
  v_mov_b32_e32 v230, 0
  v_mov_b32_e32 v231, 0
  v_mov_b32_e32 v232, 0
  v_mov_b32_e32 v233, 0
  v_mov_b32_e32 v234, 0
  v_mov_b32_e32 v235, 0
  v_mov_b32_e32 v236, 0
  v_mov_b32_e32 v237, 0
  v_mov_b32_e32 v238, 0
  v_mov_b32_e32 v239, 0
  v_mov_b32_e32 v240, 0
  v_mov_b32_e32 v241, 0
  v_mov_b32_e32 v242, 0
  v_mov_b32_e32 v243, 0
  v_mov_b32_e32 v244, 0
  v_mov_b32_e32 v245, 0
  v_mov_b32_e32 v246, 0
  v_mov_b32_e32 v247, 0
  v_mov_b32_e32 v248, 0
  v_mov_b32_e32 v249, 0
  v_mov_b32_e32 v250, 0
  v_mov_b32_e32 v251, 0
  v_mov_b32_e32 v252, 0
  v_mov_b32_e32 v253, 0
  v_mov_b32_e32 v254, 0
  v_mov_b32_e32 v255, 0
  s_mov_b32 s41, s40
  s_mov_b32 s42, 0
L_fb_p2:
  s_add_u32 m0, s27, 0
  s_add_u32 s3, s41, 0
  buffer_load_dwordx4 v3, s[12:15], s3 offen offset:0 lds
  buffer_load_dwordx4 v3, s[12:15], s3 offen offset:1024 lds
  buffer_load_dwordx4 v3, s[12:15], s3 offen offset:2048 lds
  s_add_u32 m0, s27, 12320
  s_add_u32 s3, s41, 3072
  buffer_load_dwordx4 v3, s[12:15], s3 offen offset:0 lds
  buffer_load_dwordx4 v3, s[12:15], s3 offen offset:1024 lds
  buffer_load_dwordx4 v3, s[12:15], s3 offen offset:2048 lds
  s_add_u32 m0, s27, 135680
  s_add_u32 s3, s41, 6144
  buffer_load_dwordx4 v3, s[12:15], s3 offen offset:0 lds
  buffer_load_dwordx4 v3, s[12:15], s3 offen offset:1024 lds
  buffer_load_dwordx4 v3, s[12:15], s3 offen offset:2048 lds
  s_add_u32 m0, s27, 148000
  s_add_u32 s3, s41, 9216
  buffer_load_dwordx4 v3, s[12:15], s3 offen offset:0 lds
  buffer_load_dwordx4 v3, s[12:15], s3 offen offset:1024 lds
  buffer_load_dwordx4 v3, s[12:15], s3 offen offset:2048 lds
  buffer_load_dwordx4 a[96:99], v1, s[8:11], s41 offen offset:0
  buffer_load_dwordx4 a[100:103], v1, s[8:11], s41 offen offset:64
  buffer_load_dwordx4 a[104:107], v1, s[8:11], s41 offen offset:128
  buffer_load_dwordx4 a[108:111], v1, s[8:11], s41 offen offset:192
  buffer_load_dwordx4 a[112:115], v1, s[8:11], s41 offen offset:256
  buffer_load_dwordx4 a[116:119], v1, s[8:11], s41 offen offset:320
  buffer_load_dwordx4 a[120:123], v2, s[8:11], s41 offen offset:0
  buffer_load_dwordx4 a[124:127], v2, s[8:11], s41 offen offset:64
  buffer_load_dwordx4 a[128:131], v2, s[8:11], s41 offen offset:128
  buffer_load_dwordx4 a[132:135], v2, s[8:11], s41 offen offset:192
  buffer_load_dwordx4 a[136:139], v2, s[8:11], s41 offen offset:256
  buffer_load_dwordx4 a[140:143], v2, s[8:11], s41 offen offset:320
  s_waitcnt vmcnt(0)
  v_mfma_f32_16x16x32_bf16 v[20:23], a[96:99], a[0:3], 0
  v_mfma_f32_16x16x32_bf16 v[20:23], a[100:103], a[4:7], v[20:23]
  v_mfma_f32_16x16x32_bf16 v[20:23], a[104:107], a[8:11], v[20:23]
  v_mfma_f32_16x16x32_bf16 v[20:23], a[108:111], a[12:15], v[20:23]
  v_mfma_f32_16x16x32_bf16 v[20:23], a[112:115], a[16:19], v[20:23]
  v_mfma_f32_16x16x32_bf16 v[20:23], a[116:119], a[20:23], v[20:23]
  v_mfma_f32_16x16x32_bf16 v[24:27], a[120:123], a[0:3], 0
  v_mfma_f32_16x16x32_bf16 v[24:27], a[124:127], a[4:7], v[24:27]
  v_mfma_f32_16x16x32_bf16 v[24:27], a[128:131], a[8:11], v[24:27]
  v_mfma_f32_16x16x32_bf16 v[24:27], a[132:135], a[12:15], v[24:27]
  v_mfma_f32_16x16x32_bf16 v[24:27], a[136:139], a[16:19], v[24:27]
  v_mfma_f32_16x16x32_bf16 v[24:27], a[140:143], a[20:23], v[24:27]
  v_mfma_f32_16x16x32_bf16 v[28:31], a[96:99], a[24:27], 0
  v_mfma_f32_16x16x32_bf16 v[28:31], a[100:103], a[28:31], v[28:31]
  v_mfma_f32_16x16x32_bf16 v[28:31], a[104:107], a[32:35], v[28:31]
  v_mfma_f32_16x16x32_bf16 v[28:31], a[108:111], a[36:39], v[28:31]
  v_mfma_f32_16x16x32_bf16 v[28:31], a[112:115], a[40:43], v[28:31]
  v_mfma_f32_16x16x32_bf16 v[28:31], a[116:119], a[44:47], v[28:31]
  v_mfma_f32_16x16x32_bf16 v[32:35], a[120:123], a[24:27], 0
  v_mfma_f32_16x16x32_bf16 v[32:35], a[124:127], a[28:31], v[32:35]
  v_mfma_f32_16x16x32_bf16 v[32:35], a[128:131], a[32:35], v[32:35]
  v_mfma_f32_16x16x32_bf16 v[32:35], a[132:135], a[36:39], v[32:35]
  v_mfma_f32_16x16x32_bf16 v[32:35], a[136:139], a[40:43], v[32:35]
  v_mfma_f32_16x16x32_bf16 v[32:35], a[140:143], a[44:47], v[32:35]
  v_mfma_f32_16x16x32_bf16 v[36:39], a[96:99], a[48:51], 0
  v_mfma_f32_16x16x32_bf16 v[36:39], a[100:103], a[52:55], v[36:39]
  v_mfma_f32_16x16x32_bf16 v[36:39], a[104:107], a[56:59], v[36:39]
  v_mfma_f32_16x16x32_bf16 v[36:39], a[108:111], a[60:63], v[36:39]
  v_mfma_f32_16x16x32_bf16 v[36:39], a[112:115], a[64:67], v[36:39]
  v_mfma_f32_16x16x32_bf16 v[36:39], a[116:119], a[68:71], v[36:39]
  v_mfma_f32_16x16x32_bf16 v[40:43], a[120:123], a[48:51], 0
  v_mfma_f32_16x16x32_bf16 v[40:43], a[124:127], a[52:55], v[40:43]
  v_mfma_f32_16x16x32_bf16 v[40:43], a[128:131], a[56:59], v[40:43]
  v_mfma_f32_16x16x32_bf16 v[40:43], a[132:135], a[60:63], v[40:43]
  v_mfma_f32_16x16x32_bf16 v[40:43], a[136:139], a[64:67], v[40:43]
  v_mfma_f32_16x16x32_bf16 v[40:43], a[140:143], a[68:71], v[40:43]
  v_mfma_f32_16x16x32_bf16 v[44:47], a[96:99], a[72:75], 0
  v_mfma_f32_16x16x32_bf16 v[44:47], a[100:103], a[76:79], v[44:47]
  v_mfma_f32_16x16x32_bf16 v[44:47], a[104:107], a[80:83], v[44:47]
  v_mfma_f32_16x16x32_bf16 v[44:47], a[108:111], a[84:87], v[44:47]
  v_mfma_f32_16x16x32_bf16 v[44:47], a[112:115], a[88:91], v[44:47]
  v_mfma_f32_16x16x32_bf16 v[44:47], a[116:119], a[92:95], v[44:47]
  v_mfma_f32_16x16x32_bf16 v[48:51], a[120:123], a[72:75], 0
  v_mfma_f32_16x16x32_bf16 v[48:51], a[124:127], a[76:79], v[48:51]
  v_mfma_f32_16x16x32_bf16 v[48:51], a[128:131], a[80:83], v[48:51]
  v_mfma_f32_16x16x32_bf16 v[48:51], a[132:135], a[84:87], v[48:51]
  v_mfma_f32_16x16x32_bf16 v[48:51], a[136:139], a[88:91], v[48:51]
  v_mfma_f32_16x16x32_bf16 v[48:51], a[140:143], a[92:95], v[48:51]
  s_nop 7
  ds_read_b64_tr_b16 a[144:145], v4 offset:0
  ds_read_b64_tr_b16 a[146:147], v18 offset:0
  ds_read_b64_tr_b16 a[148:149], v4 offset:32
  ds_read_b64_tr_b16 a[150:151], v18 offset:32
  ds_read_b64_tr_b16 a[152:153], v4 offset:64
  ds_read_b64_tr_b16 a[154:155], v18 offset:64
  ds_read_b64_tr_b16 a[156:157], v4 offset:96
  ds_read_b64_tr_b16 a[158:159], v18 offset:96
  ds_read_b64_tr_b16 a[160:161], v4 offset:128
  ds_read_b64_tr_b16 a[162:163], v18 offset:128
  ds_read_b64_tr_b16 a[164:165], v4 offset:160
  ds_read_b64_tr_b16 a[166:167], v18 offset:160
  ds_read_b64_tr_b16 a[168:169], v4 offset:192
  ds_read_b64_tr_b16 a[170:171], v18 offset:192
  ds_read_b64_tr_b16 a[172:173], v4 offset:224
  ds_read_b64_tr_b16 a[174:175], v18 offset:224
  ds_read_b64_tr_b16 a[176:177], v4 offset:256
  ds_read_b64_tr_b16 a[178:179], v18 offset:256
  ds_read_b64_tr_b16 a[180:181], v4 offset:288
  ds_read_b64_tr_b16 a[182:183], v18 offset:288
  ds_read_b64_tr_b16 a[184:185], v4 offset:320
  ds_read_b64_tr_b16 a[186:187], v18 offset:320
  ds_read_b64_tr_b16 a[188:189], v4 offset:352
  ds_read_b64_tr_b16 a[190:191], v18 offset:352
  v_sub_f32_e32 v20, v20, v10
  v_sub_f32_e32 v21, v21, v10
  v_sub_f32_e32 v22, v22, v10
  v_sub_f32_e32 v23, v23, v10
  v_sub_f32_e32 v24, v24, v10
  v_sub_f32_e32 v25, v25, v10
  v_sub_f32_e32 v26, v26, v10
  v_sub_f32_e32 v27, v27, v10
  v_mul_f32_e32 v20, s25, v20
  v_mul_f32_e32 v21, s25, v21
  v_mul_f32_e32 v22, s25, v22
  v_mul_f32_e32 v23, s25, v23
  v_mul_f32_e32 v24, s25, v24
  v_mul_f32_e32 v25, s25, v25
  v_mul_f32_e32 v26, s25, v26
  v_mul_f32_e32 v27, s25, v27
  v_exp_f32_e32 v20, v20
  v_exp_f32_e32 v21, v21
  v_exp_f32_e32 v22, v22
  v_exp_f32_e32 v23, v23
  v_exp_f32_e32 v24, v24
  v_exp_f32_e32 v25, v25
  v_exp_f32_e32 v26, v26
  v_exp_f32_e32 v27, v27
  v_add_f32_e32 v14, v14, v20
  v_add_f32_e32 v14, v14, v21
  v_add_f32_e32 v14, v14, v22
  v_add_f32_e32 v14, v14, v23
  v_add_f32_e32 v14, v14, v24
  v_add_f32_e32 v14, v14, v25
  v_add_f32_e32 v14, v14, v26
  v_add_f32_e32 v14, v14, v27
  v_cvt_pk_bf16_f32 v20, v20, v21
  v_cvt_pk_bf16_f32 v21, v22, v23
  v_cvt_pk_bf16_f32 v22, v24, v25
  v_cvt_pk_bf16_f32 v23, v26, v27
  v_sub_f32_e32 v28, v28, v11
  v_sub_f32_e32 v29, v29, v11
  v_sub_f32_e32 v30, v30, v11
  v_sub_f32_e32 v31, v31, v11
  v_sub_f32_e32 v32, v32, v11
  v_sub_f32_e32 v33, v33, v11
  v_sub_f32_e32 v34, v34, v11
  v_sub_f32_e32 v35, v35, v11
  v_mul_f32_e32 v28, s25, v28
  v_mul_f32_e32 v29, s25, v29
  v_mul_f32_e32 v30, s25, v30
  v_mul_f32_e32 v31, s25, v31
  v_mul_f32_e32 v32, s25, v32
  v_mul_f32_e32 v33, s25, v33
  v_mul_f32_e32 v34, s25, v34
  v_mul_f32_e32 v35, s25, v35
  v_exp_f32_e32 v28, v28
  v_exp_f32_e32 v29, v29
  v_exp_f32_e32 v30, v30
  v_exp_f32_e32 v31, v31
  v_exp_f32_e32 v32, v32
  v_exp_f32_e32 v33, v33
  v_exp_f32_e32 v34, v34
  v_exp_f32_e32 v35, v35
  v_add_f32_e32 v15, v15, v28
  v_add_f32_e32 v15, v15, v29
  v_add_f32_e32 v15, v15, v30
  v_add_f32_e32 v15, v15, v31
  v_add_f32_e32 v15, v15, v32
  v_add_f32_e32 v15, v15, v33
  v_add_f32_e32 v15, v15, v34
  v_add_f32_e32 v15, v15, v35
  v_cvt_pk_bf16_f32 v28, v28, v29
  v_cvt_pk_bf16_f32 v29, v30, v31
  v_cvt_pk_bf16_f32 v30, v32, v33
  v_cvt_pk_bf16_f32 v31, v34, v35
  v_sub_f32_e32 v36, v36, v12
  v_sub_f32_e32 v37, v37, v12
  v_sub_f32_e32 v38, v38, v12
  v_sub_f32_e32 v39, v39, v12
  v_sub_f32_e32 v40, v40, v12
  v_sub_f32_e32 v41, v41, v12
  v_sub_f32_e32 v42, v42, v12
  v_sub_f32_e32 v43, v43, v12
  v_mul_f32_e32 v36, s25, v36
  v_mul_f32_e32 v37, s25, v37
  v_mul_f32_e32 v38, s25, v38
  v_mul_f32_e32 v39, s25, v39
  v_mul_f32_e32 v40, s25, v40
  v_mul_f32_e32 v41, s25, v41
  v_mul_f32_e32 v42, s25, v42
  v_mul_f32_e32 v43, s25, v43
  v_exp_f32_e32 v36, v36
  v_exp_f32_e32 v37, v37
  v_exp_f32_e32 v38, v38
  v_exp_f32_e32 v39, v39
  v_exp_f32_e32 v40, v40
  v_exp_f32_e32 v41, v41
  v_exp_f32_e32 v42, v42
  v_exp_f32_e32 v43, v43
  v_add_f32_e32 v16, v16, v36
  v_add_f32_e32 v16, v16, v37
  v_add_f32_e32 v16, v16, v38
  v_add_f32_e32 v16, v16, v39
  v_add_f32_e32 v16, v16, v40
  v_add_f32_e32 v16, v16, v41
  v_add_f32_e32 v16, v16, v42
  v_add_f32_e32 v16, v16, v43
  v_cvt_pk_bf16_f32 v36, v36, v37
  v_cvt_pk_bf16_f32 v37, v38, v39
  v_cvt_pk_bf16_f32 v38, v40, v41
  v_cvt_pk_bf16_f32 v39, v42, v43
  v_sub_f32_e32 v44, v44, v13
  v_sub_f32_e32 v45, v45, v13
  v_sub_f32_e32 v46, v46, v13
  v_sub_f32_e32 v47, v47, v13
  v_sub_f32_e32 v48, v48, v13
  v_sub_f32_e32 v49, v49, v13
  v_sub_f32_e32 v50, v50, v13
  v_sub_f32_e32 v51, v51, v13
  v_mul_f32_e32 v44, s25, v44
  v_mul_f32_e32 v45, s25, v45
  v_mul_f32_e32 v46, s25, v46
  v_mul_f32_e32 v47, s25, v47
  v_mul_f32_e32 v48, s25, v48
  v_mul_f32_e32 v49, s25, v49
  v_mul_f32_e32 v50, s25, v50
  v_mul_f32_e32 v51, s25, v51
  v_exp_f32_e32 v44, v44
  v_exp_f32_e32 v45, v45
  v_exp_f32_e32 v46, v46
  v_exp_f32_e32 v47, v47
  v_exp_f32_e32 v48, v48
  v_exp_f32_e32 v49, v49
  v_exp_f32_e32 v50, v50
  v_exp_f32_e32 v51, v51
  v_add_f32_e32 v17, v17, v44
  v_add_f32_e32 v17, v17, v45
  v_add_f32_e32 v17, v17, v46
  v_add_f32_e32 v17, v17, v47
  v_add_f32_e32 v17, v17, v48
  v_add_f32_e32 v17, v17, v49
  v_add_f32_e32 v17, v17, v50
  v_add_f32_e32 v17, v17, v51
  v_cvt_pk_bf16_f32 v44, v44, v45
  v_cvt_pk_bf16_f32 v45, v46, v47
  v_cvt_pk_bf16_f32 v46, v48, v49
  v_cvt_pk_bf16_f32 v47, v50, v51
  s_waitcnt lgkmcnt(0)
  v_mfma_f32_16x16x32_bf16 v[64:67], a[144:147], v[20:23], v[64:67]
  v_mfma_f32_16x16x32_bf16 v[68:71], a[144:147], v[28:31], v[68:71]
  v_mfma_f32_16x16x32_bf16 v[72:75], a[144:147], v[36:39], v[72:75]
  v_mfma_f32_16x16x32_bf16 v[76:79], a[144:147], v[44:47], v[76:79]
  v_mfma_f32_16x16x32_bf16 v[80:83], a[148:151], v[20:23], v[80:83]
  v_mfma_f32_16x16x32_bf16 v[84:87], a[148:151], v[28:31], v[84:87]
  v_mfma_f32_16x16x32_bf16 v[88:91], a[148:151], v[36:39], v[88:91]
  v_mfma_f32_16x16x32_bf16 v[92:95], a[148:151], v[44:47], v[92:95]
  v_mfma_f32_16x16x32_bf16 v[96:99], a[152:155], v[20:23], v[96:99]
  v_mfma_f32_16x16x32_bf16 v[100:103], a[152:155], v[28:31], v[100:103]
  v_mfma_f32_16x16x32_bf16 v[104:107], a[152:155], v[36:39], v[104:107]
  v_mfma_f32_16x16x32_bf16 v[108:111], a[152:155], v[44:47], v[108:111]
  v_mfma_f32_16x16x32_bf16 v[112:115], a[156:159], v[20:23], v[112:115]
  v_mfma_f32_16x16x32_bf16 v[116:119], a[156:159], v[28:31], v[116:119]
  v_mfma_f32_16x16x32_bf16 v[120:123], a[156:159], v[36:39], v[120:123]
  v_mfma_f32_16x16x32_bf16 v[124:127], a[156:159], v[44:47], v[124:127]
  v_mfma_f32_16x16x32_bf16 v[128:131], a[160:163], v[20:23], v[128:131]
  v_mfma_f32_16x16x32_bf16 v[132:135], a[160:163], v[28:31], v[132:135]
  v_mfma_f32_16x16x32_bf16 v[136:139], a[160:163], v[36:39], v[136:139]
  v_mfma_f32_16x16x32_bf16 v[140:143], a[160:163], v[44:47], v[140:143]
  v_mfma_f32_16x16x32_bf16 v[144:147], a[164:167], v[20:23], v[144:147]
  v_mfma_f32_16x16x32_bf16 v[148:151], a[164:167], v[28:31], v[148:151]
  v_mfma_f32_16x16x32_bf16 v[152:155], a[164:167], v[36:39], v[152:155]
  v_mfma_f32_16x16x32_bf16 v[156:159], a[164:167], v[44:47], v[156:159]
  v_mfma_f32_16x16x32_bf16 v[160:163], a[168:171], v[20:23], v[160:163]
  v_mfma_f32_16x16x32_bf16 v[164:167], a[168:171], v[28:31], v[164:167]
  v_mfma_f32_16x16x32_bf16 v[168:171], a[168:171], v[36:39], v[168:171]
  v_mfma_f32_16x16x32_bf16 v[172:175], a[168:171], v[44:47], v[172:175]
  v_mfma_f32_16x16x32_bf16 v[176:179], a[172:175], v[20:23], v[176:179]
  v_mfma_f32_16x16x32_bf16 v[180:183], a[172:175], v[28:31], v[180:183]
  v_mfma_f32_16x16x32_bf16 v[184:187], a[172:175], v[36:39], v[184:187]
  v_mfma_f32_16x16x32_bf16 v[188:191], a[172:175], v[44:47], v[188:191]
  v_mfma_f32_16x16x32_bf16 v[192:195], a[176:179], v[20:23], v[192:195]
  v_mfma_f32_16x16x32_bf16 v[196:199], a[176:179], v[28:31], v[196:199]
  v_mfma_f32_16x16x32_bf16 v[200:203], a[176:179], v[36:39], v[200:203]
  v_mfma_f32_16x16x32_bf16 v[204:207], a[176:179], v[44:47], v[204:207]
  v_mfma_f32_16x16x32_bf16 v[208:211], a[180:183], v[20:23], v[208:211]
  v_mfma_f32_16x16x32_bf16 v[212:215], a[180:183], v[28:31], v[212:215]
  v_mfma_f32_16x16x32_bf16 v[216:219], a[180:183], v[36:39], v[216:219]
  v_mfma_f32_16x16x32_bf16 v[220:223], a[180:183], v[44:47], v[220:223]
  v_mfma_f32_16x16x32_bf16 v[224:227], a[184:187], v[20:23], v[224:227]
  v_mfma_f32_16x16x32_bf16 v[228:231], a[184:187], v[28:31], v[228:231]
  v_mfma_f32_16x16x32_bf16 v[232:235], a[184:187], v[36:39], v[232:235]
  v_mfma_f32_16x16x32_bf16 v[236:239], a[184:187], v[44:47], v[236:239]
  v_mfma_f32_16x16x32_bf16 v[240:243], a[188:191], v[20:23], v[240:243]
  v_mfma_f32_16x16x32_bf16 v[244:247], a[188:191], v[28:31], v[244:247]
  v_mfma_f32_16x16x32_bf16 v[248:251], a[188:191], v[36:39], v[248:251]
  v_mfma_f32_16x16x32_bf16 v[252:255], a[188:191], v[44:47], v[252:255]
  s_add_u32 s41, s41, 12288
  s_add_u32 s42, s42, 1
  s_cmp_lt_u32 s42, 16
  s_nop 7
  s_cbranch_scc1 L_fb_p2
  v_mov_b32_e32 v6, v14
  s_nop 1
  v_permlane16_swap_b32_e32 v14, v6
  v_add_f32_e32 v14, v14, v6
  v_mov_b32_e32 v6, v14
  s_nop 1
  v_permlane32_swap_b32_e32 v14, v6
  v_add_f32_e32 v14, v14, v6
  v_rcp_f32_e32 v14, v14
  s_add_u32 s3, s43, 0
  v_mul_f32_e32 v64, v14, v64
  v_mul_f32_e32 v65, v14, v65
  v_mul_f32_e32 v66, v14, v66
  v_mul_f32_e32 v67, v14, v67
  v_cvt_pk_bf16_f32 v64, v64, v65
  v_cvt_pk_bf16_f32 v65, v66, v67
  buffer_store_dwordx2 v[64:65], v5, s[20:23], s3 offen offset:0
  v_mul_f32_e32 v80, v14, v80
  v_mul_f32_e32 v81, v14, v81
  v_mul_f32_e32 v82, v14, v82
  v_mul_f32_e32 v83, v14, v83
  v_cvt_pk_bf16_f32 v80, v80, v81
  v_cvt_pk_bf16_f32 v81, v82, v83
  buffer_store_dwordx2 v[80:81], v5, s[20:23], s3 offen offset:32
  v_mul_f32_e32 v96, v14, v96
  v_mul_f32_e32 v97, v14, v97
  v_mul_f32_e32 v98, v14, v98
  v_mul_f32_e32 v99, v14, v99
  v_cvt_pk_bf16_f32 v96, v96, v97
  v_cvt_pk_bf16_f32 v97, v98, v99
  buffer_store_dwordx2 v[96:97], v5, s[20:23], s3 offen offset:64
  v_mul_f32_e32 v112, v14, v112
  v_mul_f32_e32 v113, v14, v113
  v_mul_f32_e32 v114, v14, v114
  v_mul_f32_e32 v115, v14, v115
  v_cvt_pk_bf16_f32 v112, v112, v113
  v_cvt_pk_bf16_f32 v113, v114, v115
  buffer_store_dwordx2 v[112:113], v5, s[20:23], s3 offen offset:96
  v_mul_f32_e32 v128, v14, v128
  v_mul_f32_e32 v129, v14, v129
  v_mul_f32_e32 v130, v14, v130
  v_mul_f32_e32 v131, v14, v131
  v_cvt_pk_bf16_f32 v128, v128, v129
  v_cvt_pk_bf16_f32 v129, v130, v131
  buffer_store_dwordx2 v[128:129], v5, s[20:23], s3 offen offset:128
  v_mul_f32_e32 v144, v14, v144
  v_mul_f32_e32 v145, v14, v145
  v_mul_f32_e32 v146, v14, v146
  v_mul_f32_e32 v147, v14, v147
  v_cvt_pk_bf16_f32 v144, v144, v145
  v_cvt_pk_bf16_f32 v145, v146, v147
  buffer_store_dwordx2 v[144:145], v5, s[20:23], s3 offen offset:160
  v_mul_f32_e32 v160, v14, v160
  v_mul_f32_e32 v161, v14, v161
  v_mul_f32_e32 v162, v14, v162
  v_mul_f32_e32 v163, v14, v163
  v_cvt_pk_bf16_f32 v160, v160, v161
  v_cvt_pk_bf16_f32 v161, v162, v163
  buffer_store_dwordx2 v[160:161], v5, s[20:23], s3 offen offset:192
  v_mul_f32_e32 v176, v14, v176
  v_mul_f32_e32 v177, v14, v177
  v_mul_f32_e32 v178, v14, v178
  v_mul_f32_e32 v179, v14, v179
  v_cvt_pk_bf16_f32 v176, v176, v177
  v_cvt_pk_bf16_f32 v177, v178, v179
  buffer_store_dwordx2 v[176:177], v5, s[20:23], s3 offen offset:224
  v_mul_f32_e32 v192, v14, v192
  v_mul_f32_e32 v193, v14, v193
  v_mul_f32_e32 v194, v14, v194
  v_mul_f32_e32 v195, v14, v195
  v_cvt_pk_bf16_f32 v192, v192, v193
  v_cvt_pk_bf16_f32 v193, v194, v195
  buffer_store_dwordx2 v[192:193], v5, s[20:23], s3 offen offset:256
  v_mul_f32_e32 v208, v14, v208
  v_mul_f32_e32 v209, v14, v209
  v_mul_f32_e32 v210, v14, v210
  v_mul_f32_e32 v211, v14, v211
  v_cvt_pk_bf16_f32 v208, v208, v209
  v_cvt_pk_bf16_f32 v209, v210, v211
  buffer_store_dwordx2 v[208:209], v5, s[20:23], s3 offen offset:288
  v_mul_f32_e32 v224, v14, v224
  v_mul_f32_e32 v225, v14, v225
  v_mul_f32_e32 v226, v14, v226
  v_mul_f32_e32 v227, v14, v227
  v_cvt_pk_bf16_f32 v224, v224, v225
  v_cvt_pk_bf16_f32 v225, v226, v227
  buffer_store_dwordx2 v[224:225], v5, s[20:23], s3 offen offset:320
  v_mul_f32_e32 v240, v14, v240
  v_mul_f32_e32 v241, v14, v241
  v_mul_f32_e32 v242, v14, v242
  v_mul_f32_e32 v243, v14, v243
  v_cvt_pk_bf16_f32 v240, v240, v241
  v_cvt_pk_bf16_f32 v241, v242, v243
  buffer_store_dwordx2 v[240:241], v5, s[20:23], s3 offen offset:352
  v_mov_b32_e32 v6, v15
  s_nop 1
  v_permlane16_swap_b32_e32 v15, v6
  v_add_f32_e32 v15, v15, v6
  v_mov_b32_e32 v6, v15
  s_nop 1
  v_permlane32_swap_b32_e32 v15, v6
  v_add_f32_e32 v15, v15, v6
  v_rcp_f32_e32 v15, v15
  s_add_u32 s3, s43, 6144
  v_mul_f32_e32 v68, v15, v68
  v_mul_f32_e32 v69, v15, v69
  v_mul_f32_e32 v70, v15, v70
  v_mul_f32_e32 v71, v15, v71
  v_cvt_pk_bf16_f32 v68, v68, v69
  v_cvt_pk_bf16_f32 v69, v70, v71
  buffer_store_dwordx2 v[68:69], v5, s[20:23], s3 offen offset:0
  v_mul_f32_e32 v84, v15, v84
  v_mul_f32_e32 v85, v15, v85
  v_mul_f32_e32 v86, v15, v86
  v_mul_f32_e32 v87, v15, v87
  v_cvt_pk_bf16_f32 v84, v84, v85
  v_cvt_pk_bf16_f32 v85, v86, v87
  buffer_store_dwordx2 v[84:85], v5, s[20:23], s3 offen offset:32
  v_mul_f32_e32 v100, v15, v100
  v_mul_f32_e32 v101, v15, v101
  v_mul_f32_e32 v102, v15, v102
  v_mul_f32_e32 v103, v15, v103
  v_cvt_pk_bf16_f32 v100, v100, v101
  v_cvt_pk_bf16_f32 v101, v102, v103
  buffer_store_dwordx2 v[100:101], v5, s[20:23], s3 offen offset:64
  v_mul_f32_e32 v116, v15, v116
  v_mul_f32_e32 v117, v15, v117
  v_mul_f32_e32 v118, v15, v118
  v_mul_f32_e32 v119, v15, v119
  v_cvt_pk_bf16_f32 v116, v116, v117
  v_cvt_pk_bf16_f32 v117, v118, v119
  buffer_store_dwordx2 v[116:117], v5, s[20:23], s3 offen offset:96
  v_mul_f32_e32 v132, v15, v132
  v_mul_f32_e32 v133, v15, v133
  v_mul_f32_e32 v134, v15, v134
  v_mul_f32_e32 v135, v15, v135
  v_cvt_pk_bf16_f32 v132, v132, v133
  v_cvt_pk_bf16_f32 v133, v134, v135
  buffer_store_dwordx2 v[132:133], v5, s[20:23], s3 offen offset:128
  v_mul_f32_e32 v148, v15, v148
  v_mul_f32_e32 v149, v15, v149
  v_mul_f32_e32 v150, v15, v150
  v_mul_f32_e32 v151, v15, v151
  v_cvt_pk_bf16_f32 v148, v148, v149
  v_cvt_pk_bf16_f32 v149, v150, v151
  buffer_store_dwordx2 v[148:149], v5, s[20:23], s3 offen offset:160
  v_mul_f32_e32 v164, v15, v164
  v_mul_f32_e32 v165, v15, v165
  v_mul_f32_e32 v166, v15, v166
  v_mul_f32_e32 v167, v15, v167
  v_cvt_pk_bf16_f32 v164, v164, v165
  v_cvt_pk_bf16_f32 v165, v166, v167
  buffer_store_dwordx2 v[164:165], v5, s[20:23], s3 offen offset:192
  v_mul_f32_e32 v180, v15, v180
  v_mul_f32_e32 v181, v15, v181
  v_mul_f32_e32 v182, v15, v182
  v_mul_f32_e32 v183, v15, v183
  v_cvt_pk_bf16_f32 v180, v180, v181
  v_cvt_pk_bf16_f32 v181, v182, v183
  buffer_store_dwordx2 v[180:181], v5, s[20:23], s3 offen offset:224
  v_mul_f32_e32 v196, v15, v196
  v_mul_f32_e32 v197, v15, v197
  v_mul_f32_e32 v198, v15, v198
  v_mul_f32_e32 v199, v15, v199
  v_cvt_pk_bf16_f32 v196, v196, v197
  v_cvt_pk_bf16_f32 v197, v198, v199
  buffer_store_dwordx2 v[196:197], v5, s[20:23], s3 offen offset:256
  v_mul_f32_e32 v212, v15, v212
  v_mul_f32_e32 v213, v15, v213
  v_mul_f32_e32 v214, v15, v214
  v_mul_f32_e32 v215, v15, v215
  v_cvt_pk_bf16_f32 v212, v212, v213
  v_cvt_pk_bf16_f32 v213, v214, v215
  buffer_store_dwordx2 v[212:213], v5, s[20:23], s3 offen offset:288
  v_mul_f32_e32 v228, v15, v228
  v_mul_f32_e32 v229, v15, v229
  v_mul_f32_e32 v230, v15, v230
  v_mul_f32_e32 v231, v15, v231
  v_cvt_pk_bf16_f32 v228, v228, v229
  v_cvt_pk_bf16_f32 v229, v230, v231
  buffer_store_dwordx2 v[228:229], v5, s[20:23], s3 offen offset:320
  v_mul_f32_e32 v244, v15, v244
  v_mul_f32_e32 v245, v15, v245
  v_mul_f32_e32 v246, v15, v246
  v_mul_f32_e32 v247, v15, v247
  v_cvt_pk_bf16_f32 v244, v244, v245
  v_cvt_pk_bf16_f32 v245, v246, v247
  buffer_store_dwordx2 v[244:245], v5, s[20:23], s3 offen offset:352
  v_mov_b32_e32 v6, v16
  s_nop 1
  v_permlane16_swap_b32_e32 v16, v6
  v_add_f32_e32 v16, v16, v6
  v_mov_b32_e32 v6, v16
  s_nop 1
  v_permlane32_swap_b32_e32 v16, v6
  v_add_f32_e32 v16, v16, v6
  v_rcp_f32_e32 v16, v16
  s_add_u32 s3, s43, 12288
  v_mul_f32_e32 v72, v16, v72
  v_mul_f32_e32 v73, v16, v73
  v_mul_f32_e32 v74, v16, v74
  v_mul_f32_e32 v75, v16, v75
  v_cvt_pk_bf16_f32 v72, v72, v73
  v_cvt_pk_bf16_f32 v73, v74, v75
  buffer_store_dwordx2 v[72:73], v5, s[20:23], s3 offen offset:0
  v_mul_f32_e32 v88, v16, v88
  v_mul_f32_e32 v89, v16, v89
  v_mul_f32_e32 v90, v16, v90
  v_mul_f32_e32 v91, v16, v91
  v_cvt_pk_bf16_f32 v88, v88, v89
  v_cvt_pk_bf16_f32 v89, v90, v91
  buffer_store_dwordx2 v[88:89], v5, s[20:23], s3 offen offset:32
  v_mul_f32_e32 v104, v16, v104
  v_mul_f32_e32 v105, v16, v105
  v_mul_f32_e32 v106, v16, v106
  v_mul_f32_e32 v107, v16, v107
  v_cvt_pk_bf16_f32 v104, v104, v105
  v_cvt_pk_bf16_f32 v105, v106, v107
  buffer_store_dwordx2 v[104:105], v5, s[20:23], s3 offen offset:64
  v_mul_f32_e32 v120, v16, v120
  v_mul_f32_e32 v121, v16, v121
  v_mul_f32_e32 v122, v16, v122
  v_mul_f32_e32 v123, v16, v123
  v_cvt_pk_bf16_f32 v120, v120, v121
  v_cvt_pk_bf16_f32 v121, v122, v123
  buffer_store_dwordx2 v[120:121], v5, s[20:23], s3 offen offset:96
  v_mul_f32_e32 v136, v16, v136
  v_mul_f32_e32 v137, v16, v137
  v_mul_f32_e32 v138, v16, v138
  v_mul_f32_e32 v139, v16, v139
  v_cvt_pk_bf16_f32 v136, v136, v137
  v_cvt_pk_bf16_f32 v137, v138, v139
  buffer_store_dwordx2 v[136:137], v5, s[20:23], s3 offen offset:128
  v_mul_f32_e32 v152, v16, v152
  v_mul_f32_e32 v153, v16, v153
  v_mul_f32_e32 v154, v16, v154
  v_mul_f32_e32 v155, v16, v155
  v_cvt_pk_bf16_f32 v152, v152, v153
  v_cvt_pk_bf16_f32 v153, v154, v155
  buffer_store_dwordx2 v[152:153], v5, s[20:23], s3 offen offset:160
  v_mul_f32_e32 v168, v16, v168
  v_mul_f32_e32 v169, v16, v169
  v_mul_f32_e32 v170, v16, v170
  v_mul_f32_e32 v171, v16, v171
  v_cvt_pk_bf16_f32 v168, v168, v169
  v_cvt_pk_bf16_f32 v169, v170, v171
  buffer_store_dwordx2 v[168:169], v5, s[20:23], s3 offen offset:192
  v_mul_f32_e32 v184, v16, v184
  v_mul_f32_e32 v185, v16, v185
  v_mul_f32_e32 v186, v16, v186
  v_mul_f32_e32 v187, v16, v187
  v_cvt_pk_bf16_f32 v184, v184, v185
  v_cvt_pk_bf16_f32 v185, v186, v187
  buffer_store_dwordx2 v[184:185], v5, s[20:23], s3 offen offset:224
  v_mul_f32_e32 v200, v16, v200
  v_mul_f32_e32 v201, v16, v201
  v_mul_f32_e32 v202, v16, v202
  v_mul_f32_e32 v203, v16, v203
  v_cvt_pk_bf16_f32 v200, v200, v201
  v_cvt_pk_bf16_f32 v201, v202, v203
  buffer_store_dwordx2 v[200:201], v5, s[20:23], s3 offen offset:256
  v_mul_f32_e32 v216, v16, v216
  v_mul_f32_e32 v217, v16, v217
  v_mul_f32_e32 v218, v16, v218
  v_mul_f32_e32 v219, v16, v219
  v_cvt_pk_bf16_f32 v216, v216, v217
  v_cvt_pk_bf16_f32 v217, v218, v219
  buffer_store_dwordx2 v[216:217], v5, s[20:23], s3 offen offset:288
  v_mul_f32_e32 v232, v16, v232
  v_mul_f32_e32 v233, v16, v233
  v_mul_f32_e32 v234, v16, v234
  v_mul_f32_e32 v235, v16, v235
  v_cvt_pk_bf16_f32 v232, v232, v233
  v_cvt_pk_bf16_f32 v233, v234, v235
  buffer_store_dwordx2 v[232:233], v5, s[20:23], s3 offen offset:320
  v_mul_f32_e32 v248, v16, v248
  v_mul_f32_e32 v249, v16, v249
  v_mul_f32_e32 v250, v16, v250
  v_mul_f32_e32 v251, v16, v251
  v_cvt_pk_bf16_f32 v248, v248, v249
  v_cvt_pk_bf16_f32 v249, v250, v251
  buffer_store_dwordx2 v[248:249], v5, s[20:23], s3 offen offset:352
  v_mov_b32_e32 v6, v17
  s_nop 1
  v_permlane16_swap_b32_e32 v17, v6
  v_add_f32_e32 v17, v17, v6
  v_mov_b32_e32 v6, v17
  s_nop 1
  v_permlane32_swap_b32_e32 v17, v6
  v_add_f32_e32 v17, v17, v6
  v_rcp_f32_e32 v17, v17
  s_add_u32 s3, s43, 18432
  v_mul_f32_e32 v76, v17, v76
  v_mul_f32_e32 v77, v17, v77
  v_mul_f32_e32 v78, v17, v78
  v_mul_f32_e32 v79, v17, v79
  v_cvt_pk_bf16_f32 v76, v76, v77
  v_cvt_pk_bf16_f32 v77, v78, v79
  buffer_store_dwordx2 v[76:77], v5, s[20:23], s3 offen offset:0
  v_mul_f32_e32 v92, v17, v92
  v_mul_f32_e32 v93, v17, v93
  v_mul_f32_e32 v94, v17, v94
  v_mul_f32_e32 v95, v17, v95
  v_cvt_pk_bf16_f32 v92, v92, v93
  v_cvt_pk_bf16_f32 v93, v94, v95
  buffer_store_dwordx2 v[92:93], v5, s[20:23], s3 offen offset:32
  v_mul_f32_e32 v108, v17, v108
  v_mul_f32_e32 v109, v17, v109
  v_mul_f32_e32 v110, v17, v110
  v_mul_f32_e32 v111, v17, v111
  v_cvt_pk_bf16_f32 v108, v108, v109
  v_cvt_pk_bf16_f32 v109, v110, v111
  buffer_store_dwordx2 v[108:109], v5, s[20:23], s3 offen offset:64
  v_mul_f32_e32 v124, v17, v124
  v_mul_f32_e32 v125, v17, v125
  v_mul_f32_e32 v126, v17, v126
  v_mul_f32_e32 v127, v17, v127
  v_cvt_pk_bf16_f32 v124, v124, v125
  v_cvt_pk_bf16_f32 v125, v126, v127
  buffer_store_dwordx2 v[124:125], v5, s[20:23], s3 offen offset:96
  v_mul_f32_e32 v140, v17, v140
  v_mul_f32_e32 v141, v17, v141
  v_mul_f32_e32 v142, v17, v142
  v_mul_f32_e32 v143, v17, v143
  v_cvt_pk_bf16_f32 v140, v140, v141
  v_cvt_pk_bf16_f32 v141, v142, v143
  buffer_store_dwordx2 v[140:141], v5, s[20:23], s3 offen offset:128
  v_mul_f32_e32 v156, v17, v156
  v_mul_f32_e32 v157, v17, v157
  v_mul_f32_e32 v158, v17, v158
  v_mul_f32_e32 v159, v17, v159
  v_cvt_pk_bf16_f32 v156, v156, v157
  v_cvt_pk_bf16_f32 v157, v158, v159
  buffer_store_dwordx2 v[156:157], v5, s[20:23], s3 offen offset:160
  v_mul_f32_e32 v172, v17, v172
  v_mul_f32_e32 v173, v17, v173
  v_mul_f32_e32 v174, v17, v174
  v_mul_f32_e32 v175, v17, v175
  v_cvt_pk_bf16_f32 v172, v172, v173
  v_cvt_pk_bf16_f32 v173, v174, v175
  buffer_store_dwordx2 v[172:173], v5, s[20:23], s3 offen offset:192
  v_mul_f32_e32 v188, v17, v188
  v_mul_f32_e32 v189, v17, v189
  v_mul_f32_e32 v190, v17, v190
  v_mul_f32_e32 v191, v17, v191
  v_cvt_pk_bf16_f32 v188, v188, v189
  v_cvt_pk_bf16_f32 v189, v190, v191
  buffer_store_dwordx2 v[188:189], v5, s[20:23], s3 offen offset:224
  v_mul_f32_e32 v204, v17, v204
  v_mul_f32_e32 v205, v17, v205
  v_mul_f32_e32 v206, v17, v206
  v_mul_f32_e32 v207, v17, v207
  v_cvt_pk_bf16_f32 v204, v204, v205
  v_cvt_pk_bf16_f32 v205, v206, v207
  buffer_store_dwordx2 v[204:205], v5, s[20:23], s3 offen offset:256
  v_mul_f32_e32 v220, v17, v220
  v_mul_f32_e32 v221, v17, v221
  v_mul_f32_e32 v222, v17, v222
  v_mul_f32_e32 v223, v17, v223
  v_cvt_pk_bf16_f32 v220, v220, v221
  v_cvt_pk_bf16_f32 v221, v222, v223
  buffer_store_dwordx2 v[220:221], v5, s[20:23], s3 offen offset:288
  v_mul_f32_e32 v236, v17, v236
  v_mul_f32_e32 v237, v17, v237
  v_mul_f32_e32 v238, v17, v238
  v_mul_f32_e32 v239, v17, v239
  v_cvt_pk_bf16_f32 v236, v236, v237
  v_cvt_pk_bf16_f32 v237, v238, v239
  buffer_store_dwordx2 v[236:237], v5, s[20:23], s3 offen offset:320
  v_mul_f32_e32 v252, v17, v252
  v_mul_f32_e32 v253, v17, v253
  v_mul_f32_e32 v254, v17, v254
  v_mul_f32_e32 v255, v17, v255
  v_cvt_pk_bf16_f32 v252, v252, v253
  v_cvt_pk_bf16_f32 v253, v254, v255
  buffer_store_dwordx2 v[252:253], v5, s[20:23], s3 offen offset:352
  s_waitcnt vmcnt(0)
L_fb_next:
  s_mov_b64 s[34:35], s[36:37]
  s_add_u32 s40, s40, 196608
  s_cmp_lt_u32 s40, 393216
  s_cbranch_scc1 L_fb_blk
  s_endpgm
.section .rodata,"a"
.p2align 6
.amdhsa_kernel standalone__mha_softmax__near_ridge_kernel
  .amdhsa_next_free_vgpr 512
  .amdhsa_next_free_sgpr 102
  .amdhsa_accum_offset 256
  .amdhsa_group_segment_fixed_size 0
  .amdhsa_kernarg_size 48
  .amdhsa_user_sgpr_count 2
  .amdhsa_user_sgpr_kernarg_segment_ptr 1
  .amdhsa_system_sgpr_workgroup_id_x 1
.end_amdhsa_kernel
```
